```python
import torch

def _softmax(x, axis=-1):
    return torch.softmax(x, dim=axis)
def _gelu(x):
    return torch.nn.functional.gelu(x, approximate="tanh")
def _silu(x):
    return torch.nn.functional.silu(x)
def _sigmoid(x):
    return torch.sigmoid(x)
def _layernorm(x, axis=-1, eps=1e-5):
    m = x.mean(dim=axis, keepdim=True)
    v = x.var(dim=axis, keepdim=True, unbiased=False)
    return (x - m) / torch.sqrt(v + eps)
def _scatter_add(tgt, idx, src, axis=0):
    return tgt.clone().index_add_(axis, idx, src)
def _segment_sum(src, seg, n):
    out = torch.zeros((n,) + src.shape[1:], dtype=src.dtype)
    return out.index_add_(0, seg, src)
def _pad(x, pw):
    flat = tuple(v for pair in reversed(pw) for v in pair)
    return torch.nn.functional.pad(x, flat)

kernel_name = 'concat_heads__gqa_block_cached__mha_block_cached__near_ridge'

def setup_inputs():

    _w = (lambda a: (lambda t: t.to(torch.bfloat16) if t.is_floating_point() else t)(torch.as_tensor(a)))
    def _A_setup():
        B, Sq, D = 8, 288, 640
        Hq, Hkv, Sk, Dh = 32, 32, 1024, 128
        assert Hq % Hkv == 0, (Hq, Hkv)
        return {
            "x": _w((lambda *s: torch.randn(*s, dtype=torch.bfloat16) * 0.8)(B, Sq, D)),
            "k_cache": _w((lambda *s: torch.randn(*s, dtype=torch.bfloat16) * 0.8)(B, Hkv, Sk, Dh)),
            "v_cache": _w((lambda *s: torch.randn(*s, dtype=torch.bfloat16) * 0.05)(B, Hkv, Sk, Dh)),
            "wq": _w((lambda *s: torch.randn(*s, dtype=torch.bfloat16) * 0.8)(D, Hq * Dh) * (D ** -0.5)),
            "wo": _w((lambda *s: torch.randn(*s, dtype=torch.bfloat16) * 0.05)(Hq * Dh, D) * ((Hq * Dh) ** -0.5)),
        }
    _A_in = _A_setup()

    def _B_setup():
        B, Sq, D = 8, 288, 640
        H, Sk, Dh = 32, 1024, 128
        return {
            "x": _w((lambda *s: torch.randn(*s, dtype=torch.bfloat16) * 0.8)(B, Sq, D)),
            "k_cache": _w((lambda *s: torch.randn(*s, dtype=torch.bfloat16) * 0.8)(B, H, Sk, Dh)),
            "v_cache": _w((lambda *s: torch.randn(*s, dtype=torch.bfloat16) * 0.05)(B, H, Sk, Dh)),
            "wq": _w((lambda *s: torch.randn(*s, dtype=torch.bfloat16) * 0.8)(D, H * Dh) * (D ** -0.5)),
            "wo": _w((lambda *s: torch.randn(*s, dtype=torch.bfloat16) * 0.05)(H * Dh, D) * ((H * Dh) ** -0.5)),
        }
    _B_in = _B_setup()

    return {
        "A_x": _A_in["x"],
        "A_k_cache": _A_in["k_cache"],
        "A_v_cache": _A_in["v_cache"],
        "A_wq": _A_in["wq"],
        "A_wo": _A_in["wo"],
        "B_x": _B_in["x"],
        "B_k_cache": _B_in["k_cache"],
        "B_v_cache": _B_in["v_cache"],
        "B_wq": _B_in["wq"],
        "B_wo": _B_in["wo"],
    }

def reference(A_x, A_k_cache, A_v_cache, A_wq, A_wo, B_x, B_k_cache, B_v_cache, B_wq, B_wo):
    def _A_ref(x, k_cache, v_cache, wq, wo):
        B, Sq, D = x.shape
        Hq, Dh = 32, 128
        Hkv = k_cache.shape[1]
        rep = Hq // Hkv
        q = (lambda x, *d: x.permute(*d))((x @ wq).reshape(B, Sq, Hq, Dh), 0, 2, 1, 3)
        k = (lambda x, n, axis: torch.repeat_interleave(x, n, dim=axis))(k_cache, rep, axis=1)
        v = (lambda x, n, axis: torch.repeat_interleave(x, n, dim=axis))(v_cache, rep, axis=1)
        scores = torch.einsum("bhqd,bhkd->bhqk", q, k) * (Dh ** -0.5)
        p = _softmax(scores, axis=-1)
        o = torch.einsum("bhqk,bhkd->bhqd", p, v)
        return (lambda x, *d: x.permute(*d))(o, 0, 2, 1, 3).reshape(B, Sq, Hq * Dh) @ wo

    def _B_ref(x, k_cache, v_cache, wq, wo):
        B, Sq, D = x.shape
        H, Dh = 32, 128
        q = (lambda x, *d: x.permute(*d))((x @ wq).reshape(B, Sq, H, Dh), 0, 2, 1, 3)
        scores = torch.einsum("bhqd,bhkd->bhqk", q, k_cache) * (Dh ** -0.5)
        p = _softmax(scores, axis=-1)
        o = torch.einsum("bhqk,bhkd->bhqd", p, v_cache)
        return (lambda x, *d: x.permute(*d))(o, 0, 2, 1, 3).reshape(B, Sq, H * Dh) @ wo

    a = _A_ref(A_x, A_k_cache, A_v_cache, A_wq, A_wo)
    b = _B_ref(B_x, B_k_cache, B_v_cache, B_wq, B_wo)
    return torch.concatenate([a, b], axis=-1)
```

```asm
; @launch kernel=attn_kernel grid=(256,1,1) block=(256,1,1) lds=163840
; @launch kernel=oproj_kernel grid=(256,1,1) block=(256,1,1) lds=147456
.amdgcn_target "amdgcn-amd-amdhsa--gfx950"
.text
.globl attn_kernel
.p2align 8
.type attn_kernel,@function
attn_kernel:
    s_cmp_ge_u32 s2, 256
    s_cbranch_scc1 K1_END
    s_load_dwordx2 s[6:7], s[0:1], 96
    s_add_u32 s42, s2, 0
    s_and_b32 s42, s42, 7
    s_lshr_b32 s43, s2, 3
    s_lshr_b32 s34, s42, 2
    s_mul_i32 s46, s34, 40
    s_add_u32 s64, s0, s46
    s_addc_u32 s65, s1, 0
    s_load_dwordx4 s[72:75], s[64:65], 0
    s_load_dwordx4 s[76:79], s[64:65], 16
    s_load_dwordx2 s[80:81], s[64:65], 32
    v_lshrrev_b32 v2, 6, v0
    s_nop 0
    v_readfirstlane_b32 s3, v2
    s_and_b32 s32, s42, 1
    s_lshl_b32 s32, s32, 2
    s_and_b32 s46, s43, 3
    s_add_u32 s32, s32, s46
    s_bfe_u32 s33, s42, 65537
    s_lshl_b32 s33, s33, 3
    s_lshr_b32 s46, s43, 2
    s_add_u32 s33, s33, s46
    s_lshl_b32 s33, s33, 1
    s_mov_b32 s4, 0
    s_mov_b32 s35, 1199570944
    s_mov_b32 s44, 1040356334
    s_mov_b32 s45, 1040356334
    s_waitcnt lgkmcnt(0)
    s_mov_b32 s24, s6
    s_mov_b32 s25, s7
    s_mov_b32 s26, 67108864
    s_mov_b32 s27, 131072
    s_mul_i32 s42, s32, 368640
    s_add_u32 s8, s72, s42
    s_addc_u32 s9, s73, 0
    s_mov_b32 s10, 368640
    s_mov_b32 s11, 131072
    s_lshl_b32 s42, s33, 8
    s_add_u32 s12, s78, s42
    s_addc_u32 s13, s79, 0
    s_sub_u32 s14, 5242880, s42
    s_mov_b32 s15, 131072
    s_lshl_b32 s42, s32, 5
    s_add_u32 s42, s42, s33
    s_lshl_b32 s42, s42, 18
    s_add_u32 s16, s74, s42
    s_addc_u32 s17, s75, 0
    s_mov_b32 s18, 524288
    s_mov_b32 s19, 131072
    s_add_u32 s20, s76, s42
    s_addc_u32 s21, s77, 0
    s_mov_b32 s22, 524288
    s_mov_b32 s23, 131072
    s_mov_b32 s28, s80
    s_mov_b32 s29, s81
    s_mov_b32 s30, 5242880
    s_mov_b32 s31, 131072
    s_mov_b32 s56, s72
    s_mov_b32 s57, s73
    s_mov_b32 s58, 2949120
    s_mov_b32 s59, 131072
    s_mov_b32 s60, s78
    s_mov_b32 s61, s79
    s_mov_b32 s62, 5242880
    s_mov_b32 s63, 131072
    s_lshl_b32 s42, s34, 7
    s_lshl_b32 s43, s33, 2
    s_add_u32 s42, s42, s43
    s_mul_i32 s42, s42, 144
    s_mul_i32 s43, s32, 18
    s_add_u32 s42, s42, s43
    s_lshl_b32 s53, s42, 10
    v_and_b32 v1, 63, v0
    v_lshlrev_b32 v245, 4, v1
    s_lshl_b32 s82, s3, 12
    s_mul_i32 s83, s3, 40960
    s_lshl_b32 s84, s3, 17
    s_lshl_b32 s85, s3, 10
    s_add_u32 s86, s82, 16384
    v_lshrrev_b32 v5, 4, v1
    v_and_b32 v4, 15, v1
    v_lshrrev_b32 v7, 3, v1
    v_mul_u32_u24 v7, 1280, v7
    v_and_b32 v8, 7, v1
    v_add_u32 v9, 0, v5
    v_xor_b32 v9, v9, v8
    v_lshl_add_u32 v168, v9, 4, v7
    v_add_u32 v9, 4, v5
    v_xor_b32 v9, v9, v8
    v_lshl_add_u32 v169, v9, 4, v7
    v_add_u32 v170, 18432, v168
    v_add_u32 v171, 18432, v169
    v_add_u32 v171, 9216, v171
    s_and_b32 s42, s3, 1
    v_mov_b32 v10, s42
    v_cmp_ne_u32 vcc, 0, v10
    s_nop 1
    v_cndmask_b32 v212, v168, v169, vcc
    s_mul_i32 s42, s3, 10240
    v_add_u32 v212, s42, v212
    v_add_u32 v169, 9216, v169
    v_lshlrev_b32 v7, 13, v5
    v_lshlrev_b32 v8, 2, v5
    v_xor_b32 v8, v8, v4
    v_lshl_add_u32 v172, v8, 4, v7
    v_add_u32 v173, 31744, v172
    v_add_u32 v174, 63488, v172
    v_add_u32 v175, 95232, v172
    s_mov_b32 s48, 0
    s_mov_b32 s49, 0
    s_mov_b32 s50, 0
    s_mov_b32 s52, 4294897664
    s_add_u32 s46, s50, s82
    s_add_u32 s47, s48, s83
    s_add_u32 m0, s46, 0
    s_nop 0
    buffer_load_dwordx4 v168, s[8:11], s47 offen lds
    buffer_load_dwordx4 v169, s[8:11], s47 offen offset:1024 lds
    buffer_load_dwordx4 v170, s[8:11], s47 offen offset:2048 lds
    buffer_load_dwordx4 v171, s[8:11], s47 offen offset:3072 lds
    s_add_u32 m0, s46, 16384
    s_add_u32 s47, s47, 163840
    buffer_load_dwordx4 v168, s[8:11], s47 offen lds
    buffer_load_dwordx4 v169, s[8:11], s47 offen offset:1024 lds
    buffer_load_dwordx4 v170, s[8:11], s47 offen offset:2048 lds
    buffer_load_dwordx4 v171, s[8:11], s47 offen offset:3072 lds
    s_add_u32 s42, s50, s85
    s_add_u32 m0, s42, 32768
    s_add_u32 s42, s48, 327680
    buffer_load_dwordx4 v212, s[8:11], s42 offen lds
    s_add_u32 s47, s49, s84
    s_add_u32 m0, s46, 36864
    s_nop 0
    buffer_load_dwordx4 v172, s[12:15], s47 offen lds
    buffer_load_dwordx4 v173, s[12:15], s47 offen offset:1024 lds
    buffer_load_dwordx4 v174, s[12:15], s47 offen offset:2048 lds
    buffer_load_dwordx4 v175, s[12:15], s47 offen offset:3072 lds
    s_add_u32 m0, s46, 53248
    s_add_u32 s47, s47, 256
    buffer_load_dwordx4 v172, s[12:15], s47 offen lds
    buffer_load_dwordx4 v173, s[12:15], s47 offen offset:1024 lds
    buffer_load_dwordx4 v174, s[12:15], s47 offen offset:2048 lds
    buffer_load_dwordx4 v175, s[12:15], s47 offen offset:3072 lds
    s_add_u32 s48, s48, 128
    s_add_u32 s49, s49, 524288
    s_sub_u32 s50, 69632, s50
    s_add_u32 s46, s50, s82
    s_add_u32 s47, s48, s83
    s_add_u32 m0, s46, 0
    s_nop 0
    buffer_load_dwordx4 v168, s[8:11], s47 offen lds
    buffer_load_dwordx4 v169, s[8:11], s47 offen offset:1024 lds
    buffer_load_dwordx4 v170, s[8:11], s47 offen offset:2048 lds
    buffer_load_dwordx4 v171, s[8:11], s47 offen offset:3072 lds
    s_add_u32 m0, s46, 16384
    s_add_u32 s47, s47, 163840
    buffer_load_dwordx4 v168, s[8:11], s47 offen lds
    buffer_load_dwordx4 v169, s[8:11], s47 offen offset:1024 lds
    buffer_load_dwordx4 v170, s[8:11], s47 offen offset:2048 lds
    buffer_load_dwordx4 v171, s[8:11], s47 offen offset:3072 lds
    s_add_u32 s42, s50, s85
    s_add_u32 m0, s42, 32768
    s_add_u32 s42, s48, 327680
    buffer_load_dwordx4 v212, s[8:11], s42 offen lds
    s_add_u32 s47, s49, s84
    s_add_u32 m0, s46, 36864
    s_nop 0
    buffer_load_dwordx4 v172, s[12:15], s47 offen lds
    buffer_load_dwordx4 v173, s[12:15], s47 offen offset:1024 lds
    buffer_load_dwordx4 v174, s[12:15], s47 offen offset:2048 lds
    buffer_load_dwordx4 v175, s[12:15], s47 offen offset:3072 lds
    s_add_u32 m0, s46, 53248
    s_add_u32 s47, s47, 256
    buffer_load_dwordx4 v172, s[12:15], s47 offen lds
    buffer_load_dwordx4 v173, s[12:15], s47 offen offset:1024 lds
    buffer_load_dwordx4 v174, s[12:15], s47 offen offset:2048 lds
    buffer_load_dwordx4 v175, s[12:15], s47 offen offset:3072 lds
    s_add_u32 s48, s48, 128
    s_add_u32 s49, s49, 524288
    s_sub_u32 s50, 69632, s50
    s_getpc_b64 s[88:89]
K1_PCREF:
    s_lshr_b32 s43, s2, 3
    s_lshl_b32 s43, s43, 2
    s_add_u32 s43, s43, s3
    s_lshl_b32 s43, s43, 10
    s_min_u32 s43, s43, K1_END-K1_PCREF-1024
    v_and_b32 v2, 7, v1
    v_lshlrev_b32 v2, 7, v2
    v_add_u32 v2, s43, v2
    global_load_dword v206, v2, s[88:89]
    s_lshr_b32 s43, s2, 3
    s_and_b32 s46, s32, 4
    s_lshr_b32 s47, s33, 4
    s_lshl_b32 s47, s47, 3
    s_lshl_b32 s42, s43, 2
    s_add_u32 s42, s42, s3
    s_mul_i32 s42, s42, 25
    v_add_u32 v2, s42, v1
    s_mul_i32 s42, s46, 288
    v_add_u32 v3, s42, v2
    v_mul_u32_u24 v3, 1280, v3
    v_subrev_u32 v4, 1152, v2
    v_lshrrev_b32 v5, 5, v4
    v_lshlrev_b32 v5, 13, v5
    v_and_b32 v4, 31, v4
    v_lshl_add_u32 v5, v4, 7, v5
    s_lshl_b32 s42, s47, 9
    v_add_u32 v5, s42, v5
    v_mov_b32 v6, 2130706432
    v_cmp_gt_u32 vcc, 1152, v2
    s_nop 1
    v_cndmask_b32 v204, v6, v3, vcc
    v_cndmask_b32 v205, v5, v6, vcc
    v_cmp_gt_u32 vcc, 25, v1
    s_nop 1
    v_cndmask_b32 v204, v6, v204, vcc
    v_cndmask_b32 v205, v6, v205, vcc
    s_mov_b32 s55, 256
    s_mov_b32 s51, 1048576
    buffer_load_dword v206, v204, s[56:59], s55 offen
    buffer_load_dword v206, v205, s[60:63], s51 offen
    s_add_u32 s55, s55, 128
    s_add_u32 s51, s51, 524288
    v_and_b32 v2, 31, v1
    v_lshrrev_b32 v3, 5, v1
    v_bfe_u32 v6, v1, 1, 3
    v_lshlrev_b32 v7, 7, v2
    s_lshl_b32 s42, s3, 13
    v_add_u32 v8, 0, v3
    v_xor_b32 v8, v8, v6
    v_lshl_add_u32 v8, v8, 4, v7
    v_add_u32 v160, s42, v8
    v_add_u32 v208, 32768, v8
    v_add_u32 v8, 2, v3
    v_xor_b32 v8, v8, v6
    v_lshl_add_u32 v8, v8, 4, v7
    v_add_u32 v161, s42, v8
    v_add_u32 v209, 32768, v8
    v_add_u32 v8, 4, v3
    v_xor_b32 v8, v8, v6
    v_lshl_add_u32 v8, v8, 4, v7
    v_add_u32 v162, s42, v8
    v_add_u32 v210, 32768, v8
    v_add_u32 v8, 6, v3
    v_xor_b32 v8, v8, v6
    v_lshl_add_u32 v8, v8, 4, v7
    v_add_u32 v163, s42, v8
    v_add_u32 v211, 32768, v8
    v_bfe_u32 v7, v1, 2, 2
    v_bfe_u32 v8, v1, 4, 1
    v_and_b32 v9, 1, v1
    v_bfe_u32 v10, v1, 1, 1
    v_lshl_add_u32 v9, v9, 1, v10
    v_lshl_add_u32 v10, v3, 3, v7
    v_lshlrev_b32 v10, 8, v10
    v_lshl_add_u32 v10, v8, 5, v10
    v_lshl_add_u32 v10, v9, 3, v10
    v_add_u32 v10, 36864, v10
    s_add_u32 s42, s3, 0
    s_and_b32 s42, s42, 3
    v_xor_b32 v11, s42, v7
    v_lshl_add_u32 v164, v11, 6, v10
    s_add_u32 s42, s3, 1
    s_and_b32 s42, s42, 3
    v_xor_b32 v11, s42, v7
    v_lshl_add_u32 v165, v11, 6, v10
    s_add_u32 s42, s3, 2
    s_and_b32 s42, s42, 3
    v_xor_b32 v11, s42, v7
    v_lshl_add_u32 v166, v11, 6, v10
    s_add_u32 s42, s3, 3
    s_and_b32 s42, s42, 3
    v_xor_b32 v11, s42, v7
    v_lshl_add_u32 v167, v11, 6, v10
    s_mov_b32 s43, 6554
    v_add_u32 v2, 0, v1
    v_mul_lo_u32 v3, v2, s43
    v_lshrrev_b32 v3, 16, v3
    v_mul_u32_u24 v4, 10, v3
    v_sub_u32 v4, v2, v4
    v_mul_u32_u24 v3, 1280, v3
    v_lshl_add_u32 v176, v4, 4, v3
    v_add_u32 v2, 64, v1
    v_mul_lo_u32 v3, v2, s43
    v_lshrrev_b32 v3, 16, v3
    v_mul_u32_u24 v4, 10, v3
    v_sub_u32 v4, v2, v4
    v_mul_u32_u24 v3, 1280, v3
    v_lshl_add_u32 v177, v4, 4, v3
    v_add_u32 v2, 128, v1
    v_mul_lo_u32 v3, v2, s43
    v_lshrrev_b32 v3, 16, v3
    v_mul_u32_u24 v4, 10, v3
    v_sub_u32 v4, v2, v4
    v_mul_u32_u24 v3, 1280, v3
    v_lshl_add_u32 v178, v4, 4, v3
    v_add_u32 v2, 192, v1
    v_mul_lo_u32 v3, v2, s43
    v_lshrrev_b32 v3, 16, v3
    v_mul_u32_u24 v4, 10, v3
    v_sub_u32 v4, v2, v4
    v_mul_u32_u24 v3, 1280, v3
    v_lshl_add_u32 v179, v4, 4, v3
    v_add_u32 v2, 256, v1
    v_mul_lo_u32 v3, v2, s43
    v_lshrrev_b32 v3, 16, v3
    v_mul_u32_u24 v4, 10, v3
    v_sub_u32 v4, v2, v4
    v_mul_u32_u24 v3, 1280, v3
    v_lshl_add_u32 v180, v4, 4, v3
    v_lshrrev_b32 v2, 5, v1
    v_bfe_u32 v3, v1, 4, 1
    v_bfe_u32 v4, v1, 2, 2
    v_lshl_add_u32 v4, v3, 2, v4
    v_lshl_add_u32 v4, v2, 4, v4
    v_mul_u32_u24 v4, 160, v4
    v_and_b32 v3, 3, v1
    v_lshl_add_u32 v4, v3, 3, v4
    s_mul_i32 s87, s3, 5120
    s_add_u32 s87, s87, 139264
    v_add_u32 v181, s87, v4
    s_add_u32 s46, s33, 0
    s_mul_i32 s46, s46, 163840
    s_mul_i32 s47, s32, 160
    s_add_u32 s46, s46, s47
    s_add_u32 s46, s46, s83
    s_add_u32 m0, s87, 0
    s_nop 0
    buffer_load_dwordx4 v176, s[28:31], s46 offen nt lds
    s_add_u32 m0, s87, 1024
    s_nop 0
    buffer_load_dwordx4 v177, s[28:31], s46 offen nt lds
    s_add_u32 m0, s87, 2048
    s_nop 0
    buffer_load_dwordx4 v178, s[28:31], s46 offen nt lds
    s_add_u32 m0, s87, 3072
    s_nop 0
    buffer_load_dwordx4 v179, s[28:31], s46 offen nt lds
    s_add_u32 m0, s87, 4096
    s_nop 0
    buffer_load_dwordx4 v180, s[28:31], s46 offen nt lds
    v_and_b32 v2, 31, v1
    v_lshrrev_b32 v3, 5, v1
    v_and_b32 v4, 15, v1
    v_lshrrev_b32 v5, 4, v1
    v_lshlrev_b32 v6, 8, v2
    v_add_u32 v7, 0, v3
    v_xor_b32 v7, v7, v4
    v_lshl_add_u32 v220, v7, 4, v6
    v_add_u32 v7, 2, v3
    v_xor_b32 v7, v7, v4
    v_lshl_add_u32 v221, v7, 4, v6
    v_add_u32 v7, 4, v3
    v_xor_b32 v7, v7, v4
    v_lshl_add_u32 v222, v7, 4, v6
    v_add_u32 v7, 6, v3
    v_xor_b32 v7, v7, v4
    v_lshl_add_u32 v223, v7, 4, v6
    v_add_u32 v7, 8, v3
    v_xor_b32 v7, v7, v4
    v_lshl_add_u32 v224, v7, 4, v6
    v_add_u32 v7, 10, v3
    v_xor_b32 v7, v7, v4
    v_lshl_add_u32 v225, v7, 4, v6
    v_add_u32 v7, 12, v3
    v_xor_b32 v7, v7, v4
    v_lshl_add_u32 v226, v7, 4, v6
    v_add_u32 v7, 14, v3
    v_xor_b32 v7, v7, v4
    v_lshl_add_u32 v227, v7, 4, v6
    v_bfe_u32 v7, v1, 2, 2
    v_bfe_u32 v8, v1, 4, 1
    v_and_b32 v9, 3, v1
    v_lshl_add_u32 v10, v3, 2, v7
    v_lshlrev_b32 v10, 8, v10
    v_lshl_add_u32 v10, v8, 5, v10
    v_lshl_add_u32 v10, v9, 3, v10
    v_xor_b32 v11, 0, v7
    v_lshl_add_u32 v228, v11, 6, v10
    v_xor_b32 v11, 1, v7
    v_lshl_add_u32 v229, v11, 6, v10
    v_xor_b32 v11, 2, v7
    v_lshl_add_u32 v230, v11, 6, v10
    v_xor_b32 v11, 3, v7
    v_lshl_add_u32 v231, v11, 6, v10
    v_lshlrev_b32 v10, 8, v5
    v_add_u32 v10, s82, v10
    v_add_u32 v11, 0, v5
    v_xor_b32 v11, v11, v4
    v_lshl_add_u32 v232, v11, 4, v10
    v_add_u32 v11, 4, v5
    v_xor_b32 v11, v11, v4
    v_lshl_add_u32 v233, v11, 4, v10
    v_add_u32 v11, 8, v5
    v_xor_b32 v11, v11, v4
    v_lshl_add_u32 v234, v11, 4, v10
    v_add_u32 v11, 12, v5
    v_xor_b32 v11, v11, v4
    v_lshl_add_u32 v235, v11, 4, v10
    v_lshlrev_b32 v11, 2, v5
    v_xor_b32 v11, v11, v4
    v_lshl_add_u32 v236, v11, 4, v10
    s_cmp_ge_u32 s3, 2
    s_cselect_b32 s42, -1, 0
    v_subrev_u32 v213, 8192, v236
    v_mov_b32 v11, 2130706432
    v_mov_b32 v12, s42
    v_cmp_ne_u32 vcc, 0, v12
    s_nop 1
    v_cndmask_b32 v213, v11, v213, vcc
    v_add_u32 v237, 131072, v245
    s_lshl_b32 s42, s3, 11
    v_add_u32 v254, s42, v237
    v_bfe_u32 v11, v1, 4, 1
    v_lshlrev_b32 v238, 10, v11
    v_lshl_add_u32 v238, v3, 8, v238
    v_lshl_add_u32 v238, v4, 4, v238
    s_lshl_b32 s42, s2, 2
    s_add_u32 s42, s42, s3
    s_mul_i32 s54, s42, 18432
    s_add_u32 s54, s54, 48234496
    s_waitcnt vmcnt(25) lgkmcnt(0)
    s_barrier
    ds_read_b64_tr_b16 a[144:145], v164
    ds_read_b64_tr_b16 a[146:147], v164 offset:1024
    ds_read_b128 a[208:211], v160
    ds_read_b128 a[212:215], v160 offset:4096
    ds_read_b64_tr_b16 a[148:149], v165
    ds_read_b64_tr_b16 a[150:151], v165 offset:1024
    ds_read_b64_tr_b16 a[152:153], v166
    ds_read_b64_tr_b16 a[154:155], v166 offset:1024
    ds_read_b64_tr_b16 a[156:157], v167
    ds_read_b64_tr_b16 a[158:159], v167 offset:1024
    ds_read_b128 a[216:219], v208
    ds_read_b64_tr_b16 a[160:161], v164 offset:16384
    ds_read_b64_tr_b16 a[162:163], v164 offset:17408
    ds_read_b64_tr_b16 a[164:165], v165 offset:16384
    ds_read_b64_tr_b16 a[166:167], v165 offset:17408
    ds_read_b64_tr_b16 a[168:169], v166 offset:16384
    ds_read_b64_tr_b16 a[170:171], v166 offset:17408
    ds_read_b64_tr_b16 a[172:173], v167 offset:16384
    ds_read_b64_tr_b16 a[174:175], v167 offset:17408
    s_waitcnt lgkmcnt(8)
    v_mfma_f32_32x32x16_bf16 v[16:31], a[144:147], a[208:211], 0
    ds_read_b64_tr_b16 a[176:177], v164 offset:4096
    ds_read_b64_tr_b16 a[178:179], v164 offset:5120
    v_mfma_f32_32x32x16_bf16 v[80:95], a[144:147], a[212:215], 0
    ds_read_b128 a[220:223], v161
    v_mfma_f32_32x32x16_bf16 v[32:47], a[148:151], a[208:211], 0
    ds_read_b128 a[224:227], v161 offset:4096
    v_mfma_f32_32x32x16_bf16 v[96:111], a[148:151], a[212:215], 0
    ds_read_b64_tr_b16 a[180:181], v165 offset:4096
    v_mfma_f32_32x32x16_bf16 v[48:63], a[152:155], a[208:211], 0
    ds_read_b64_tr_b16 a[182:183], v165 offset:5120
    v_mfma_f32_32x32x16_bf16 v[112:127], a[152:155], a[212:215], 0
    ds_read_b64_tr_b16 a[184:185], v166 offset:4096
    v_mfma_f32_32x32x16_bf16 v[64:79], a[156:159], a[208:211], 0
    ds_read_b64_tr_b16 a[186:187], v166 offset:5120
    v_mfma_f32_32x32x16_bf16 v[128:143], a[156:159], a[212:215], 0
    ds_read_b64_tr_b16 a[188:189], v167 offset:4096
    v_mfma_f32_32x32x16_bf16 v[144:159], a[144:147], a[216:219], 0
    ds_read_b64_tr_b16 a[190:191], v167 offset:5120
    s_waitcnt lgkmcnt(10)
    v_mfma_f32_32x32x16_bf16 a[0:15], a[160:163], a[208:211], 0
    ds_read_b128 a[228:231], v209
    v_mfma_f32_32x32x16_bf16 a[64:79], a[160:163], a[212:215], 0
    ds_read_b64_tr_b16 a[192:193], v164 offset:20480
    v_mfma_f32_32x32x16_bf16 a[16:31], a[164:167], a[208:211], 0
    ds_read_b64_tr_b16 a[194:195], v164 offset:21504
    v_mfma_f32_32x32x16_bf16 a[80:95], a[164:167], a[212:215], 0
    ds_read_b64_tr_b16 a[196:197], v165 offset:20480
    v_mfma_f32_32x32x16_bf16 a[32:47], a[168:171], a[208:211], 0
    ds_read_b64_tr_b16 a[198:199], v165 offset:21504
    v_mfma_f32_32x32x16_bf16 a[96:111], a[168:171], a[212:215], 0
    ds_read_b64_tr_b16 a[200:201], v166 offset:20480
    v_mfma_f32_32x32x16_bf16 a[48:63], a[172:175], a[208:211], 0
    ds_read_b64_tr_b16 a[202:203], v166 offset:21504
    v_mfma_f32_32x32x16_bf16 a[112:127], a[172:175], a[212:215], 0
    ds_read_b64_tr_b16 a[204:205], v167 offset:20480
    v_mfma_f32_32x32x16_bf16 a[128:143], a[160:163], a[216:219], 0
    ds_read_b64_tr_b16 a[206:207], v167 offset:21504
    s_waitcnt lgkmcnt(8)
    v_mfma_f32_32x32x16_bf16 v[16:31], a[176:179], a[220:223], v[16:31]
    ds_read_b64_tr_b16 a[144:145], v164 offset:8192
    ds_read_b64_tr_b16 a[146:147], v164 offset:9216
    v_mfma_f32_32x32x16_bf16 v[80:95], a[176:179], a[224:227], v[80:95]
    ds_read_b128 a[208:211], v162
    v_mfma_f32_32x32x16_bf16 v[32:47], a[180:183], a[220:223], v[32:47]
    ds_read_b128 a[212:215], v162 offset:4096
    v_mfma_f32_32x32x16_bf16 v[96:111], a[180:183], a[224:227], v[96:111]
    ds_read_b64_tr_b16 a[148:149], v165 offset:8192
    v_mfma_f32_32x32x16_bf16 v[48:63], a[184:187], a[220:223], v[48:63]
    ds_read_b64_tr_b16 a[150:151], v165 offset:9216
    v_mfma_f32_32x32x16_bf16 v[112:127], a[184:187], a[224:227], v[112:127]
    ds_read_b64_tr_b16 a[152:153], v166 offset:8192
    v_mfma_f32_32x32x16_bf16 v[64:79], a[188:191], a[220:223], v[64:79]
    ds_read_b64_tr_b16 a[154:155], v166 offset:9216
    v_mfma_f32_32x32x16_bf16 v[128:143], a[188:191], a[224:227], v[128:143]
    ds_read_b64_tr_b16 a[156:157], v167 offset:8192
    v_mfma_f32_32x32x16_bf16 v[144:159], a[176:179], a[228:231], v[144:159]
    ds_read_b64_tr_b16 a[158:159], v167 offset:9216
    s_waitcnt lgkmcnt(10)
    v_mfma_f32_32x32x16_bf16 a[0:15], a[192:195], a[220:223], a[0:15]
    ds_read_b128 a[216:219], v210
    v_mfma_f32_32x32x16_bf16 a[64:79], a[192:195], a[224:227], a[64:79]
    ds_read_b64_tr_b16 a[160:161], v164 offset:24576
    v_mfma_f32_32x32x16_bf16 a[16:31], a[196:199], a[220:223], a[16:31]
    ds_read_b64_tr_b16 a[162:163], v164 offset:25600
    v_mfma_f32_32x32x16_bf16 a[80:95], a[196:199], a[224:227], a[80:95]
    ds_read_b64_tr_b16 a[164:165], v165 offset:24576
    v_mfma_f32_32x32x16_bf16 a[32:47], a[200:203], a[220:223], a[32:47]
    ds_read_b64_tr_b16 a[166:167], v165 offset:25600
    v_mfma_f32_32x32x16_bf16 a[96:111], a[200:203], a[224:227], a[96:111]
    ds_read_b64_tr_b16 a[168:169], v166 offset:24576
    v_mfma_f32_32x32x16_bf16 a[48:63], a[204:207], a[220:223], a[48:63]
    ds_read_b64_tr_b16 a[170:171], v166 offset:25600
    v_mfma_f32_32x32x16_bf16 a[112:127], a[204:207], a[224:227], a[112:127]
    ds_read_b64_tr_b16 a[172:173], v167 offset:24576
    v_mfma_f32_32x32x16_bf16 a[128:143], a[192:195], a[228:231], a[128:143]
    ds_read_b64_tr_b16 a[174:175], v167 offset:25600
    s_waitcnt lgkmcnt(8)
    v_mfma_f32_32x32x16_bf16 v[16:31], a[144:147], a[208:211], v[16:31]
    ds_read_b64_tr_b16 a[176:177], v164 offset:12288
    ds_read_b64_tr_b16 a[178:179], v164 offset:13312
    v_mfma_f32_32x32x16_bf16 v[80:95], a[144:147], a[212:215], v[80:95]
    ds_read_b128 a[220:223], v163
    v_mfma_f32_32x32x16_bf16 v[32:47], a[148:151], a[208:211], v[32:47]
    ds_read_b128 a[224:227], v163 offset:4096
    v_mfma_f32_32x32x16_bf16 v[96:111], a[148:151], a[212:215], v[96:111]
    ds_read_b64_tr_b16 a[180:181], v165 offset:12288
    v_mfma_f32_32x32x16_bf16 v[48:63], a[152:155], a[208:211], v[48:63]
    ds_read_b64_tr_b16 a[182:183], v165 offset:13312
    v_mfma_f32_32x32x16_bf16 v[112:127], a[152:155], a[212:215], v[112:127]
    ds_read_b64_tr_b16 a[184:185], v166 offset:12288
    v_mfma_f32_32x32x16_bf16 v[64:79], a[156:159], a[208:211], v[64:79]
    ds_read_b64_tr_b16 a[186:187], v166 offset:13312
    v_mfma_f32_32x32x16_bf16 v[128:143], a[156:159], a[212:215], v[128:143]
    ds_read_b64_tr_b16 a[188:189], v167 offset:12288
    v_mfma_f32_32x32x16_bf16 v[144:159], a[144:147], a[216:219], v[144:159]
    ds_read_b64_tr_b16 a[190:191], v167 offset:13312
    s_waitcnt lgkmcnt(10)
    v_mfma_f32_32x32x16_bf16 a[0:15], a[160:163], a[208:211], a[0:15]
    ds_read_b128 a[228:231], v211
    v_mfma_f32_32x32x16_bf16 a[64:79], a[160:163], a[212:215], a[64:79]
    ds_read_b64_tr_b16 a[192:193], v164 offset:28672
    v_mfma_f32_32x32x16_bf16 a[16:31], a[164:167], a[208:211], a[16:31]
    ds_read_b64_tr_b16 a[194:195], v164 offset:29696
    v_mfma_f32_32x32x16_bf16 a[80:95], a[164:167], a[212:215], a[80:95]
    ds_read_b64_tr_b16 a[196:197], v165 offset:28672
    v_mfma_f32_32x32x16_bf16 a[32:47], a[168:171], a[208:211], a[32:47]
    ds_read_b64_tr_b16 a[198:199], v165 offset:29696
    v_mfma_f32_32x32x16_bf16 a[96:111], a[168:171], a[212:215], a[96:111]
    ds_read_b64_tr_b16 a[200:201], v166 offset:28672
    v_mfma_f32_32x32x16_bf16 a[48:63], a[172:175], a[208:211], a[48:63]
    ds_read_b64_tr_b16 a[202:203], v166 offset:29696
    v_mfma_f32_32x32x16_bf16 a[112:127], a[172:175], a[212:215], a[112:127]
    ds_read_b64_tr_b16 a[204:205], v167 offset:28672
    v_mfma_f32_32x32x16_bf16 a[128:143], a[160:163], a[216:219], a[128:143]
    ds_read_b64_tr_b16 a[206:207], v167 offset:29696
    s_waitcnt lgkmcnt(8)
    v_mfma_f32_32x32x16_bf16 v[16:31], a[176:179], a[220:223], v[16:31]
    s_sub_u32 s52, 0, s52
    v_add_u32 v160, s52, v160
    v_add_u32 v161, s52, v161
    v_add_u32 v162, s52, v162
    v_add_u32 v163, s52, v163
    v_mfma_f32_32x32x16_bf16 v[80:95], a[176:179], a[224:227], v[80:95]
    v_add_u32 v208, s52, v208
    v_add_u32 v209, s52, v209
    v_add_u32 v210, s52, v210
    v_add_u32 v211, s52, v211
    v_mfma_f32_32x32x16_bf16 v[32:47], a[180:183], a[220:223], v[32:47]
    v_add_u32 v164, s52, v164
    v_add_u32 v165, s52, v165
    v_add_u32 v166, s52, v166
    v_add_u32 v167, s52, v167
    s_waitcnt vmcnt(2) lgkmcnt(0)
    s_barrier
    v_mfma_f32_32x32x16_bf16 v[96:111], a[180:183], a[224:227], v[96:111]
    ds_read_b64_tr_b16 a[144:145], v164
    s_add_u32 s46, s50, s82
    v_mfma_f32_32x32x16_bf16 v[48:63], a[184:187], a[220:223], v[48:63]
    ds_read_b64_tr_b16 a[146:147], v164 offset:1024
    s_add_u32 s47, s48, s83
    v_mfma_f32_32x32x16_bf16 v[112:127], a[184:187], a[224:227], v[112:127]
    ds_read_b128 a[208:211], v160
    ds_read_b128 a[212:215], v160 offset:4096
    v_mfma_f32_32x32x16_bf16 v[64:79], a[188:191], a[220:223], v[64:79]
    s_add_u32 m0, s46, 0
    ds_read_b64_tr_b16 a[148:149], v165
    v_mfma_f32_32x32x16_bf16 v[128:143], a[188:191], a[224:227], v[128:143]
    ds_read_b64_tr_b16 a[150:151], v165 offset:1024
    buffer_load_dwordx4 v168, s[8:11], s47 offen lds
    v_mfma_f32_32x32x16_bf16 v[144:159], a[176:179], a[228:231], v[144:159]
    ds_read_b64_tr_b16 a[152:153], v166
    ds_read_b64_tr_b16 a[154:155], v166 offset:1024
    v_mfma_f32_32x32x16_bf16 a[0:15], a[192:195], a[220:223], a[0:15]
    buffer_load_dwordx4 v169, s[8:11], s47 offen offset:1024 lds
    ds_read_b64_tr_b16 a[156:157], v167
    v_mfma_f32_32x32x16_bf16 a[64:79], a[192:195], a[224:227], a[64:79]
    ds_read_b64_tr_b16 a[158:159], v167 offset:1024
    buffer_load_dwordx4 v170, s[8:11], s47 offen offset:2048 lds
    v_mfma_f32_32x32x16_bf16 a[16:31], a[196:199], a[220:223], a[16:31]
    ds_read_b128 a[216:219], v208
    ds_read_b64_tr_b16 a[160:161], v164 offset:16384
    v_mfma_f32_32x32x16_bf16 a[80:95], a[196:199], a[224:227], a[80:95]
    buffer_load_dwordx4 v171, s[8:11], s47 offen offset:3072 lds
    ds_read_b64_tr_b16 a[162:163], v164 offset:17408
    v_mfma_f32_32x32x16_bf16 a[32:47], a[200:203], a[220:223], a[32:47]
    ds_read_b64_tr_b16 a[164:165], v165 offset:16384
    s_add_u32 m0, s46, 16384
    v_mfma_f32_32x32x16_bf16 a[96:111], a[200:203], a[224:227], a[96:111]
    ds_read_b64_tr_b16 a[166:167], v165 offset:17408
    ds_read_b64_tr_b16 a[168:169], v166 offset:16384
    v_mfma_f32_32x32x16_bf16 a[48:63], a[204:207], a[220:223], a[48:63]
    s_add_u32 s47, s47, 163840
    ds_read_b64_tr_b16 a[170:171], v166 offset:17408
    v_mfma_f32_32x32x16_bf16 a[112:127], a[204:207], a[224:227], a[112:127]
    ds_read_b64_tr_b16 a[172:173], v167 offset:16384
    buffer_load_dwordx4 v168, s[8:11], s47 offen lds
    v_mfma_f32_32x32x16_bf16 a[128:143], a[192:195], a[228:231], a[128:143]
    ds_read_b64_tr_b16 a[174:175], v167 offset:17408
    s_waitcnt lgkmcnt(8)
    v_mfma_f32_32x32x16_bf16 v[16:31], a[144:147], a[208:211], v[16:31]
    ds_read_b64_tr_b16 a[176:177], v164 offset:4096
    buffer_load_dwordx4 v169, s[8:11], s47 offen offset:1024 lds
    v_mfma_f32_32x32x16_bf16 v[80:95], a[144:147], a[212:215], v[80:95]
    ds_read_b64_tr_b16 a[178:179], v164 offset:5120
    buffer_load_dwordx4 v170, s[8:11], s47 offen offset:2048 lds
    v_mfma_f32_32x32x16_bf16 v[32:47], a[148:151], a[208:211], v[32:47]
    ds_read_b128 a[220:223], v161
    v_mfma_f32_32x32x16_bf16 v[96:111], a[148:151], a[212:215], v[96:111]
    ds_read_b128 a[224:227], v161 offset:4096
    buffer_load_dwordx4 v171, s[8:11], s47 offen offset:3072 lds
    v_mfma_f32_32x32x16_bf16 v[48:63], a[152:155], a[208:211], v[48:63]
    ds_read_b64_tr_b16 a[180:181], v165 offset:4096
    ds_read_b64_tr_b16 a[182:183], v165 offset:5120
    v_mfma_f32_32x32x16_bf16 v[112:127], a[152:155], a[212:215], v[112:127]
    s_add_u32 s42, s50, s85
    v_mfma_f32_32x32x16_bf16 v[64:79], a[156:159], a[208:211], v[64:79]
    ds_read_b64_tr_b16 a[184:185], v166 offset:4096
    s_add_u32 m0, s42, 32768
    v_mfma_f32_32x32x16_bf16 v[128:143], a[156:159], a[212:215], v[128:143]
    ds_read_b64_tr_b16 a[186:187], v166 offset:5120
    ds_read_b64_tr_b16 a[188:189], v167 offset:4096
    v_mfma_f32_32x32x16_bf16 v[144:159], a[144:147], a[216:219], v[144:159]
    s_add_u32 s42, s48, 327680
    s_waitcnt lgkmcnt(9)
    v_mfma_f32_32x32x16_bf16 a[0:15], a[160:163], a[208:211], a[0:15]
    ds_read_b64_tr_b16 a[190:191], v167 offset:5120
    ds_read_b128 a[228:231], v209
    v_mfma_f32_32x32x16_bf16 a[64:79], a[160:163], a[212:215], a[64:79]
    buffer_load_dwordx4 v212, s[8:11], s42 offen lds
    ds_read_b64_tr_b16 a[192:193], v164 offset:20480
    v_mfma_f32_32x32x16_bf16 a[16:31], a[164:167], a[208:211], a[16:31]
    ds_read_b64_tr_b16 a[194:195], v164 offset:21504
    v_mfma_f32_32x32x16_bf16 a[80:95], a[164:167], a[212:215], a[80:95]
    s_add_u32 s47, s49, s84
    ds_read_b64_tr_b16 a[196:197], v165 offset:20480
    v_mfma_f32_32x32x16_bf16 a[32:47], a[168:171], a[208:211], a[32:47]
    s_add_u32 m0, s46, 36864
    ds_read_b64_tr_b16 a[198:199], v165 offset:21504
    v_mfma_f32_32x32x16_bf16 a[96:111], a[168:171], a[212:215], a[96:111]
    ds_read_b64_tr_b16 a[200:201], v166 offset:20480
    v_mfma_f32_32x32x16_bf16 a[48:63], a[172:175], a[208:211], a[48:63]
    buffer_load_dwordx4 v172, s[12:15], s47 offen lds
    ds_read_b64_tr_b16 a[202:203], v166 offset:21504
    v_mfma_f32_32x32x16_bf16 a[112:127], a[172:175], a[212:215], a[112:127]
    ds_read_b64_tr_b16 a[204:205], v167 offset:20480
    buffer_load_dwordx4 v173, s[12:15], s47 offen offset:1024 lds
    v_mfma_f32_32x32x16_bf16 a[128:143], a[160:163], a[216:219], a[128:143]
    ds_read_b64_tr_b16 a[206:207], v167 offset:21504
    s_waitcnt lgkmcnt(8)
    v_mfma_f32_32x32x16_bf16 v[16:31], a[176:179], a[220:223], v[16:31]
    ds_read_b64_tr_b16 a[144:145], v164 offset:8192
    buffer_load_dwordx4 v174, s[12:15], s47 offen offset:2048 lds
    v_mfma_f32_32x32x16_bf16 v[80:95], a[176:179], a[224:227], v[80:95]
    ds_read_b64_tr_b16 a[146:147], v164 offset:9216
    buffer_load_dwordx4 v175, s[12:15], s47 offen offset:3072 lds
    v_mfma_f32_32x32x16_bf16 v[32:47], a[180:183], a[220:223], v[32:47]
    ds_read_b128 a[208:211], v162
    v_mfma_f32_32x32x16_bf16 v[96:111], a[180:183], a[224:227], v[96:111]
    ds_read_b128 a[212:215], v162 offset:4096
    s_add_u32 m0, s46, 53248
    v_mfma_f32_32x32x16_bf16 v[48:63], a[184:187], a[220:223], v[48:63]
    ds_read_b64_tr_b16 a[148:149], v165 offset:8192
    ds_read_b64_tr_b16 a[150:151], v165 offset:9216
    v_mfma_f32_32x32x16_bf16 v[112:127], a[184:187], a[224:227], v[112:127]
    s_add_u32 s47, s47, 256
    v_mfma_f32_32x32x16_bf16 v[64:79], a[188:191], a[220:223], v[64:79]
    ds_read_b64_tr_b16 a[152:153], v166 offset:8192
    buffer_load_dwordx4 v172, s[12:15], s47 offen lds
    v_mfma_f32_32x32x16_bf16 v[128:143], a[188:191], a[224:227], v[128:143]
    ds_read_b64_tr_b16 a[154:155], v166 offset:9216
    ds_read_b64_tr_b16 a[156:157], v167 offset:8192
    v_mfma_f32_32x32x16_bf16 v[144:159], a[176:179], a[228:231], v[144:159]
    buffer_load_dwordx4 v173, s[12:15], s47 offen offset:1024 lds
    s_waitcnt lgkmcnt(9)
    v_mfma_f32_32x32x16_bf16 a[0:15], a[192:195], a[220:223], a[0:15]
    ds_read_b64_tr_b16 a[158:159], v167 offset:9216
    ds_read_b128 a[216:219], v210
    v_mfma_f32_32x32x16_bf16 a[64:79], a[192:195], a[224:227], a[64:79]
    buffer_load_dwordx4 v174, s[12:15], s47 offen offset:2048 lds
    ds_read_b64_tr_b16 a[160:161], v164 offset:24576
    v_mfma_f32_32x32x16_bf16 a[16:31], a[196:199], a[220:223], a[16:31]
    ds_read_b64_tr_b16 a[162:163], v164 offset:25600
    v_mfma_f32_32x32x16_bf16 a[80:95], a[196:199], a[224:227], a[80:95]
    buffer_load_dwordx4 v175, s[12:15], s47 offen offset:3072 lds
    ds_read_b64_tr_b16 a[164:165], v165 offset:24576
    v_mfma_f32_32x32x16_bf16 a[32:47], a[200:203], a[220:223], a[32:47]
    s_add_u32 s48, s48, 128
    ds_read_b64_tr_b16 a[166:167], v165 offset:25600
    v_mfma_f32_32x32x16_bf16 a[96:111], a[200:203], a[224:227], a[96:111]
    ds_read_b64_tr_b16 a[168:169], v166 offset:24576
    v_mfma_f32_32x32x16_bf16 a[48:63], a[204:207], a[220:223], a[48:63]
    s_add_u32 s49, s49, 524288
    ds_read_b64_tr_b16 a[170:171], v166 offset:25600
    v_mfma_f32_32x32x16_bf16 a[112:127], a[204:207], a[224:227], a[112:127]
    ds_read_b64_tr_b16 a[172:173], v167 offset:24576
    s_sub_u32 s50, 69632, s50
    v_mfma_f32_32x32x16_bf16 a[128:143], a[192:195], a[228:231], a[128:143]
    ds_read_b64_tr_b16 a[174:175], v167 offset:25600
    s_waitcnt lgkmcnt(8)
    v_mfma_f32_32x32x16_bf16 v[16:31], a[144:147], a[208:211], v[16:31]
    ds_read_b64_tr_b16 a[176:177], v164 offset:12288
    buffer_load_dword v206, v204, s[56:59], s55 offen
    buffer_load_dword v206, v205, s[60:63], s51 offen
    s_add_u32 s55, s55, 128
    v_mfma_f32_32x32x16_bf16 v[80:95], a[144:147], a[212:215], v[80:95]
    ds_read_b64_tr_b16 a[178:179], v164 offset:13312
    s_add_u32 s51, s51, 524288
    ds_read_b64_tr_b16 v[182:183], v181
    ds_read_b128 a[220:223], v163
    v_mfma_f32_32x32x16_bf16 v[32:47], a[148:151], a[208:211], v[32:47]
    ds_read_b64_tr_b16 v[184:185], v181 offset:1280
    ds_read_b64_tr_b16 v[186:187], v181 offset:32
    ds_read_b64_tr_b16 v[188:189], v181 offset:1312
    v_mfma_f32_32x32x16_bf16 v[96:111], a[148:151], a[212:215], v[96:111]
    ds_read_b128 a[224:227], v163 offset:4096
    ds_read_b64_tr_b16 v[190:191], v181 offset:64
    ds_read_b64_tr_b16 v[192:193], v181 offset:1344
    ds_read_b64_tr_b16 a[180:181], v165 offset:12288
    v_mfma_f32_32x32x16_bf16 v[48:63], a[152:155], a[208:211], v[48:63]
    ds_read_b64_tr_b16 v[194:195], v181 offset:96
    ds_read_b64_tr_b16 v[196:197], v181 offset:1376
    ds_read_b64_tr_b16 a[182:183], v165 offset:13312
    v_mfma_f32_32x32x16_bf16 v[112:127], a[152:155], a[212:215], v[112:127]
    ds_read_b64_tr_b16 v[198:199], v181 offset:128
    ds_read_b64_tr_b16 v[200:201], v181 offset:1408
    s_lshl_b32 s46, s34, 7
    ds_read_b64_tr_b16 a[184:185], v166 offset:12288
    v_mfma_f32_32x32x16_bf16 v[64:79], a[156:159], a[208:211], v[64:79]
    s_add_u32 s47, s33, 0
    s_lshl_b32 s47, s47, 2
    ds_read_b64_tr_b16 a[186:187], v166 offset:13312
    v_mfma_f32_32x32x16_bf16 v[128:143], a[156:159], a[212:215], v[128:143]
    s_add_u32 s46, s46, s47
    s_add_u32 s46, s46, s3
    ds_read_b64_tr_b16 a[188:189], v167 offset:12288
    s_mul_i32 s46, s46, 40
    v_mfma_f32_32x32x16_bf16 v[144:159], a[144:147], a[216:219], v[144:159]
    s_mul_i32 s47, s32, 5
    s_add_u32 s46, s46, s47
    ds_read_b64_tr_b16 a[190:191], v167 offset:13312
    s_waitcnt lgkmcnt(15)
    v_mfma_f32_32x32x16_bf16 a[0:15], a[160:163], a[208:211], a[0:15]
    s_lshl_b32 s46, s46, 10
    s_add_u32 s46, s46, 37748736
    ds_read_b128 a[228:231], v211
    s_add_u32 s47, s46, 4096
    v_mfma_f32_32x32x16_bf16 a[64:79], a[160:163], a[212:215], a[64:79]
    buffer_store_dwordx4 v[182:185], v245, s[24:27], s46 offen sc1
    s_waitcnt lgkmcnt(14)
    buffer_store_dwordx4 v[186:189], v245, s[24:27], s46 offen offset:1024 sc1
    ds_read_b64_tr_b16 a[192:193], v164 offset:28672
    s_waitcnt lgkmcnt(12)
    buffer_store_dwordx4 v[190:193], v245, s[24:27], s46 offen offset:2048 sc1
    v_mfma_f32_32x32x16_bf16 a[16:31], a[164:167], a[208:211], a[16:31]
    s_waitcnt lgkmcnt(9)
    buffer_store_dwordx4 v[194:197], v245, s[24:27], s46 offen offset:3072 sc1
    ds_read_b64_tr_b16 a[194:195], v164 offset:29696
    s_waitcnt lgkmcnt(7)
    buffer_store_dwordx4 v[198:201], v245, s[24:27], s47 offen sc1
    v_mfma_f32_32x32x16_bf16 a[80:95], a[164:167], a[212:215], a[80:95]
    s_add_u32 s46, s33, 1
    ds_read_b64_tr_b16 a[196:197], v165 offset:28672
    s_mul_i32 s46, s46, 163840
    s_mul_i32 s47, s32, 160
    v_mfma_f32_32x32x16_bf16 a[32:47], a[168:171], a[208:211], a[32:47]
    s_add_u32 s46, s46, s47
    ds_read_b64_tr_b16 a[198:199], v165 offset:29696
    s_add_u32 s46, s46, s83
    v_mfma_f32_32x32x16_bf16 a[96:111], a[168:171], a[212:215], a[96:111]
    s_add_u32 m0, s87, 0
    ds_read_b64_tr_b16 a[200:201], v166 offset:28672
    buffer_load_dwordx4 v176, s[28:31], s46 offen nt lds
    s_add_u32 m0, s87, 1024
    v_mfma_f32_32x32x16_bf16 a[48:63], a[172:175], a[208:211], a[48:63]
    ds_read_b64_tr_b16 a[202:203], v166 offset:29696
    buffer_load_dwordx4 v177, s[28:31], s46 offen nt lds
    s_add_u32 m0, s87, 2048
    v_mfma_f32_32x32x16_bf16 a[112:127], a[172:175], a[212:215], a[112:127]
    buffer_load_dwordx4 v178, s[28:31], s46 offen nt lds
    ds_read_b64_tr_b16 a[204:205], v167 offset:28672
    s_add_u32 m0, s87, 3072
    s_nop 0
    buffer_load_dwordx4 v179, s[28:31], s46 offen nt lds
    v_mfma_f32_32x32x16_bf16 a[128:143], a[160:163], a[216:219], a[128:143]
    ds_read_b64_tr_b16 a[206:207], v167 offset:29696
    s_add_u32 m0, s87, 4096
    s_nop 0
    buffer_load_dwordx4 v180, s[28:31], s46 offen nt lds
    s_mov_b32 s39, 6
C_QL:
    s_waitcnt lgkmcnt(8)
    v_mfma_f32_32x32x16_bf16 v[16:31], a[176:179], a[220:223], v[16:31]
    s_sub_u32 s52, 0, s52
    v_add_u32 v160, s52, v160
    v_add_u32 v161, s52, v161
    v_add_u32 v162, s52, v162
    v_add_u32 v163, s52, v163
    v_mfma_f32_32x32x16_bf16 v[80:95], a[176:179], a[224:227], v[80:95]
    v_add_u32 v208, s52, v208
    v_add_u32 v209, s52, v209
    v_add_u32 v210, s52, v210
    v_add_u32 v211, s52, v211
    v_mfma_f32_32x32x16_bf16 v[32:47], a[180:183], a[220:223], v[32:47]
    v_add_u32 v164, s52, v164
    v_add_u32 v165, s52, v165
    v_add_u32 v166, s52, v166
    v_add_u32 v167, s52, v167
    s_waitcnt vmcnt(2) lgkmcnt(0)
    s_barrier
    v_mfma_f32_32x32x16_bf16 v[96:111], a[180:183], a[224:227], v[96:111]
    ds_read_b64_tr_b16 a[144:145], v164
    s_add_u32 s46, s50, s82
    v_mfma_f32_32x32x16_bf16 v[48:63], a[184:187], a[220:223], v[48:63]
    ds_read_b64_tr_b16 a[146:147], v164 offset:1024
    s_add_u32 s47, s48, s83
    v_mfma_f32_32x32x16_bf16 v[112:127], a[184:187], a[224:227], v[112:127]
    ds_read_b128 a[208:211], v160
    ds_read_b128 a[212:215], v160 offset:4096
    v_mfma_f32_32x32x16_bf16 v[64:79], a[188:191], a[220:223], v[64:79]
    s_add_u32 m0, s46, 0
    ds_read_b64_tr_b16 a[148:149], v165
    v_mfma_f32_32x32x16_bf16 v[128:143], a[188:191], a[224:227], v[128:143]
    ds_read_b64_tr_b16 a[150:151], v165 offset:1024
    buffer_load_dwordx4 v168, s[8:11], s47 offen lds
    v_mfma_f32_32x32x16_bf16 v[144:159], a[176:179], a[228:231], v[144:159]
    ds_read_b64_tr_b16 a[152:153], v166
    ds_read_b64_tr_b16 a[154:155], v166 offset:1024
    v_mfma_f32_32x32x16_bf16 a[0:15], a[192:195], a[220:223], a[0:15]
    buffer_load_dwordx4 v169, s[8:11], s47 offen offset:1024 lds
    ds_read_b64_tr_b16 a[156:157], v167
    v_mfma_f32_32x32x16_bf16 a[64:79], a[192:195], a[224:227], a[64:79]
    ds_read_b64_tr_b16 a[158:159], v167 offset:1024
    buffer_load_dwordx4 v170, s[8:11], s47 offen offset:2048 lds
    v_mfma_f32_32x32x16_bf16 a[16:31], a[196:199], a[220:223], a[16:31]
    ds_read_b128 a[216:219], v208
    ds_read_b64_tr_b16 a[160:161], v164 offset:16384
    v_mfma_f32_32x32x16_bf16 a[80:95], a[196:199], a[224:227], a[80:95]
    buffer_load_dwordx4 v171, s[8:11], s47 offen offset:3072 lds
    ds_read_b64_tr_b16 a[162:163], v164 offset:17408
    v_mfma_f32_32x32x16_bf16 a[32:47], a[200:203], a[220:223], a[32:47]
    ds_read_b64_tr_b16 a[164:165], v165 offset:16384
    s_add_u32 m0, s46, 16384
    v_mfma_f32_32x32x16_bf16 a[96:111], a[200:203], a[224:227], a[96:111]
    ds_read_b64_tr_b16 a[166:167], v165 offset:17408
    ds_read_b64_tr_b16 a[168:169], v166 offset:16384
    v_mfma_f32_32x32x16_bf16 a[48:63], a[204:207], a[220:223], a[48:63]
    s_add_u32 s47, s47, 163840
    ds_read_b64_tr_b16 a[170:171], v166 offset:17408
    v_mfma_f32_32x32x16_bf16 a[112:127], a[204:207], a[224:227], a[112:127]
    ds_read_b64_tr_b16 a[172:173], v167 offset:16384
    buffer_load_dwordx4 v168, s[8:11], s47 offen lds
    v_mfma_f32_32x32x16_bf16 a[128:143], a[192:195], a[228:231], a[128:143]
    ds_read_b64_tr_b16 a[174:175], v167 offset:17408
    s_waitcnt lgkmcnt(8)
    v_mfma_f32_32x32x16_bf16 v[16:31], a[144:147], a[208:211], v[16:31]
    ds_read_b64_tr_b16 a[176:177], v164 offset:4096
    buffer_load_dwordx4 v169, s[8:11], s47 offen offset:1024 lds
    v_mfma_f32_32x32x16_bf16 v[80:95], a[144:147], a[212:215], v[80:95]
    ds_read_b64_tr_b16 a[178:179], v164 offset:5120
    buffer_load_dwordx4 v170, s[8:11], s47 offen offset:2048 lds
    v_mfma_f32_32x32x16_bf16 v[32:47], a[148:151], a[208:211], v[32:47]
    ds_read_b128 a[220:223], v161
    v_mfma_f32_32x32x16_bf16 v[96:111], a[148:151], a[212:215], v[96:111]
    ds_read_b128 a[224:227], v161 offset:4096
    buffer_load_dwordx4 v171, s[8:11], s47 offen offset:3072 lds
    v_mfma_f32_32x32x16_bf16 v[48:63], a[152:155], a[208:211], v[48:63]
    ds_read_b64_tr_b16 a[180:181], v165 offset:4096
    ds_read_b64_tr_b16 a[182:183], v165 offset:5120
    v_mfma_f32_32x32x16_bf16 v[112:127], a[152:155], a[212:215], v[112:127]
    s_add_u32 s42, s50, s85
    v_mfma_f32_32x32x16_bf16 v[64:79], a[156:159], a[208:211], v[64:79]
    ds_read_b64_tr_b16 a[184:185], v166 offset:4096
    s_add_u32 m0, s42, 32768
    v_mfma_f32_32x32x16_bf16 v[128:143], a[156:159], a[212:215], v[128:143]
    ds_read_b64_tr_b16 a[186:187], v166 offset:5120
    ds_read_b64_tr_b16 a[188:189], v167 offset:4096
    v_mfma_f32_32x32x16_bf16 v[144:159], a[144:147], a[216:219], v[144:159]
    s_add_u32 s42, s48, 327680
    s_waitcnt lgkmcnt(9)
    v_mfma_f32_32x32x16_bf16 a[0:15], a[160:163], a[208:211], a[0:15]
    ds_read_b64_tr_b16 a[190:191], v167 offset:5120
    ds_read_b128 a[228:231], v209
    v_mfma_f32_32x32x16_bf16 a[64:79], a[160:163], a[212:215], a[64:79]
    buffer_load_dwordx4 v212, s[8:11], s42 offen lds
    ds_read_b64_tr_b16 a[192:193], v164 offset:20480
    v_mfma_f32_32x32x16_bf16 a[16:31], a[164:167], a[208:211], a[16:31]
    ds_read_b64_tr_b16 a[194:195], v164 offset:21504
    v_mfma_f32_32x32x16_bf16 a[80:95], a[164:167], a[212:215], a[80:95]
    s_add_u32 s47, s49, s84
    ds_read_b64_tr_b16 a[196:197], v165 offset:20480
    v_mfma_f32_32x32x16_bf16 a[32:47], a[168:171], a[208:211], a[32:47]
    s_add_u32 m0, s46, 36864
    ds_read_b64_tr_b16 a[198:199], v165 offset:21504
    v_mfma_f32_32x32x16_bf16 a[96:111], a[168:171], a[212:215], a[96:111]
    ds_read_b64_tr_b16 a[200:201], v166 offset:20480
    v_mfma_f32_32x32x16_bf16 a[48:63], a[172:175], a[208:211], a[48:63]
    buffer_load_dwordx4 v172, s[12:15], s47 offen lds
    ds_read_b64_tr_b16 a[202:203], v166 offset:21504
    v_mfma_f32_32x32x16_bf16 a[112:127], a[172:175], a[212:215], a[112:127]
    ds_read_b64_tr_b16 a[204:205], v167 offset:20480
    buffer_load_dwordx4 v173, s[12:15], s47 offen offset:1024 lds
    v_mfma_f32_32x32x16_bf16 a[128:143], a[160:163], a[216:219], a[128:143]
    ds_read_b64_tr_b16 a[206:207], v167 offset:21504
    s_waitcnt lgkmcnt(8)
    v_mfma_f32_32x32x16_bf16 v[16:31], a[176:179], a[220:223], v[16:31]
    ds_read_b64_tr_b16 a[144:145], v164 offset:8192
    buffer_load_dwordx4 v174, s[12:15], s47 offen offset:2048 lds
    v_mfma_f32_32x32x16_bf16 v[80:95], a[176:179], a[224:227], v[80:95]
    ds_read_b64_tr_b16 a[146:147], v164 offset:9216
    buffer_load_dwordx4 v175, s[12:15], s47 offen offset:3072 lds
    v_mfma_f32_32x32x16_bf16 v[32:47], a[180:183], a[220:223], v[32:47]
    ds_read_b128 a[208:211], v162
    v_mfma_f32_32x32x16_bf16 v[96:111], a[180:183], a[224:227], v[96:111]
    ds_read_b128 a[212:215], v162 offset:4096
    s_add_u32 m0, s46, 53248
    v_mfma_f32_32x32x16_bf16 v[48:63], a[184:187], a[220:223], v[48:63]
    ds_read_b64_tr_b16 a[148:149], v165 offset:8192
    ds_read_b64_tr_b16 a[150:151], v165 offset:9216
    v_mfma_f32_32x32x16_bf16 v[112:127], a[184:187], a[224:227], v[112:127]
    s_add_u32 s47, s47, 256
    v_mfma_f32_32x32x16_bf16 v[64:79], a[188:191], a[220:223], v[64:79]
    ds_read_b64_tr_b16 a[152:153], v166 offset:8192
    buffer_load_dwordx4 v172, s[12:15], s47 offen lds
    v_mfma_f32_32x32x16_bf16 v[128:143], a[188:191], a[224:227], v[128:143]
    ds_read_b64_tr_b16 a[154:155], v166 offset:9216
    ds_read_b64_tr_b16 a[156:157], v167 offset:8192
    v_mfma_f32_32x32x16_bf16 v[144:159], a[176:179], a[228:231], v[144:159]
    buffer_load_dwordx4 v173, s[12:15], s47 offen offset:1024 lds
    s_waitcnt lgkmcnt(9)
    v_mfma_f32_32x32x16_bf16 a[0:15], a[192:195], a[220:223], a[0:15]
    ds_read_b64_tr_b16 a[158:159], v167 offset:9216
    ds_read_b128 a[216:219], v210
    v_mfma_f32_32x32x16_bf16 a[64:79], a[192:195], a[224:227], a[64:79]
    buffer_load_dwordx4 v174, s[12:15], s47 offen offset:2048 lds
    ds_read_b64_tr_b16 a[160:161], v164 offset:24576
    v_mfma_f32_32x32x16_bf16 a[16:31], a[196:199], a[220:223], a[16:31]
    ds_read_b64_tr_b16 a[162:163], v164 offset:25600
    v_mfma_f32_32x32x16_bf16 a[80:95], a[196:199], a[224:227], a[80:95]
    buffer_load_dwordx4 v175, s[12:15], s47 offen offset:3072 lds
    ds_read_b64_tr_b16 a[164:165], v165 offset:24576
    v_mfma_f32_32x32x16_bf16 a[32:47], a[200:203], a[220:223], a[32:47]
    s_add_u32 s48, s48, 128
    ds_read_b64_tr_b16 a[166:167], v165 offset:25600
    v_mfma_f32_32x32x16_bf16 a[96:111], a[200:203], a[224:227], a[96:111]
    ds_read_b64_tr_b16 a[168:169], v166 offset:24576
    v_mfma_f32_32x32x16_bf16 a[48:63], a[204:207], a[220:223], a[48:63]
    s_add_u32 s49, s49, 524288
    ds_read_b64_tr_b16 a[170:171], v166 offset:25600
    v_mfma_f32_32x32x16_bf16 a[112:127], a[204:207], a[224:227], a[112:127]
    ds_read_b64_tr_b16 a[172:173], v167 offset:24576
    s_sub_u32 s50, 69632, s50
    v_mfma_f32_32x32x16_bf16 a[128:143], a[192:195], a[228:231], a[128:143]
    ds_read_b64_tr_b16 a[174:175], v167 offset:25600
    s_waitcnt lgkmcnt(8)
    v_mfma_f32_32x32x16_bf16 v[16:31], a[144:147], a[208:211], v[16:31]
    ds_read_b64_tr_b16 a[176:177], v164 offset:12288
    buffer_load_dword v206, v204, s[56:59], s55 offen
    v_mfma_f32_32x32x16_bf16 v[80:95], a[144:147], a[212:215], v[80:95]
    ds_read_b64_tr_b16 a[178:179], v164 offset:13312
    v_mfma_f32_32x32x16_bf16 v[32:47], a[148:151], a[208:211], v[32:47]
    ds_read_b128 a[220:223], v163
    v_mfma_f32_32x32x16_bf16 v[96:111], a[148:151], a[212:215], v[96:111]
    ds_read_b128 a[224:227], v163 offset:4096
    ds_read_b64_tr_b16 a[180:181], v165 offset:12288
    v_mfma_f32_32x32x16_bf16 v[48:63], a[152:155], a[208:211], v[48:63]
    buffer_load_dword v206, v205, s[60:63], s51 offen
    v_mfma_f32_32x32x16_bf16 v[112:127], a[152:155], a[212:215], v[112:127]
    ds_read_b64_tr_b16 a[182:183], v165 offset:13312
    v_mfma_f32_32x32x16_bf16 v[64:79], a[156:159], a[208:211], v[64:79]
    ds_read_b64_tr_b16 a[184:185], v166 offset:12288
    v_mfma_f32_32x32x16_bf16 v[128:143], a[156:159], a[212:215], v[128:143]
    ds_read_b64_tr_b16 a[186:187], v166 offset:13312
    ds_read_b64_tr_b16 a[188:189], v167 offset:12288
    v_mfma_f32_32x32x16_bf16 v[144:159], a[144:147], a[216:219], v[144:159]
    ds_read_b64_tr_b16 a[190:191], v167 offset:13312
    s_waitcnt lgkmcnt(10)
    v_mfma_f32_32x32x16_bf16 a[0:15], a[160:163], a[208:211], a[0:15]
    s_add_u32 s55, s55, 128
    v_mfma_f32_32x32x16_bf16 a[64:79], a[160:163], a[212:215], a[64:79]
    ds_read_b128 a[228:231], v211
    ds_read_b64_tr_b16 a[192:193], v164 offset:28672
    v_mfma_f32_32x32x16_bf16 a[16:31], a[164:167], a[208:211], a[16:31]
    ds_read_b64_tr_b16 a[194:195], v164 offset:29696
    v_mfma_f32_32x32x16_bf16 a[80:95], a[164:167], a[212:215], a[80:95]
    ds_read_b64_tr_b16 a[196:197], v165 offset:28672
    v_mfma_f32_32x32x16_bf16 a[32:47], a[168:171], a[208:211], a[32:47]
    ds_read_b64_tr_b16 a[198:199], v165 offset:29696
    v_mfma_f32_32x32x16_bf16 a[96:111], a[168:171], a[212:215], a[96:111]
    s_add_u32 s51, s51, 524288
    ds_read_b64_tr_b16 a[200:201], v166 offset:28672
    v_mfma_f32_32x32x16_bf16 a[48:63], a[172:175], a[208:211], a[48:63]
    ds_read_b64_tr_b16 a[202:203], v166 offset:29696
    v_mfma_f32_32x32x16_bf16 a[112:127], a[172:175], a[212:215], a[112:127]
    ds_read_b64_tr_b16 a[204:205], v167 offset:28672
    v_mfma_f32_32x32x16_bf16 a[128:143], a[160:163], a[216:219], a[128:143]
    ds_read_b64_tr_b16 a[206:207], v167 offset:29696
    s_sub_u32 s39, s39, 1
    s_cmp_lg_u32 s39, 0
    s_cbranch_scc1 C_QL
    s_waitcnt lgkmcnt(8)
    v_mfma_f32_32x32x16_bf16 v[16:31], a[176:179], a[220:223], v[16:31]
    s_sub_u32 s52, 0, s52
    v_add_u32 v160, s52, v160
    v_add_u32 v161, s52, v161
    v_add_u32 v162, s52, v162
    v_add_u32 v163, s52, v163
    v_mfma_f32_32x32x16_bf16 v[80:95], a[176:179], a[224:227], v[80:95]
    v_add_u32 v208, s52, v208
    v_add_u32 v209, s52, v209
    v_add_u32 v210, s52, v210
    v_add_u32 v211, s52, v211
    v_mfma_f32_32x32x16_bf16 v[32:47], a[180:183], a[220:223], v[32:47]
    v_add_u32 v164, s52, v164
    v_add_u32 v165, s52, v165
    v_add_u32 v166, s52, v166
    v_add_u32 v167, s52, v167
    s_waitcnt vmcnt(2) lgkmcnt(0)
    s_barrier
    v_mfma_f32_32x32x16_bf16 v[96:111], a[180:183], a[224:227], v[96:111]
    ds_read_b64_tr_b16 a[144:145], v164
    s_add_u32 s46, s50, s82
    v_mfma_f32_32x32x16_bf16 v[48:63], a[184:187], a[220:223], v[48:63]
    ds_read_b64_tr_b16 a[146:147], v164 offset:1024
    s_add_u32 s47, s48, s83
    v_mfma_f32_32x32x16_bf16 v[112:127], a[184:187], a[224:227], v[112:127]
    ds_read_b128 a[208:211], v160
    ds_read_b128 a[212:215], v160 offset:4096
    v_mfma_f32_32x32x16_bf16 v[64:79], a[188:191], a[220:223], v[64:79]
    s_add_u32 m0, s46, 0
    ds_read_b64_tr_b16 a[148:149], v165
    v_mfma_f32_32x32x16_bf16 v[128:143], a[188:191], a[224:227], v[128:143]
    ds_read_b64_tr_b16 a[150:151], v165 offset:1024
    buffer_load_dwordx4 v168, s[8:11], s47 offen lds
    v_mfma_f32_32x32x16_bf16 v[144:159], a[176:179], a[228:231], v[144:159]
    ds_read_b64_tr_b16 a[152:153], v166
    ds_read_b64_tr_b16 a[154:155], v166 offset:1024
    v_mfma_f32_32x32x16_bf16 a[0:15], a[192:195], a[220:223], a[0:15]
    buffer_load_dwordx4 v169, s[8:11], s47 offen offset:1024 lds
    ds_read_b64_tr_b16 a[156:157], v167
    v_mfma_f32_32x32x16_bf16 a[64:79], a[192:195], a[224:227], a[64:79]
    ds_read_b64_tr_b16 a[158:159], v167 offset:1024
    buffer_load_dwordx4 v170, s[8:11], s47 offen offset:2048 lds
    v_mfma_f32_32x32x16_bf16 a[16:31], a[196:199], a[220:223], a[16:31]
    ds_read_b128 a[216:219], v208
    ds_read_b64_tr_b16 a[160:161], v164 offset:16384
    v_mfma_f32_32x32x16_bf16 a[80:95], a[196:199], a[224:227], a[80:95]
    buffer_load_dwordx4 v171, s[8:11], s47 offen offset:3072 lds
    ds_read_b64_tr_b16 a[162:163], v164 offset:17408
    v_mfma_f32_32x32x16_bf16 a[32:47], a[200:203], a[220:223], a[32:47]
    ds_read_b64_tr_b16 a[164:165], v165 offset:16384
    s_add_u32 m0, s46, 16384
    v_mfma_f32_32x32x16_bf16 a[96:111], a[200:203], a[224:227], a[96:111]
    ds_read_b64_tr_b16 a[166:167], v165 offset:17408
    ds_read_b64_tr_b16 a[168:169], v166 offset:16384
    v_mfma_f32_32x32x16_bf16 a[48:63], a[204:207], a[220:223], a[48:63]
    s_add_u32 s47, s47, 163840
    ds_read_b64_tr_b16 a[170:171], v166 offset:17408
    v_mfma_f32_32x32x16_bf16 a[112:127], a[204:207], a[224:227], a[112:127]
    ds_read_b64_tr_b16 a[172:173], v167 offset:16384
    buffer_load_dwordx4 v168, s[8:11], s47 offen lds
    v_mfma_f32_32x32x16_bf16 a[128:143], a[192:195], a[228:231], a[128:143]
    ds_read_b64_tr_b16 a[174:175], v167 offset:17408
    s_waitcnt lgkmcnt(8)
    v_mfma_f32_32x32x16_bf16 v[16:31], a[144:147], a[208:211], v[16:31]
    ds_read_b64_tr_b16 a[176:177], v164 offset:4096
    buffer_load_dwordx4 v169, s[8:11], s47 offen offset:1024 lds
    v_mfma_f32_32x32x16_bf16 v[80:95], a[144:147], a[212:215], v[80:95]
    ds_read_b64_tr_b16 a[178:179], v164 offset:5120
    buffer_load_dwordx4 v170, s[8:11], s47 offen offset:2048 lds
    v_mfma_f32_32x32x16_bf16 v[32:47], a[148:151], a[208:211], v[32:47]
    ds_read_b128 a[220:223], v161
    v_mfma_f32_32x32x16_bf16 v[96:111], a[148:151], a[212:215], v[96:111]
    ds_read_b128 a[224:227], v161 offset:4096
    buffer_load_dwordx4 v171, s[8:11], s47 offen offset:3072 lds
    v_mfma_f32_32x32x16_bf16 v[48:63], a[152:155], a[208:211], v[48:63]
    ds_read_b64_tr_b16 a[180:181], v165 offset:4096
    ds_read_b64_tr_b16 a[182:183], v165 offset:5120
    v_mfma_f32_32x32x16_bf16 v[112:127], a[152:155], a[212:215], v[112:127]
    s_add_u32 s42, s50, s85
    v_mfma_f32_32x32x16_bf16 v[64:79], a[156:159], a[208:211], v[64:79]
    ds_read_b64_tr_b16 a[184:185], v166 offset:4096
    s_add_u32 m0, s42, 32768
    v_mfma_f32_32x32x16_bf16 v[128:143], a[156:159], a[212:215], v[128:143]
    ds_read_b64_tr_b16 a[186:187], v166 offset:5120
    ds_read_b64_tr_b16 a[188:189], v167 offset:4096
    v_mfma_f32_32x32x16_bf16 v[144:159], a[144:147], a[216:219], v[144:159]
    s_add_u32 s42, s48, 327680
    s_waitcnt lgkmcnt(9)
    v_mfma_f32_32x32x16_bf16 a[0:15], a[160:163], a[208:211], a[0:15]
    ds_read_b64_tr_b16 a[190:191], v167 offset:5120
    ds_read_b128 a[228:231], v209
    v_mfma_f32_32x32x16_bf16 a[64:79], a[160:163], a[212:215], a[64:79]
    buffer_load_dwordx4 v212, s[8:11], s42 offen lds
    ds_read_b64_tr_b16 a[192:193], v164 offset:20480
    v_mfma_f32_32x32x16_bf16 a[16:31], a[164:167], a[208:211], a[16:31]
    ds_read_b64_tr_b16 a[194:195], v164 offset:21504
    v_mfma_f32_32x32x16_bf16 a[80:95], a[164:167], a[212:215], a[80:95]
    s_add_u32 s47, s49, s84
    ds_read_b64_tr_b16 a[196:197], v165 offset:20480
    v_mfma_f32_32x32x16_bf16 a[32:47], a[168:171], a[208:211], a[32:47]
    s_add_u32 m0, s46, 36864
    ds_read_b64_tr_b16 a[198:199], v165 offset:21504
    v_mfma_f32_32x32x16_bf16 a[96:111], a[168:171], a[212:215], a[96:111]
    ds_read_b64_tr_b16 a[200:201], v166 offset:20480
    v_mfma_f32_32x32x16_bf16 a[48:63], a[172:175], a[208:211], a[48:63]
    buffer_load_dwordx4 v172, s[12:15], s47 offen lds
    ds_read_b64_tr_b16 a[202:203], v166 offset:21504
    v_mfma_f32_32x32x16_bf16 a[112:127], a[172:175], a[212:215], a[112:127]
    ds_read_b64_tr_b16 a[204:205], v167 offset:20480
    buffer_load_dwordx4 v173, s[12:15], s47 offen offset:1024 lds
    v_mfma_f32_32x32x16_bf16 a[128:143], a[160:163], a[216:219], a[128:143]
    ds_read_b64_tr_b16 a[206:207], v167 offset:21504
    s_waitcnt lgkmcnt(8)
    v_mfma_f32_32x32x16_bf16 v[16:31], a[176:179], a[220:223], v[16:31]
    ds_read_b64_tr_b16 a[144:145], v164 offset:8192
    buffer_load_dwordx4 v174, s[12:15], s47 offen offset:2048 lds
    v_mfma_f32_32x32x16_bf16 v[80:95], a[176:179], a[224:227], v[80:95]
    ds_read_b64_tr_b16 a[146:147], v164 offset:9216
    buffer_load_dwordx4 v175, s[12:15], s47 offen offset:3072 lds
    v_mfma_f32_32x32x16_bf16 v[32:47], a[180:183], a[220:223], v[32:47]
    ds_read_b128 a[208:211], v162
    v_mfma_f32_32x32x16_bf16 v[96:111], a[180:183], a[224:227], v[96:111]
    ds_read_b128 a[212:215], v162 offset:4096
    s_add_u32 m0, s46, 53248
    v_mfma_f32_32x32x16_bf16 v[48:63], a[184:187], a[220:223], v[48:63]
    ds_read_b64_tr_b16 a[148:149], v165 offset:8192
    ds_read_b64_tr_b16 a[150:151], v165 offset:9216
    v_mfma_f32_32x32x16_bf16 v[112:127], a[184:187], a[224:227], v[112:127]
    s_add_u32 s47, s47, 256
    v_mfma_f32_32x32x16_bf16 v[64:79], a[188:191], a[220:223], v[64:79]
    ds_read_b64_tr_b16 a[152:153], v166 offset:8192
    buffer_load_dwordx4 v172, s[12:15], s47 offen lds
    v_mfma_f32_32x32x16_bf16 v[128:143], a[188:191], a[224:227], v[128:143]
    ds_read_b64_tr_b16 a[154:155], v166 offset:9216
    ds_read_b64_tr_b16 a[156:157], v167 offset:8192
    v_mfma_f32_32x32x16_bf16 v[144:159], a[176:179], a[228:231], v[144:159]
    buffer_load_dwordx4 v173, s[12:15], s47 offen offset:1024 lds
    s_waitcnt lgkmcnt(9)
    v_mfma_f32_32x32x16_bf16 a[0:15], a[192:195], a[220:223], a[0:15]
    ds_read_b64_tr_b16 a[158:159], v167 offset:9216
    ds_read_b128 a[216:219], v210
    v_mfma_f32_32x32x16_bf16 a[64:79], a[192:195], a[224:227], a[64:79]
    buffer_load_dwordx4 v174, s[12:15], s47 offen offset:2048 lds
    ds_read_b64_tr_b16 a[160:161], v164 offset:24576
    v_mfma_f32_32x32x16_bf16 a[16:31], a[196:199], a[220:223], a[16:31]
    ds_read_b64_tr_b16 a[162:163], v164 offset:25600
    v_mfma_f32_32x32x16_bf16 a[80:95], a[196:199], a[224:227], a[80:95]
    buffer_load_dwordx4 v175, s[12:15], s47 offen offset:3072 lds
    ds_read_b64_tr_b16 a[164:165], v165 offset:24576
    v_mfma_f32_32x32x16_bf16 a[32:47], a[200:203], a[220:223], a[32:47]
    s_add_u32 s48, s48, 128
    ds_read_b64_tr_b16 a[166:167], v165 offset:25600
    v_mfma_f32_32x32x16_bf16 a[96:111], a[200:203], a[224:227], a[96:111]
    ds_read_b64_tr_b16 a[168:169], v166 offset:24576
    v_mfma_f32_32x32x16_bf16 a[48:63], a[204:207], a[220:223], a[48:63]
    s_add_u32 s49, s49, 524288
    ds_read_b64_tr_b16 a[170:171], v166 offset:25600
    v_mfma_f32_32x32x16_bf16 a[112:127], a[204:207], a[224:227], a[112:127]
    ds_read_b64_tr_b16 a[172:173], v167 offset:24576
    s_sub_u32 s50, 69632, s50
    v_mfma_f32_32x32x16_bf16 a[128:143], a[192:195], a[228:231], a[128:143]
    ds_read_b64_tr_b16 a[174:175], v167 offset:25600
    s_waitcnt lgkmcnt(8)
    v_mfma_f32_32x32x16_bf16 v[16:31], a[144:147], a[208:211], v[16:31]
    ds_read_b64_tr_b16 a[176:177], v164 offset:12288
    buffer_load_dword v206, v204, s[56:59], s55 offen
    buffer_load_dword v206, v205, s[60:63], s51 offen
    v_mfma_f32_32x32x16_bf16 v[80:95], a[144:147], a[212:215], v[80:95]
    ds_read_b64_tr_b16 a[178:179], v164 offset:13312
    s_add_u32 s55, s55, 128
    s_add_u32 s51, s51, 524288
    v_mfma_f32_32x32x16_bf16 v[32:47], a[148:151], a[208:211], v[32:47]
    ds_read_b128 a[220:223], v163
    ds_read_b64_tr_b16 v[182:183], v181
    ds_read_b128 a[224:227], v163 offset:4096
    v_mfma_f32_32x32x16_bf16 v[96:111], a[148:151], a[212:215], v[96:111]
    ds_read_b64_tr_b16 v[184:185], v181 offset:1280
    ds_read_b64_tr_b16 v[186:187], v181 offset:32
    v_mfma_f32_32x32x16_bf16 v[48:63], a[152:155], a[208:211], v[48:63]
    ds_read_b64_tr_b16 a[180:181], v165 offset:12288
    ds_read_b64_tr_b16 v[188:189], v181 offset:1312
    ds_read_b64_tr_b16 a[182:183], v165 offset:13312
    v_mfma_f32_32x32x16_bf16 v[112:127], a[152:155], a[212:215], v[112:127]
    ds_read_b64_tr_b16 v[190:191], v181 offset:64
    ds_read_b64_tr_b16 v[192:193], v181 offset:1344
    ds_read_b64_tr_b16 a[184:185], v166 offset:12288
    v_mfma_f32_32x32x16_bf16 v[64:79], a[156:159], a[208:211], v[64:79]
    ds_read_b64_tr_b16 v[194:195], v181 offset:96
    ds_read_b64_tr_b16 v[196:197], v181 offset:1376
    ds_read_b64_tr_b16 a[186:187], v166 offset:13312
    v_mfma_f32_32x32x16_bf16 v[128:143], a[156:159], a[212:215], v[128:143]
    ds_read_b64_tr_b16 v[198:199], v181 offset:128
    ds_read_b64_tr_b16 a[188:189], v167 offset:12288
    v_mfma_f32_32x32x16_bf16 v[144:159], a[144:147], a[216:219], v[144:159]
    ds_read_b64_tr_b16 v[200:201], v181 offset:1408
    s_lshl_b32 s46, s34, 7
    ds_read_b64_tr_b16 a[190:191], v167 offset:13312
    s_waitcnt lgkmcnt(15)
    v_mfma_f32_32x32x16_bf16 a[0:15], a[160:163], a[208:211], a[0:15]
    s_add_u32 s47, s33, 1
    ds_read_b128 a[228:231], v211
    s_lshl_b32 s47, s47, 2
    v_mfma_f32_32x32x16_bf16 a[64:79], a[160:163], a[212:215], a[64:79]
    s_add_u32 s46, s46, s47
    ds_read_b64_tr_b16 a[192:193], v164 offset:28672
    v_mfma_f32_32x32x16_bf16 a[16:31], a[164:167], a[208:211], a[16:31]
    s_add_u32 s46, s46, s3
    ds_read_b64_tr_b16 a[194:195], v164 offset:29696
    s_mul_i32 s46, s46, 40
    v_mfma_f32_32x32x16_bf16 a[80:95], a[164:167], a[212:215], a[80:95]
    s_mul_i32 s47, s32, 5
    ds_read_b64_tr_b16 a[196:197], v165 offset:28672
    s_add_u32 s46, s46, s47
    v_mfma_f32_32x32x16_bf16 a[32:47], a[168:171], a[208:211], a[32:47]
    s_lshl_b32 s46, s46, 10
    ds_read_b64_tr_b16 a[198:199], v165 offset:29696
    s_add_u32 s46, s46, 37748736
    v_mfma_f32_32x32x16_bf16 a[96:111], a[168:171], a[212:215], a[96:111]
    ds_read_b64_tr_b16 a[200:201], v166 offset:28672
    s_add_u32 s47, s46, 4096
    v_mfma_f32_32x32x16_bf16 a[48:63], a[172:175], a[208:211], a[48:63]
    s_waitcnt lgkmcnt(15)
    buffer_store_dwordx4 v[182:185], v245, s[24:27], s46 offen sc1
    ds_read_b64_tr_b16 a[202:203], v166 offset:29696
    buffer_store_dwordx4 v[186:189], v245, s[24:27], s46 offen offset:1024 sc1
    v_mfma_f32_32x32x16_bf16 a[112:127], a[172:175], a[212:215], a[112:127]
    ds_read_b64_tr_b16 a[204:205], v167 offset:28672
    s_waitcnt lgkmcnt(15)
    buffer_store_dwordx4 v[190:193], v245, s[24:27], s46 offen offset:2048 sc1
    s_waitcnt lgkmcnt(13)
    buffer_store_dwordx4 v[194:197], v245, s[24:27], s46 offen offset:3072 sc1
    v_mfma_f32_32x32x16_bf16 a[128:143], a[160:163], a[216:219], a[128:143]
    ds_read_b64_tr_b16 a[206:207], v167 offset:29696
    s_waitcnt lgkmcnt(10)
    buffer_store_dwordx4 v[198:201], v245, s[24:27], s47 offen sc1
    s_mov_b32 s36, 0
    s_mov_b32 s38, 0
    s_waitcnt lgkmcnt(8)
    v_mfma_f32_32x32x16_bf16 v[16:31], a[176:179], a[220:223], v[16:31]
    s_sub_u32 s52, 0, s52
    v_add_u32 v160, s52, v160
    v_add_u32 v161, s52, v161
    v_add_u32 v162, s52, v162
    v_add_u32 v163, s52, v163
    v_mfma_f32_32x32x16_bf16 v[80:95], a[176:179], a[224:227], v[80:95]
    v_add_u32 v208, s52, v208
    v_add_u32 v209, s52, v209
    v_add_u32 v210, s52, v210
    v_add_u32 v211, s52, v211
    v_mfma_f32_32x32x16_bf16 v[32:47], a[180:183], a[220:223], v[32:47]
    v_add_u32 v164, s52, v164
    v_add_u32 v165, s52, v165
    v_add_u32 v166, s52, v166
    v_add_u32 v167, s52, v167
    s_waitcnt vmcnt(7) lgkmcnt(0)
    s_barrier
    v_mfma_f32_32x32x16_bf16 v[96:111], a[180:183], a[224:227], v[96:111]
    ds_read_b64_tr_b16 a[160:161], v164 offset:16384
    s_add_u32 m0, s38, s82
    v_mfma_f32_32x32x16_bf16 v[48:63], a[184:187], a[220:223], v[48:63]
    ds_read_b64_tr_b16 a[162:163], v164 offset:17408
    v_mfma_f32_32x32x16_bf16 v[112:127], a[184:187], a[224:227], v[112:127]
    buffer_load_dwordx4 v232, s[16:19], s36 offen nt lds
    v_mfma_f32_32x32x16_bf16 v[64:79], a[188:191], a[220:223], v[64:79]
    ds_read_b128 a[208:211], v160
    v_mfma_f32_32x32x16_bf16 v[128:143], a[188:191], a[224:227], v[128:143]
    ds_read_b128 a[212:215], v160 offset:4096
    v_mfma_f32_32x32x16_bf16 v[144:159], a[176:179], a[228:231], v[144:159]
    buffer_load_dwordx4 v233, s[16:19], s36 offen offset:1024 nt lds
    ds_read_b64_tr_b16 a[164:165], v165 offset:16384
    v_mfma_f32_32x32x16_bf16 a[0:15], a[192:195], a[220:223], a[0:15]
    buffer_load_dwordx4 v234, s[16:19], s36 offen offset:2048 nt lds
    v_mfma_f32_32x32x16_bf16 a[64:79], a[192:195], a[224:227], a[64:79]
    ds_read_b64_tr_b16 a[166:167], v165 offset:17408
    v_mfma_f32_32x32x16_bf16 a[16:31], a[196:199], a[220:223], a[16:31]
    ds_read_b64_tr_b16 a[168:169], v166 offset:16384
    v_mfma_f32_32x32x16_bf16 a[80:95], a[196:199], a[224:227], a[80:95]
    buffer_load_dwordx4 v235, s[16:19], s36 offen offset:3072 nt lds
    v_mfma_f32_32x32x16_bf16 a[32:47], a[200:203], a[220:223], a[32:47]
    ds_read_b64_tr_b16 a[170:171], v166 offset:17408
    s_add_u32 s36, s36, 16384
    v_mfma_f32_32x32x16_bf16 a[96:111], a[200:203], a[224:227], a[96:111]
    ds_read_b64_tr_b16 a[172:173], v167 offset:16384
    v_mfma_f32_32x32x16_bf16 a[48:63], a[204:207], a[220:223], a[48:63]
    ds_read_b64_tr_b16 a[174:175], v167 offset:17408
    v_mfma_f32_32x32x16_bf16 a[112:127], a[204:207], a[224:227], a[112:127]
    s_add_u32 s42, s38, s82
    v_mfma_f32_32x32x16_bf16 a[128:143], a[192:195], a[228:231], a[128:143]
    ds_read_b128 a[216:219], v208
    s_waitcnt lgkmcnt(0)
    v_mfma_f32_32x32x16_bf16 a[0:15], a[160:163], a[208:211], a[0:15]
    ds_read_b64_tr_b16 a[192:193], v164 offset:20480
    s_add_u32 m0, s42, 16384
    v_mfma_f32_32x32x16_bf16 a[64:79], a[160:163], a[212:215], a[64:79]
    ds_read_b64_tr_b16 a[194:195], v164 offset:21504
    buffer_load_dwordx4 v213, s[20:23], 0 offen nt lds
    v_mfma_f32_32x32x16_bf16 a[16:31], a[164:167], a[208:211], a[16:31]
    ds_read_b128 a[220:223], v161
    ds_read_b128 a[224:227], v161 offset:4096
    v_mfma_f32_32x32x16_bf16 a[80:95], a[164:167], a[212:215], a[80:95]
    buffer_load_dwordx4 v213, s[20:23], 0 offen offset:1024 nt lds
    ds_read_b64_tr_b16 a[196:197], v165 offset:20480
    v_mfma_f32_32x32x16_bf16 a[32:47], a[168:171], a[208:211], a[32:47]
    buffer_load_dwordx4 v213, s[20:23], 0 offen offset:2048 nt lds
    ds_read_b64_tr_b16 a[198:199], v165 offset:21504
    v_mfma_f32_32x32x16_bf16 a[96:111], a[168:171], a[212:215], a[96:111]
    ds_read_b64_tr_b16 a[200:201], v166 offset:20480
    buffer_load_dwordx4 v213, s[20:23], 0 offen offset:3072 nt lds
    v_mfma_f32_32x32x16_bf16 a[48:63], a[172:175], a[208:211], a[48:63]
    ds_read_b64_tr_b16 a[202:203], v166 offset:21504
    s_mov_b32 s37, 8192
    v_mfma_f32_32x32x16_bf16 a[112:127], a[172:175], a[212:215], a[112:127]
    ds_read_b64_tr_b16 a[204:205], v167 offset:20480
    ds_read_b64_tr_b16 a[206:207], v167 offset:21504
    v_mfma_f32_32x32x16_bf16 a[128:143], a[160:163], a[216:219], a[128:143]
    s_add_u32 s38, s38, 32768
    ds_read_b128 a[228:231], v209
    s_waitcnt lgkmcnt(0)
    v_mfma_f32_32x32x16_bf16 a[0:15], a[192:195], a[220:223], a[0:15]
    ds_read_b64_tr_b16 a[160:161], v164 offset:24576
    s_and_b32 s38, s38, 131071
    v_mfma_f32_32x32x16_bf16 a[64:79], a[192:195], a[224:227], a[64:79]
    ds_read_b64_tr_b16 a[162:163], v164 offset:25600
    s_add_u32 m0, s38, s82
    v_mfma_f32_32x32x16_bf16 a[16:31], a[196:199], a[220:223], a[16:31]
    ds_read_b128 a[208:211], v162
    ds_read_b128 a[212:215], v162 offset:4096
    v_mfma_f32_32x32x16_bf16 a[80:95], a[196:199], a[224:227], a[80:95]
    buffer_load_dwordx4 v232, s[16:19], s36 offen nt lds
    ds_read_b64_tr_b16 a[164:165], v165 offset:24576
    v_mfma_f32_32x32x16_bf16 a[32:47], a[200:203], a[220:223], a[32:47]
    buffer_load_dwordx4 v233, s[16:19], s36 offen offset:1024 nt lds
    ds_read_b64_tr_b16 a[166:167], v165 offset:25600
    v_mfma_f32_32x32x16_bf16 a[96:111], a[200:203], a[224:227], a[96:111]
    ds_read_b64_tr_b16 a[168:169], v166 offset:24576
    buffer_load_dwordx4 v234, s[16:19], s36 offen offset:2048 nt lds
    v_mfma_f32_32x32x16_bf16 a[48:63], a[204:207], a[220:223], a[48:63]
    ds_read_b64_tr_b16 a[170:171], v166 offset:25600
    buffer_load_dwordx4 v235, s[16:19], s36 offen offset:3072 nt lds
    v_mfma_f32_32x32x16_bf16 a[112:127], a[204:207], a[224:227], a[112:127]
    ds_read_b64_tr_b16 a[172:173], v167 offset:24576
    ds_read_b64_tr_b16 a[174:175], v167 offset:25600
    v_mfma_f32_32x32x16_bf16 a[128:143], a[192:195], a[228:231], a[128:143]
    s_add_u32 s36, s36, 16384
    ds_read_b128 a[216:219], v210
    s_waitcnt lgkmcnt(0)
    v_mfma_f32_32x32x16_bf16 a[0:15], a[160:163], a[208:211], a[0:15]
    ds_read_b64_tr_b16 a[192:193], v164 offset:28672
    s_add_u32 m0, s38, s86
    ds_read_b64_tr_b16 a[194:195], v164 offset:29696
    v_mfma_f32_32x32x16_bf16 a[64:79], a[160:163], a[212:215], a[64:79]
    buffer_load_dwordx4 v236, s[20:23], s37 offen nt lds
    ds_read_b128 a[220:223], v163
    v_mfma_f32_32x32x16_bf16 a[16:31], a[164:167], a[208:211], a[16:31]
    buffer_load_dwordx4 v236, s[20:23], s37 offen offset:1024 nt lds
    ds_read_b128 a[224:227], v163 offset:4096
    v_mfma_f32_32x32x16_bf16 a[80:95], a[164:167], a[212:215], a[80:95]
    ds_read_b64_tr_b16 a[196:197], v165 offset:28672
    buffer_load_dwordx4 v236, s[20:23], s37 offen offset:2048 nt lds
    v_mfma_f32_32x32x16_bf16 a[32:47], a[168:171], a[208:211], a[32:47]
    ds_read_b64_tr_b16 a[198:199], v165 offset:29696
    buffer_load_dwordx4 v236, s[20:23], s37 offen offset:3072 nt lds
    v_mfma_f32_32x32x16_bf16 a[96:111], a[168:171], a[212:215], a[96:111]
    ds_read_b64_tr_b16 a[200:201], v166 offset:28672
    s_add_u32 s37, s37, 16384
    v_mfma_f32_32x32x16_bf16 a[48:63], a[172:175], a[208:211], a[48:63]
    ds_read_b64_tr_b16 a[202:203], v166 offset:29696
    ds_read_b64_tr_b16 a[204:205], v167 offset:28672
    v_mfma_f32_32x32x16_bf16 a[112:127], a[172:175], a[212:215], a[112:127]
    s_add_u32 s38, s38, 32768
    ds_read_b64_tr_b16 a[206:207], v167 offset:29696
    v_mfma_f32_32x32x16_bf16 a[128:143], a[160:163], a[216:219], a[128:143]
    s_and_b32 s38, s38, 131071
    ds_read_b128 a[228:231], v211
    s_waitcnt lgkmcnt(0)
    v_mfma_f32_32x32x16_bf16 a[0:15], a[192:195], a[220:223], a[0:15]
    ds_read_b64_tr_b16 a[144:145], v164
    ds_read_b64_tr_b16 a[146:147], v164 offset:1024
    v_mfma_f32_32x32x16_bf16 a[64:79], a[192:195], a[224:227], a[64:79]
    ds_read_b128 a[208:211], v160
    v_mfma_f32_32x32x16_bf16 a[16:31], a[196:199], a[220:223], a[16:31]
    ds_read_b128 a[212:215], v160 offset:4096
    v_mfma_f32_32x32x16_bf16 a[80:95], a[196:199], a[224:227], a[80:95]
    ds_read_b64_tr_b16 a[148:149], v165
    v_mfma_f32_32x32x16_bf16 a[32:47], a[200:203], a[220:223], a[32:47]
    ds_read_b64_tr_b16 a[150:151], v165 offset:1024
    ds_read_b64_tr_b16 a[152:153], v166
    v_mfma_f32_32x32x16_bf16 a[96:111], a[200:203], a[224:227], a[96:111]
    ds_read_b64_tr_b16 a[154:155], v166 offset:1024
    v_mfma_f32_32x32x16_bf16 a[48:63], a[204:207], a[220:223], a[48:63]
    ds_read_b64_tr_b16 a[156:157], v167
    v_mfma_f32_32x32x16_bf16 a[112:127], a[204:207], a[224:227], a[112:127]
    ds_read_b64_tr_b16 a[158:159], v167 offset:1024
    v_mfma_f32_32x32x16_bf16 a[128:143], a[192:195], a[228:231], a[128:143]
    ds_read_b128 a[216:219], v208
    s_waitcnt lgkmcnt(0)
    v_mfma_f32_32x32x16_bf16 v[16:31], a[144:147], a[208:211], v[16:31]
    ds_read_b64_tr_b16 a[176:177], v164 offset:4096
    v_accvgpr_read_b32 v176, a0
    v_accvgpr_read_b32 v177, a1
    v_accvgpr_read_b32 v178, a2
    v_accvgpr_read_b32 v179, a3
    v_accvgpr_read_b32 v180, a4
    v_accvgpr_read_b32 v181, a5
    v_accvgpr_read_b32 v182, a6
    ds_read_b64_tr_b16 a[178:179], v164 offset:5120
    v_accvgpr_read_b32 v183, a7
    v_mfma_f32_32x32x16_bf16 v[80:95], a[144:147], a[212:215], v[80:95]
    v_pk_mul_f32 v[176:177], v[176:177], s[44:45]
    v_pk_mul_f32 v[178:179], v[178:179], s[44:45]
    v_pk_mul_f32 v[180:181], v[180:181], s[44:45]
    v_pk_mul_f32 v[182:183], v[182:183], s[44:45]
    v_cvt_pk_bf16_f32 v192, v176, v177
    v_cvt_pk_bf16_f32 v193, v178, v179
    ds_read_b128 a[220:223], v161
    v_cvt_pk_bf16_f32 v194, v180, v181
    v_cvt_pk_bf16_f32 v195, v182, v183
    s_add_u32 s46, s54, 0
    v_mfma_f32_32x32x16_bf16 v[32:47], a[148:151], a[208:211], v[32:47]
    buffer_store_dwordx4 v[192:195], v245, s[24:27], s46 offen sc1
    v_accvgpr_read_b32 v184, a8
    v_accvgpr_read_b32 v185, a9
    v_accvgpr_read_b32 v186, a10
    ds_read_b128 a[224:227], v161 offset:4096
    v_accvgpr_read_b32 v187, a11
    v_accvgpr_read_b32 v188, a12
    v_accvgpr_read_b32 v189, a13
    v_accvgpr_read_b32 v190, a14
    v_accvgpr_read_b32 v191, a15
    v_mfma_f32_32x32x16_bf16 v[96:111], a[148:151], a[212:215], v[96:111]
    v_pk_mul_f32 v[184:185], v[184:185], s[44:45]
    v_pk_mul_f32 v[186:187], v[186:187], s[44:45]
    ds_read_b64_tr_b16 a[180:181], v165 offset:4096
    v_pk_mul_f32 v[188:189], v[188:189], s[44:45]
    v_pk_mul_f32 v[190:191], v[190:191], s[44:45]
    v_cvt_pk_bf16_f32 v196, v184, v185
    v_cvt_pk_bf16_f32 v197, v186, v187
    v_cvt_pk_bf16_f32 v198, v188, v189
    v_cvt_pk_bf16_f32 v199, v190, v191
    buffer_store_dwordx4 v[196:199], v245, s[24:27], s46 offen offset:1024 sc1
    v_mfma_f32_32x32x16_bf16 v[48:63], a[152:155], a[208:211], v[48:63]
    ds_read_b64_tr_b16 a[182:183], v165 offset:5120
    v_accvgpr_read_b32 v176, a16
    v_accvgpr_read_b32 v177, a17
    v_accvgpr_read_b32 v178, a18
    v_accvgpr_read_b32 v179, a19
    v_accvgpr_read_b32 v180, a20
    v_accvgpr_read_b32 v181, a21
    v_accvgpr_read_b32 v182, a22
    ds_read_b64_tr_b16 a[184:185], v166 offset:4096
    v_mfma_f32_32x32x16_bf16 v[112:127], a[152:155], a[212:215], v[112:127]
    v_accvgpr_read_b32 v183, a23
    v_pk_mul_f32 v[176:177], v[176:177], s[44:45]
    v_pk_mul_f32 v[178:179], v[178:179], s[44:45]
    v_pk_mul_f32 v[180:181], v[180:181], s[44:45]
    v_pk_mul_f32 v[182:183], v[182:183], s[44:45]
    v_cvt_pk_bf16_f32 v192, v176, v177
    v_cvt_pk_bf16_f32 v193, v178, v179
    ds_read_b64_tr_b16 a[186:187], v166 offset:5120
    v_cvt_pk_bf16_f32 v194, v180, v181
    v_cvt_pk_bf16_f32 v195, v182, v183
    v_mfma_f32_32x32x16_bf16 v[64:79], a[156:159], a[208:211], v[64:79]
    buffer_store_dwordx4 v[192:195], v245, s[24:27], s46 offen offset:2048 sc1
    v_accvgpr_read_b32 v184, a24
    v_accvgpr_read_b32 v185, a25
    v_accvgpr_read_b32 v186, a26
    v_accvgpr_read_b32 v187, a27
    ds_read_b64_tr_b16 a[188:189], v167 offset:4096
    v_accvgpr_read_b32 v188, a28
    v_accvgpr_read_b32 v189, a29
    v_accvgpr_read_b32 v190, a30
    v_accvgpr_read_b32 v191, a31
    v_mfma_f32_32x32x16_bf16 v[128:143], a[156:159], a[212:215], v[128:143]
    v_pk_mul_f32 v[184:185], v[184:185], s[44:45]
    v_pk_mul_f32 v[186:187], v[186:187], s[44:45]
    v_pk_mul_f32 v[188:189], v[188:189], s[44:45]
    ds_read_b64_tr_b16 a[190:191], v167 offset:5120
    v_pk_mul_f32 v[190:191], v[190:191], s[44:45]
    v_cvt_pk_bf16_f32 v196, v184, v185
    v_cvt_pk_bf16_f32 v197, v186, v187
    v_cvt_pk_bf16_f32 v198, v188, v189
    v_cvt_pk_bf16_f32 v199, v190, v191
    buffer_store_dwordx4 v[196:199], v245, s[24:27], s46 offen offset:3072 sc1
    v_mfma_f32_32x32x16_bf16 v[144:159], a[144:147], a[216:219], v[144:159]
    v_accvgpr_read_b32 v176, a32
    ds_read_b128 a[228:231], v209
    v_accvgpr_read_b32 v177, a33
    v_accvgpr_read_b32 v178, a34
    v_accvgpr_read_b32 v179, a35
    v_accvgpr_read_b32 v180, a36
    v_accvgpr_read_b32 v181, a37
    v_accvgpr_read_b32 v182, a38
    v_accvgpr_read_b32 v183, a39
    s_waitcnt lgkmcnt(0)
    v_mfma_f32_32x32x16_bf16 v[16:31], a[176:179], a[220:223], v[16:31]
    ds_read_b64_tr_b16 a[144:145], v164 offset:8192
    v_pk_mul_f32 v[176:177], v[176:177], s[44:45]
    v_pk_mul_f32 v[178:179], v[178:179], s[44:45]
    v_pk_mul_f32 v[180:181], v[180:181], s[44:45]
    v_pk_mul_f32 v[182:183], v[182:183], s[44:45]
    v_cvt_pk_bf16_f32 v192, v176, v177
    v_cvt_pk_bf16_f32 v193, v178, v179
    v_cvt_pk_bf16_f32 v194, v180, v181
    v_cvt_pk_bf16_f32 v195, v182, v183
    ds_read_b64_tr_b16 a[146:147], v164 offset:9216
    v_mfma_f32_32x32x16_bf16 v[80:95], a[176:179], a[224:227], v[80:95]
    s_add_u32 s46, s54, 4096
    buffer_store_dwordx4 v[192:195], v245, s[24:27], s46 offen sc1
    v_accvgpr_read_b32 v184, a40
    v_accvgpr_read_b32 v185, a41
    v_accvgpr_read_b32 v186, a42
    v_accvgpr_read_b32 v187, a43
    v_accvgpr_read_b32 v188, a44
    ds_read_b128 a[208:211], v162
    v_accvgpr_read_b32 v189, a45
    v_accvgpr_read_b32 v190, a46
    v_mfma_f32_32x32x16_bf16 v[32:47], a[180:183], a[220:223], v[32:47]
    v_accvgpr_read_b32 v191, a47
    v_pk_mul_f32 v[184:185], v[184:185], s[44:45]
    v_pk_mul_f32 v[186:187], v[186:187], s[44:45]
    v_pk_mul_f32 v[188:189], v[188:189], s[44:45]
    v_pk_mul_f32 v[190:191], v[190:191], s[44:45]
    ds_read_b128 a[212:215], v162 offset:4096
    v_cvt_pk_bf16_f32 v196, v184, v185
    v_cvt_pk_bf16_f32 v197, v186, v187
    v_cvt_pk_bf16_f32 v198, v188, v189
    v_cvt_pk_bf16_f32 v199, v190, v191
    v_mfma_f32_32x32x16_bf16 v[96:111], a[180:183], a[224:227], v[96:111]
    buffer_store_dwordx4 v[196:199], v245, s[24:27], s46 offen offset:1024 sc1
    v_accvgpr_read_b32 v176, a48
    v_accvgpr_read_b32 v177, a49
    ds_read_b64_tr_b16 a[148:149], v165 offset:8192
    v_accvgpr_read_b32 v178, a50
    v_accvgpr_read_b32 v179, a51
    v_accvgpr_read_b32 v180, a52
    v_accvgpr_read_b32 v181, a53
    v_accvgpr_read_b32 v182, a54
    v_accvgpr_read_b32 v183, a55
    v_mfma_f32_32x32x16_bf16 v[48:63], a[184:187], a[220:223], v[48:63]
    v_pk_mul_f32 v[176:177], v[176:177], s[44:45]
    ds_read_b64_tr_b16 a[150:151], v165 offset:9216
    v_pk_mul_f32 v[178:179], v[178:179], s[44:45]
    v_pk_mul_f32 v[180:181], v[180:181], s[44:45]
    v_pk_mul_f32 v[182:183], v[182:183], s[44:45]
    v_cvt_pk_bf16_f32 v192, v176, v177
    v_cvt_pk_bf16_f32 v193, v178, v179
    v_cvt_pk_bf16_f32 v194, v180, v181
    v_cvt_pk_bf16_f32 v195, v182, v183
    ds_read_b64_tr_b16 a[152:153], v166 offset:8192
    v_mfma_f32_32x32x16_bf16 v[112:127], a[184:187], a[224:227], v[112:127]
    buffer_store_dwordx4 v[192:195], v245, s[24:27], s46 offen offset:2048 sc1
    v_accvgpr_read_b32 v184, a56
    v_accvgpr_read_b32 v185, a57
    v_accvgpr_read_b32 v186, a58
    v_accvgpr_read_b32 v187, a59
    v_accvgpr_read_b32 v188, a60
    v_accvgpr_read_b32 v189, a61
    ds_read_b64_tr_b16 a[154:155], v166 offset:9216
    v_accvgpr_read_b32 v190, a62
    v_accvgpr_read_b32 v191, a63
    v_mfma_f32_32x32x16_bf16 v[64:79], a[188:191], a[220:223], v[64:79]
    v_pk_mul_f32 v[184:185], v[184:185], s[44:45]
    v_pk_mul_f32 v[186:187], v[186:187], s[44:45]
    v_pk_mul_f32 v[188:189], v[188:189], s[44:45]
    v_pk_mul_f32 v[190:191], v[190:191], s[44:45]
    v_cvt_pk_bf16_f32 v196, v184, v185
    ds_read_b64_tr_b16 a[156:157], v167 offset:8192
    v_cvt_pk_bf16_f32 v197, v186, v187
    v_cvt_pk_bf16_f32 v198, v188, v189
    v_cvt_pk_bf16_f32 v199, v190, v191
    buffer_store_dwordx4 v[196:199], v245, s[24:27], s46 offen offset:3072 sc1
    v_mfma_f32_32x32x16_bf16 v[128:143], a[188:191], a[224:227], v[128:143]
    v_accvgpr_read_b32 v176, a64
    v_accvgpr_read_b32 v177, a65
    v_accvgpr_read_b32 v178, a66
    ds_read_b64_tr_b16 a[158:159], v167 offset:9216
    v_accvgpr_read_b32 v179, a67
    v_accvgpr_read_b32 v180, a68
    v_accvgpr_read_b32 v181, a69
    v_accvgpr_read_b32 v182, a70
    v_accvgpr_read_b32 v183, a71
    v_pk_mul_f32 v[176:177], v[176:177], s[44:45]
    v_mfma_f32_32x32x16_bf16 v[144:159], a[176:179], a[228:231], v[144:159]
    v_pk_mul_f32 v[178:179], v[178:179], s[44:45]
    ds_read_b128 a[216:219], v210
    v_pk_mul_f32 v[180:181], v[180:181], s[44:45]
    v_pk_mul_f32 v[182:183], v[182:183], s[44:45]
    v_cvt_pk_bf16_f32 v192, v176, v177
    v_cvt_pk_bf16_f32 v193, v178, v179
    v_cvt_pk_bf16_f32 v194, v180, v181
    v_cvt_pk_bf16_f32 v195, v182, v183
    s_add_u32 s46, s54, 8192
    s_waitcnt lgkmcnt(0)
    v_mfma_f32_32x32x16_bf16 v[16:31], a[144:147], a[208:211], v[16:31]
    ds_read_b64_tr_b16 a[176:177], v164 offset:12288
    buffer_store_dwordx4 v[192:195], v245, s[24:27], s46 offen sc1
    v_accvgpr_read_b32 v184, a72
    v_accvgpr_read_b32 v185, a73
    v_accvgpr_read_b32 v186, a74
    v_accvgpr_read_b32 v187, a75
    v_accvgpr_read_b32 v188, a76
    v_accvgpr_read_b32 v189, a77
    v_accvgpr_read_b32 v190, a78
    ds_read_b64_tr_b16 a[178:179], v164 offset:13312
    v_mfma_f32_32x32x16_bf16 v[80:95], a[144:147], a[212:215], v[80:95]
    v_accvgpr_read_b32 v191, a79
    v_pk_mul_f32 v[184:185], v[184:185], s[44:45]
    v_pk_mul_f32 v[186:187], v[186:187], s[44:45]
    v_pk_mul_f32 v[188:189], v[188:189], s[44:45]
    v_pk_mul_f32 v[190:191], v[190:191], s[44:45]
    v_cvt_pk_bf16_f32 v196, v184, v185
    v_cvt_pk_bf16_f32 v197, v186, v187
    ds_read_b128 a[220:223], v163
    v_cvt_pk_bf16_f32 v198, v188, v189
    v_cvt_pk_bf16_f32 v199, v190, v191
    v_mfma_f32_32x32x16_bf16 v[32:47], a[148:151], a[208:211], v[32:47]
    buffer_store_dwordx4 v[196:199], v245, s[24:27], s46 offen offset:1024 sc1
    v_accvgpr_read_b32 v176, a80
    v_accvgpr_read_b32 v177, a81
    v_accvgpr_read_b32 v178, a82
    v_accvgpr_read_b32 v179, a83
    ds_read_b128 a[224:227], v163 offset:4096
    v_accvgpr_read_b32 v180, a84
    v_accvgpr_read_b32 v181, a85
    v_accvgpr_read_b32 v182, a86
    v_accvgpr_read_b32 v183, a87
    v_mfma_f32_32x32x16_bf16 v[96:111], a[148:151], a[212:215], v[96:111]
    v_pk_mul_f32 v[176:177], v[176:177], s[44:45]
    v_pk_mul_f32 v[178:179], v[178:179], s[44:45]
    v_pk_mul_f32 v[180:181], v[180:181], s[44:45]
    ds_read_b64_tr_b16 a[180:181], v165 offset:12288
    v_pk_mul_f32 v[182:183], v[182:183], s[44:45]
    v_cvt_pk_bf16_f32 v192, v176, v177
    v_cvt_pk_bf16_f32 v193, v178, v179
    v_cvt_pk_bf16_f32 v194, v180, v181
    v_cvt_pk_bf16_f32 v195, v182, v183
    buffer_store_dwordx4 v[192:195], v245, s[24:27], s46 offen offset:2048 sc1
    v_mfma_f32_32x32x16_bf16 v[48:63], a[152:155], a[208:211], v[48:63]
    v_accvgpr_read_b32 v184, a88
    ds_read_b64_tr_b16 a[182:183], v165 offset:13312
    v_accvgpr_read_b32 v185, a89
    v_accvgpr_read_b32 v186, a90
    v_accvgpr_read_b32 v187, a91
    v_accvgpr_read_b32 v188, a92
    v_accvgpr_read_b32 v189, a93
    v_accvgpr_read_b32 v190, a94
    v_accvgpr_read_b32 v191, a95
    ds_read_b64_tr_b16 a[184:185], v166 offset:12288
    v_mfma_f32_32x32x16_bf16 v[112:127], a[152:155], a[212:215], v[112:127]
    v_pk_mul_f32 v[184:185], v[184:185], s[44:45]
    v_pk_mul_f32 v[186:187], v[186:187], s[44:45]
    v_pk_mul_f32 v[188:189], v[188:189], s[44:45]
    v_pk_mul_f32 v[190:191], v[190:191], s[44:45]
    v_cvt_pk_bf16_f32 v196, v184, v185
    v_cvt_pk_bf16_f32 v197, v186, v187
    v_cvt_pk_bf16_f32 v198, v188, v189
    ds_read_b64_tr_b16 a[186:187], v166 offset:13312
    v_cvt_pk_bf16_f32 v199, v190, v191
    buffer_store_dwordx4 v[196:199], v245, s[24:27], s46 offen offset:3072 sc1
    v_mfma_f32_32x32x16_bf16 v[64:79], a[156:159], a[208:211], v[64:79]
    v_accvgpr_read_b32 v176, a96
    v_accvgpr_read_b32 v177, a97
    v_accvgpr_read_b32 v178, a98
    v_accvgpr_read_b32 v179, a99
    v_accvgpr_read_b32 v180, a100
    ds_read_b64_tr_b16 a[188:189], v167 offset:12288
    v_accvgpr_read_b32 v181, a101
    v_accvgpr_read_b32 v182, a102
    v_accvgpr_read_b32 v183, a103
    v_pk_mul_f32 v[176:177], v[176:177], s[44:45]
    v_mfma_f32_32x32x16_bf16 v[128:143], a[156:159], a[212:215], v[128:143]
    v_pk_mul_f32 v[178:179], v[178:179], s[44:45]
    v_pk_mul_f32 v[180:181], v[180:181], s[44:45]
    v_pk_mul_f32 v[182:183], v[182:183], s[44:45]
    ds_read_b64_tr_b16 a[190:191], v167 offset:13312
    v_cvt_pk_bf16_f32 v192, v176, v177
    v_cvt_pk_bf16_f32 v193, v178, v179
    v_cvt_pk_bf16_f32 v194, v180, v181
    v_cvt_pk_bf16_f32 v195, v182, v183
    s_add_u32 s46, s54, 12288
    buffer_store_dwordx4 v[192:195], v245, s[24:27], s46 offen sc1
    v_mfma_f32_32x32x16_bf16 v[144:159], a[144:147], a[216:219], v[144:159]
    v_accvgpr_read_b32 v184, a104
    ds_read_b128 a[228:231], v211
    v_accvgpr_read_b32 v185, a105
    v_accvgpr_read_b32 v186, a106
    v_accvgpr_read_b32 v187, a107
    v_accvgpr_read_b32 v188, a108
    v_accvgpr_read_b32 v189, a109
    v_accvgpr_read_b32 v190, a110
    v_accvgpr_read_b32 v191, a111
    s_waitcnt lgkmcnt(0)
    v_mfma_f32_32x32x16_bf16 v[16:31], a[176:179], a[220:223], v[16:31]
    v_pk_mul_f32 v[184:185], v[184:185], s[44:45]
    v_pk_mul_f32 v[186:187], v[186:187], s[44:45]
    v_pk_mul_f32 v[188:189], v[188:189], s[44:45]
    v_pk_mul_f32 v[190:191], v[190:191], s[44:45]
    v_cvt_pk_bf16_f32 v196, v184, v185
    v_cvt_pk_bf16_f32 v197, v186, v187
    v_cvt_pk_bf16_f32 v198, v188, v189
    v_cvt_pk_bf16_f32 v199, v190, v191
    buffer_store_dwordx4 v[196:199], v245, s[24:27], s46 offen offset:1024 sc1
    v_mfma_f32_32x32x16_bf16 v[80:95], a[176:179], a[224:227], v[80:95]
    v_accvgpr_read_b32 v176, a112
    v_accvgpr_read_b32 v177, a113
    v_accvgpr_read_b32 v178, a114
    v_accvgpr_read_b32 v179, a115
    v_accvgpr_read_b32 v180, a116
    v_accvgpr_read_b32 v181, a117
    v_accvgpr_read_b32 v182, a118
    v_accvgpr_read_b32 v183, a119
    v_pk_mul_f32 v[176:177], v[176:177], s[44:45]
    v_mfma_f32_32x32x16_bf16 v[32:47], a[180:183], a[220:223], v[32:47]
    v_pk_mul_f32 v[178:179], v[178:179], s[44:45]
    v_pk_mul_f32 v[180:181], v[180:181], s[44:45]
    v_pk_mul_f32 v[182:183], v[182:183], s[44:45]
    v_cvt_pk_bf16_f32 v192, v176, v177
    v_cvt_pk_bf16_f32 v193, v178, v179
    v_cvt_pk_bf16_f32 v194, v180, v181
    v_cvt_pk_bf16_f32 v195, v182, v183
    buffer_store_dwordx4 v[192:195], v245, s[24:27], s46 offen offset:2048 sc1
    v_mfma_f32_32x32x16_bf16 v[96:111], a[180:183], a[224:227], v[96:111]
    v_accvgpr_read_b32 v184, a120
    v_accvgpr_read_b32 v185, a121
    v_accvgpr_read_b32 v186, a122
    v_accvgpr_read_b32 v187, a123
    v_accvgpr_read_b32 v188, a124
    v_accvgpr_read_b32 v189, a125
    v_accvgpr_read_b32 v190, a126
    v_accvgpr_read_b32 v191, a127
    v_pk_mul_f32 v[184:185], v[184:185], s[44:45]
    v_mfma_f32_32x32x16_bf16 v[48:63], a[184:187], a[220:223], v[48:63]
    v_pk_mul_f32 v[186:187], v[186:187], s[44:45]
    v_pk_mul_f32 v[188:189], v[188:189], s[44:45]
    v_pk_mul_f32 v[190:191], v[190:191], s[44:45]
    v_cvt_pk_bf16_f32 v196, v184, v185
    v_cvt_pk_bf16_f32 v197, v186, v187
    v_cvt_pk_bf16_f32 v198, v188, v189
    v_cvt_pk_bf16_f32 v199, v190, v191
    buffer_store_dwordx4 v[196:199], v245, s[24:27], s46 offen offset:3072 sc1
    v_accvgpr_read_b32 v176, a128
    v_mfma_f32_32x32x16_bf16 v[112:127], a[184:187], a[224:227], v[112:127]
    v_accvgpr_read_b32 v177, a129
    v_accvgpr_read_b32 v178, a130
    v_accvgpr_read_b32 v179, a131
    v_accvgpr_read_b32 v180, a132
    v_accvgpr_read_b32 v181, a133
    v_accvgpr_read_b32 v182, a134
    v_accvgpr_read_b32 v183, a135
    v_pk_mul_f32 v[176:177], v[176:177], s[44:45]
    v_mfma_f32_32x32x16_bf16 v[64:79], a[188:191], a[220:223], v[64:79]
    v_pk_mul_f32 v[178:179], v[178:179], s[44:45]
    v_pk_mul_f32 v[180:181], v[180:181], s[44:45]
    v_pk_mul_f32 v[182:183], v[182:183], s[44:45]
    v_cvt_pk_bf16_f32 v192, v176, v177
    v_cvt_pk_bf16_f32 v193, v178, v179
    v_cvt_pk_bf16_f32 v194, v180, v181
    v_cvt_pk_bf16_f32 v195, v182, v183
    s_add_u32 s46, s54, 16384
    buffer_store_dwordx4 v[192:195], v245, s[24:27], s46 offen sc1
    v_mfma_f32_32x32x16_bf16 v[128:143], a[188:191], a[224:227], v[128:143]
    v_accvgpr_read_b32 v184, a136
    v_accvgpr_read_b32 v185, a137
    v_accvgpr_read_b32 v186, a138
    v_accvgpr_read_b32 v187, a139
    v_accvgpr_read_b32 v188, a140
    v_accvgpr_read_b32 v189, a141
    v_accvgpr_read_b32 v190, a142
    v_accvgpr_read_b32 v191, a143
    v_pk_mul_f32 v[184:185], v[184:185], s[44:45]
    v_mfma_f32_32x32x16_bf16 v[144:159], a[176:179], a[228:231], v[144:159]
    v_pk_mul_f32 v[186:187], v[186:187], s[44:45]
    v_pk_mul_f32 v[188:189], v[188:189], s[44:45]
    v_pk_mul_f32 v[190:191], v[190:191], s[44:45]
    v_cvt_pk_bf16_f32 v196, v184, v185
    v_cvt_pk_bf16_f32 v197, v186, v187
    v_cvt_pk_bf16_f32 v198, v188, v189
    v_cvt_pk_bf16_f32 v199, v190, v191
    buffer_store_dwordx4 v[196:199], v245, s[24:27], s46 offen offset:1024 sc1
    s_waitcnt lgkmcnt(0)
    s_barrier
    s_add_u32 m0, s38, s82
    s_nop 0
    buffer_load_dwordx4 v232, s[16:19], s36 offen nt lds
    buffer_load_dwordx4 v233, s[16:19], s36 offen offset:1024 nt lds
    buffer_load_dwordx4 v234, s[16:19], s36 offen offset:2048 nt lds
    buffer_load_dwordx4 v235, s[16:19], s36 offen offset:3072 nt lds
    s_add_u32 s36, s36, 16384
    s_add_u32 m0, s38, s86
    s_nop 0
    buffer_load_dwordx4 v236, s[20:23], s37 offen nt lds
    buffer_load_dwordx4 v236, s[20:23], s37 offen offset:1024 nt lds
    buffer_load_dwordx4 v236, s[20:23], s37 offen offset:2048 nt lds
    buffer_load_dwordx4 v236, s[20:23], s37 offen offset:3072 nt lds
    s_add_u32 s37, s37, 16384
    s_add_u32 s38, s38, 32768
    s_and_b32 s38, s38, 131071
    v_pk_mul_f32 v[16:17], v[16:17], s[44:45]
    v_pk_mul_f32 v[18:19], v[18:19], s[44:45]
    v_pk_mul_f32 v[20:21], v[20:21], s[44:45]
    v_pk_mul_f32 v[22:23], v[22:23], s[44:45]
    v_pk_mul_f32 v[24:25], v[24:25], s[44:45]
    v_pk_mul_f32 v[26:27], v[26:27], s[44:45]
    v_pk_mul_f32 v[28:29], v[28:29], s[44:45]
    v_pk_mul_f32 v[30:31], v[30:31], s[44:45]
    v_pk_mul_f32 v[32:33], v[32:33], s[44:45]
    v_pk_mul_f32 v[34:35], v[34:35], s[44:45]
    v_pk_mul_f32 v[36:37], v[36:37], s[44:45]
    v_pk_mul_f32 v[38:39], v[38:39], s[44:45]
    v_pk_mul_f32 v[40:41], v[40:41], s[44:45]
    v_pk_mul_f32 v[42:43], v[42:43], s[44:45]
    v_pk_mul_f32 v[44:45], v[44:45], s[44:45]
    v_pk_mul_f32 v[46:47], v[46:47], s[44:45]
    v_pk_mul_f32 v[48:49], v[48:49], s[44:45]
    v_pk_mul_f32 v[50:51], v[50:51], s[44:45]
    v_pk_mul_f32 v[52:53], v[52:53], s[44:45]
    v_pk_mul_f32 v[54:55], v[54:55], s[44:45]
    v_pk_mul_f32 v[56:57], v[56:57], s[44:45]
    v_pk_mul_f32 v[58:59], v[58:59], s[44:45]
    v_pk_mul_f32 v[60:61], v[60:61], s[44:45]
    v_pk_mul_f32 v[62:63], v[62:63], s[44:45]
    v_pk_mul_f32 v[64:65], v[64:65], s[44:45]
    v_pk_mul_f32 v[66:67], v[66:67], s[44:45]
    v_pk_mul_f32 v[68:69], v[68:69], s[44:45]
    v_pk_mul_f32 v[70:71], v[70:71], s[44:45]
    v_pk_mul_f32 v[72:73], v[72:73], s[44:45]
    v_pk_mul_f32 v[74:75], v[74:75], s[44:45]
    v_pk_mul_f32 v[76:77], v[76:77], s[44:45]
    v_pk_mul_f32 v[78:79], v[78:79], s[44:45]
    v_cvt_pk_bf16_f32 v16, v16, v17
    v_cvt_pk_bf16_f32 v17, v18, v19
    v_cvt_pk_bf16_f32 v18, v20, v21
    v_cvt_pk_bf16_f32 v19, v22, v23
    v_cvt_pk_bf16_f32 v20, v24, v25
    v_cvt_pk_bf16_f32 v21, v26, v27
    v_cvt_pk_bf16_f32 v22, v28, v29
    v_cvt_pk_bf16_f32 v23, v30, v31
    v_cvt_pk_bf16_f32 v24, v32, v33
    v_cvt_pk_bf16_f32 v25, v34, v35
    v_cvt_pk_bf16_f32 v26, v36, v37
    v_cvt_pk_bf16_f32 v27, v38, v39
    v_cvt_pk_bf16_f32 v28, v40, v41
    v_cvt_pk_bf16_f32 v29, v42, v43
    v_cvt_pk_bf16_f32 v30, v44, v45
    v_cvt_pk_bf16_f32 v31, v46, v47
    v_cvt_pk_bf16_f32 v32, v48, v49
    v_cvt_pk_bf16_f32 v33, v50, v51
    v_cvt_pk_bf16_f32 v34, v52, v53
    v_cvt_pk_bf16_f32 v35, v54, v55
    v_cvt_pk_bf16_f32 v36, v56, v57
    v_cvt_pk_bf16_f32 v37, v58, v59
    v_cvt_pk_bf16_f32 v38, v60, v61
    v_cvt_pk_bf16_f32 v39, v62, v63
    v_cvt_pk_bf16_f32 v40, v64, v65
    v_cvt_pk_bf16_f32 v41, v66, v67
    v_cvt_pk_bf16_f32 v42, v68, v69
    v_cvt_pk_bf16_f32 v43, v70, v71
    v_cvt_pk_bf16_f32 v44, v72, v73
    v_cvt_pk_bf16_f32 v45, v74, v75
    v_cvt_pk_bf16_f32 v46, v76, v77
    v_cvt_pk_bf16_f32 v47, v78, v79
    v_pk_mul_f32 v[80:81], v[80:81], s[44:45]
    v_pk_mul_f32 v[82:83], v[82:83], s[44:45]
    v_pk_mul_f32 v[84:85], v[84:85], s[44:45]
    v_pk_mul_f32 v[86:87], v[86:87], s[44:45]
    v_pk_mul_f32 v[88:89], v[88:89], s[44:45]
    v_pk_mul_f32 v[90:91], v[90:91], s[44:45]
    v_pk_mul_f32 v[92:93], v[92:93], s[44:45]
    v_pk_mul_f32 v[94:95], v[94:95], s[44:45]
    v_pk_mul_f32 v[96:97], v[96:97], s[44:45]
    v_pk_mul_f32 v[98:99], v[98:99], s[44:45]
    v_pk_mul_f32 v[100:101], v[100:101], s[44:45]
    v_pk_mul_f32 v[102:103], v[102:103], s[44:45]
    v_pk_mul_f32 v[104:105], v[104:105], s[44:45]
    v_pk_mul_f32 v[106:107], v[106:107], s[44:45]
    v_pk_mul_f32 v[108:109], v[108:109], s[44:45]
    v_pk_mul_f32 v[110:111], v[110:111], s[44:45]
    v_pk_mul_f32 v[112:113], v[112:113], s[44:45]
    v_pk_mul_f32 v[114:115], v[114:115], s[44:45]
    v_pk_mul_f32 v[116:117], v[116:117], s[44:45]
    v_pk_mul_f32 v[118:119], v[118:119], s[44:45]
    v_pk_mul_f32 v[120:121], v[120:121], s[44:45]
    v_pk_mul_f32 v[122:123], v[122:123], s[44:45]
    v_pk_mul_f32 v[124:125], v[124:125], s[44:45]
    v_pk_mul_f32 v[126:127], v[126:127], s[44:45]
    v_pk_mul_f32 v[128:129], v[128:129], s[44:45]
    v_pk_mul_f32 v[130:131], v[130:131], s[44:45]
    v_pk_mul_f32 v[132:133], v[132:133], s[44:45]
    v_pk_mul_f32 v[134:135], v[134:135], s[44:45]
    v_pk_mul_f32 v[136:137], v[136:137], s[44:45]
    v_pk_mul_f32 v[138:139], v[138:139], s[44:45]
    v_pk_mul_f32 v[140:141], v[140:141], s[44:45]
    v_pk_mul_f32 v[142:143], v[142:143], s[44:45]
    v_cvt_pk_bf16_f32 v80, v80, v81
    v_cvt_pk_bf16_f32 v81, v82, v83
    v_cvt_pk_bf16_f32 v82, v84, v85
    v_cvt_pk_bf16_f32 v83, v86, v87
    v_cvt_pk_bf16_f32 v84, v88, v89
    v_cvt_pk_bf16_f32 v85, v90, v91
    v_cvt_pk_bf16_f32 v86, v92, v93
    v_cvt_pk_bf16_f32 v87, v94, v95
    v_cvt_pk_bf16_f32 v88, v96, v97
    v_cvt_pk_bf16_f32 v89, v98, v99
    v_cvt_pk_bf16_f32 v90, v100, v101
    v_cvt_pk_bf16_f32 v91, v102, v103
    v_cvt_pk_bf16_f32 v92, v104, v105
    v_cvt_pk_bf16_f32 v93, v106, v107
    v_cvt_pk_bf16_f32 v94, v108, v109
    v_cvt_pk_bf16_f32 v95, v110, v111
    v_cvt_pk_bf16_f32 v96, v112, v113
    v_cvt_pk_bf16_f32 v97, v114, v115
    v_cvt_pk_bf16_f32 v98, v116, v117
    v_cvt_pk_bf16_f32 v99, v118, v119
    v_cvt_pk_bf16_f32 v100, v120, v121
    v_cvt_pk_bf16_f32 v101, v122, v123
    v_cvt_pk_bf16_f32 v102, v124, v125
    v_cvt_pk_bf16_f32 v103, v126, v127
    v_cvt_pk_bf16_f32 v104, v128, v129
    v_cvt_pk_bf16_f32 v105, v130, v131
    v_cvt_pk_bf16_f32 v106, v132, v133
    v_cvt_pk_bf16_f32 v107, v134, v135
    v_cvt_pk_bf16_f32 v108, v136, v137
    v_cvt_pk_bf16_f32 v109, v138, v139
    v_cvt_pk_bf16_f32 v110, v140, v141
    v_cvt_pk_bf16_f32 v111, v142, v143
    v_pk_mul_f32 v[144:145], v[144:145], s[44:45]
    v_pk_mul_f32 v[146:147], v[146:147], s[44:45]
    v_pk_mul_f32 v[148:149], v[148:149], s[44:45]
    v_pk_mul_f32 v[150:151], v[150:151], s[44:45]
    v_pk_mul_f32 v[152:153], v[152:153], s[44:45]
    v_pk_mul_f32 v[154:155], v[154:155], s[44:45]
    v_pk_mul_f32 v[156:157], v[156:157], s[44:45]
    v_pk_mul_f32 v[158:159], v[158:159], s[44:45]
    v_cvt_pk_bf16_f32 v184, v144, v145
    v_cvt_pk_bf16_f32 v185, v146, v147
    v_cvt_pk_bf16_f32 v186, v148, v149
    v_cvt_pk_bf16_f32 v187, v150, v151
    v_cvt_pk_bf16_f32 v188, v152, v153
    v_cvt_pk_bf16_f32 v189, v154, v155
    v_cvt_pk_bf16_f32 v190, v156, v157
    v_cvt_pk_bf16_f32 v191, v158, v159
    ds_write_b128 v254, v[184:187]
    ds_write_b128 v254, v[188:191] offset:1024
    s_waitcnt vmcnt(16) lgkmcnt(0)
    s_barrier
    ds_read_b128 a[192:195], v220
    ds_read_b128 a[196:199], v221
    ds_read_b128 a[200:203], v222
    ds_read_b128 a[204:207], v223
    ds_read_b128 a[208:211], v224
    ds_read_b128 a[212:215], v225
    ds_read_b128 a[216:219], v226
    ds_read_b128 a[220:223], v227
    s_waitcnt lgkmcnt(0)
    s_cmp_eq_u32 s3, 1
    s_cbranch_scc1 WAVE1
    s_cmp_eq_u32 s3, 2
    s_cbranch_scc1 WAVE2
    s_cmp_eq_u32 s3, 3
    s_cbranch_scc1 WAVE3
WAVE0:
W0_ITEM:
    v_mov_b32 v239, 0
    v_mov_b32 v240, 0
    v_mov_b32 v241, 0
    s_waitcnt vmcnt(33)
    v_mfma_f32_32x32x16_bf16 v[48:63], a[192:195], v[16:19], 0
    s_waitcnt vmcnt(32)
    v_mfma_f32_32x32x16_bf16 v[48:63], a[196:199], v[20:23], v[48:63]
    s_waitcnt vmcnt(31)
    v_mfma_f32_32x32x16_bf16 v[48:63], a[200:203], v[24:27], v[48:63]
    s_add_u32 m0, s38, s82
    s_waitcnt vmcnt(30)
    v_mfma_f32_32x32x16_bf16 v[48:63], a[204:207], v[28:31], v[48:63]
    buffer_load_dwordx4 v232, s[16:19], s36 offen nt lds
    s_waitcnt vmcnt(30)
    v_mfma_f32_32x32x16_bf16 v[48:63], a[208:211], v[32:35], v[48:63]
    s_waitcnt vmcnt(29)
    v_mfma_f32_32x32x16_bf16 v[48:63], a[212:215], v[36:39], v[48:63]
    s_waitcnt vmcnt(28)
    v_mfma_f32_32x32x16_bf16 v[48:63], a[216:219], v[40:43], v[48:63]
    s_waitcnt vmcnt(27)
    v_mfma_f32_32x32x16_bf16 v[48:63], a[220:223], v[44:47], v[48:63]
    ds_read_b128 v[184:187], v237
    ds_read_b128 v[188:191], v237 offset:1024
    buffer_load_dwordx4 v233, s[16:19], s36 offen offset:1024 nt lds
    s_nop 8
    v_max3_f32 v2, v48, v49, v50
    v_max3_f32 v2, v2, v51, v52
    v_max3_f32 v2, v2, v53, v54
    v_max3_f32 v2, v2, v55, v56
    v_max3_f32 v2, v2, v57, v58
    v_max3_f32 v2, v2, v59, v60
    v_max3_f32 v2, v2, v61, v62
    v_max_f32 v2, v2, v63
    v_mov_b32 v3, v2
    s_nop 1
    v_permlane32_swap_b32 v2, v3
    v_max_f32 v2, v2, v3
    v_sub_f32 v64, 0, v2
    v_sub_f32 v65, 0, v2
    v_sub_f32 v66, 0, v2
    v_sub_f32 v67, 0, v2
    v_sub_f32 v68, 0, v2
    v_sub_f32 v69, 0, v2
    v_sub_f32 v70, 0, v2
    v_sub_f32 v71, 0, v2
    v_sub_f32 v72, 0, v2
    v_sub_f32 v73, 0, v2
    v_sub_f32 v74, 0, v2
    v_sub_f32 v75, 0, v2
    v_sub_f32 v76, 0, v2
    v_sub_f32 v77, 0, v2
    v_sub_f32 v78, 0, v2
    v_sub_f32 v79, 0, v2
    v_sub_f32 v48, v48, v2
    v_sub_f32 v49, v49, v2
    v_sub_f32 v50, v50, v2
    v_sub_f32 v51, v51, v2
    v_sub_f32 v52, v52, v2
    v_sub_f32 v53, v53, v2
    v_sub_f32 v54, v54, v2
    v_sub_f32 v55, v55, v2
    v_sub_f32 v56, v56, v2
    v_sub_f32 v57, v57, v2
    v_sub_f32 v58, v58, v2
    v_sub_f32 v59, v59, v2
    v_sub_f32 v60, v60, v2
    v_sub_f32 v61, v61, v2
    v_sub_f32 v62, v62, v2
    v_sub_f32 v63, v63, v2
    ds_read_b128 v[192:195], v237 offset:2048
    v_exp_f32 v196, v48
    v_exp_f32 v197, v49
    v_exp_f32 v198, v50
    v_add_f32 v242, v196, v197
    v_cvt_pk_bf16_f32 v160, v196, v197
    s_waitcnt lgkmcnt(2)
    v_mfma_f32_32x32x16_bf16 v[144:159], a[192:195], v[184:187], 0
    v_exp_f32 v199, v51
    v_add_f32 v242, v242, v198
    s_waitcnt lgkmcnt(1)
    v_mfma_f32_32x32x16_bf16 v[144:159], a[196:199], v[188:191], v[144:159]
    ds_read_b128 v[184:187], v237 offset:3072
    buffer_load_dwordx4 v234, s[16:19], s36 offen offset:2048 nt lds
    v_exp_f32 v196, v52
    v_add_f32 v242, v242, v199
    v_cvt_pk_bf16_f32 v161, v198, v199
    s_waitcnt lgkmcnt(1)
    v_mfma_f32_32x32x16_bf16 v[144:159], a[200:203], v[192:195], v[144:159]
    ds_read_b128 v[188:191], v237 offset:4096
    v_exp_f32 v197, v53
    v_add_f32 v242, v242, v196
    s_waitcnt lgkmcnt(1)
    v_mfma_f32_32x32x16_bf16 v[144:159], a[204:207], v[184:187], v[144:159]
    ds_read_b128 v[192:195], v237 offset:5120
    v_exp_f32 v198, v54
    v_add_f32 v242, v242, v197
    v_cvt_pk_bf16_f32 v162, v196, v197
    s_waitcnt lgkmcnt(1)
    v_mfma_f32_32x32x16_bf16 v[144:159], a[208:211], v[188:191], v[144:159]
    ds_read_b128 v[184:187], v237 offset:6144
    v_exp_f32 v199, v55
    v_add_f32 v242, v242, v198
    s_waitcnt lgkmcnt(1)
    v_mfma_f32_32x32x16_bf16 v[144:159], a[212:215], v[192:195], v[144:159]
    ds_read_b128 v[188:191], v237 offset:7168
    v_exp_f32 v196, v56
    v_add_f32 v242, v242, v199
    v_cvt_pk_bf16_f32 v163, v198, v199
    s_waitcnt lgkmcnt(1)
    v_mfma_f32_32x32x16_bf16 v[144:159], a[216:219], v[184:187], v[144:159]
    v_exp_f32 v197, v57
    v_add_f32 v242, v242, v196
    s_waitcnt lgkmcnt(0)
    v_mfma_f32_32x32x16_bf16 v[144:159], a[220:223], v[188:191], v[144:159]
    v_exp_f32 v198, v58
    v_add_f32 v242, v242, v197
    v_cvt_pk_bf16_f32 v164, v196, v197
    s_waitcnt vmcnt(28)
    v_mfma_f32_32x32x16_bf16 v[112:127], a[192:195], v[80:83], 0
    buffer_load_dwordx4 v235, s[16:19], s36 offen offset:3072 nt lds
    v_exp_f32 v199, v59
    v_add_f32 v242, v242, v198
    s_waitcnt vmcnt(28)
    v_mfma_f32_32x32x16_bf16 v[112:127], a[196:199], v[84:87], v[112:127]
    ds_read_b128 a[192:195], v220 offset:8192
    v_exp_f32 v196, v60
    v_add_f32 v242, v242, v199
    v_cvt_pk_bf16_f32 v165, v198, v199
    s_waitcnt vmcnt(27)
    v_mfma_f32_32x32x16_bf16 v[112:127], a[200:203], v[88:91], v[112:127]
    ds_read_b128 a[196:199], v221 offset:8192
    s_add_u32 s36, s36, 16384
    v_exp_f32 v197, v61
    v_add_f32 v242, v242, v196
    s_waitcnt vmcnt(26)
    v_mfma_f32_32x32x16_bf16 v[112:127], a[204:207], v[92:95], v[112:127]
    ds_read_b128 a[200:203], v222 offset:8192
    v_exp_f32 v198, v62
    v_add_f32 v242, v242, v197
    v_cvt_pk_bf16_f32 v166, v196, v197
    s_waitcnt vmcnt(25)
    v_mfma_f32_32x32x16_bf16 v[112:127], a[208:211], v[96:99], v[112:127]
    v_exp_f32 v199, v63
    v_add_f32 v242, v242, v198
    s_nop 7
    v_max3_f32 v2, v144, v145, v146
    v_max3_f32 v2, v2, v147, v148
    v_max3_f32 v2, v2, v149, v150
    v_max3_f32 v2, v2, v151, v152
    v_max3_f32 v2, v2, v153, v154
    v_max3_f32 v2, v2, v155, v156
    v_max3_f32 v2, v2, v157, v158
    v_max_f32 v2, v2, v159
    v_mov_b32 v3, v2
    s_nop 1
    v_permlane32_swap_b32 v2, v3
    v_max_f32 v2, v2, v3
    v_sub_f32 v204, 0, v2
    v_sub_f32 v205, 0, v2
    v_sub_f32 v206, 0, v2
    v_sub_f32 v207, 0, v2
    v_sub_f32 v208, 0, v2
    v_sub_f32 v209, 0, v2
    v_sub_f32 v210, 0, v2
    v_sub_f32 v211, 0, v2
    v_sub_f32 v212, 0, v2
    v_sub_f32 v213, 0, v2
    v_sub_f32 v214, 0, v2
    v_sub_f32 v215, 0, v2
    v_sub_f32 v216, 0, v2
    v_sub_f32 v217, 0, v2
    v_sub_f32 v218, 0, v2
    v_sub_f32 v219, 0, v2
    v_sub_f32 v144, v144, v2
    v_sub_f32 v145, v145, v2
    v_sub_f32 v146, v146, v2
    v_sub_f32 v147, v147, v2
    v_sub_f32 v148, v148, v2
    v_sub_f32 v149, v149, v2
    v_sub_f32 v150, v150, v2
    v_sub_f32 v151, v151, v2
    v_sub_f32 v152, v152, v2
    v_sub_f32 v153, v153, v2
    v_sub_f32 v154, v154, v2
    v_sub_f32 v155, v155, v2
    v_sub_f32 v156, v156, v2
    v_sub_f32 v157, v157, v2
    v_sub_f32 v158, v158, v2
    v_sub_f32 v159, v159, v2
    ds_read_b128 a[204:207], v223 offset:8192
    s_waitcnt vmcnt(24)
    v_mfma_f32_32x32x16_bf16 v[112:127], a[212:215], v[100:103], v[112:127]
    ds_read_b128 a[208:211], v224 offset:8192
    v_add_f32 v242, v242, v199
    v_cvt_pk_bf16_f32 v167, v198, v199
    v_cmp_lt_f32 vcc, s35, v242
    v_exp_f32 v196, v144
    s_waitcnt vmcnt(23)
    v_mfma_f32_32x32x16_bf16 v[112:127], a[216:219], v[104:107], v[112:127]
    ds_read_b128 a[212:215], v225 offset:8192
    v_exp_f32 v197, v145
    s_waitcnt vmcnt(22)
    v_mfma_f32_32x32x16_bf16 v[112:127], a[220:223], v[108:111], v[112:127]
    ds_read_b128 a[216:219], v226 offset:8192
    s_cbranch_vccnz FX1
FX1_RET:
    v_add_f32 v239, v239, v242
    v_exp_f32 v198, v146
    v_add_f32 v244, v196, v197
    v_cvt_pk_bf16_f32 v176, v196, v197
    ds_read_b128 a[220:223], v227 offset:8192
    v_exp_f32 v199, v147
    v_add_f32 v244, v244, v198
    ds_read_b64_tr_b16 a[224:225], v228 offset:24576
    ds_read_b64_tr_b16 a[226:227], v228 offset:26624
    v_exp_f32 v196, v148
    v_add_f32 v244, v244, v199
    v_cvt_pk_bf16_f32 v177, v198, v199
    ds_read_b64_tr_b16 a[228:229], v229 offset:24576
    ds_read_b64_tr_b16 a[230:231], v229 offset:26624
    v_exp_f32 v197, v149
    v_add_f32 v244, v244, v196
    ds_read_b64_tr_b16 a[232:233], v230 offset:24576
    ds_read_b64_tr_b16 a[234:235], v230 offset:26624
    v_exp_f32 v198, v150
    v_add_f32 v244, v244, v197
    v_cvt_pk_bf16_f32 v178, v196, v197
    ds_read_b64_tr_b16 a[236:237], v231 offset:24576
    ds_read_b64_tr_b16 a[238:239], v231 offset:26624
    v_exp_f32 v199, v151
    v_add_f32 v244, v244, v198
    v_max3_f32 v2, v112, v113, v114
    v_max3_f32 v2, v2, v115, v116
    v_max3_f32 v2, v2, v117, v118
    v_max3_f32 v2, v2, v119, v120
    v_max3_f32 v2, v2, v121, v122
    v_max3_f32 v2, v2, v123, v124
    v_max3_f32 v2, v2, v125, v126
    v_max_f32 v2, v2, v127
    v_mov_b32 v3, v2
    s_nop 1
    v_permlane32_swap_b32 v2, v3
    v_max_f32 v2, v2, v3
    v_sub_f32 v128, 0, v2
    v_sub_f32 v129, 0, v2
    v_sub_f32 v130, 0, v2
    v_sub_f32 v131, 0, v2
    v_sub_f32 v132, 0, v2
    v_sub_f32 v133, 0, v2
    v_sub_f32 v134, 0, v2
    v_sub_f32 v135, 0, v2
    v_sub_f32 v136, 0, v2
    v_sub_f32 v137, 0, v2
    v_sub_f32 v138, 0, v2
    v_sub_f32 v139, 0, v2
    v_sub_f32 v140, 0, v2
    v_sub_f32 v141, 0, v2
    v_sub_f32 v142, 0, v2
    v_sub_f32 v143, 0, v2
    v_sub_f32 v112, v112, v2
    v_sub_f32 v113, v113, v2
    v_sub_f32 v114, v114, v2
    v_sub_f32 v115, v115, v2
    v_sub_f32 v116, v116, v2
    v_sub_f32 v117, v117, v2
    v_sub_f32 v118, v118, v2
    v_sub_f32 v119, v119, v2
    v_sub_f32 v120, v120, v2
    v_sub_f32 v121, v121, v2
    v_sub_f32 v122, v122, v2
    v_sub_f32 v123, v123, v2
    v_sub_f32 v124, v124, v2
    v_sub_f32 v125, v125, v2
    v_sub_f32 v126, v126, v2
    v_sub_f32 v127, v127, v2
    ds_read_b64_tr_b16 a[240:241], v228 offset:28672
    ds_read_b64_tr_b16 a[242:243], v228 offset:30720
    v_add_f32 v244, v244, v199
    v_cvt_pk_bf16_f32 v179, v198, v199
    v_exp_f32 v196, v112
    ds_read_b64_tr_b16 a[244:245], v229 offset:28672
    ds_read_b64_tr_b16 a[246:247], v229 offset:30720
    v_exp_f32 v197, v113
    ds_read_b64_tr_b16 a[248:249], v230 offset:28672
    ds_read_b64_tr_b16 a[250:251], v230 offset:30720
    v_exp_f32 v198, v114
    v_add_f32 v243, v196, v197
    v_cvt_pk_bf16_f32 v168, v196, v197
    s_waitcnt lgkmcnt(14)
    v_mfma_f32_32x32x16_bf16 v[48:63], a[192:195], v[16:19], v[64:79]
    ds_read_b64_tr_b16 a[252:253], v231 offset:28672
    ds_read_b64_tr_b16 a[254:255], v231 offset:30720
    v_exp_f32 v199, v115
    v_add_f32 v243, v243, v198
    v_mfma_f32_32x32x16_bf16 v[48:63], a[196:199], v[20:23], v[48:63]
    s_add_u32 m0, s38, s86
    v_exp_f32 v196, v116
    v_add_f32 v243, v243, v199
    v_cvt_pk_bf16_f32 v169, v198, v199
    v_mfma_f32_32x32x16_bf16 v[48:63], a[200:203], v[24:27], v[48:63]
    buffer_load_dwordx4 v236, s[20:23], s37 offen nt lds
    v_exp_f32 v197, v117
    v_add_f32 v243, v243, v196
    v_mfma_f32_32x32x16_bf16 v[48:63], a[204:207], v[28:31], v[48:63]
    v_exp_f32 v198, v118
    v_add_f32 v243, v243, v197
    v_cvt_pk_bf16_f32 v170, v196, v197
    v_mfma_f32_32x32x16_bf16 v[48:63], a[208:211], v[32:35], v[48:63]
    v_exp_f32 v199, v119
    v_add_f32 v243, v243, v198
    v_mfma_f32_32x32x16_bf16 v[48:63], a[212:215], v[36:39], v[48:63]
    buffer_load_dwordx4 v236, s[20:23], s37 offen offset:1024 nt lds
    v_exp_f32 v196, v120
    v_add_f32 v243, v243, v199
    v_cvt_pk_bf16_f32 v171, v198, v199
    v_mfma_f32_32x32x16_bf16 v[48:63], a[216:219], v[40:43], v[48:63]
    v_exp_f32 v197, v121
    v_add_f32 v243, v243, v196
    v_mfma_f32_32x32x16_bf16 v[48:63], a[220:223], v[44:47], v[48:63]
    v_exp_f32 v198, v122
    v_add_f32 v243, v243, v197
    v_cvt_pk_bf16_f32 v172, v196, v197
    s_waitcnt lgkmcnt(0)
    v_mfma_f32_32x32x16_bf16 a[0:15], a[224:227], v[160:163], 0
    buffer_load_dwordx4 v236, s[20:23], s37 offen offset:2048 nt lds
    v_exp_f32 v199, v123
    v_add_f32 v243, v243, v198
    v_mfma_f32_32x32x16_bf16 a[16:31], a[228:231], v[160:163], 0
    v_exp_f32 v196, v124
    v_add_f32 v243, v243, v199
    v_cvt_pk_bf16_f32 v173, v198, v199
    v_mfma_f32_32x32x16_bf16 a[32:47], a[232:235], v[160:163], 0
    v_exp_f32 v197, v125
    v_add_f32 v243, v243, v196
    v_mfma_f32_32x32x16_bf16 a[48:63], a[236:239], v[160:163], 0
    buffer_load_dwordx4 v236, s[20:23], s37 offen offset:3072 nt lds
    v_exp_f32 v198, v126
    v_add_f32 v243, v243, v197
    v_cvt_pk_bf16_f32 v174, v196, v197
    v_mfma_f32_32x32x16_bf16 a[0:15], a[240:243], v[164:167], a[0:15]
    v_exp_f32 v199, v127
    v_add_f32 v243, v243, v198
    v_mfma_f32_32x32x16_bf16 a[16:31], a[244:247], v[164:167], a[16:31]
    v_add_f32 v243, v243, v199
    v_cvt_pk_bf16_f32 v175, v198, v199
    v_cmp_lt_f32 vcc, s35, v243
    v_exp_f32 v196, v152
    v_mfma_f32_32x32x16_bf16 a[32:47], a[248:251], v[164:167], a[32:47]
    s_add_u32 s37, s37, 16384
    v_exp_f32 v197, v153
    v_add_f32 v244, v244, v196
    v_mfma_f32_32x32x16_bf16 a[48:63], a[252:255], v[164:167], a[48:63]
    s_add_u32 s38, s38, 32768
    s_and_b32 s38, s38, 131071
    s_cbranch_vccnz FX2
FX2_RET:
    v_add_f32 v240, v240, v243
    v_exp_f32 v198, v154
    v_add_f32 v244, v244, v197
    v_cvt_pk_bf16_f32 v180, v196, v197
    v_mfma_f32_32x32x16_bf16 v[112:127], a[192:195], v[80:83], v[128:143]
    v_exp_f32 v199, v155
    v_add_f32 v244, v244, v198
    v_mfma_f32_32x32x16_bf16 v[112:127], a[196:199], v[84:87], v[112:127]
    v_exp_f32 v196, v156
    v_add_f32 v244, v244, v199
    v_cvt_pk_bf16_f32 v181, v198, v199
    s_waitcnt vmcnt(16)
    s_barrier
    ds_read_b128 a[192:195], v220 offset:32768
    v_mfma_f32_32x32x16_bf16 v[112:127], a[200:203], v[88:91], v[112:127]
    ds_read_b128 a[196:199], v221 offset:32768
    v_exp_f32 v197, v157
    v_add_f32 v244, v244, v196
    v_mfma_f32_32x32x16_bf16 v[112:127], a[204:207], v[92:95], v[112:127]
    ds_read_b128 a[200:203], v222 offset:32768
    v_exp_f32 v198, v158
    v_add_f32 v244, v244, v197
    v_cvt_pk_bf16_f32 v182, v196, v197
    v_mfma_f32_32x32x16_bf16 v[112:127], a[208:211], v[96:99], v[112:127]
    ds_read_b128 a[204:207], v223 offset:32768
    v_exp_f32 v199, v159
    v_add_f32 v244, v244, v198
    v_mfma_f32_32x32x16_bf16 v[112:127], a[212:215], v[100:103], v[112:127]
    ds_read_b128 a[208:211], v224 offset:32768
    v_add_f32 v244, v244, v199
    v_cvt_pk_bf16_f32 v183, v198, v199
    v_cmp_lt_f32 vcc, s35, v244
    v_exp_f32 v196, v48
    v_mfma_f32_32x32x16_bf16 v[112:127], a[216:219], v[104:107], v[112:127]
    ds_read_b128 a[212:215], v225 offset:32768
    v_exp_f32 v197, v49
    v_mfma_f32_32x32x16_bf16 v[112:127], a[220:223], v[108:111], v[112:127]
    ds_read_b128 a[216:219], v226 offset:32768
    s_cbranch_vccnz FX3
FX3_RET:
    v_add_f32 v241, v241, v244
    v_exp_f32 v198, v50
    v_add_f32 v242, v196, v197
    v_cvt_pk_bf16_f32 v160, v196, v197
    v_mfma_f32_32x32x16_bf16 a[128:143], a[224:227], v[176:179], 0
    ds_read_b128 a[220:223], v227 offset:32768
    v_exp_f32 v199, v51
    v_add_f32 v242, v242, v198
    v_mfma_f32_32x32x16_bf16 a[144:159], a[228:231], v[176:179], 0
    v_exp_f32 v196, v52
    v_add_f32 v242, v242, v199
    v_cvt_pk_bf16_f32 v161, v198, v199
    v_mfma_f32_32x32x16_bf16 a[160:175], a[232:235], v[176:179], 0
    v_exp_f32 v197, v53
    v_add_f32 v242, v242, v196
    v_mfma_f32_32x32x16_bf16 a[176:191], a[236:239], v[176:179], 0
    v_exp_f32 v198, v54
    v_add_f32 v242, v242, v197
    v_cvt_pk_bf16_f32 v162, v196, v197
    v_mfma_f32_32x32x16_bf16 a[128:143], a[240:243], v[180:183], a[128:143]
    v_exp_f32 v199, v55
    v_add_f32 v242, v242, v198
    v_mfma_f32_32x32x16_bf16 a[144:159], a[244:247], v[180:183], a[144:159]
    v_exp_f32 v196, v56
    v_add_f32 v242, v242, v199
    v_cvt_pk_bf16_f32 v163, v198, v199
    v_mfma_f32_32x32x16_bf16 a[160:175], a[248:251], v[180:183], a[160:175]
    v_exp_f32 v197, v57
    v_add_f32 v242, v242, v196
    v_mfma_f32_32x32x16_bf16 a[176:191], a[252:255], v[180:183], a[176:191]
    v_exp_f32 v198, v58
    v_add_f32 v242, v242, v197
    v_cvt_pk_bf16_f32 v164, v196, v197
    v_mfma_f32_32x32x16_bf16 a[64:79], a[224:227], v[168:171], 0
    v_exp_f32 v199, v59
    v_add_f32 v242, v242, v198
    v_mfma_f32_32x32x16_bf16 a[80:95], a[228:231], v[168:171], 0
    ds_read_b64_tr_b16 a[224:225], v228 offset:49152
    ds_read_b64_tr_b16 a[226:227], v228 offset:51200
    v_exp_f32 v196, v60
    v_add_f32 v242, v242, v199
    v_cvt_pk_bf16_f32 v165, v198, v199
    v_mfma_f32_32x32x16_bf16 a[96:111], a[232:235], v[168:171], 0
    ds_read_b64_tr_b16 a[228:229], v229 offset:49152
    ds_read_b64_tr_b16 a[230:231], v229 offset:51200
    v_exp_f32 v197, v61
    v_add_f32 v242, v242, v196
    v_mfma_f32_32x32x16_bf16 a[112:127], a[236:239], v[168:171], 0
    ds_read_b64_tr_b16 a[232:233], v230 offset:49152
    ds_read_b64_tr_b16 a[234:235], v230 offset:51200
    v_exp_f32 v198, v62
    v_add_f32 v242, v242, v197
    v_cvt_pk_bf16_f32 v166, v196, v197
    v_mfma_f32_32x32x16_bf16 a[64:79], a[240:243], v[172:175], a[64:79]
    ds_read_b64_tr_b16 a[236:237], v231 offset:49152
    ds_read_b64_tr_b16 a[238:239], v231 offset:51200
    v_exp_f32 v199, v63
    v_add_f32 v242, v242, v198
    v_mfma_f32_32x32x16_bf16 a[80:95], a[244:247], v[172:175], a[80:95]
    ds_read_b64_tr_b16 a[240:241], v228 offset:53248
    ds_read_b64_tr_b16 a[242:243], v228 offset:55296
    v_add_f32 v242, v242, v199
    v_cvt_pk_bf16_f32 v167, v198, v199
    v_cmp_lt_f32 vcc, s35, v242
    v_exp_f32 v196, v112
    v_mfma_f32_32x32x16_bf16 a[96:111], a[248:251], v[172:175], a[96:111]
    ds_read_b64_tr_b16 a[244:245], v229 offset:53248
    ds_read_b64_tr_b16 a[246:247], v229 offset:55296
    v_exp_f32 v197, v113
    v_mfma_f32_32x32x16_bf16 a[112:127], a[252:255], v[172:175], a[112:127]
    ds_read_b64_tr_b16 a[248:249], v230 offset:53248
    ds_read_b64_tr_b16 a[250:251], v230 offset:55296
    s_cbranch_vccnz FX4
FX4_RET:
    v_add_f32 v239, v239, v242
    v_exp_f32 v198, v114
    v_add_f32 v243, v196, v197
    v_cvt_pk_bf16_f32 v168, v196, v197
    s_waitcnt lgkmcnt(14)
    v_mfma_f32_32x32x16_bf16 v[48:63], a[192:195], v[16:19], v[64:79]
    ds_read_b64_tr_b16 a[252:253], v231 offset:53248
    ds_read_b64_tr_b16 a[254:255], v231 offset:55296
    s_add_u32 s46, s54, 16384
    v_exp_f32 v199, v115
    v_add_f32 v243, v243, v198
    v_mfma_f32_32x32x16_bf16 v[48:63], a[196:199], v[20:23], v[48:63]
    v_exp_f32 v196, v116
    v_add_f32 v243, v243, v199
    v_cvt_pk_bf16_f32 v169, v198, v199
    v_mfma_f32_32x32x16_bf16 v[48:63], a[200:203], v[24:27], v[48:63]
    s_add_u32 m0, s38, s82
    v_exp_f32 v197, v117
    v_add_f32 v243, v243, v196
    v_mfma_f32_32x32x16_bf16 v[48:63], a[204:207], v[28:31], v[48:63]
    buffer_load_dwordx4 v232, s[16:19], s36 offen nt lds
    v_exp_f32 v198, v118
    v_add_f32 v243, v243, v197
    v_cvt_pk_bf16_f32 v170, v196, v197
    v_mfma_f32_32x32x16_bf16 v[48:63], a[208:211], v[32:35], v[48:63]
    v_exp_f32 v199, v119
    v_add_f32 v243, v243, v198
    v_mfma_f32_32x32x16_bf16 v[48:63], a[212:215], v[36:39], v[48:63]
    v_exp_f32 v196, v120
    v_add_f32 v243, v243, v199
    v_cvt_pk_bf16_f32 v171, v198, v199
    v_mfma_f32_32x32x16_bf16 v[48:63], a[216:219], v[40:43], v[48:63]
    v_exp_f32 v197, v121
    v_add_f32 v243, v243, v196
    v_mfma_f32_32x32x16_bf16 v[48:63], a[220:223], v[44:47], v[48:63]
    v_exp_f32 v198, v122
    v_add_f32 v243, v243, v197
    v_cvt_pk_bf16_f32 v172, v196, v197
    s_waitcnt lgkmcnt(0)
    v_mfma_f32_32x32x16_bf16 a[0:15], a[224:227], v[160:163], a[0:15]
    v_exp_f32 v199, v123
    v_add_f32 v243, v243, v198
    v_mfma_f32_32x32x16_bf16 a[16:31], a[228:231], v[160:163], a[16:31]
    v_exp_f32 v196, v124
    v_add_f32 v243, v243, v199
    v_cvt_pk_bf16_f32 v173, v198, v199
    v_mfma_f32_32x32x16_bf16 a[32:47], a[232:235], v[160:163], a[32:47]
    buffer_load_dwordx4 v233, s[16:19], s36 offen offset:1024 nt lds
    buffer_load_dwordx4 v[246:249], v245, s[24:27], s46 offen
    v_exp_f32 v197, v125
    v_add_f32 v243, v243, v196
    v_mfma_f32_32x32x16_bf16 a[48:63], a[236:239], v[160:163], a[48:63]
    v_exp_f32 v198, v126
    v_add_f32 v243, v243, v197
    v_cvt_pk_bf16_f32 v174, v196, v197
    v_mfma_f32_32x32x16_bf16 a[0:15], a[240:243], v[164:167], a[0:15]
    v_exp_f32 v199, v127
    v_add_f32 v243, v243, v198
    v_mfma_f32_32x32x16_bf16 a[16:31], a[244:247], v[164:167], a[16:31]
    v_add_f32 v243, v243, v199
    v_cvt_pk_bf16_f32 v175, v198, v199
    v_cmp_lt_f32 vcc, s35, v243
    v_exp_f32 v196, v48
    v_mfma_f32_32x32x16_bf16 a[32:47], a[248:251], v[164:167], a[32:47]
    v_exp_f32 v197, v49
    v_mfma_f32_32x32x16_bf16 a[48:63], a[252:255], v[164:167], a[48:63]
    s_cbranch_vccnz FX5
FX5_RET:
    v_add_f32 v240, v240, v243
    v_exp_f32 v198, v50
    v_add_f32 v242, v196, v197
    v_cvt_pk_bf16_f32 v160, v196, v197
    v_mfma_f32_32x32x16_bf16 v[112:127], a[192:195], v[80:83], v[128:143]
    v_exp_f32 v199, v51
    v_add_f32 v242, v242, v198
    v_mfma_f32_32x32x16_bf16 v[112:127], a[196:199], v[84:87], v[112:127]
    ds_read_b128 a[192:195], v220 offset:40960
    buffer_load_dwordx4 v234, s[16:19], s36 offen offset:2048 nt lds
    v_exp_f32 v196, v52
    v_add_f32 v242, v242, v199
    v_cvt_pk_bf16_f32 v161, v198, v199
    v_mfma_f32_32x32x16_bf16 v[112:127], a[200:203], v[88:91], v[112:127]
    ds_read_b128 a[196:199], v221 offset:40960
    v_exp_f32 v197, v53
    v_add_f32 v242, v242, v196
    v_mfma_f32_32x32x16_bf16 v[112:127], a[204:207], v[92:95], v[112:127]
    ds_read_b128 a[200:203], v222 offset:40960
    v_exp_f32 v198, v54
    v_add_f32 v242, v242, v197
    v_cvt_pk_bf16_f32 v162, v196, v197
    v_mfma_f32_32x32x16_bf16 v[112:127], a[208:211], v[96:99], v[112:127]
    ds_read_b128 a[204:207], v223 offset:40960
    v_exp_f32 v199, v55
    v_add_f32 v242, v242, v198
    v_mfma_f32_32x32x16_bf16 v[112:127], a[212:215], v[100:103], v[112:127]
    ds_read_b128 a[208:211], v224 offset:40960
    buffer_load_dwordx4 v[250:253], v245, s[24:27], s46 offen offset:1024
    v_exp_f32 v196, v56
    v_add_f32 v242, v242, v199
    v_cvt_pk_bf16_f32 v163, v198, v199
    v_mfma_f32_32x32x16_bf16 v[112:127], a[216:219], v[104:107], v[112:127]
    ds_read_b128 a[212:215], v225 offset:40960
    v_exp_f32 v197, v57
    v_add_f32 v242, v242, v196
    v_mfma_f32_32x32x16_bf16 v[112:127], a[220:223], v[108:111], v[112:127]
    ds_read_b128 a[216:219], v226 offset:40960
    v_exp_f32 v198, v58
    v_add_f32 v242, v242, v197
    v_cvt_pk_bf16_f32 v164, v196, v197
    v_mfma_f32_32x32x16_bf16 a[64:79], a[224:227], v[168:171], a[64:79]
    ds_read_b128 a[220:223], v227 offset:40960
    buffer_load_dwordx4 v235, s[16:19], s36 offen offset:3072 nt lds
    v_exp_f32 v199, v59
    v_add_f32 v242, v242, v198
    v_mfma_f32_32x32x16_bf16 a[80:95], a[228:231], v[168:171], a[80:95]
    ds_read_b64_tr_b16 a[224:225], v228 offset:57344
    ds_read_b64_tr_b16 a[226:227], v228 offset:59392
    v_exp_f32 v196, v60
    v_add_f32 v242, v242, v199
    v_cvt_pk_bf16_f32 v165, v198, v199
    v_mfma_f32_32x32x16_bf16 a[96:111], a[232:235], v[168:171], a[96:111]
    ds_read_b64_tr_b16 a[228:229], v229 offset:57344
    ds_read_b64_tr_b16 a[230:231], v229 offset:59392
    s_add_u32 s36, s36, 16384
    v_exp_f32 v197, v61
    v_add_f32 v242, v242, v196
    v_mfma_f32_32x32x16_bf16 a[112:127], a[236:239], v[168:171], a[112:127]
    ds_read_b64_tr_b16 a[232:233], v230 offset:57344
    ds_read_b64_tr_b16 a[234:235], v230 offset:59392
    v_exp_f32 v198, v62
    v_add_f32 v242, v242, v197
    v_cvt_pk_bf16_f32 v166, v196, v197
    v_mfma_f32_32x32x16_bf16 a[64:79], a[240:243], v[172:175], a[64:79]
    ds_read_b64_tr_b16 a[236:237], v231 offset:57344
    ds_read_b64_tr_b16 a[238:239], v231 offset:59392
    v_exp_f32 v199, v63
    v_add_f32 v242, v242, v198
    v_mfma_f32_32x32x16_bf16 a[80:95], a[244:247], v[172:175], a[80:95]
    ds_read_b64_tr_b16 a[240:241], v228 offset:61440
    ds_read_b64_tr_b16 a[242:243], v228 offset:63488
    v_add_f32 v242, v242, v199
    v_cvt_pk_bf16_f32 v167, v198, v199
    v_cmp_lt_f32 vcc, s35, v242
    v_exp_f32 v196, v112
    v_mfma_f32_32x32x16_bf16 a[96:111], a[248:251], v[172:175], a[96:111]
    ds_read_b64_tr_b16 a[244:245], v229 offset:61440
    ds_read_b64_tr_b16 a[246:247], v229 offset:63488
    v_exp_f32 v197, v113
    v_mfma_f32_32x32x16_bf16 a[112:127], a[252:255], v[172:175], a[112:127]
    ds_read_b64_tr_b16 a[248:249], v230 offset:61440
    ds_read_b64_tr_b16 a[250:251], v230 offset:63488
    s_cbranch_vccnz FX6
FX6_RET:
    v_add_f32 v239, v239, v242
    v_exp_f32 v198, v114
    v_add_f32 v243, v196, v197
    v_cvt_pk_bf16_f32 v168, v196, v197
    s_waitcnt lgkmcnt(14)
    v_mfma_f32_32x32x16_bf16 v[48:63], a[192:195], v[16:19], v[64:79]
    ds_read_b64_tr_b16 a[252:253], v231 offset:61440
    ds_read_b64_tr_b16 a[254:255], v231 offset:63488
    v_exp_f32 v199, v115
    v_add_f32 v243, v243, v198
    v_mfma_f32_32x32x16_bf16 v[48:63], a[196:199], v[20:23], v[48:63]
    s_add_u32 m0, s38, s86
    v_exp_f32 v196, v116
    v_add_f32 v243, v243, v199
    v_cvt_pk_bf16_f32 v169, v198, v199
    v_mfma_f32_32x32x16_bf16 v[48:63], a[200:203], v[24:27], v[48:63]
    buffer_load_dwordx4 v236, s[20:23], s37 offen nt lds
    v_exp_f32 v197, v117
    v_add_f32 v243, v243, v196
    v_xor_b32 v220, 65536, v220
    v_mfma_f32_32x32x16_bf16 v[48:63], a[204:207], v[28:31], v[48:63]
    v_exp_f32 v198, v118
    v_add_f32 v243, v243, v197
    v_cvt_pk_bf16_f32 v170, v196, v197
    v_xor_b32 v221, 65536, v221
    v_mfma_f32_32x32x16_bf16 v[48:63], a[208:211], v[32:35], v[48:63]
    v_exp_f32 v199, v119
    v_add_f32 v243, v243, v198
    v_xor_b32 v222, 65536, v222
    v_mfma_f32_32x32x16_bf16 v[48:63], a[212:215], v[36:39], v[48:63]
    buffer_load_dwordx4 v236, s[20:23], s37 offen offset:1024 nt lds
    v_exp_f32 v196, v120
    v_add_f32 v243, v243, v199
    v_cvt_pk_bf16_f32 v171, v198, v199
    v_xor_b32 v223, 65536, v223
    v_mfma_f32_32x32x16_bf16 v[48:63], a[216:219], v[40:43], v[48:63]
    v_exp_f32 v197, v121
    v_add_f32 v243, v243, v196
    v_xor_b32 v224, 65536, v224
    v_mfma_f32_32x32x16_bf16 v[48:63], a[220:223], v[44:47], v[48:63]
    v_exp_f32 v198, v122
    v_add_f32 v243, v243, v197
    v_cvt_pk_bf16_f32 v172, v196, v197
    v_xor_b32 v225, 65536, v225
    s_waitcnt lgkmcnt(0)
    v_mfma_f32_32x32x16_bf16 a[0:15], a[224:227], v[160:163], a[0:15]
    buffer_load_dwordx4 v236, s[20:23], s37 offen offset:2048 nt lds
    v_exp_f32 v199, v123
    v_add_f32 v243, v243, v198
    v_xor_b32 v226, 65536, v226
    v_mfma_f32_32x32x16_bf16 a[16:31], a[228:231], v[160:163], a[16:31]
    v_exp_f32 v196, v124
    v_add_f32 v243, v243, v199
    v_cvt_pk_bf16_f32 v173, v198, v199
    v_xor_b32 v227, 65536, v227
    v_mfma_f32_32x32x16_bf16 a[32:47], a[232:235], v[160:163], a[32:47]
    v_exp_f32 v197, v125
    v_add_f32 v243, v243, v196
    v_xor_b32 v228, 65536, v228
    v_mfma_f32_32x32x16_bf16 a[48:63], a[236:239], v[160:163], a[48:63]
    buffer_load_dwordx4 v236, s[20:23], s37 offen offset:3072 nt lds
    v_exp_f32 v198, v126
    v_add_f32 v243, v243, v197
    v_cvt_pk_bf16_f32 v174, v196, v197
    v_xor_b32 v229, 65536, v229
    v_mfma_f32_32x32x16_bf16 a[0:15], a[240:243], v[164:167], a[0:15]
    v_exp_f32 v199, v127
    v_add_f32 v243, v243, v198
    v_xor_b32 v230, 65536, v230
    v_mfma_f32_32x32x16_bf16 a[16:31], a[244:247], v[164:167], a[16:31]
    v_add_f32 v243, v243, v199
    v_cvt_pk_bf16_f32 v175, v198, v199
    v_cmp_lt_f32 vcc, s35, v243
    v_exp_f32 v196, v48
    v_xor_b32 v231, 65536, v231
    v_mfma_f32_32x32x16_bf16 a[32:47], a[248:251], v[164:167], a[32:47]
    s_add_u32 s37, s37, 16384
    v_exp_f32 v197, v49
    v_mfma_f32_32x32x16_bf16 a[48:63], a[252:255], v[164:167], a[48:63]
    s_add_u32 s38, s38, 32768
    s_and_b32 s38, s38, 131071
    s_cbranch_vccnz FX7
FX7_RET:
    v_add_f32 v240, v240, v243
    v_exp_f32 v198, v50
    v_add_f32 v242, v196, v197
    v_cvt_pk_bf16_f32 v160, v196, v197
    v_mfma_f32_32x32x16_bf16 v[112:127], a[192:195], v[80:83], v[128:143]
    v_exp_f32 v199, v51
    v_add_f32 v242, v242, v198
    v_mfma_f32_32x32x16_bf16 v[112:127], a[196:199], v[84:87], v[112:127]
    v_exp_f32 v196, v52
    v_add_f32 v242, v242, v199
    v_cvt_pk_bf16_f32 v161, v198, v199
    s_waitcnt vmcnt(16)
    s_barrier
    ds_read_b128 a[192:195], v220
    v_mfma_f32_32x32x16_bf16 v[112:127], a[200:203], v[88:91], v[112:127]
    ds_read_b128 a[196:199], v221
    v_exp_f32 v197, v53
    v_add_f32 v242, v242, v196
    v_mfma_f32_32x32x16_bf16 v[112:127], a[204:207], v[92:95], v[112:127]
    ds_read_b128 a[200:203], v222
    v_exp_f32 v198, v54
    v_add_f32 v242, v242, v197
    v_cvt_pk_bf16_f32 v162, v196, v197
    v_mfma_f32_32x32x16_bf16 v[112:127], a[208:211], v[96:99], v[112:127]
    ds_read_b128 a[204:207], v223
    v_exp_f32 v199, v55
    v_add_f32 v242, v242, v198
    v_mfma_f32_32x32x16_bf16 v[112:127], a[212:215], v[100:103], v[112:127]
    ds_read_b128 a[208:211], v224
    v_exp_f32 v196, v56
    v_add_f32 v242, v242, v199
    v_cvt_pk_bf16_f32 v163, v198, v199
    v_mfma_f32_32x32x16_bf16 v[112:127], a[216:219], v[104:107], v[112:127]
    ds_read_b128 a[212:215], v225
    v_exp_f32 v197, v57
    v_add_f32 v242, v242, v196
    v_mfma_f32_32x32x16_bf16 v[112:127], a[220:223], v[108:111], v[112:127]
    ds_read_b128 a[216:219], v226
    v_exp_f32 v198, v58
    v_add_f32 v242, v242, v197
    v_cvt_pk_bf16_f32 v164, v196, v197
    v_mfma_f32_32x32x16_bf16 a[64:79], a[224:227], v[168:171], a[64:79]
    ds_read_b128 a[220:223], v227
    v_exp_f32 v199, v59
    v_add_f32 v242, v242, v198
    v_mfma_f32_32x32x16_bf16 a[80:95], a[228:231], v[168:171], a[80:95]
    ds_read_b64_tr_b16 a[224:225], v228 offset:16384
    ds_read_b64_tr_b16 a[226:227], v228 offset:18432
    v_exp_f32 v196, v60
    v_add_f32 v242, v242, v199
    v_cvt_pk_bf16_f32 v165, v198, v199
    v_mfma_f32_32x32x16_bf16 a[96:111], a[232:235], v[168:171], a[96:111]
    ds_read_b64_tr_b16 a[228:229], v229 offset:16384
    ds_read_b64_tr_b16 a[230:231], v229 offset:18432
    v_exp_f32 v197, v61
    v_add_f32 v242, v242, v196
    v_mfma_f32_32x32x16_bf16 a[112:127], a[236:239], v[168:171], a[112:127]
    ds_read_b64_tr_b16 a[232:233], v230 offset:16384
    ds_read_b64_tr_b16 a[234:235], v230 offset:18432
    v_exp_f32 v198, v62
    v_add_f32 v242, v242, v197
    v_cvt_pk_bf16_f32 v166, v196, v197
    v_mfma_f32_32x32x16_bf16 a[64:79], a[240:243], v[172:175], a[64:79]
    ds_read_b64_tr_b16 a[236:237], v231 offset:16384
    ds_read_b64_tr_b16 a[238:239], v231 offset:18432
    v_exp_f32 v199, v63
    v_add_f32 v242, v242, v198
    v_mfma_f32_32x32x16_bf16 a[80:95], a[244:247], v[172:175], a[80:95]
    ds_read_b64_tr_b16 a[240:241], v228 offset:20480
    ds_read_b64_tr_b16 a[242:243], v228 offset:22528
    v_add_f32 v242, v242, v199
    v_cvt_pk_bf16_f32 v167, v198, v199
    v_cmp_lt_f32 vcc, s35, v242
    v_exp_f32 v196, v112
    v_mfma_f32_32x32x16_bf16 a[96:111], a[248:251], v[172:175], a[96:111]
    ds_read_b64_tr_b16 a[244:245], v229 offset:20480
    ds_read_b64_tr_b16 a[246:247], v229 offset:22528
    v_exp_f32 v197, v113
    v_mfma_f32_32x32x16_bf16 a[112:127], a[252:255], v[172:175], a[112:127]
    ds_read_b64_tr_b16 a[248:249], v230 offset:20480
    ds_read_b64_tr_b16 a[250:251], v230 offset:22528
    s_cbranch_vccnz FX8
FX8_RET:
    v_add_f32 v239, v239, v242
    v_exp_f32 v198, v114
    v_add_f32 v243, v196, v197
    v_cvt_pk_bf16_f32 v168, v196, v197
    s_mov_b32 s39, 7
W0_AL:
    s_waitcnt lgkmcnt(14)
    v_mfma_f32_32x32x16_bf16 v[48:63], a[192:195], v[16:19], v[64:79]
    ds_read_b64_tr_b16 a[252:253], v231 offset:20480
    ds_read_b64_tr_b16 a[254:255], v231 offset:22528
    v_exp_f32 v199, v115
    v_add_f32 v243, v243, v198
    v_mfma_f32_32x32x16_bf16 v[48:63], a[196:199], v[20:23], v[48:63]
    v_exp_f32 v196, v116
    v_add_f32 v243, v243, v199
    v_cvt_pk_bf16_f32 v169, v198, v199
    v_mfma_f32_32x32x16_bf16 v[48:63], a[200:203], v[24:27], v[48:63]
    s_add_u32 m0, s38, s82
    v_exp_f32 v197, v117
    v_add_f32 v243, v243, v196
    v_mfma_f32_32x32x16_bf16 v[48:63], a[204:207], v[28:31], v[48:63]
    buffer_load_dwordx4 v232, s[16:19], s36 offen nt lds
    v_exp_f32 v198, v118
    v_add_f32 v243, v243, v197
    v_cvt_pk_bf16_f32 v170, v196, v197
    v_mfma_f32_32x32x16_bf16 v[48:63], a[208:211], v[32:35], v[48:63]
    v_exp_f32 v199, v119
    v_add_f32 v243, v243, v198
    v_mfma_f32_32x32x16_bf16 v[48:63], a[212:215], v[36:39], v[48:63]
    v_exp_f32 v196, v120
    v_add_f32 v243, v243, v199
    v_cvt_pk_bf16_f32 v171, v198, v199
    v_mfma_f32_32x32x16_bf16 v[48:63], a[216:219], v[40:43], v[48:63]
    v_exp_f32 v197, v121
    v_add_f32 v243, v243, v196
    v_mfma_f32_32x32x16_bf16 v[48:63], a[220:223], v[44:47], v[48:63]
    v_exp_f32 v198, v122
    v_add_f32 v243, v243, v197
    v_cvt_pk_bf16_f32 v172, v196, v197
    s_waitcnt lgkmcnt(0)
    v_mfma_f32_32x32x16_bf16 a[0:15], a[224:227], v[160:163], a[0:15]
    v_exp_f32 v199, v123
    v_add_f32 v243, v243, v198
    v_mfma_f32_32x32x16_bf16 a[16:31], a[228:231], v[160:163], a[16:31]
    ds_read_b128 v[184:187], v237
    v_exp_f32 v196, v124
    v_add_f32 v243, v243, v199
    v_cvt_pk_bf16_f32 v173, v198, v199
    v_mfma_f32_32x32x16_bf16 a[32:47], a[232:235], v[160:163], a[32:47]
    ds_read_b128 v[188:191], v237 offset:1024
    buffer_load_dwordx4 v233, s[16:19], s36 offen offset:1024 nt lds
    v_exp_f32 v197, v125
    v_add_f32 v243, v243, v196
    v_mfma_f32_32x32x16_bf16 a[48:63], a[236:239], v[160:163], a[48:63]
    ds_read_b128 v[192:195], v237 offset:2048
    v_exp_f32 v198, v126
    v_add_f32 v243, v243, v197
    v_cvt_pk_bf16_f32 v174, v196, v197
    v_mfma_f32_32x32x16_bf16 a[0:15], a[240:243], v[164:167], a[0:15]
    v_exp_f32 v199, v127
    v_add_f32 v243, v243, v198
    v_mfma_f32_32x32x16_bf16 a[16:31], a[244:247], v[164:167], a[16:31]
    v_add_f32 v243, v243, v199
    v_cvt_pk_bf16_f32 v175, v198, v199
    v_cmp_lt_f32 vcc, s35, v243
    v_exp_f32 v196, v48
    v_mfma_f32_32x32x16_bf16 a[32:47], a[248:251], v[164:167], a[32:47]
    v_exp_f32 v197, v49
    v_mfma_f32_32x32x16_bf16 a[48:63], a[252:255], v[164:167], a[48:63]
    s_cbranch_vccnz FX9
FX9_RET:
    v_add_f32 v240, v240, v243
    v_exp_f32 v198, v50
    v_add_f32 v242, v196, v197
    v_cvt_pk_bf16_f32 v160, v196, v197
    s_waitcnt lgkmcnt(2)
    v_mfma_f32_32x32x16_bf16 v[144:159], a[192:195], v[184:187], v[204:219]
    v_exp_f32 v199, v51
    v_add_f32 v242, v242, v198
    s_waitcnt lgkmcnt(1)
    v_mfma_f32_32x32x16_bf16 v[144:159], a[196:199], v[188:191], v[144:159]
    ds_read_b128 v[184:187], v237 offset:3072
    buffer_load_dwordx4 v234, s[16:19], s36 offen offset:2048 nt lds
    v_exp_f32 v196, v52
    v_add_f32 v242, v242, v199
    v_cvt_pk_bf16_f32 v161, v198, v199
    s_waitcnt lgkmcnt(1)
    v_mfma_f32_32x32x16_bf16 v[144:159], a[200:203], v[192:195], v[144:159]
    ds_read_b128 v[188:191], v237 offset:4096
    v_exp_f32 v197, v53
    v_add_f32 v242, v242, v196
    s_waitcnt lgkmcnt(1)
    v_mfma_f32_32x32x16_bf16 v[144:159], a[204:207], v[184:187], v[144:159]
    ds_read_b128 v[192:195], v237 offset:5120
    v_exp_f32 v198, v54
    v_add_f32 v242, v242, v197
    v_cvt_pk_bf16_f32 v162, v196, v197
    s_waitcnt lgkmcnt(1)
    v_mfma_f32_32x32x16_bf16 v[144:159], a[208:211], v[188:191], v[144:159]
    ds_read_b128 v[184:187], v237 offset:6144
    v_exp_f32 v199, v55
    v_add_f32 v242, v242, v198
    s_waitcnt lgkmcnt(1)
    v_mfma_f32_32x32x16_bf16 v[144:159], a[212:215], v[192:195], v[144:159]
    ds_read_b128 v[188:191], v237 offset:7168
    v_exp_f32 v196, v56
    v_add_f32 v242, v242, v199
    v_cvt_pk_bf16_f32 v163, v198, v199
    s_waitcnt lgkmcnt(1)
    v_mfma_f32_32x32x16_bf16 v[144:159], a[216:219], v[184:187], v[144:159]
    v_exp_f32 v197, v57
    v_add_f32 v242, v242, v196
    s_waitcnt lgkmcnt(0)
    v_mfma_f32_32x32x16_bf16 v[144:159], a[220:223], v[188:191], v[144:159]
    v_exp_f32 v198, v58
    v_add_f32 v242, v242, v197
    v_cvt_pk_bf16_f32 v164, v196, v197
    v_mfma_f32_32x32x16_bf16 v[112:127], a[192:195], v[80:83], v[128:143]
    buffer_load_dwordx4 v235, s[16:19], s36 offen offset:3072 nt lds
    v_exp_f32 v199, v59
    v_add_f32 v242, v242, v198
    v_mfma_f32_32x32x16_bf16 v[112:127], a[196:199], v[84:87], v[112:127]
    ds_read_b128 a[192:195], v220 offset:8192
    v_exp_f32 v196, v60
    v_add_f32 v242, v242, v199
    v_cvt_pk_bf16_f32 v165, v198, v199
    v_mfma_f32_32x32x16_bf16 v[112:127], a[200:203], v[88:91], v[112:127]
    ds_read_b128 a[196:199], v221 offset:8192
    s_add_u32 s36, s36, 16384
    v_exp_f32 v197, v61
    v_add_f32 v242, v242, v196
    v_mfma_f32_32x32x16_bf16 v[112:127], a[204:207], v[92:95], v[112:127]
    ds_read_b128 a[200:203], v222 offset:8192
    v_exp_f32 v198, v62
    v_add_f32 v242, v242, v197
    v_cvt_pk_bf16_f32 v166, v196, v197
    v_mfma_f32_32x32x16_bf16 v[112:127], a[208:211], v[96:99], v[112:127]
    ds_read_b128 a[204:207], v223 offset:8192
    v_exp_f32 v199, v63
    v_add_f32 v242, v242, v198
    v_mfma_f32_32x32x16_bf16 v[112:127], a[212:215], v[100:103], v[112:127]
    ds_read_b128 a[208:211], v224 offset:8192
    v_add_f32 v242, v242, v199
    v_cvt_pk_bf16_f32 v167, v198, v199
    v_cmp_lt_f32 vcc, s35, v242
    v_exp_f32 v196, v144
    v_mfma_f32_32x32x16_bf16 v[112:127], a[216:219], v[104:107], v[112:127]
    ds_read_b128 a[212:215], v225 offset:8192
    v_exp_f32 v197, v145
    v_mfma_f32_32x32x16_bf16 v[112:127], a[220:223], v[108:111], v[112:127]
    ds_read_b128 a[216:219], v226 offset:8192
    s_cbranch_vccnz FX10
FX10_RET:
    v_add_f32 v239, v239, v242
    v_exp_f32 v198, v146
    v_add_f32 v244, v196, v197
    v_cvt_pk_bf16_f32 v176, v196, v197
    v_mfma_f32_32x32x16_bf16 a[64:79], a[224:227], v[168:171], a[64:79]
    ds_read_b128 a[220:223], v227 offset:8192
    v_exp_f32 v199, v147
    v_add_f32 v244, v244, v198
    v_mfma_f32_32x32x16_bf16 a[80:95], a[228:231], v[168:171], a[80:95]
    ds_read_b64_tr_b16 a[224:225], v228 offset:24576
    ds_read_b64_tr_b16 a[226:227], v228 offset:26624
    v_exp_f32 v196, v148
    v_add_f32 v244, v244, v199
    v_cvt_pk_bf16_f32 v177, v198, v199
    v_mfma_f32_32x32x16_bf16 a[96:111], a[232:235], v[168:171], a[96:111]
    ds_read_b64_tr_b16 a[228:229], v229 offset:24576
    ds_read_b64_tr_b16 a[230:231], v229 offset:26624
    v_exp_f32 v197, v149
    v_add_f32 v244, v244, v196
    v_mfma_f32_32x32x16_bf16 a[112:127], a[236:239], v[168:171], a[112:127]
    ds_read_b64_tr_b16 a[232:233], v230 offset:24576
    ds_read_b64_tr_b16 a[234:235], v230 offset:26624
    v_exp_f32 v198, v150
    v_add_f32 v244, v244, v197
    v_cvt_pk_bf16_f32 v178, v196, v197
    v_mfma_f32_32x32x16_bf16 a[64:79], a[240:243], v[172:175], a[64:79]
    ds_read_b64_tr_b16 a[236:237], v231 offset:24576
    ds_read_b64_tr_b16 a[238:239], v231 offset:26624
    v_exp_f32 v199, v151
    v_add_f32 v244, v244, v198
    v_mfma_f32_32x32x16_bf16 a[80:95], a[244:247], v[172:175], a[80:95]
    ds_read_b64_tr_b16 a[240:241], v228 offset:28672
    ds_read_b64_tr_b16 a[242:243], v228 offset:30720
    v_add_f32 v244, v244, v199
    v_cvt_pk_bf16_f32 v179, v198, v199
    v_exp_f32 v196, v112
    v_mfma_f32_32x32x16_bf16 a[96:111], a[248:251], v[172:175], a[96:111]
    ds_read_b64_tr_b16 a[244:245], v229 offset:28672
    ds_read_b64_tr_b16 a[246:247], v229 offset:30720
    v_exp_f32 v197, v113
    v_mfma_f32_32x32x16_bf16 a[112:127], a[252:255], v[172:175], a[112:127]
    ds_read_b64_tr_b16 a[248:249], v230 offset:28672
    ds_read_b64_tr_b16 a[250:251], v230 offset:30720
    v_exp_f32 v198, v114
    v_add_f32 v243, v196, v197
    v_cvt_pk_bf16_f32 v168, v196, v197
    s_waitcnt lgkmcnt(14)
    v_mfma_f32_32x32x16_bf16 v[48:63], a[192:195], v[16:19], v[64:79]
    ds_read_b64_tr_b16 a[252:253], v231 offset:28672
    ds_read_b64_tr_b16 a[254:255], v231 offset:30720
    v_exp_f32 v199, v115
    v_add_f32 v243, v243, v198
    v_mfma_f32_32x32x16_bf16 v[48:63], a[196:199], v[20:23], v[48:63]
    s_add_u32 m0, s38, s86
    v_exp_f32 v196, v116
    v_add_f32 v243, v243, v199
    v_cvt_pk_bf16_f32 v169, v198, v199
    v_mfma_f32_32x32x16_bf16 v[48:63], a[200:203], v[24:27], v[48:63]
    buffer_load_dwordx4 v236, s[20:23], s37 offen nt lds
    v_exp_f32 v197, v117
    v_add_f32 v243, v243, v196
    v_mfma_f32_32x32x16_bf16 v[48:63], a[204:207], v[28:31], v[48:63]
    v_exp_f32 v198, v118
    v_add_f32 v243, v243, v197
    v_cvt_pk_bf16_f32 v170, v196, v197
    v_mfma_f32_32x32x16_bf16 v[48:63], a[208:211], v[32:35], v[48:63]
    v_exp_f32 v199, v119
    v_add_f32 v243, v243, v198
    v_mfma_f32_32x32x16_bf16 v[48:63], a[212:215], v[36:39], v[48:63]
    buffer_load_dwordx4 v236, s[20:23], s37 offen offset:1024 nt lds
    v_exp_f32 v196, v120
    v_add_f32 v243, v243, v199
    v_cvt_pk_bf16_f32 v171, v198, v199
    v_mfma_f32_32x32x16_bf16 v[48:63], a[216:219], v[40:43], v[48:63]
    v_exp_f32 v197, v121
    v_add_f32 v243, v243, v196
    v_mfma_f32_32x32x16_bf16 v[48:63], a[220:223], v[44:47], v[48:63]
    v_exp_f32 v198, v122
    v_add_f32 v243, v243, v197
    v_cvt_pk_bf16_f32 v172, v196, v197
    s_waitcnt lgkmcnt(0)
    v_mfma_f32_32x32x16_bf16 a[0:15], a[224:227], v[160:163], a[0:15]
    buffer_load_dwordx4 v236, s[20:23], s37 offen offset:2048 nt lds
    v_exp_f32 v199, v123
    v_add_f32 v243, v243, v198
    v_mfma_f32_32x32x16_bf16 a[16:31], a[228:231], v[160:163], a[16:31]
    v_exp_f32 v196, v124
    v_add_f32 v243, v243, v199
    v_cvt_pk_bf16_f32 v173, v198, v199
    v_mfma_f32_32x32x16_bf16 a[32:47], a[232:235], v[160:163], a[32:47]
    v_exp_f32 v197, v125
    v_add_f32 v243, v243, v196
    v_mfma_f32_32x32x16_bf16 a[48:63], a[236:239], v[160:163], a[48:63]
    buffer_load_dwordx4 v236, s[20:23], s37 offen offset:3072 nt lds
    v_exp_f32 v198, v126
    v_add_f32 v243, v243, v197
    v_cvt_pk_bf16_f32 v174, v196, v197
    v_mfma_f32_32x32x16_bf16 a[0:15], a[240:243], v[164:167], a[0:15]
    v_exp_f32 v199, v127
    v_add_f32 v243, v243, v198
    v_mfma_f32_32x32x16_bf16 a[16:31], a[244:247], v[164:167], a[16:31]
    v_add_f32 v243, v243, v199
    v_cvt_pk_bf16_f32 v175, v198, v199
    v_cmp_lt_f32 vcc, s35, v243
    v_exp_f32 v196, v152
    v_mfma_f32_32x32x16_bf16 a[32:47], a[248:251], v[164:167], a[32:47]
    s_add_u32 s37, s37, 16384
    v_exp_f32 v197, v153
    v_add_f32 v244, v244, v196
    v_mfma_f32_32x32x16_bf16 a[48:63], a[252:255], v[164:167], a[48:63]
    s_add_u32 s38, s38, 32768
    s_and_b32 s38, s38, 131071
    s_cbranch_vccnz FX11
FX11_RET:
    v_add_f32 v240, v240, v243
    v_exp_f32 v198, v154
    v_add_f32 v244, v244, v197
    v_cvt_pk_bf16_f32 v180, v196, v197
    v_mfma_f32_32x32x16_bf16 v[112:127], a[192:195], v[80:83], v[128:143]
    v_exp_f32 v199, v155
    v_add_f32 v244, v244, v198
    v_mfma_f32_32x32x16_bf16 v[112:127], a[196:199], v[84:87], v[112:127]
    v_exp_f32 v196, v156
    v_add_f32 v244, v244, v199
    v_cvt_pk_bf16_f32 v181, v198, v199
    s_waitcnt vmcnt(16)
    s_barrier
    ds_read_b128 a[192:195], v220 offset:32768
    v_mfma_f32_32x32x16_bf16 v[112:127], a[200:203], v[88:91], v[112:127]
    ds_read_b128 a[196:199], v221 offset:32768
    v_exp_f32 v197, v157
    v_add_f32 v244, v244, v196
    v_mfma_f32_32x32x16_bf16 v[112:127], a[204:207], v[92:95], v[112:127]
    ds_read_b128 a[200:203], v222 offset:32768
    v_exp_f32 v198, v158
    v_add_f32 v244, v244, v197
    v_cvt_pk_bf16_f32 v182, v196, v197
    v_mfma_f32_32x32x16_bf16 v[112:127], a[208:211], v[96:99], v[112:127]
    ds_read_b128 a[204:207], v223 offset:32768
    v_exp_f32 v199, v159
    v_add_f32 v244, v244, v198
    v_mfma_f32_32x32x16_bf16 v[112:127], a[212:215], v[100:103], v[112:127]
    ds_read_b128 a[208:211], v224 offset:32768
    v_add_f32 v244, v244, v199
    v_cvt_pk_bf16_f32 v183, v198, v199
    v_cmp_lt_f32 vcc, s35, v244
    v_exp_f32 v196, v48
    v_mfma_f32_32x32x16_bf16 v[112:127], a[216:219], v[104:107], v[112:127]
    ds_read_b128 a[212:215], v225 offset:32768
    v_exp_f32 v197, v49
    v_mfma_f32_32x32x16_bf16 v[112:127], a[220:223], v[108:111], v[112:127]
    ds_read_b128 a[216:219], v226 offset:32768
    s_cbranch_vccnz FX12
FX12_RET:
    v_add_f32 v241, v241, v244
    v_exp_f32 v198, v50
    v_add_f32 v242, v196, v197
    v_cvt_pk_bf16_f32 v160, v196, v197
    v_mfma_f32_32x32x16_bf16 a[128:143], a[224:227], v[176:179], a[128:143]
    ds_read_b128 a[220:223], v227 offset:32768
    v_exp_f32 v199, v51
    v_add_f32 v242, v242, v198
    v_mfma_f32_32x32x16_bf16 a[144:159], a[228:231], v[176:179], a[144:159]
    v_exp_f32 v196, v52
    v_add_f32 v242, v242, v199
    v_cvt_pk_bf16_f32 v161, v198, v199
    v_mfma_f32_32x32x16_bf16 a[160:175], a[232:235], v[176:179], a[160:175]
    v_exp_f32 v197, v53
    v_add_f32 v242, v242, v196
    v_mfma_f32_32x32x16_bf16 a[176:191], a[236:239], v[176:179], a[176:191]
    v_exp_f32 v198, v54
    v_add_f32 v242, v242, v197
    v_cvt_pk_bf16_f32 v162, v196, v197
    v_mfma_f32_32x32x16_bf16 a[128:143], a[240:243], v[180:183], a[128:143]
    v_exp_f32 v199, v55
    v_add_f32 v242, v242, v198
    v_mfma_f32_32x32x16_bf16 a[144:159], a[244:247], v[180:183], a[144:159]
    v_exp_f32 v196, v56
    v_add_f32 v242, v242, v199
    v_cvt_pk_bf16_f32 v163, v198, v199
    v_mfma_f32_32x32x16_bf16 a[160:175], a[248:251], v[180:183], a[160:175]
    v_exp_f32 v197, v57
    v_add_f32 v242, v242, v196
    v_mfma_f32_32x32x16_bf16 a[176:191], a[252:255], v[180:183], a[176:191]
    v_exp_f32 v198, v58
    v_add_f32 v242, v242, v197
    v_cvt_pk_bf16_f32 v164, v196, v197
    v_mfma_f32_32x32x16_bf16 a[64:79], a[224:227], v[168:171], a[64:79]
    v_exp_f32 v199, v59
    v_add_f32 v242, v242, v198
    v_mfma_f32_32x32x16_bf16 a[80:95], a[228:231], v[168:171], a[80:95]
    ds_read_b64_tr_b16 a[224:225], v228 offset:49152
    ds_read_b64_tr_b16 a[226:227], v228 offset:51200
    v_exp_f32 v196, v60
    v_add_f32 v242, v242, v199
    v_cvt_pk_bf16_f32 v165, v198, v199
    v_mfma_f32_32x32x16_bf16 a[96:111], a[232:235], v[168:171], a[96:111]
    ds_read_b64_tr_b16 a[228:229], v229 offset:49152
    ds_read_b64_tr_b16 a[230:231], v229 offset:51200
    v_exp_f32 v197, v61
    v_add_f32 v242, v242, v196
    v_mfma_f32_32x32x16_bf16 a[112:127], a[236:239], v[168:171], a[112:127]
    ds_read_b64_tr_b16 a[232:233], v230 offset:49152
    ds_read_b64_tr_b16 a[234:235], v230 offset:51200
    v_exp_f32 v198, v62
    v_add_f32 v242, v242, v197
    v_cvt_pk_bf16_f32 v166, v196, v197
    v_mfma_f32_32x32x16_bf16 a[64:79], a[240:243], v[172:175], a[64:79]
    ds_read_b64_tr_b16 a[236:237], v231 offset:49152
    ds_read_b64_tr_b16 a[238:239], v231 offset:51200
    v_exp_f32 v199, v63
    v_add_f32 v242, v242, v198
    v_mfma_f32_32x32x16_bf16 a[80:95], a[244:247], v[172:175], a[80:95]
    ds_read_b64_tr_b16 a[240:241], v228 offset:53248
    ds_read_b64_tr_b16 a[242:243], v228 offset:55296
    v_add_f32 v242, v242, v199
    v_cvt_pk_bf16_f32 v167, v198, v199
    v_cmp_lt_f32 vcc, s35, v242
    v_exp_f32 v196, v112
    v_mfma_f32_32x32x16_bf16 a[96:111], a[248:251], v[172:175], a[96:111]
    ds_read_b64_tr_b16 a[244:245], v229 offset:53248
    ds_read_b64_tr_b16 a[246:247], v229 offset:55296
    v_exp_f32 v197, v113
    v_mfma_f32_32x32x16_bf16 a[112:127], a[252:255], v[172:175], a[112:127]
    ds_read_b64_tr_b16 a[248:249], v230 offset:53248
    ds_read_b64_tr_b16 a[250:251], v230 offset:55296
    s_cbranch_vccnz FX13
FX13_RET:
    v_add_f32 v239, v239, v242
    v_exp_f32 v198, v114
    v_add_f32 v243, v196, v197
    v_cvt_pk_bf16_f32 v168, v196, v197
    s_waitcnt lgkmcnt(14)
    v_mfma_f32_32x32x16_bf16 v[48:63], a[192:195], v[16:19], v[64:79]
    ds_read_b64_tr_b16 a[252:253], v231 offset:53248
    ds_read_b64_tr_b16 a[254:255], v231 offset:55296
    v_exp_f32 v199, v115
    v_add_f32 v243, v243, v198
    v_mfma_f32_32x32x16_bf16 v[48:63], a[196:199], v[20:23], v[48:63]
    v_exp_f32 v196, v116
    v_add_f32 v243, v243, v199
    v_cvt_pk_bf16_f32 v169, v198, v199
    v_mfma_f32_32x32x16_bf16 v[48:63], a[200:203], v[24:27], v[48:63]
    s_add_u32 m0, s38, s82
    v_exp_f32 v197, v117
    v_add_f32 v243, v243, v196
    v_mfma_f32_32x32x16_bf16 v[48:63], a[204:207], v[28:31], v[48:63]
    buffer_load_dwordx4 v232, s[16:19], s36 offen nt lds
    v_exp_f32 v198, v118
    v_add_f32 v243, v243, v197
    v_cvt_pk_bf16_f32 v170, v196, v197
    v_mfma_f32_32x32x16_bf16 v[48:63], a[208:211], v[32:35], v[48:63]
    v_exp_f32 v199, v119
    v_add_f32 v243, v243, v198
    v_mfma_f32_32x32x16_bf16 v[48:63], a[212:215], v[36:39], v[48:63]
    v_exp_f32 v196, v120
    v_add_f32 v243, v243, v199
    v_cvt_pk_bf16_f32 v171, v198, v199
    v_mfma_f32_32x32x16_bf16 v[48:63], a[216:219], v[40:43], v[48:63]
    v_exp_f32 v197, v121
    v_add_f32 v243, v243, v196
    v_mfma_f32_32x32x16_bf16 v[48:63], a[220:223], v[44:47], v[48:63]
    v_exp_f32 v198, v122
    v_add_f32 v243, v243, v197
    v_cvt_pk_bf16_f32 v172, v196, v197
    s_waitcnt lgkmcnt(0)
    v_mfma_f32_32x32x16_bf16 a[0:15], a[224:227], v[160:163], a[0:15]
    v_exp_f32 v199, v123
    v_add_f32 v243, v243, v198
    v_mfma_f32_32x32x16_bf16 a[16:31], a[228:231], v[160:163], a[16:31]
    v_exp_f32 v196, v124
    v_add_f32 v243, v243, v199
    v_cvt_pk_bf16_f32 v173, v198, v199
    v_mfma_f32_32x32x16_bf16 a[32:47], a[232:235], v[160:163], a[32:47]
    buffer_load_dwordx4 v233, s[16:19], s36 offen offset:1024 nt lds
    v_exp_f32 v197, v125
    v_add_f32 v243, v243, v196
    v_mfma_f32_32x32x16_bf16 a[48:63], a[236:239], v[160:163], a[48:63]
    v_exp_f32 v198, v126
    v_add_f32 v243, v243, v197
    v_cvt_pk_bf16_f32 v174, v196, v197
    v_mfma_f32_32x32x16_bf16 a[0:15], a[240:243], v[164:167], a[0:15]
    v_exp_f32 v199, v127
    v_add_f32 v243, v243, v198
    v_mfma_f32_32x32x16_bf16 a[16:31], a[244:247], v[164:167], a[16:31]
    v_add_f32 v243, v243, v199
    v_cvt_pk_bf16_f32 v175, v198, v199
    v_cmp_lt_f32 vcc, s35, v243
    v_exp_f32 v196, v48
    v_mfma_f32_32x32x16_bf16 a[32:47], a[248:251], v[164:167], a[32:47]
    v_exp_f32 v197, v49
    v_mfma_f32_32x32x16_bf16 a[48:63], a[252:255], v[164:167], a[48:63]
    s_cbranch_vccnz FX14
FX14_RET:
    v_add_f32 v240, v240, v243
    v_exp_f32 v198, v50
    v_add_f32 v242, v196, v197
    v_cvt_pk_bf16_f32 v160, v196, v197
    v_mfma_f32_32x32x16_bf16 v[112:127], a[192:195], v[80:83], v[128:143]
    v_exp_f32 v199, v51
    v_add_f32 v242, v242, v198
    v_mfma_f32_32x32x16_bf16 v[112:127], a[196:199], v[84:87], v[112:127]
    ds_read_b128 a[192:195], v220 offset:40960
    buffer_load_dwordx4 v234, s[16:19], s36 offen offset:2048 nt lds
    v_exp_f32 v196, v52
    v_add_f32 v242, v242, v199
    v_cvt_pk_bf16_f32 v161, v198, v199
    v_mfma_f32_32x32x16_bf16 v[112:127], a[200:203], v[88:91], v[112:127]
    ds_read_b128 a[196:199], v221 offset:40960
    v_exp_f32 v197, v53
    v_add_f32 v242, v242, v196
    v_mfma_f32_32x32x16_bf16 v[112:127], a[204:207], v[92:95], v[112:127]
    ds_read_b128 a[200:203], v222 offset:40960
    v_exp_f32 v198, v54
    v_add_f32 v242, v242, v197
    v_cvt_pk_bf16_f32 v162, v196, v197
    v_mfma_f32_32x32x16_bf16 v[112:127], a[208:211], v[96:99], v[112:127]
    ds_read_b128 a[204:207], v223 offset:40960
    v_exp_f32 v199, v55
    v_add_f32 v242, v242, v198
    v_mfma_f32_32x32x16_bf16 v[112:127], a[212:215], v[100:103], v[112:127]
    ds_read_b128 a[208:211], v224 offset:40960
    v_exp_f32 v196, v56
    v_add_f32 v242, v242, v199
    v_cvt_pk_bf16_f32 v163, v198, v199
    v_mfma_f32_32x32x16_bf16 v[112:127], a[216:219], v[104:107], v[112:127]
    ds_read_b128 a[212:215], v225 offset:40960
    v_exp_f32 v197, v57
    v_add_f32 v242, v242, v196
    v_mfma_f32_32x32x16_bf16 v[112:127], a[220:223], v[108:111], v[112:127]
    ds_read_b128 a[216:219], v226 offset:40960
    v_exp_f32 v198, v58
    v_add_f32 v242, v242, v197
    v_cvt_pk_bf16_f32 v164, v196, v197
    v_mfma_f32_32x32x16_bf16 a[64:79], a[224:227], v[168:171], a[64:79]
    ds_read_b128 a[220:223], v227 offset:40960
    buffer_load_dwordx4 v235, s[16:19], s36 offen offset:3072 nt lds
    v_exp_f32 v199, v59
    v_add_f32 v242, v242, v198
    v_mfma_f32_32x32x16_bf16 a[80:95], a[228:231], v[168:171], a[80:95]
    ds_read_b64_tr_b16 a[224:225], v228 offset:57344
    ds_read_b64_tr_b16 a[226:227], v228 offset:59392
    v_exp_f32 v196, v60
    v_add_f32 v242, v242, v199
    v_cvt_pk_bf16_f32 v165, v198, v199
    v_mfma_f32_32x32x16_bf16 a[96:111], a[232:235], v[168:171], a[96:111]
    ds_read_b64_tr_b16 a[228:229], v229 offset:57344
    ds_read_b64_tr_b16 a[230:231], v229 offset:59392
    s_add_u32 s36, s36, 16384
    v_exp_f32 v197, v61
    v_add_f32 v242, v242, v196
    v_mfma_f32_32x32x16_bf16 a[112:127], a[236:239], v[168:171], a[112:127]
    ds_read_b64_tr_b16 a[232:233], v230 offset:57344
    ds_read_b64_tr_b16 a[234:235], v230 offset:59392
    v_exp_f32 v198, v62
    v_add_f32 v242, v242, v197
    v_cvt_pk_bf16_f32 v166, v196, v197
    v_mfma_f32_32x32x16_bf16 a[64:79], a[240:243], v[172:175], a[64:79]
    ds_read_b64_tr_b16 a[236:237], v231 offset:57344
    ds_read_b64_tr_b16 a[238:239], v231 offset:59392
    v_exp_f32 v199, v63
    v_add_f32 v242, v242, v198
    v_mfma_f32_32x32x16_bf16 a[80:95], a[244:247], v[172:175], a[80:95]
    ds_read_b64_tr_b16 a[240:241], v228 offset:61440
    ds_read_b64_tr_b16 a[242:243], v228 offset:63488
    v_add_f32 v242, v242, v199
    v_cvt_pk_bf16_f32 v167, v198, v199
    v_cmp_lt_f32 vcc, s35, v242
    v_exp_f32 v196, v112
    v_mfma_f32_32x32x16_bf16 a[96:111], a[248:251], v[172:175], a[96:111]
    ds_read_b64_tr_b16 a[244:245], v229 offset:61440
    ds_read_b64_tr_b16 a[246:247], v229 offset:63488
    v_exp_f32 v197, v113
    v_mfma_f32_32x32x16_bf16 a[112:127], a[252:255], v[172:175], a[112:127]
    ds_read_b64_tr_b16 a[248:249], v230 offset:61440
    ds_read_b64_tr_b16 a[250:251], v230 offset:63488
    s_cbranch_vccnz FX15
FX15_RET:
    v_add_f32 v239, v239, v242
    v_exp_f32 v198, v114
    v_add_f32 v243, v196, v197
    v_cvt_pk_bf16_f32 v168, v196, v197
    s_waitcnt lgkmcnt(14)
    v_mfma_f32_32x32x16_bf16 v[48:63], a[192:195], v[16:19], v[64:79]
    ds_read_b64_tr_b16 a[252:253], v231 offset:61440
    ds_read_b64_tr_b16 a[254:255], v231 offset:63488
    v_exp_f32 v199, v115
    v_add_f32 v243, v243, v198
    v_mfma_f32_32x32x16_bf16 v[48:63], a[196:199], v[20:23], v[48:63]
    s_add_u32 m0, s38, s86
    v_exp_f32 v196, v116
    v_add_f32 v243, v243, v199
    v_cvt_pk_bf16_f32 v169, v198, v199
    v_mfma_f32_32x32x16_bf16 v[48:63], a[200:203], v[24:27], v[48:63]
    buffer_load_dwordx4 v236, s[20:23], s37 offen nt lds
    v_exp_f32 v197, v117
    v_add_f32 v243, v243, v196
    v_xor_b32 v220, 65536, v220
    v_mfma_f32_32x32x16_bf16 v[48:63], a[204:207], v[28:31], v[48:63]
    v_exp_f32 v198, v118
    v_add_f32 v243, v243, v197
    v_cvt_pk_bf16_f32 v170, v196, v197
    v_xor_b32 v221, 65536, v221
    v_mfma_f32_32x32x16_bf16 v[48:63], a[208:211], v[32:35], v[48:63]
    v_exp_f32 v199, v119
    v_add_f32 v243, v243, v198
    v_xor_b32 v222, 65536, v222
    v_mfma_f32_32x32x16_bf16 v[48:63], a[212:215], v[36:39], v[48:63]
    buffer_load_dwordx4 v236, s[20:23], s37 offen offset:1024 nt lds
    v_exp_f32 v196, v120
    v_add_f32 v243, v243, v199
    v_cvt_pk_bf16_f32 v171, v198, v199
    v_xor_b32 v223, 65536, v223
    v_mfma_f32_32x32x16_bf16 v[48:63], a[216:219], v[40:43], v[48:63]
    v_exp_f32 v197, v121
    v_add_f32 v243, v243, v196
    v_xor_b32 v224, 65536, v224
    v_mfma_f32_32x32x16_bf16 v[48:63], a[220:223], v[44:47], v[48:63]
    v_exp_f32 v198, v122
    v_add_f32 v243, v243, v197
    v_cvt_pk_bf16_f32 v172, v196, v197
    v_xor_b32 v225, 65536, v225
    s_waitcnt lgkmcnt(0)
    v_mfma_f32_32x32x16_bf16 a[0:15], a[224:227], v[160:163], a[0:15]
    buffer_load_dwordx4 v236, s[20:23], s37 offen offset:2048 nt lds
    v_exp_f32 v199, v123
    v_add_f32 v243, v243, v198
    v_xor_b32 v226, 65536, v226
    v_mfma_f32_32x32x16_bf16 a[16:31], a[228:231], v[160:163], a[16:31]
    v_exp_f32 v196, v124
    v_add_f32 v243, v243, v199
    v_cvt_pk_bf16_f32 v173, v198, v199
    v_xor_b32 v227, 65536, v227
    v_mfma_f32_32x32x16_bf16 a[32:47], a[232:235], v[160:163], a[32:47]
    v_exp_f32 v197, v125
    v_add_f32 v243, v243, v196
    v_xor_b32 v228, 65536, v228
    v_mfma_f32_32x32x16_bf16 a[48:63], a[236:239], v[160:163], a[48:63]
    buffer_load_dwordx4 v236, s[20:23], s37 offen offset:3072 nt lds
    v_exp_f32 v198, v126
    v_add_f32 v243, v243, v197
    v_cvt_pk_bf16_f32 v174, v196, v197
    v_xor_b32 v229, 65536, v229
    v_mfma_f32_32x32x16_bf16 a[0:15], a[240:243], v[164:167], a[0:15]
    v_exp_f32 v199, v127
    v_add_f32 v243, v243, v198
    v_xor_b32 v230, 65536, v230
    v_mfma_f32_32x32x16_bf16 a[16:31], a[244:247], v[164:167], a[16:31]
    v_add_f32 v243, v243, v199
    v_cvt_pk_bf16_f32 v175, v198, v199
    v_cmp_lt_f32 vcc, s35, v243
    v_exp_f32 v196, v48
    v_xor_b32 v231, 65536, v231
    v_mfma_f32_32x32x16_bf16 a[32:47], a[248:251], v[164:167], a[32:47]
    s_add_u32 s37, s37, 16384
    v_exp_f32 v197, v49
    v_mfma_f32_32x32x16_bf16 a[48:63], a[252:255], v[164:167], a[48:63]
    s_add_u32 s38, s38, 32768
    s_and_b32 s38, s38, 131071
    s_cbranch_vccnz FX16
FX16_RET:
    v_add_f32 v240, v240, v243
    v_exp_f32 v198, v50
    v_add_f32 v242, v196, v197
    v_cvt_pk_bf16_f32 v160, v196, v197
    v_mfma_f32_32x32x16_bf16 v[112:127], a[192:195], v[80:83], v[128:143]
    v_exp_f32 v199, v51
    v_add_f32 v242, v242, v198
    v_mfma_f32_32x32x16_bf16 v[112:127], a[196:199], v[84:87], v[112:127]
    v_exp_f32 v196, v52
    v_add_f32 v242, v242, v199
    v_cvt_pk_bf16_f32 v161, v198, v199
    s_waitcnt vmcnt(16)
    s_barrier
    ds_read_b128 a[192:195], v220
    v_mfma_f32_32x32x16_bf16 v[112:127], a[200:203], v[88:91], v[112:127]
    ds_read_b128 a[196:199], v221
    v_exp_f32 v197, v53
    v_add_f32 v242, v242, v196
    v_mfma_f32_32x32x16_bf16 v[112:127], a[204:207], v[92:95], v[112:127]
    ds_read_b128 a[200:203], v222
    v_exp_f32 v198, v54
    v_add_f32 v242, v242, v197
    v_cvt_pk_bf16_f32 v162, v196, v197
    v_mfma_f32_32x32x16_bf16 v[112:127], a[208:211], v[96:99], v[112:127]
    ds_read_b128 a[204:207], v223
    v_exp_f32 v199, v55
    v_add_f32 v242, v242, v198
    v_mfma_f32_32x32x16_bf16 v[112:127], a[212:215], v[100:103], v[112:127]
    ds_read_b128 a[208:211], v224
    v_exp_f32 v196, v56
    v_add_f32 v242, v242, v199
    v_cvt_pk_bf16_f32 v163, v198, v199
    v_mfma_f32_32x32x16_bf16 v[112:127], a[216:219], v[104:107], v[112:127]
    ds_read_b128 a[212:215], v225
    v_exp_f32 v197, v57
    v_add_f32 v242, v242, v196
    v_mfma_f32_32x32x16_bf16 v[112:127], a[220:223], v[108:111], v[112:127]
    ds_read_b128 a[216:219], v226
    v_exp_f32 v198, v58
    v_add_f32 v242, v242, v197
    v_cvt_pk_bf16_f32 v164, v196, v197
    v_mfma_f32_32x32x16_bf16 a[64:79], a[224:227], v[168:171], a[64:79]
    ds_read_b128 a[220:223], v227
    v_exp_f32 v199, v59
    v_add_f32 v242, v242, v198
    v_mfma_f32_32x32x16_bf16 a[80:95], a[228:231], v[168:171], a[80:95]
    ds_read_b64_tr_b16 a[224:225], v228 offset:16384
    ds_read_b64_tr_b16 a[226:227], v228 offset:18432
    v_exp_f32 v196, v60
    v_add_f32 v242, v242, v199
    v_cvt_pk_bf16_f32 v165, v198, v199
    v_mfma_f32_32x32x16_bf16 a[96:111], a[232:235], v[168:171], a[96:111]
    ds_read_b64_tr_b16 a[228:229], v229 offset:16384
    ds_read_b64_tr_b16 a[230:231], v229 offset:18432
    v_exp_f32 v197, v61
    v_add_f32 v242, v242, v196
    v_mfma_f32_32x32x16_bf16 a[112:127], a[236:239], v[168:171], a[112:127]
    ds_read_b64_tr_b16 a[232:233], v230 offset:16384
    ds_read_b64_tr_b16 a[234:235], v230 offset:18432
    v_exp_f32 v198, v62
    v_add_f32 v242, v242, v197
    v_cvt_pk_bf16_f32 v166, v196, v197
    v_mfma_f32_32x32x16_bf16 a[64:79], a[240:243], v[172:175], a[64:79]
    ds_read_b64_tr_b16 a[236:237], v231 offset:16384
    ds_read_b64_tr_b16 a[238:239], v231 offset:18432
    v_exp_f32 v199, v63
    v_add_f32 v242, v242, v198
    v_mfma_f32_32x32x16_bf16 a[80:95], a[244:247], v[172:175], a[80:95]
    ds_read_b64_tr_b16 a[240:241], v228 offset:20480
    ds_read_b64_tr_b16 a[242:243], v228 offset:22528
    v_add_f32 v242, v242, v199
    v_cvt_pk_bf16_f32 v167, v198, v199
    v_cmp_lt_f32 vcc, s35, v242
    v_exp_f32 v196, v112
    v_mfma_f32_32x32x16_bf16 a[96:111], a[248:251], v[172:175], a[96:111]
    ds_read_b64_tr_b16 a[244:245], v229 offset:20480
    ds_read_b64_tr_b16 a[246:247], v229 offset:22528
    v_exp_f32 v197, v113
    v_mfma_f32_32x32x16_bf16 a[112:127], a[252:255], v[172:175], a[112:127]
    ds_read_b64_tr_b16 a[248:249], v230 offset:20480
    ds_read_b64_tr_b16 a[250:251], v230 offset:22528
    s_cbranch_vccnz FX17
FX17_RET:
    v_add_f32 v239, v239, v242
    v_exp_f32 v198, v114
    v_add_f32 v243, v196, v197
    v_cvt_pk_bf16_f32 v168, v196, v197
    s_sub_u32 s39, s39, 1
    s_cmp_lg_u32 s39, 0
    s_cbranch_scc1 W0_AL
    ds_read_b64_tr_b16 a[252:253], v231 offset:20480
    ds_read_b64_tr_b16 a[254:255], v231 offset:22528
    s_add_u32 s46, s54, 0
    v_exp_f32 v199, v115
    v_add_f32 v243, v243, v198
    buffer_load_dwordx4 v[16:19], v245, s[24:27], s46 offen
    v_exp_f32 v196, v116
    v_add_f32 v243, v243, v199
    v_cvt_pk_bf16_f32 v169, v198, v199
    v_exp_f32 v197, v117
    v_add_f32 v243, v243, v196
    buffer_load_dwordx4 v[20:23], v245, s[24:27], s46 offen offset:1024
    v_exp_f32 v198, v118
    v_add_f32 v243, v243, v197
    v_cvt_pk_bf16_f32 v170, v196, v197
    buffer_load_dwordx4 v[24:27], v245, s[24:27], s46 offen offset:2048
    v_exp_f32 v199, v119
    v_add_f32 v243, v243, v198
    v_exp_f32 v196, v120
    v_add_f32 v243, v243, v199
    v_cvt_pk_bf16_f32 v171, v198, v199
    buffer_load_dwordx4 v[28:31], v245, s[24:27], s46 offen offset:3072
    v_exp_f32 v197, v121
    v_add_f32 v243, v243, v196
    v_exp_f32 v198, v122
    v_add_f32 v243, v243, v197
    v_cvt_pk_bf16_f32 v172, v196, v197
    s_waitcnt lgkmcnt(0)
    v_mfma_f32_32x32x16_bf16 a[0:15], a[224:227], v[160:163], a[0:15]
    s_add_u32 s46, s54, 4096
    v_exp_f32 v199, v123
    v_add_f32 v243, v243, v198
    v_mfma_f32_32x32x16_bf16 a[16:31], a[228:231], v[160:163], a[16:31]
    buffer_load_dwordx4 v[32:35], v245, s[24:27], s46 offen
    v_exp_f32 v196, v124
    v_add_f32 v243, v243, v199
    v_cvt_pk_bf16_f32 v173, v198, v199
    v_mfma_f32_32x32x16_bf16 a[32:47], a[232:235], v[160:163], a[32:47]
    v_exp_f32 v197, v125
    v_add_f32 v243, v243, v196
    v_mfma_f32_32x32x16_bf16 a[48:63], a[236:239], v[160:163], a[48:63]
    buffer_load_dwordx4 v[36:39], v245, s[24:27], s46 offen offset:1024
    v_exp_f32 v198, v126
    v_add_f32 v243, v243, v197
    v_cvt_pk_bf16_f32 v174, v196, v197
    v_mfma_f32_32x32x16_bf16 a[0:15], a[240:243], v[164:167], a[0:15]
    buffer_load_dwordx4 v[40:43], v245, s[24:27], s46 offen offset:2048
    v_exp_f32 v199, v127
    v_add_f32 v243, v243, v198
    v_mfma_f32_32x32x16_bf16 a[16:31], a[244:247], v[164:167], a[16:31]
    v_add_f32 v243, v243, v199
    v_cvt_pk_bf16_f32 v175, v198, v199
    v_cmp_lt_f32 vcc, s35, v243
    v_mfma_f32_32x32x16_bf16 a[32:47], a[248:251], v[164:167], a[32:47]
    buffer_load_dwordx4 v[44:47], v245, s[24:27], s46 offen offset:3072
    v_mfma_f32_32x32x16_bf16 a[48:63], a[252:255], v[164:167], a[48:63]
    s_cbranch_vccnz FX18
FX18_RET:
    v_add_f32 v240, v240, v243
    s_add_u32 s46, s54, 8192
    buffer_load_dwordx4 v[80:83], v245, s[24:27], s46 offen
    buffer_load_dwordx4 v[84:87], v245, s[24:27], s46 offen offset:1024
    buffer_load_dwordx4 v[88:91], v245, s[24:27], s46 offen offset:2048
    buffer_load_dwordx4 v[92:95], v245, s[24:27], s46 offen offset:3072
    v_mfma_f32_32x32x16_bf16 a[64:79], a[224:227], v[168:171], a[64:79]
    s_add_u32 s46, s54, 12288
    v_mfma_f32_32x32x16_bf16 a[80:95], a[228:231], v[168:171], a[80:95]
    buffer_load_dwordx4 v[96:99], v245, s[24:27], s46 offen
    v_mfma_f32_32x32x16_bf16 a[96:111], a[232:235], v[168:171], a[96:111]
    v_mfma_f32_32x32x16_bf16 a[112:127], a[236:239], v[168:171], a[112:127]
    buffer_load_dwordx4 v[100:103], v245, s[24:27], s46 offen offset:1024
    v_mfma_f32_32x32x16_bf16 a[64:79], a[240:243], v[172:175], a[64:79]
    buffer_load_dwordx4 v[104:107], v245, s[24:27], s46 offen offset:2048
    v_mfma_f32_32x32x16_bf16 a[80:95], a[244:247], v[172:175], a[80:95]
    v_mfma_f32_32x32x16_bf16 a[96:111], a[248:251], v[172:175], a[96:111]
    buffer_load_dwordx4 v[108:111], v245, s[24:27], s46 offen offset:3072
    v_mfma_f32_32x32x16_bf16 a[112:127], a[252:255], v[172:175], a[112:127]
    v_mov_b32 v2, v241
    s_nop 1
    v_permlane32_swap_b32 v241, v2
    v_add_f32 v241, v241, v2
    v_mov_b32 v2, v239
    s_nop 1
    v_permlane32_swap_b32 v239, v2
    v_add_f32 v239, v239, v2
    v_mov_b32 v2, v240
    s_nop 1
    v_permlane32_swap_b32 v240, v2
    v_add_f32 v240, v240, v2
    v_and_b32 v2, 31, v1
    v_lshlrev_b32 v2, 2, v2
    v_add_u32 v2, 159744, v2
    v_sub_f32 v3, 0, v204
    ds_write_b32 v2, v3
    ds_write_b32 v2, v241 offset:128
    v_rcp_f32 v48, v239
    s_nop 0
    v_mov_b32 v49, v48
    v_rcp_f32 v50, v240
    s_nop 0
    v_mov_b32 v51, v50
    s_add_u32 s42, s53, 0
    v_accvgpr_read_b32 v112, a0
    v_accvgpr_read_b32 v113, a1
    v_accvgpr_read_b32 v114, a2
    v_accvgpr_read_b32 v115, a3
    v_accvgpr_read_b32 v116, a4
    v_accvgpr_read_b32 v117, a5
    v_accvgpr_read_b32 v118, a6
    v_accvgpr_read_b32 v119, a7
    v_pk_mul_f32 v[112:113], v[112:113], v[48:49]
    v_pk_mul_f32 v[114:115], v[114:115], v[48:49]
    v_pk_mul_f32 v[116:117], v[116:117], v[48:49]
    v_pk_mul_f32 v[118:119], v[118:119], v[48:49]
    v_cvt_pk_bf16_f32 v176, v112, v113
    v_cvt_pk_bf16_f32 v177, v114, v115
    v_cvt_pk_bf16_f32 v178, v116, v117
    v_cvt_pk_bf16_f32 v179, v118, v119
    buffer_store_dwordx4 v[176:179], v238, s[24:27], s42 offen sc1
    v_accvgpr_read_b32 v120, a8
    v_accvgpr_read_b32 v121, a9
    v_accvgpr_read_b32 v122, a10
    v_accvgpr_read_b32 v123, a11
    v_accvgpr_read_b32 v124, a12
    v_accvgpr_read_b32 v125, a13
    v_accvgpr_read_b32 v126, a14
    v_accvgpr_read_b32 v127, a15
    v_pk_mul_f32 v[120:121], v[120:121], v[48:49]
    v_pk_mul_f32 v[122:123], v[122:123], v[48:49]
    v_pk_mul_f32 v[124:125], v[124:125], v[48:49]
    v_pk_mul_f32 v[126:127], v[126:127], v[48:49]
    v_cvt_pk_bf16_f32 v180, v120, v121
    v_cvt_pk_bf16_f32 v181, v122, v123
    v_cvt_pk_bf16_f32 v182, v124, v125
    v_cvt_pk_bf16_f32 v183, v126, v127
    buffer_store_dwordx4 v[180:183], v238, s[24:27], s42 offen offset:512 sc1
    s_add_u32 s42, s53, 147456
    v_accvgpr_read_b32 v112, a16
    v_accvgpr_read_b32 v113, a17
    v_accvgpr_read_b32 v114, a18
    v_accvgpr_read_b32 v115, a19
    v_accvgpr_read_b32 v116, a20
    v_accvgpr_read_b32 v117, a21
    v_accvgpr_read_b32 v118, a22
    v_accvgpr_read_b32 v119, a23
    v_pk_mul_f32 v[112:113], v[112:113], v[48:49]
    v_pk_mul_f32 v[114:115], v[114:115], v[48:49]
    v_pk_mul_f32 v[116:117], v[116:117], v[48:49]
    v_pk_mul_f32 v[118:119], v[118:119], v[48:49]
    v_cvt_pk_bf16_f32 v184, v112, v113
    v_cvt_pk_bf16_f32 v185, v114, v115
    v_cvt_pk_bf16_f32 v186, v116, v117
    v_cvt_pk_bf16_f32 v187, v118, v119
    buffer_store_dwordx4 v[184:187], v238, s[24:27], s42 offen sc1
    v_accvgpr_read_b32 v120, a24
    v_accvgpr_read_b32 v121, a25
    v_accvgpr_read_b32 v122, a26
    v_accvgpr_read_b32 v123, a27
    v_accvgpr_read_b32 v124, a28
    v_accvgpr_read_b32 v125, a29
    v_accvgpr_read_b32 v126, a30
    v_accvgpr_read_b32 v127, a31
    v_pk_mul_f32 v[120:121], v[120:121], v[48:49]
    v_pk_mul_f32 v[122:123], v[122:123], v[48:49]
    v_pk_mul_f32 v[124:125], v[124:125], v[48:49]
    v_pk_mul_f32 v[126:127], v[126:127], v[48:49]
    v_cvt_pk_bf16_f32 v188, v120, v121
    v_cvt_pk_bf16_f32 v189, v122, v123
    v_cvt_pk_bf16_f32 v190, v124, v125
    v_cvt_pk_bf16_f32 v191, v126, v127
    buffer_store_dwordx4 v[188:191], v238, s[24:27], s42 offen offset:512 sc1
    s_add_u32 s42, s53, 294912
    v_accvgpr_read_b32 v112, a32
    v_accvgpr_read_b32 v113, a33
    v_accvgpr_read_b32 v114, a34
    v_accvgpr_read_b32 v115, a35
    v_accvgpr_read_b32 v116, a36
    v_accvgpr_read_b32 v117, a37
    v_accvgpr_read_b32 v118, a38
    v_accvgpr_read_b32 v119, a39
    v_pk_mul_f32 v[112:113], v[112:113], v[48:49]
    v_pk_mul_f32 v[114:115], v[114:115], v[48:49]
    v_pk_mul_f32 v[116:117], v[116:117], v[48:49]
    v_pk_mul_f32 v[118:119], v[118:119], v[48:49]
    v_cvt_pk_bf16_f32 v176, v112, v113
    v_cvt_pk_bf16_f32 v177, v114, v115
    v_cvt_pk_bf16_f32 v178, v116, v117
    v_cvt_pk_bf16_f32 v179, v118, v119
    buffer_store_dwordx4 v[176:179], v238, s[24:27], s42 offen sc1
    v_accvgpr_read_b32 v120, a40
    v_accvgpr_read_b32 v121, a41
    v_accvgpr_read_b32 v122, a42
    v_accvgpr_read_b32 v123, a43
    v_accvgpr_read_b32 v124, a44
    v_accvgpr_read_b32 v125, a45
    v_accvgpr_read_b32 v126, a46
    v_accvgpr_read_b32 v127, a47
    v_pk_mul_f32 v[120:121], v[120:121], v[48:49]
    v_pk_mul_f32 v[122:123], v[122:123], v[48:49]
    v_pk_mul_f32 v[124:125], v[124:125], v[48:49]
    v_pk_mul_f32 v[126:127], v[126:127], v[48:49]
    v_cvt_pk_bf16_f32 v180, v120, v121
    v_cvt_pk_bf16_f32 v181, v122, v123
    v_cvt_pk_bf16_f32 v182, v124, v125
    v_cvt_pk_bf16_f32 v183, v126, v127
    buffer_store_dwordx4 v[180:183], v238, s[24:27], s42 offen offset:512 sc1
    s_add_u32 s42, s53, 442368
    v_accvgpr_read_b32 v112, a48
    v_accvgpr_read_b32 v113, a49
    v_accvgpr_read_b32 v114, a50
    v_accvgpr_read_b32 v115, a51
    v_accvgpr_read_b32 v116, a52
    v_accvgpr_read_b32 v117, a53
    v_accvgpr_read_b32 v118, a54
    v_accvgpr_read_b32 v119, a55
    v_pk_mul_f32 v[112:113], v[112:113], v[48:49]
    v_pk_mul_f32 v[114:115], v[114:115], v[48:49]
    v_pk_mul_f32 v[116:117], v[116:117], v[48:49]
    v_pk_mul_f32 v[118:119], v[118:119], v[48:49]
    v_cvt_pk_bf16_f32 v184, v112, v113
    v_cvt_pk_bf16_f32 v185, v114, v115
    v_cvt_pk_bf16_f32 v186, v116, v117
    v_cvt_pk_bf16_f32 v187, v118, v119
    buffer_store_dwordx4 v[184:187], v238, s[24:27], s42 offen sc1
    v_accvgpr_read_b32 v120, a56
    v_accvgpr_read_b32 v121, a57
    v_accvgpr_read_b32 v122, a58
    v_accvgpr_read_b32 v123, a59
    v_accvgpr_read_b32 v124, a60
    v_accvgpr_read_b32 v125, a61
    v_accvgpr_read_b32 v126, a62
    v_accvgpr_read_b32 v127, a63
    v_pk_mul_f32 v[120:121], v[120:121], v[48:49]
    v_pk_mul_f32 v[122:123], v[122:123], v[48:49]
    v_pk_mul_f32 v[124:125], v[124:125], v[48:49]
    v_pk_mul_f32 v[126:127], v[126:127], v[48:49]
    v_cvt_pk_bf16_f32 v188, v120, v121
    v_cvt_pk_bf16_f32 v189, v122, v123
    v_cvt_pk_bf16_f32 v190, v124, v125
    v_cvt_pk_bf16_f32 v191, v126, v127
    buffer_store_dwordx4 v[188:191], v238, s[24:27], s42 offen offset:512 sc1
    s_waitcnt lgkmcnt(0)
    s_barrier
    ds_read_b32 v52, v2
    ds_read_b32 v56, v2 offset:128
    ds_read_b32 v53, v2 offset:256
    ds_read_b32 v57, v2 offset:384
    ds_read_b32 v54, v2 offset:512
    ds_read_b32 v58, v2 offset:640
    ds_read_b32 v55, v2 offset:768
    ds_read_b32 v59, v2 offset:896
    ds_write_b128 v254, v[246:249]
    ds_write_b128 v254, v[250:253] offset:1024
    s_waitcnt lgkmcnt(5)
    v_max3_f32 v4, v52, v53, v54
    s_waitcnt lgkmcnt(3)
    v_max_f32 v4, v4, v55
    v_sub_f32 v52, v52, v4
    v_exp_f32 v52, v52
    v_sub_f32 v53, v53, v4
    v_exp_f32 v53, v53
    v_sub_f32 v54, v54, v4
    v_exp_f32 v54, v54
    v_sub_f32 v55, v55, v4
    v_exp_f32 v55, v55
    v_mul_f32 v60, v52, v56
    v_fma_f32 v60, v53, v57, v60
    v_fma_f32 v60, v54, v58, v60
    s_waitcnt lgkmcnt(2)
    v_fma_f32 v60, v55, v59, v60
    v_rcp_f32 v60, v60
    s_nop 0
    v_mul_f32 v60, v60, v52
    v_mov_b32 v61, v60
    v_add_u32 v6, 98304, v245
    v_accvgpr_read_b32 v128, a144
    v_accvgpr_read_b32 v129, a145
    v_accvgpr_read_b32 v130, a146
    v_accvgpr_read_b32 v131, a147
    v_pk_mul_f32 v[128:129], v[128:129], v[60:61]
    v_pk_mul_f32 v[130:131], v[130:131], v[60:61]
    ds_write_b128 v6, v[128:131] offset:12288
    v_accvgpr_read_b32 v132, a148
    v_accvgpr_read_b32 v133, a149
    v_accvgpr_read_b32 v134, a150
    v_accvgpr_read_b32 v135, a151
    v_pk_mul_f32 v[132:133], v[132:133], v[60:61]
    v_pk_mul_f32 v[134:135], v[134:135], v[60:61]
    ds_write_b128 v6, v[132:135] offset:13312
    v_accvgpr_read_b32 v136, a152
    v_accvgpr_read_b32 v137, a153
    v_accvgpr_read_b32 v138, a154
    v_accvgpr_read_b32 v139, a155
    v_pk_mul_f32 v[136:137], v[136:137], v[60:61]
    v_pk_mul_f32 v[138:139], v[138:139], v[60:61]
    ds_write_b128 v6, v[136:139] offset:14336
    v_accvgpr_read_b32 v140, a156
    v_accvgpr_read_b32 v141, a157
    v_accvgpr_read_b32 v142, a158
    v_accvgpr_read_b32 v143, a159
    v_pk_mul_f32 v[140:141], v[140:141], v[60:61]
    v_pk_mul_f32 v[142:143], v[142:143], v[60:61]
    ds_write_b128 v6, v[140:143] offset:15360
    v_accvgpr_read_b32 v128, a160
    v_accvgpr_read_b32 v129, a161
    v_accvgpr_read_b32 v130, a162
    v_accvgpr_read_b32 v131, a163
    v_pk_mul_f32 v[128:129], v[128:129], v[60:61]
    v_pk_mul_f32 v[130:131], v[130:131], v[60:61]
    ds_write_b128 v6, v[128:131] offset:28672
    v_accvgpr_read_b32 v132, a164
    v_accvgpr_read_b32 v133, a165
    v_accvgpr_read_b32 v134, a166
    v_accvgpr_read_b32 v135, a167
    v_pk_mul_f32 v[132:133], v[132:133], v[60:61]
    v_pk_mul_f32 v[134:135], v[134:135], v[60:61]
    ds_write_b128 v6, v[132:135] offset:29696
    v_accvgpr_read_b32 v136, a168
    v_accvgpr_read_b32 v137, a169
    v_accvgpr_read_b32 v138, a170
    v_accvgpr_read_b32 v139, a171
    v_pk_mul_f32 v[136:137], v[136:137], v[60:61]
    v_pk_mul_f32 v[138:139], v[138:139], v[60:61]
    ds_write_b128 v6, v[136:139] offset:30720
    v_accvgpr_read_b32 v140, a172
    v_accvgpr_read_b32 v141, a173
    v_accvgpr_read_b32 v142, a174
    v_accvgpr_read_b32 v143, a175
    v_pk_mul_f32 v[140:141], v[140:141], v[60:61]
    v_pk_mul_f32 v[142:143], v[142:143], v[60:61]
    ds_write_b128 v6, v[140:143] offset:31744
    v_accvgpr_read_b32 v128, a176
    v_accvgpr_read_b32 v129, a177
    v_accvgpr_read_b32 v130, a178
    v_accvgpr_read_b32 v131, a179
    v_pk_mul_f32 v[128:129], v[128:129], v[60:61]
    v_pk_mul_f32 v[130:131], v[130:131], v[60:61]
    ds_write_b128 v6, v[128:131] offset:53248
    v_accvgpr_read_b32 v132, a180
    v_accvgpr_read_b32 v133, a181
    v_accvgpr_read_b32 v134, a182
    v_accvgpr_read_b32 v135, a183
    v_pk_mul_f32 v[132:133], v[132:133], v[60:61]
    v_pk_mul_f32 v[134:135], v[134:135], v[60:61]
    ds_write_b128 v6, v[132:135] offset:54272
    v_accvgpr_read_b32 v136, a184
    v_accvgpr_read_b32 v137, a185
    v_accvgpr_read_b32 v138, a186
    v_accvgpr_read_b32 v139, a187
    v_pk_mul_f32 v[136:137], v[136:137], v[60:61]
    v_pk_mul_f32 v[138:139], v[138:139], v[60:61]
    ds_write_b128 v6, v[136:139] offset:55296
    v_accvgpr_read_b32 v140, a188
    v_accvgpr_read_b32 v141, a189
    v_accvgpr_read_b32 v142, a190
    v_accvgpr_read_b32 v143, a191
    v_pk_mul_f32 v[140:141], v[140:141], v[60:61]
    v_pk_mul_f32 v[142:143], v[142:143], v[60:61]
    ds_write_b128 v6, v[140:143] offset:56320
    v_accvgpr_read_b32 v64, a128
    v_accvgpr_read_b32 v65, a129
    v_accvgpr_read_b32 v66, a130
    v_accvgpr_read_b32 v67, a131
    v_pk_mul_f32 v[64:65], v[64:65], v[60:61]
    v_pk_mul_f32 v[66:67], v[66:67], v[60:61]
    v_accvgpr_read_b32 v68, a132
    v_accvgpr_read_b32 v69, a133
    v_accvgpr_read_b32 v70, a134
    v_accvgpr_read_b32 v71, a135
    v_pk_mul_f32 v[68:69], v[68:69], v[60:61]
    v_pk_mul_f32 v[70:71], v[70:71], v[60:61]
    v_accvgpr_read_b32 v72, a136
    v_accvgpr_read_b32 v73, a137
    v_accvgpr_read_b32 v74, a138
    v_accvgpr_read_b32 v75, a139
    v_pk_mul_f32 v[72:73], v[72:73], v[60:61]
    v_pk_mul_f32 v[74:75], v[74:75], v[60:61]
    v_accvgpr_read_b32 v76, a140
    v_accvgpr_read_b32 v77, a141
    v_accvgpr_read_b32 v78, a142
    v_accvgpr_read_b32 v79, a143
    v_pk_mul_f32 v[76:77], v[76:77], v[60:61]
    v_pk_mul_f32 v[78:79], v[78:79], v[60:61]
    s_waitcnt lgkmcnt(0)
    s_barrier
    ds_read_b128 v[128:131], v6
    ds_read_b128 v[132:135], v6 offset:1024
    ds_read_b128 v[136:139], v6 offset:2048
    ds_read_b128 v[140:143], v6 offset:3072
    ds_read_b128 v[144:147], v6 offset:4096
    ds_read_b128 v[148:151], v6 offset:5120
    ds_read_b128 v[152:155], v6 offset:6144
    ds_read_b128 v[156:159], v6 offset:7168
    ds_read_b128 v[160:163], v6 offset:8192
    ds_read_b128 v[164:167], v6 offset:9216
    ds_read_b128 v[168:171], v6 offset:10240
    ds_read_b128 v[172:175], v6 offset:11264
    s_add_u32 s42, s53, 2048
    v_accvgpr_read_b32 v112, a64
    v_accvgpr_read_b32 v113, a65
    v_accvgpr_read_b32 v114, a66
    v_accvgpr_read_b32 v115, a67
    v_accvgpr_read_b32 v116, a68
    v_accvgpr_read_b32 v117, a69
    v_accvgpr_read_b32 v118, a70
    v_accvgpr_read_b32 v119, a71
    v_pk_mul_f32 v[112:113], v[112:113], v[50:51]
    v_pk_mul_f32 v[114:115], v[114:115], v[50:51]
    v_pk_mul_f32 v[116:117], v[116:117], v[50:51]
    v_pk_mul_f32 v[118:119], v[118:119], v[50:51]
    v_cvt_pk_bf16_f32 v176, v112, v113
    v_cvt_pk_bf16_f32 v177, v114, v115
    v_cvt_pk_bf16_f32 v178, v116, v117
    v_cvt_pk_bf16_f32 v179, v118, v119
    buffer_store_dwordx4 v[176:179], v238, s[24:27], s42 offen sc1
    v_accvgpr_read_b32 v120, a72
    v_accvgpr_read_b32 v121, a73
    v_accvgpr_read_b32 v122, a74
    v_accvgpr_read_b32 v123, a75
    v_accvgpr_read_b32 v124, a76
    v_accvgpr_read_b32 v125, a77
    v_accvgpr_read_b32 v126, a78
    v_accvgpr_read_b32 v127, a79
    v_pk_mul_f32 v[120:121], v[120:121], v[50:51]
    v_pk_mul_f32 v[122:123], v[122:123], v[50:51]
    v_pk_mul_f32 v[124:125], v[124:125], v[50:51]
    v_pk_mul_f32 v[126:127], v[126:127], v[50:51]
    v_cvt_pk_bf16_f32 v180, v120, v121
    v_cvt_pk_bf16_f32 v181, v122, v123
    v_cvt_pk_bf16_f32 v182, v124, v125
    v_cvt_pk_bf16_f32 v183, v126, v127
    buffer_store_dwordx4 v[180:183], v238, s[24:27], s42 offen offset:512 sc1
    s_add_u32 s42, s53, 149504
    v_accvgpr_read_b32 v112, a80
    v_accvgpr_read_b32 v113, a81
    v_accvgpr_read_b32 v114, a82
    v_accvgpr_read_b32 v115, a83
    v_accvgpr_read_b32 v116, a84
    v_accvgpr_read_b32 v117, a85
    v_accvgpr_read_b32 v118, a86
    v_accvgpr_read_b32 v119, a87
    v_pk_mul_f32 v[112:113], v[112:113], v[50:51]
    v_pk_mul_f32 v[114:115], v[114:115], v[50:51]
    v_pk_mul_f32 v[116:117], v[116:117], v[50:51]
    v_pk_mul_f32 v[118:119], v[118:119], v[50:51]
    v_cvt_pk_bf16_f32 v184, v112, v113
    v_cvt_pk_bf16_f32 v185, v114, v115
    v_cvt_pk_bf16_f32 v186, v116, v117
    v_cvt_pk_bf16_f32 v187, v118, v119
    buffer_store_dwordx4 v[184:187], v238, s[24:27], s42 offen sc1
    v_accvgpr_read_b32 v120, a88
    v_accvgpr_read_b32 v121, a89
    v_accvgpr_read_b32 v122, a90
    v_accvgpr_read_b32 v123, a91
    v_accvgpr_read_b32 v124, a92
    v_accvgpr_read_b32 v125, a93
    v_accvgpr_read_b32 v126, a94
    v_accvgpr_read_b32 v127, a95
    v_pk_mul_f32 v[120:121], v[120:121], v[50:51]
    v_pk_mul_f32 v[122:123], v[122:123], v[50:51]
    v_pk_mul_f32 v[124:125], v[124:125], v[50:51]
    v_pk_mul_f32 v[126:127], v[126:127], v[50:51]
    v_cvt_pk_bf16_f32 v188, v120, v121
    v_cvt_pk_bf16_f32 v189, v122, v123
    v_cvt_pk_bf16_f32 v190, v124, v125
    v_cvt_pk_bf16_f32 v191, v126, v127
    buffer_store_dwordx4 v[188:191], v238, s[24:27], s42 offen offset:512 sc1
    s_add_u32 s42, s53, 296960
    v_accvgpr_read_b32 v112, a96
    v_accvgpr_read_b32 v113, a97
    v_accvgpr_read_b32 v114, a98
    v_accvgpr_read_b32 v115, a99
    v_accvgpr_read_b32 v116, a100
    v_accvgpr_read_b32 v117, a101
    v_accvgpr_read_b32 v118, a102
    v_accvgpr_read_b32 v119, a103
    v_pk_mul_f32 v[112:113], v[112:113], v[50:51]
    v_pk_mul_f32 v[114:115], v[114:115], v[50:51]
    v_pk_mul_f32 v[116:117], v[116:117], v[50:51]
    v_pk_mul_f32 v[118:119], v[118:119], v[50:51]
    v_cvt_pk_bf16_f32 v176, v112, v113
    v_cvt_pk_bf16_f32 v177, v114, v115
    v_cvt_pk_bf16_f32 v178, v116, v117
    v_cvt_pk_bf16_f32 v179, v118, v119
    buffer_store_dwordx4 v[176:179], v238, s[24:27], s42 offen sc1
    v_accvgpr_read_b32 v120, a104
    v_accvgpr_read_b32 v121, a105
    v_accvgpr_read_b32 v122, a106
    v_accvgpr_read_b32 v123, a107
    v_accvgpr_read_b32 v124, a108
    v_accvgpr_read_b32 v125, a109
    v_accvgpr_read_b32 v126, a110
    v_accvgpr_read_b32 v127, a111
    v_pk_mul_f32 v[120:121], v[120:121], v[50:51]
    v_pk_mul_f32 v[122:123], v[122:123], v[50:51]
    v_pk_mul_f32 v[124:125], v[124:125], v[50:51]
    v_pk_mul_f32 v[126:127], v[126:127], v[50:51]
    v_cvt_pk_bf16_f32 v180, v120, v121
    v_cvt_pk_bf16_f32 v181, v122, v123
    v_cvt_pk_bf16_f32 v182, v124, v125
    v_cvt_pk_bf16_f32 v183, v126, v127
    buffer_store_dwordx4 v[180:183], v238, s[24:27], s42 offen offset:512 sc1
    s_add_u32 s42, s53, 444416
    v_accvgpr_read_b32 v112, a112
    v_accvgpr_read_b32 v113, a113
    v_accvgpr_read_b32 v114, a114
    v_accvgpr_read_b32 v115, a115
    v_accvgpr_read_b32 v116, a116
    v_accvgpr_read_b32 v117, a117
    v_accvgpr_read_b32 v118, a118
    v_accvgpr_read_b32 v119, a119
    v_pk_mul_f32 v[112:113], v[112:113], v[50:51]
    v_pk_mul_f32 v[114:115], v[114:115], v[50:51]
    v_pk_mul_f32 v[116:117], v[116:117], v[50:51]
    v_pk_mul_f32 v[118:119], v[118:119], v[50:51]
    v_cvt_pk_bf16_f32 v184, v112, v113
    v_cvt_pk_bf16_f32 v185, v114, v115
    v_cvt_pk_bf16_f32 v186, v116, v117
    v_cvt_pk_bf16_f32 v187, v118, v119
    buffer_store_dwordx4 v[184:187], v238, s[24:27], s42 offen sc1
    v_accvgpr_read_b32 v120, a120
    v_accvgpr_read_b32 v121, a121
    v_accvgpr_read_b32 v122, a122
    v_accvgpr_read_b32 v123, a123
    v_accvgpr_read_b32 v124, a124
    v_accvgpr_read_b32 v125, a125
    v_accvgpr_read_b32 v126, a126
    v_accvgpr_read_b32 v127, a127
    v_pk_mul_f32 v[120:121], v[120:121], v[50:51]
    v_pk_mul_f32 v[122:123], v[122:123], v[50:51]
    v_pk_mul_f32 v[124:125], v[124:125], v[50:51]
    v_pk_mul_f32 v[126:127], v[126:127], v[50:51]
    v_cvt_pk_bf16_f32 v188, v120, v121
    v_cvt_pk_bf16_f32 v189, v122, v123
    v_cvt_pk_bf16_f32 v190, v124, v125
    v_cvt_pk_bf16_f32 v191, v126, v127
    buffer_store_dwordx4 v[188:191], v238, s[24:27], s42 offen offset:512 sc1
    s_waitcnt lgkmcnt(11)
    v_pk_add_f32 v[64:65], v[64:65], v[128:129]
    v_pk_add_f32 v[66:67], v[66:67], v[130:131]
    s_waitcnt lgkmcnt(10)
    v_pk_add_f32 v[68:69], v[68:69], v[132:133]
    v_pk_add_f32 v[70:71], v[70:71], v[134:135]
    s_waitcnt lgkmcnt(9)
    v_pk_add_f32 v[72:73], v[72:73], v[136:137]
    v_pk_add_f32 v[74:75], v[74:75], v[138:139]
    s_waitcnt lgkmcnt(8)
    v_pk_add_f32 v[76:77], v[76:77], v[140:141]
    v_pk_add_f32 v[78:79], v[78:79], v[142:143]
    s_waitcnt lgkmcnt(7)
    v_pk_add_f32 v[64:65], v[64:65], v[144:145]
    v_pk_add_f32 v[66:67], v[66:67], v[146:147]
    s_waitcnt lgkmcnt(6)
    v_pk_add_f32 v[68:69], v[68:69], v[148:149]
    v_pk_add_f32 v[70:71], v[70:71], v[150:151]
    s_waitcnt lgkmcnt(5)
    v_pk_add_f32 v[72:73], v[72:73], v[152:153]
    v_pk_add_f32 v[74:75], v[74:75], v[154:155]
    s_waitcnt lgkmcnt(4)
    v_pk_add_f32 v[76:77], v[76:77], v[156:157]
    v_pk_add_f32 v[78:79], v[78:79], v[158:159]
    s_waitcnt lgkmcnt(3)
    v_pk_add_f32 v[64:65], v[64:65], v[160:161]
    v_pk_add_f32 v[66:67], v[66:67], v[162:163]
    s_waitcnt lgkmcnt(2)
    v_pk_add_f32 v[68:69], v[68:69], v[164:165]
    v_pk_add_f32 v[70:71], v[70:71], v[166:167]
    s_waitcnt lgkmcnt(1)
    v_pk_add_f32 v[72:73], v[72:73], v[168:169]
    v_pk_add_f32 v[74:75], v[74:75], v[170:171]
    s_waitcnt lgkmcnt(0)
    v_pk_add_f32 v[76:77], v[76:77], v[172:173]
    v_pk_add_f32 v[78:79], v[78:79], v[174:175]
    s_waitcnt lgkmcnt(0)
    s_barrier
    s_add_u32 s42, s53, 16384
    v_cvt_pk_bf16_f32 v192, v64, v65
    v_cvt_pk_bf16_f32 v193, v66, v67
    v_cvt_pk_bf16_f32 v194, v68, v69
    v_cvt_pk_bf16_f32 v195, v70, v71
    buffer_store_dwordx4 v[192:195], v238, s[24:27], s42 offen sc1
    v_cvt_pk_bf16_f32 v196, v72, v73
    v_cvt_pk_bf16_f32 v197, v74, v75
    v_cvt_pk_bf16_f32 v198, v76, v77
    v_cvt_pk_bf16_f32 v199, v78, v79
    buffer_store_dwordx4 v[196:199], v238, s[24:27], s42 offen offset:512 sc1
    s_add_u32 s53, s53, 589824
    s_add_u32 s4, s4, 1
    s_cmp_lt_u32 s4, 2
    s_cbranch_scc1 W0_ITEM
    s_branch K1_END
WAVE1:
W1_ITEM:
    v_mov_b32 v239, 0
    v_mov_b32 v240, 0
    v_mov_b32 v241, 0
    s_waitcnt vmcnt(27)
    v_mfma_f32_32x32x16_bf16 v[48:63], a[192:195], v[40:43], 0
    s_waitcnt vmcnt(26)
    v_mfma_f32_32x32x16_bf16 v[48:63], a[196:199], v[44:47], v[48:63]
    v_mfma_f32_32x32x16_bf16 v[48:63], a[200:203], v[16:19], v[48:63]
    v_mfma_f32_32x32x16_bf16 v[48:63], a[204:207], v[20:23], v[48:63]
    s_add_u32 m0, s38, s82
    v_mfma_f32_32x32x16_bf16 v[48:63], a[208:211], v[24:27], v[48:63]
    buffer_load_dwordx4 v232, s[16:19], s36 offen nt lds
    v_mfma_f32_32x32x16_bf16 v[48:63], a[212:215], v[28:31], v[48:63]
    v_mfma_f32_32x32x16_bf16 v[48:63], a[216:219], v[32:35], v[48:63]
    v_mfma_f32_32x32x16_bf16 v[48:63], a[220:223], v[36:39], v[48:63]
    s_nop 11
    v_max3_f32 v2, v48, v49, v50
    v_max3_f32 v2, v2, v51, v52
    v_max3_f32 v2, v2, v53, v54
    v_max3_f32 v2, v2, v55, v56
    v_max3_f32 v2, v2, v57, v58
    v_max3_f32 v2, v2, v59, v60
    v_max3_f32 v2, v2, v61, v62
    v_max_f32 v2, v2, v63
    v_mov_b32 v3, v2
    s_nop 1
    v_permlane32_swap_b32 v2, v3
    v_max_f32 v2, v2, v3
    v_sub_f32 v64, 0, v2
    v_sub_f32 v65, 0, v2
    v_sub_f32 v66, 0, v2
    v_sub_f32 v67, 0, v2
    v_sub_f32 v68, 0, v2
    v_sub_f32 v69, 0, v2
    v_sub_f32 v70, 0, v2
    v_sub_f32 v71, 0, v2
    v_sub_f32 v72, 0, v2
    v_sub_f32 v73, 0, v2
    v_sub_f32 v74, 0, v2
    v_sub_f32 v75, 0, v2
    v_sub_f32 v76, 0, v2
    v_sub_f32 v77, 0, v2
    v_sub_f32 v78, 0, v2
    v_sub_f32 v79, 0, v2
    v_sub_f32 v48, v48, v2
    v_sub_f32 v49, v49, v2
    v_sub_f32 v50, v50, v2
    v_sub_f32 v51, v51, v2
    v_sub_f32 v52, v52, v2
    v_sub_f32 v53, v53, v2
    v_sub_f32 v54, v54, v2
    v_sub_f32 v55, v55, v2
    v_sub_f32 v56, v56, v2
    v_sub_f32 v57, v57, v2
    v_sub_f32 v58, v58, v2
    v_sub_f32 v59, v59, v2
    v_sub_f32 v60, v60, v2
    v_sub_f32 v61, v61, v2
    v_sub_f32 v62, v62, v2
    v_sub_f32 v63, v63, v2
    buffer_load_dwordx4 v233, s[16:19], s36 offen offset:1024 nt lds
    v_exp_f32 v196, v48
    v_exp_f32 v197, v49
    v_exp_f32 v198, v50
    v_add_f32 v242, v196, v197
    v_cvt_pk_bf16_f32 v160, v196, v197
    s_waitcnt vmcnt(21)
    v_mfma_f32_32x32x16_bf16 v[112:127], a[192:195], v[104:107], 0
    v_exp_f32 v199, v51
    v_add_f32 v242, v242, v198
    s_waitcnt vmcnt(20)
    v_mfma_f32_32x32x16_bf16 v[112:127], a[196:199], v[108:111], v[112:127]
    ds_read_b128 a[192:195], v220 offset:8192
    v_exp_f32 v196, v52
    v_add_f32 v242, v242, v199
    v_cvt_pk_bf16_f32 v161, v198, v199
    v_mfma_f32_32x32x16_bf16 v[112:127], a[200:203], v[80:83], v[112:127]
    ds_read_b128 a[196:199], v221 offset:8192
    buffer_load_dwordx4 v234, s[16:19], s36 offen offset:2048 nt lds
    v_exp_f32 v197, v53
    v_add_f32 v242, v242, v196
    v_mfma_f32_32x32x16_bf16 v[112:127], a[204:207], v[84:87], v[112:127]
    ds_read_b128 a[200:203], v222 offset:8192
    v_exp_f32 v198, v54
    v_add_f32 v242, v242, v197
    v_cvt_pk_bf16_f32 v162, v196, v197
    v_mfma_f32_32x32x16_bf16 v[112:127], a[208:211], v[88:91], v[112:127]
    ds_read_b128 a[204:207], v223 offset:8192
    v_exp_f32 v199, v55
    v_add_f32 v242, v242, v198
    v_mfma_f32_32x32x16_bf16 v[112:127], a[212:215], v[92:95], v[112:127]
    ds_read_b128 a[208:211], v224 offset:8192
    v_exp_f32 v196, v56
    v_add_f32 v242, v242, v199
    v_cvt_pk_bf16_f32 v163, v198, v199
    v_mfma_f32_32x32x16_bf16 v[112:127], a[216:219], v[96:99], v[112:127]
    ds_read_b128 a[212:215], v225 offset:8192
    v_exp_f32 v197, v57
    v_add_f32 v242, v242, v196
    v_mfma_f32_32x32x16_bf16 v[112:127], a[220:223], v[100:103], v[112:127]
    ds_read_b128 a[216:219], v226 offset:8192
    v_exp_f32 v198, v58
    v_add_f32 v242, v242, v197
    v_cvt_pk_bf16_f32 v164, v196, v197
    ds_read_b128 a[220:223], v227 offset:8192
    v_exp_f32 v199, v59
    v_add_f32 v242, v242, v198
    ds_read_b64_tr_b16 a[224:225], v228 offset:24576
    ds_read_b64_tr_b16 a[226:227], v228 offset:26624
    buffer_load_dwordx4 v235, s[16:19], s36 offen offset:3072 nt lds
    v_exp_f32 v196, v60
    v_add_f32 v242, v242, v199
    v_cvt_pk_bf16_f32 v165, v198, v199
    ds_read_b64_tr_b16 a[228:229], v229 offset:24576
    ds_read_b64_tr_b16 a[230:231], v229 offset:26624
    v_exp_f32 v197, v61
    v_add_f32 v242, v242, v196
    ds_read_b64_tr_b16 a[232:233], v230 offset:24576
    ds_read_b64_tr_b16 a[234:235], v230 offset:26624
    s_add_u32 s36, s36, 16384
    v_exp_f32 v198, v62
    v_add_f32 v242, v242, v197
    v_cvt_pk_bf16_f32 v166, v196, v197
    ds_read_b64_tr_b16 a[236:237], v231 offset:24576
    ds_read_b64_tr_b16 a[238:239], v231 offset:26624
    v_exp_f32 v199, v63
    v_add_f32 v242, v242, v198
    v_max3_f32 v2, v112, v113, v114
    v_max3_f32 v2, v2, v115, v116
    v_max3_f32 v2, v2, v117, v118
    v_max3_f32 v2, v2, v119, v120
    v_max3_f32 v2, v2, v121, v122
    v_max3_f32 v2, v2, v123, v124
    v_max3_f32 v2, v2, v125, v126
    v_max_f32 v2, v2, v127
    v_mov_b32 v3, v2
    s_nop 1
    v_permlane32_swap_b32 v2, v3
    v_max_f32 v2, v2, v3
    v_sub_f32 v128, 0, v2
    v_sub_f32 v129, 0, v2
    v_sub_f32 v130, 0, v2
    v_sub_f32 v131, 0, v2
    v_sub_f32 v132, 0, v2
    v_sub_f32 v133, 0, v2
    v_sub_f32 v134, 0, v2
    v_sub_f32 v135, 0, v2
    v_sub_f32 v136, 0, v2
    v_sub_f32 v137, 0, v2
    v_sub_f32 v138, 0, v2
    v_sub_f32 v139, 0, v2
    v_sub_f32 v140, 0, v2
    v_sub_f32 v141, 0, v2
    v_sub_f32 v142, 0, v2
    v_sub_f32 v143, 0, v2
    v_sub_f32 v112, v112, v2
    v_sub_f32 v113, v113, v2
    v_sub_f32 v114, v114, v2
    v_sub_f32 v115, v115, v2
    v_sub_f32 v116, v116, v2
    v_sub_f32 v117, v117, v2
    v_sub_f32 v118, v118, v2
    v_sub_f32 v119, v119, v2
    v_sub_f32 v120, v120, v2
    v_sub_f32 v121, v121, v2
    v_sub_f32 v122, v122, v2
    v_sub_f32 v123, v123, v2
    v_sub_f32 v124, v124, v2
    v_sub_f32 v125, v125, v2
    v_sub_f32 v126, v126, v2
    v_sub_f32 v127, v127, v2
    ds_read_b64_tr_b16 a[240:241], v228 offset:28672
    ds_read_b64_tr_b16 a[242:243], v228 offset:30720
    v_add_f32 v242, v242, v199
    v_cvt_pk_bf16_f32 v167, v198, v199
    v_cmp_lt_f32 vcc, s35, v242
    v_exp_f32 v196, v112
    ds_read_b64_tr_b16 a[244:245], v229 offset:28672
    ds_read_b64_tr_b16 a[246:247], v229 offset:30720
    v_exp_f32 v197, v113
    ds_read_b64_tr_b16 a[248:249], v230 offset:28672
    ds_read_b64_tr_b16 a[250:251], v230 offset:30720
    s_cbranch_vccnz FX19
FX19_RET:
    v_add_f32 v239, v239, v242
    v_exp_f32 v198, v114
    v_add_f32 v243, v196, v197
    v_cvt_pk_bf16_f32 v168, v196, v197
    s_waitcnt lgkmcnt(14)
    v_mfma_f32_32x32x16_bf16 v[48:63], a[192:195], v[40:43], v[64:79]
    ds_read_b64_tr_b16 a[252:253], v231 offset:28672
    ds_read_b64_tr_b16 a[254:255], v231 offset:30720
    v_exp_f32 v199, v115
    v_add_f32 v243, v243, v198
    v_mfma_f32_32x32x16_bf16 v[48:63], a[196:199], v[44:47], v[48:63]
    s_add_u32 m0, s38, s86
    v_exp_f32 v196, v116
    v_add_f32 v243, v243, v199
    v_cvt_pk_bf16_f32 v169, v198, v199
    v_mfma_f32_32x32x16_bf16 v[48:63], a[200:203], v[16:19], v[48:63]
    v_exp_f32 v197, v117
    v_add_f32 v243, v243, v196
    v_mfma_f32_32x32x16_bf16 v[48:63], a[204:207], v[20:23], v[48:63]
    buffer_load_dwordx4 v236, s[20:23], s37 offen nt lds
    v_exp_f32 v198, v118
    v_add_f32 v243, v243, v197
    v_cvt_pk_bf16_f32 v170, v196, v197
    v_mfma_f32_32x32x16_bf16 v[48:63], a[208:211], v[24:27], v[48:63]
    v_exp_f32 v199, v119
    v_add_f32 v243, v243, v198
    v_mfma_f32_32x32x16_bf16 v[48:63], a[212:215], v[28:31], v[48:63]
    v_exp_f32 v196, v120
    v_add_f32 v243, v243, v199
    v_cvt_pk_bf16_f32 v171, v198, v199
    v_mfma_f32_32x32x16_bf16 v[48:63], a[216:219], v[32:35], v[48:63]
    buffer_load_dwordx4 v236, s[20:23], s37 offen offset:1024 nt lds
    v_exp_f32 v197, v121
    v_add_f32 v243, v243, v196
    v_mfma_f32_32x32x16_bf16 v[48:63], a[220:223], v[36:39], v[48:63]
    v_exp_f32 v198, v122
    v_add_f32 v243, v243, v197
    v_cvt_pk_bf16_f32 v172, v196, v197
    s_waitcnt lgkmcnt(0)
    v_mfma_f32_32x32x16_bf16 a[0:15], a[224:227], v[160:163], 0
    v_exp_f32 v199, v123
    v_add_f32 v243, v243, v198
    v_mfma_f32_32x32x16_bf16 a[16:31], a[228:231], v[160:163], 0
    ds_read_b128 v[184:187], v237
    buffer_load_dwordx4 v236, s[20:23], s37 offen offset:2048 nt lds
    v_exp_f32 v196, v124
    v_add_f32 v243, v243, v199
    v_cvt_pk_bf16_f32 v173, v198, v199
    v_mfma_f32_32x32x16_bf16 a[32:47], a[232:235], v[160:163], 0
    ds_read_b128 v[188:191], v237 offset:1024
    v_exp_f32 v197, v125
    v_add_f32 v243, v243, v196
    v_mfma_f32_32x32x16_bf16 a[48:63], a[236:239], v[160:163], 0
    ds_read_b128 v[192:195], v237 offset:2048
    v_exp_f32 v198, v126
    v_add_f32 v243, v243, v197
    v_cvt_pk_bf16_f32 v174, v196, v197
    v_mfma_f32_32x32x16_bf16 a[0:15], a[240:243], v[164:167], a[0:15]
    buffer_load_dwordx4 v236, s[20:23], s37 offen offset:3072 nt lds
    v_exp_f32 v199, v127
    v_add_f32 v243, v243, v198
    v_mfma_f32_32x32x16_bf16 a[16:31], a[244:247], v[164:167], a[16:31]
    v_add_f32 v243, v243, v199
    v_cvt_pk_bf16_f32 v175, v198, v199
    v_cmp_lt_f32 vcc, s35, v243
    v_exp_f32 v196, v48
    v_mfma_f32_32x32x16_bf16 a[32:47], a[248:251], v[164:167], a[32:47]
    s_add_u32 s37, s37, 16384
    v_exp_f32 v197, v49
    v_mfma_f32_32x32x16_bf16 a[48:63], a[252:255], v[164:167], a[48:63]
    s_add_u32 s38, s38, 32768
    s_and_b32 s38, s38, 131071
    s_cbranch_vccnz FX20
FX20_RET:
    v_add_f32 v240, v240, v243
    v_exp_f32 v198, v50
    v_add_f32 v242, v196, v197
    v_cvt_pk_bf16_f32 v160, v196, v197
    s_waitcnt lgkmcnt(2)
    v_mfma_f32_32x32x16_bf16 v[144:159], a[192:195], v[184:187], 0
    v_exp_f32 v199, v51
    v_add_f32 v242, v242, v198
    s_waitcnt lgkmcnt(1)
    v_mfma_f32_32x32x16_bf16 v[144:159], a[196:199], v[188:191], v[144:159]
    ds_read_b128 v[184:187], v237 offset:3072
    v_exp_f32 v196, v52
    v_add_f32 v242, v242, v199
    v_cvt_pk_bf16_f32 v161, v198, v199
    s_waitcnt lgkmcnt(1)
    v_mfma_f32_32x32x16_bf16 v[144:159], a[200:203], v[192:195], v[144:159]
    ds_read_b128 v[188:191], v237 offset:4096
    v_exp_f32 v197, v53
    v_add_f32 v242, v242, v196
    s_waitcnt lgkmcnt(1)
    v_mfma_f32_32x32x16_bf16 v[144:159], a[204:207], v[184:187], v[144:159]
    ds_read_b128 v[192:195], v237 offset:5120
    v_exp_f32 v198, v54
    v_add_f32 v242, v242, v197
    v_cvt_pk_bf16_f32 v162, v196, v197
    s_waitcnt lgkmcnt(1)
    v_mfma_f32_32x32x16_bf16 v[144:159], a[208:211], v[188:191], v[144:159]
    ds_read_b128 v[184:187], v237 offset:6144
    v_exp_f32 v199, v55
    v_add_f32 v242, v242, v198
    s_waitcnt lgkmcnt(1)
    v_mfma_f32_32x32x16_bf16 v[144:159], a[212:215], v[192:195], v[144:159]
    ds_read_b128 v[188:191], v237 offset:7168
    v_exp_f32 v196, v56
    v_add_f32 v242, v242, v199
    v_cvt_pk_bf16_f32 v163, v198, v199
    s_waitcnt lgkmcnt(1)
    v_mfma_f32_32x32x16_bf16 v[144:159], a[216:219], v[184:187], v[144:159]
    v_exp_f32 v197, v57
    v_add_f32 v242, v242, v196
    s_waitcnt lgkmcnt(0)
    v_mfma_f32_32x32x16_bf16 v[144:159], a[220:223], v[188:191], v[144:159]
    v_exp_f32 v198, v58
    v_add_f32 v242, v242, v197
    v_cvt_pk_bf16_f32 v164, v196, v197
    v_mfma_f32_32x32x16_bf16 v[112:127], a[192:195], v[104:107], v[128:143]
    v_exp_f32 v199, v59
    v_add_f32 v242, v242, v198
    v_mfma_f32_32x32x16_bf16 v[112:127], a[196:199], v[108:111], v[112:127]
    v_exp_f32 v196, v60
    v_add_f32 v242, v242, v199
    v_cvt_pk_bf16_f32 v165, v198, v199
    s_waitcnt vmcnt(16)
    s_barrier
    ds_read_b128 a[192:195], v220 offset:32768
    v_mfma_f32_32x32x16_bf16 v[112:127], a[200:203], v[80:83], v[112:127]
    ds_read_b128 a[196:199], v221 offset:32768
    v_exp_f32 v197, v61
    v_add_f32 v242, v242, v196
    v_mfma_f32_32x32x16_bf16 v[112:127], a[204:207], v[84:87], v[112:127]
    ds_read_b128 a[200:203], v222 offset:32768
    v_exp_f32 v198, v62
    v_add_f32 v242, v242, v197
    v_cvt_pk_bf16_f32 v166, v196, v197
    v_mfma_f32_32x32x16_bf16 v[112:127], a[208:211], v[88:91], v[112:127]
    v_exp_f32 v199, v63
    v_add_f32 v242, v242, v198
    s_nop 7
    v_max3_f32 v2, v144, v145, v146
    v_max3_f32 v2, v2, v147, v148
    v_max3_f32 v2, v2, v149, v150
    v_max3_f32 v2, v2, v151, v152
    v_max3_f32 v2, v2, v153, v154
    v_max3_f32 v2, v2, v155, v156
    v_max3_f32 v2, v2, v157, v158
    v_max_f32 v2, v2, v159
    v_mov_b32 v3, v2
    s_nop 1
    v_permlane32_swap_b32 v2, v3
    v_max_f32 v2, v2, v3
    v_sub_f32 v204, 0, v2
    v_sub_f32 v205, 0, v2
    v_sub_f32 v206, 0, v2
    v_sub_f32 v207, 0, v2
    v_sub_f32 v208, 0, v2
    v_sub_f32 v209, 0, v2
    v_sub_f32 v210, 0, v2
    v_sub_f32 v211, 0, v2
    v_sub_f32 v212, 0, v2
    v_sub_f32 v213, 0, v2
    v_sub_f32 v214, 0, v2
    v_sub_f32 v215, 0, v2
    v_sub_f32 v216, 0, v2
    v_sub_f32 v217, 0, v2
    v_sub_f32 v218, 0, v2
    v_sub_f32 v219, 0, v2
    v_sub_f32 v144, v144, v2
    v_sub_f32 v145, v145, v2
    v_sub_f32 v146, v146, v2
    v_sub_f32 v147, v147, v2
    v_sub_f32 v148, v148, v2
    v_sub_f32 v149, v149, v2
    v_sub_f32 v150, v150, v2
    v_sub_f32 v151, v151, v2
    v_sub_f32 v152, v152, v2
    v_sub_f32 v153, v153, v2
    v_sub_f32 v154, v154, v2
    v_sub_f32 v155, v155, v2
    v_sub_f32 v156, v156, v2
    v_sub_f32 v157, v157, v2
    v_sub_f32 v158, v158, v2
    v_sub_f32 v159, v159, v2
    ds_read_b128 a[204:207], v223 offset:32768
    v_mfma_f32_32x32x16_bf16 v[112:127], a[212:215], v[92:95], v[112:127]
    ds_read_b128 a[208:211], v224 offset:32768
    v_add_f32 v242, v242, v199
    v_cvt_pk_bf16_f32 v167, v198, v199
    v_cmp_lt_f32 vcc, s35, v242
    v_exp_f32 v196, v144
    v_mfma_f32_32x32x16_bf16 v[112:127], a[216:219], v[96:99], v[112:127]
    ds_read_b128 a[212:215], v225 offset:32768
    v_exp_f32 v197, v145
    v_mfma_f32_32x32x16_bf16 v[112:127], a[220:223], v[100:103], v[112:127]
    ds_read_b128 a[216:219], v226 offset:32768
    s_cbranch_vccnz FX21
FX21_RET:
    v_add_f32 v239, v239, v242
    v_exp_f32 v198, v146
    v_add_f32 v244, v196, v197
    v_cvt_pk_bf16_f32 v176, v196, v197
    v_mfma_f32_32x32x16_bf16 a[64:79], a[224:227], v[168:171], 0
    ds_read_b128 a[220:223], v227 offset:32768
    v_exp_f32 v199, v147
    v_add_f32 v244, v244, v198
    v_mfma_f32_32x32x16_bf16 a[80:95], a[228:231], v[168:171], 0
    ds_read_b64_tr_b16 a[224:225], v228 offset:49152
    ds_read_b64_tr_b16 a[226:227], v228 offset:51200
    v_exp_f32 v196, v148
    v_add_f32 v244, v244, v199
    v_cvt_pk_bf16_f32 v177, v198, v199
    v_mfma_f32_32x32x16_bf16 a[96:111], a[232:235], v[168:171], 0
    ds_read_b64_tr_b16 a[228:229], v229 offset:49152
    ds_read_b64_tr_b16 a[230:231], v229 offset:51200
    v_exp_f32 v197, v149
    v_add_f32 v244, v244, v196
    v_mfma_f32_32x32x16_bf16 a[112:127], a[236:239], v[168:171], 0
    ds_read_b64_tr_b16 a[232:233], v230 offset:49152
    ds_read_b64_tr_b16 a[234:235], v230 offset:51200
    v_exp_f32 v198, v150
    v_add_f32 v244, v244, v197
    v_cvt_pk_bf16_f32 v178, v196, v197
    v_mfma_f32_32x32x16_bf16 a[64:79], a[240:243], v[172:175], a[64:79]
    ds_read_b64_tr_b16 a[236:237], v231 offset:49152
    ds_read_b64_tr_b16 a[238:239], v231 offset:51200
    v_exp_f32 v199, v151
    v_add_f32 v244, v244, v198
    v_mfma_f32_32x32x16_bf16 a[80:95], a[244:247], v[172:175], a[80:95]
    ds_read_b64_tr_b16 a[240:241], v228 offset:53248
    ds_read_b64_tr_b16 a[242:243], v228 offset:55296
    v_add_f32 v244, v244, v199
    v_cvt_pk_bf16_f32 v179, v198, v199
    v_exp_f32 v196, v112
    v_mfma_f32_32x32x16_bf16 a[96:111], a[248:251], v[172:175], a[96:111]
    ds_read_b64_tr_b16 a[244:245], v229 offset:53248
    ds_read_b64_tr_b16 a[246:247], v229 offset:55296
    v_exp_f32 v197, v113
    v_mfma_f32_32x32x16_bf16 a[112:127], a[252:255], v[172:175], a[112:127]
    ds_read_b64_tr_b16 a[248:249], v230 offset:53248
    ds_read_b64_tr_b16 a[250:251], v230 offset:55296
    v_exp_f32 v198, v114
    v_add_f32 v243, v196, v197
    v_cvt_pk_bf16_f32 v168, v196, v197
    s_waitcnt lgkmcnt(14)
    v_mfma_f32_32x32x16_bf16 v[48:63], a[192:195], v[40:43], v[64:79]
    ds_read_b64_tr_b16 a[252:253], v231 offset:53248
    ds_read_b64_tr_b16 a[254:255], v231 offset:55296
    s_add_u32 s46, s54, 16384
    v_exp_f32 v199, v115
    v_add_f32 v243, v243, v198
    v_mfma_f32_32x32x16_bf16 v[48:63], a[196:199], v[44:47], v[48:63]
    v_exp_f32 v196, v116
    v_add_f32 v243, v243, v199
    v_cvt_pk_bf16_f32 v169, v198, v199
    v_mfma_f32_32x32x16_bf16 v[48:63], a[200:203], v[16:19], v[48:63]
    v_exp_f32 v197, v117
    v_add_f32 v243, v243, v196
    v_mfma_f32_32x32x16_bf16 v[48:63], a[204:207], v[20:23], v[48:63]
    s_add_u32 m0, s38, s82
    v_exp_f32 v198, v118
    v_add_f32 v243, v243, v197
    v_cvt_pk_bf16_f32 v170, v196, v197
    v_mfma_f32_32x32x16_bf16 v[48:63], a[208:211], v[24:27], v[48:63]
    buffer_load_dwordx4 v232, s[16:19], s36 offen nt lds
    v_exp_f32 v199, v119
    v_add_f32 v243, v243, v198
    v_mfma_f32_32x32x16_bf16 v[48:63], a[212:215], v[28:31], v[48:63]
    v_exp_f32 v196, v120
    v_add_f32 v243, v243, v199
    v_cvt_pk_bf16_f32 v171, v198, v199
    v_mfma_f32_32x32x16_bf16 v[48:63], a[216:219], v[32:35], v[48:63]
    v_exp_f32 v197, v121
    v_add_f32 v243, v243, v196
    v_mfma_f32_32x32x16_bf16 v[48:63], a[220:223], v[36:39], v[48:63]
    v_exp_f32 v198, v122
    v_add_f32 v243, v243, v197
    v_cvt_pk_bf16_f32 v172, v196, v197
    s_waitcnt lgkmcnt(0)
    v_mfma_f32_32x32x16_bf16 a[0:15], a[224:227], v[160:163], a[0:15]
    v_exp_f32 v199, v123
    v_add_f32 v243, v243, v198
    v_mfma_f32_32x32x16_bf16 a[16:31], a[228:231], v[160:163], a[16:31]
    v_exp_f32 v196, v124
    v_add_f32 v243, v243, v199
    v_cvt_pk_bf16_f32 v173, v198, v199
    v_mfma_f32_32x32x16_bf16 a[32:47], a[232:235], v[160:163], a[32:47]
    v_exp_f32 v197, v125
    v_add_f32 v243, v243, v196
    v_mfma_f32_32x32x16_bf16 a[48:63], a[236:239], v[160:163], a[48:63]
    buffer_load_dwordx4 v233, s[16:19], s36 offen offset:1024 nt lds
    v_exp_f32 v198, v126
    v_add_f32 v243, v243, v197
    v_cvt_pk_bf16_f32 v174, v196, v197
    v_mfma_f32_32x32x16_bf16 a[0:15], a[240:243], v[164:167], a[0:15]
    v_exp_f32 v199, v127
    v_add_f32 v243, v243, v198
    v_mfma_f32_32x32x16_bf16 a[16:31], a[244:247], v[164:167], a[16:31]
    buffer_load_dwordx4 v[246:249], v245, s[24:27], s46 offen
    v_add_f32 v243, v243, v199
    v_cvt_pk_bf16_f32 v175, v198, v199
    v_cmp_lt_f32 vcc, s35, v243
    v_exp_f32 v196, v152
    v_mfma_f32_32x32x16_bf16 a[32:47], a[248:251], v[164:167], a[32:47]
    v_exp_f32 v197, v153
    v_add_f32 v244, v244, v196
    v_mfma_f32_32x32x16_bf16 a[48:63], a[252:255], v[164:167], a[48:63]
    s_cbranch_vccnz FX22
FX22_RET:
    v_add_f32 v240, v240, v243
    v_exp_f32 v198, v154
    v_add_f32 v244, v244, v197
    v_cvt_pk_bf16_f32 v180, v196, v197
    v_mfma_f32_32x32x16_bf16 v[112:127], a[192:195], v[104:107], v[128:143]
    v_exp_f32 v199, v155
    v_add_f32 v244, v244, v198
    v_mfma_f32_32x32x16_bf16 v[112:127], a[196:199], v[108:111], v[112:127]
    ds_read_b128 a[192:195], v220 offset:40960
    v_exp_f32 v196, v156
    v_add_f32 v244, v244, v199
    v_cvt_pk_bf16_f32 v181, v198, v199
    v_mfma_f32_32x32x16_bf16 v[112:127], a[200:203], v[80:83], v[112:127]
    ds_read_b128 a[196:199], v221 offset:40960
    buffer_load_dwordx4 v234, s[16:19], s36 offen offset:2048 nt lds
    v_exp_f32 v197, v157
    v_add_f32 v244, v244, v196
    v_mfma_f32_32x32x16_bf16 v[112:127], a[204:207], v[84:87], v[112:127]
    ds_read_b128 a[200:203], v222 offset:40960
    v_exp_f32 v198, v158
    v_add_f32 v244, v244, v197
    v_cvt_pk_bf16_f32 v182, v196, v197
    v_mfma_f32_32x32x16_bf16 v[112:127], a[208:211], v[88:91], v[112:127]
    ds_read_b128 a[204:207], v223 offset:40960
    v_exp_f32 v199, v159
    v_add_f32 v244, v244, v198
    v_mfma_f32_32x32x16_bf16 v[112:127], a[212:215], v[92:95], v[112:127]
    ds_read_b128 a[208:211], v224 offset:40960
    v_add_f32 v244, v244, v199
    v_cvt_pk_bf16_f32 v183, v198, v199
    v_cmp_lt_f32 vcc, s35, v244
    v_exp_f32 v196, v48
    v_mfma_f32_32x32x16_bf16 v[112:127], a[216:219], v[96:99], v[112:127]
    ds_read_b128 a[212:215], v225 offset:40960
    v_exp_f32 v197, v49
    v_mfma_f32_32x32x16_bf16 v[112:127], a[220:223], v[100:103], v[112:127]
    ds_read_b128 a[216:219], v226 offset:40960
    s_cbranch_vccnz FX23
FX23_RET:
    v_add_f32 v241, v241, v244
    v_exp_f32 v198, v50
    v_add_f32 v242, v196, v197
    v_cvt_pk_bf16_f32 v160, v196, v197
    v_mfma_f32_32x32x16_bf16 a[128:143], a[224:227], v[176:179], 0
    ds_read_b128 a[220:223], v227 offset:40960
    v_exp_f32 v199, v51
    v_add_f32 v242, v242, v198
    v_mfma_f32_32x32x16_bf16 a[144:159], a[228:231], v[176:179], 0
    buffer_load_dwordx4 v235, s[16:19], s36 offen offset:3072 nt lds
    v_exp_f32 v196, v52
    v_add_f32 v242, v242, v199
    v_cvt_pk_bf16_f32 v161, v198, v199
    v_mfma_f32_32x32x16_bf16 a[160:175], a[232:235], v[176:179], 0
    buffer_load_dwordx4 v[250:253], v245, s[24:27], s46 offen offset:1024
    v_exp_f32 v197, v53
    v_add_f32 v242, v242, v196
    v_mfma_f32_32x32x16_bf16 a[176:191], a[236:239], v[176:179], 0
    s_add_u32 s36, s36, 16384
    v_exp_f32 v198, v54
    v_add_f32 v242, v242, v197
    v_cvt_pk_bf16_f32 v162, v196, v197
    v_mfma_f32_32x32x16_bf16 a[128:143], a[240:243], v[180:183], a[128:143]
    v_exp_f32 v199, v55
    v_add_f32 v242, v242, v198
    v_mfma_f32_32x32x16_bf16 a[144:159], a[244:247], v[180:183], a[144:159]
    v_exp_f32 v196, v56
    v_add_f32 v242, v242, v199
    v_cvt_pk_bf16_f32 v163, v198, v199
    v_mfma_f32_32x32x16_bf16 a[160:175], a[248:251], v[180:183], a[160:175]
    v_exp_f32 v197, v57
    v_add_f32 v242, v242, v196
    v_mfma_f32_32x32x16_bf16 a[176:191], a[252:255], v[180:183], a[176:191]
    v_exp_f32 v198, v58
    v_add_f32 v242, v242, v197
    v_cvt_pk_bf16_f32 v164, v196, v197
    v_mfma_f32_32x32x16_bf16 a[64:79], a[224:227], v[168:171], a[64:79]
    v_exp_f32 v199, v59
    v_add_f32 v242, v242, v198
    v_mfma_f32_32x32x16_bf16 a[80:95], a[228:231], v[168:171], a[80:95]
    ds_read_b64_tr_b16 a[224:225], v228 offset:57344
    ds_read_b64_tr_b16 a[226:227], v228 offset:59392
    v_exp_f32 v196, v60
    v_add_f32 v242, v242, v199
    v_cvt_pk_bf16_f32 v165, v198, v199
    v_mfma_f32_32x32x16_bf16 a[96:111], a[232:235], v[168:171], a[96:111]
    ds_read_b64_tr_b16 a[228:229], v229 offset:57344
    ds_read_b64_tr_b16 a[230:231], v229 offset:59392
    v_exp_f32 v197, v61
    v_add_f32 v242, v242, v196
    v_mfma_f32_32x32x16_bf16 a[112:127], a[236:239], v[168:171], a[112:127]
    ds_read_b64_tr_b16 a[232:233], v230 offset:57344
    ds_read_b64_tr_b16 a[234:235], v230 offset:59392
    v_exp_f32 v198, v62
    v_add_f32 v242, v242, v197
    v_cvt_pk_bf16_f32 v166, v196, v197
    v_mfma_f32_32x32x16_bf16 a[64:79], a[240:243], v[172:175], a[64:79]
    ds_read_b64_tr_b16 a[236:237], v231 offset:57344
    ds_read_b64_tr_b16 a[238:239], v231 offset:59392
    v_exp_f32 v199, v63
    v_add_f32 v242, v242, v198
    v_mfma_f32_32x32x16_bf16 a[80:95], a[244:247], v[172:175], a[80:95]
    ds_read_b64_tr_b16 a[240:241], v228 offset:61440
    ds_read_b64_tr_b16 a[242:243], v228 offset:63488
    v_add_f32 v242, v242, v199
    v_cvt_pk_bf16_f32 v167, v198, v199
    v_cmp_lt_f32 vcc, s35, v242
    v_exp_f32 v196, v112
    v_mfma_f32_32x32x16_bf16 a[96:111], a[248:251], v[172:175], a[96:111]
    ds_read_b64_tr_b16 a[244:245], v229 offset:61440
    ds_read_b64_tr_b16 a[246:247], v229 offset:63488
    v_exp_f32 v197, v113
    v_mfma_f32_32x32x16_bf16 a[112:127], a[252:255], v[172:175], a[112:127]
    ds_read_b64_tr_b16 a[248:249], v230 offset:61440
    ds_read_b64_tr_b16 a[250:251], v230 offset:63488
    s_cbranch_vccnz FX24
FX24_RET:
    v_add_f32 v239, v239, v242
    v_exp_f32 v198, v114
    v_add_f32 v243, v196, v197
    v_cvt_pk_bf16_f32 v168, v196, v197
    s_waitcnt lgkmcnt(14)
    v_mfma_f32_32x32x16_bf16 v[48:63], a[192:195], v[40:43], v[64:79]
    ds_read_b64_tr_b16 a[252:253], v231 offset:61440
    ds_read_b64_tr_b16 a[254:255], v231 offset:63488
    v_exp_f32 v199, v115
    v_add_f32 v243, v243, v198
    v_mfma_f32_32x32x16_bf16 v[48:63], a[196:199], v[44:47], v[48:63]
    s_add_u32 m0, s38, s86
    v_exp_f32 v196, v116
    v_add_f32 v243, v243, v199
    v_cvt_pk_bf16_f32 v169, v198, v199
    v_mfma_f32_32x32x16_bf16 v[48:63], a[200:203], v[16:19], v[48:63]
    v_exp_f32 v197, v117
    v_add_f32 v243, v243, v196
    v_xor_b32 v220, 65536, v220
    v_mfma_f32_32x32x16_bf16 v[48:63], a[204:207], v[20:23], v[48:63]
    buffer_load_dwordx4 v236, s[20:23], s37 offen nt lds
    v_exp_f32 v198, v118
    v_add_f32 v243, v243, v197
    v_cvt_pk_bf16_f32 v170, v196, v197
    v_xor_b32 v221, 65536, v221
    v_mfma_f32_32x32x16_bf16 v[48:63], a[208:211], v[24:27], v[48:63]
    v_exp_f32 v199, v119
    v_add_f32 v243, v243, v198
    v_xor_b32 v222, 65536, v222
    v_mfma_f32_32x32x16_bf16 v[48:63], a[212:215], v[28:31], v[48:63]
    v_exp_f32 v196, v120
    v_add_f32 v243, v243, v199
    v_cvt_pk_bf16_f32 v171, v198, v199
    v_xor_b32 v223, 65536, v223
    v_mfma_f32_32x32x16_bf16 v[48:63], a[216:219], v[32:35], v[48:63]
    buffer_load_dwordx4 v236, s[20:23], s37 offen offset:1024 nt lds
    v_exp_f32 v197, v121
    v_add_f32 v243, v243, v196
    v_xor_b32 v224, 65536, v224
    v_mfma_f32_32x32x16_bf16 v[48:63], a[220:223], v[36:39], v[48:63]
    v_exp_f32 v198, v122
    v_add_f32 v243, v243, v197
    v_cvt_pk_bf16_f32 v172, v196, v197
    v_xor_b32 v225, 65536, v225
    s_waitcnt lgkmcnt(0)
    v_mfma_f32_32x32x16_bf16 a[0:15], a[224:227], v[160:163], a[0:15]
    v_exp_f32 v199, v123
    v_add_f32 v243, v243, v198
    v_xor_b32 v226, 65536, v226
    v_mfma_f32_32x32x16_bf16 a[16:31], a[228:231], v[160:163], a[16:31]
    buffer_load_dwordx4 v236, s[20:23], s37 offen offset:2048 nt lds
    v_exp_f32 v196, v124
    v_add_f32 v243, v243, v199
    v_cvt_pk_bf16_f32 v173, v198, v199
    v_xor_b32 v227, 65536, v227
    v_mfma_f32_32x32x16_bf16 a[32:47], a[232:235], v[160:163], a[32:47]
    v_exp_f32 v197, v125
    v_add_f32 v243, v243, v196
    v_xor_b32 v228, 65536, v228
    v_mfma_f32_32x32x16_bf16 a[48:63], a[236:239], v[160:163], a[48:63]
    v_exp_f32 v198, v126
    v_add_f32 v243, v243, v197
    v_cvt_pk_bf16_f32 v174, v196, v197
    v_xor_b32 v229, 65536, v229
    v_mfma_f32_32x32x16_bf16 a[0:15], a[240:243], v[164:167], a[0:15]
    buffer_load_dwordx4 v236, s[20:23], s37 offen offset:3072 nt lds
    v_exp_f32 v199, v127
    v_add_f32 v243, v243, v198
    v_xor_b32 v230, 65536, v230
    v_mfma_f32_32x32x16_bf16 a[16:31], a[244:247], v[164:167], a[16:31]
    v_add_f32 v243, v243, v199
    v_cvt_pk_bf16_f32 v175, v198, v199
    v_cmp_lt_f32 vcc, s35, v243
    v_exp_f32 v196, v48
    v_xor_b32 v231, 65536, v231
    v_mfma_f32_32x32x16_bf16 a[32:47], a[248:251], v[164:167], a[32:47]
    s_add_u32 s37, s37, 16384
    v_exp_f32 v197, v49
    v_mfma_f32_32x32x16_bf16 a[48:63], a[252:255], v[164:167], a[48:63]
    s_add_u32 s38, s38, 32768
    s_and_b32 s38, s38, 131071
    s_cbranch_vccnz FX25
FX25_RET:
    v_add_f32 v240, v240, v243
    v_exp_f32 v198, v50
    v_add_f32 v242, v196, v197
    v_cvt_pk_bf16_f32 v160, v196, v197
    v_mfma_f32_32x32x16_bf16 v[112:127], a[192:195], v[104:107], v[128:143]
    v_exp_f32 v199, v51
    v_add_f32 v242, v242, v198
    v_mfma_f32_32x32x16_bf16 v[112:127], a[196:199], v[108:111], v[112:127]
    v_exp_f32 v196, v52
    v_add_f32 v242, v242, v199
    v_cvt_pk_bf16_f32 v161, v198, v199
    s_waitcnt vmcnt(16)
    s_barrier
    ds_read_b128 a[192:195], v220
    v_mfma_f32_32x32x16_bf16 v[112:127], a[200:203], v[80:83], v[112:127]
    ds_read_b128 a[196:199], v221
    v_exp_f32 v197, v53
    v_add_f32 v242, v242, v196
    v_mfma_f32_32x32x16_bf16 v[112:127], a[204:207], v[84:87], v[112:127]
    ds_read_b128 a[200:203], v222
    v_exp_f32 v198, v54
    v_add_f32 v242, v242, v197
    v_cvt_pk_bf16_f32 v162, v196, v197
    v_mfma_f32_32x32x16_bf16 v[112:127], a[208:211], v[88:91], v[112:127]
    ds_read_b128 a[204:207], v223
    v_exp_f32 v199, v55
    v_add_f32 v242, v242, v198
    v_mfma_f32_32x32x16_bf16 v[112:127], a[212:215], v[92:95], v[112:127]
    ds_read_b128 a[208:211], v224
    v_exp_f32 v196, v56
    v_add_f32 v242, v242, v199
    v_cvt_pk_bf16_f32 v163, v198, v199
    v_mfma_f32_32x32x16_bf16 v[112:127], a[216:219], v[96:99], v[112:127]
    ds_read_b128 a[212:215], v225
    v_exp_f32 v197, v57
    v_add_f32 v242, v242, v196
    v_mfma_f32_32x32x16_bf16 v[112:127], a[220:223], v[100:103], v[112:127]
    ds_read_b128 a[216:219], v226
    v_exp_f32 v198, v58
    v_add_f32 v242, v242, v197
    v_cvt_pk_bf16_f32 v164, v196, v197
    v_mfma_f32_32x32x16_bf16 a[64:79], a[224:227], v[168:171], a[64:79]
    ds_read_b128 a[220:223], v227
    v_exp_f32 v199, v59
    v_add_f32 v242, v242, v198
    v_mfma_f32_32x32x16_bf16 a[80:95], a[228:231], v[168:171], a[80:95]
    ds_read_b64_tr_b16 a[224:225], v228 offset:16384
    ds_read_b64_tr_b16 a[226:227], v228 offset:18432
    v_exp_f32 v196, v60
    v_add_f32 v242, v242, v199
    v_cvt_pk_bf16_f32 v165, v198, v199
    v_mfma_f32_32x32x16_bf16 a[96:111], a[232:235], v[168:171], a[96:111]
    ds_read_b64_tr_b16 a[228:229], v229 offset:16384
    ds_read_b64_tr_b16 a[230:231], v229 offset:18432
    v_exp_f32 v197, v61
    v_add_f32 v242, v242, v196
    v_mfma_f32_32x32x16_bf16 a[112:127], a[236:239], v[168:171], a[112:127]
    ds_read_b64_tr_b16 a[232:233], v230 offset:16384
    ds_read_b64_tr_b16 a[234:235], v230 offset:18432
    v_exp_f32 v198, v62
    v_add_f32 v242, v242, v197
    v_cvt_pk_bf16_f32 v166, v196, v197
    v_mfma_f32_32x32x16_bf16 a[64:79], a[240:243], v[172:175], a[64:79]
    ds_read_b64_tr_b16 a[236:237], v231 offset:16384
    ds_read_b64_tr_b16 a[238:239], v231 offset:18432
    v_exp_f32 v199, v63
    v_add_f32 v242, v242, v198
    v_mfma_f32_32x32x16_bf16 a[80:95], a[244:247], v[172:175], a[80:95]
    ds_read_b64_tr_b16 a[240:241], v228 offset:20480
    ds_read_b64_tr_b16 a[242:243], v228 offset:22528
    v_add_f32 v242, v242, v199
    v_cvt_pk_bf16_f32 v167, v198, v199
    v_cmp_lt_f32 vcc, s35, v242
    v_exp_f32 v196, v112
    v_mfma_f32_32x32x16_bf16 a[96:111], a[248:251], v[172:175], a[96:111]
    ds_read_b64_tr_b16 a[244:245], v229 offset:20480
    ds_read_b64_tr_b16 a[246:247], v229 offset:22528
    v_exp_f32 v197, v113
    v_mfma_f32_32x32x16_bf16 a[112:127], a[252:255], v[172:175], a[112:127]
    ds_read_b64_tr_b16 a[248:249], v230 offset:20480
    ds_read_b64_tr_b16 a[250:251], v230 offset:22528
    s_cbranch_vccnz FX26
FX26_RET:
    v_add_f32 v239, v239, v242
    v_exp_f32 v198, v114
    v_add_f32 v243, v196, v197
    v_cvt_pk_bf16_f32 v168, v196, v197
    s_mov_b32 s39, 7
W1_AL:
    s_waitcnt lgkmcnt(14)
    v_mfma_f32_32x32x16_bf16 v[48:63], a[192:195], v[40:43], v[64:79]
    ds_read_b64_tr_b16 a[252:253], v231 offset:20480
    ds_read_b64_tr_b16 a[254:255], v231 offset:22528
    v_exp_f32 v199, v115
    v_add_f32 v243, v243, v198
    v_mfma_f32_32x32x16_bf16 v[48:63], a[196:199], v[44:47], v[48:63]
    v_exp_f32 v196, v116
    v_add_f32 v243, v243, v199
    v_cvt_pk_bf16_f32 v169, v198, v199
    v_mfma_f32_32x32x16_bf16 v[48:63], a[200:203], v[16:19], v[48:63]
    v_exp_f32 v197, v117
    v_add_f32 v243, v243, v196
    v_mfma_f32_32x32x16_bf16 v[48:63], a[204:207], v[20:23], v[48:63]
    s_add_u32 m0, s38, s82
    v_exp_f32 v198, v118
    v_add_f32 v243, v243, v197
    v_cvt_pk_bf16_f32 v170, v196, v197
    v_mfma_f32_32x32x16_bf16 v[48:63], a[208:211], v[24:27], v[48:63]
    buffer_load_dwordx4 v232, s[16:19], s36 offen nt lds
    v_exp_f32 v199, v119
    v_add_f32 v243, v243, v198
    v_mfma_f32_32x32x16_bf16 v[48:63], a[212:215], v[28:31], v[48:63]
    v_exp_f32 v196, v120
    v_add_f32 v243, v243, v199
    v_cvt_pk_bf16_f32 v171, v198, v199
    v_mfma_f32_32x32x16_bf16 v[48:63], a[216:219], v[32:35], v[48:63]
    v_exp_f32 v197, v121
    v_add_f32 v243, v243, v196
    v_mfma_f32_32x32x16_bf16 v[48:63], a[220:223], v[36:39], v[48:63]
    v_exp_f32 v198, v122
    v_add_f32 v243, v243, v197
    v_cvt_pk_bf16_f32 v172, v196, v197
    s_waitcnt lgkmcnt(0)
    v_mfma_f32_32x32x16_bf16 a[0:15], a[224:227], v[160:163], a[0:15]
    v_exp_f32 v199, v123
    v_add_f32 v243, v243, v198
    v_mfma_f32_32x32x16_bf16 a[16:31], a[228:231], v[160:163], a[16:31]
    v_exp_f32 v196, v124
    v_add_f32 v243, v243, v199
    v_cvt_pk_bf16_f32 v173, v198, v199
    v_mfma_f32_32x32x16_bf16 a[32:47], a[232:235], v[160:163], a[32:47]
    v_exp_f32 v197, v125
    v_add_f32 v243, v243, v196
    v_mfma_f32_32x32x16_bf16 a[48:63], a[236:239], v[160:163], a[48:63]
    buffer_load_dwordx4 v233, s[16:19], s36 offen offset:1024 nt lds
    v_exp_f32 v198, v126
    v_add_f32 v243, v243, v197
    v_cvt_pk_bf16_f32 v174, v196, v197
    v_mfma_f32_32x32x16_bf16 a[0:15], a[240:243], v[164:167], a[0:15]
    v_exp_f32 v199, v127
    v_add_f32 v243, v243, v198
    v_mfma_f32_32x32x16_bf16 a[16:31], a[244:247], v[164:167], a[16:31]
    v_add_f32 v243, v243, v199
    v_cvt_pk_bf16_f32 v175, v198, v199
    v_cmp_lt_f32 vcc, s35, v243
    v_exp_f32 v196, v48
    v_mfma_f32_32x32x16_bf16 a[32:47], a[248:251], v[164:167], a[32:47]
    v_exp_f32 v197, v49
    v_mfma_f32_32x32x16_bf16 a[48:63], a[252:255], v[164:167], a[48:63]
    s_cbranch_vccnz FX27
FX27_RET:
    v_add_f32 v240, v240, v243
    v_exp_f32 v198, v50
    v_add_f32 v242, v196, v197
    v_cvt_pk_bf16_f32 v160, v196, v197
    v_mfma_f32_32x32x16_bf16 v[112:127], a[192:195], v[104:107], v[128:143]
    v_exp_f32 v199, v51
    v_add_f32 v242, v242, v198
    v_mfma_f32_32x32x16_bf16 v[112:127], a[196:199], v[108:111], v[112:127]
    ds_read_b128 a[192:195], v220 offset:8192
    v_exp_f32 v196, v52
    v_add_f32 v242, v242, v199
    v_cvt_pk_bf16_f32 v161, v198, v199
    v_mfma_f32_32x32x16_bf16 v[112:127], a[200:203], v[80:83], v[112:127]
    ds_read_b128 a[196:199], v221 offset:8192
    buffer_load_dwordx4 v234, s[16:19], s36 offen offset:2048 nt lds
    v_exp_f32 v197, v53
    v_add_f32 v242, v242, v196
    v_mfma_f32_32x32x16_bf16 v[112:127], a[204:207], v[84:87], v[112:127]
    ds_read_b128 a[200:203], v222 offset:8192
    v_exp_f32 v198, v54
    v_add_f32 v242, v242, v197
    v_cvt_pk_bf16_f32 v162, v196, v197
    v_mfma_f32_32x32x16_bf16 v[112:127], a[208:211], v[88:91], v[112:127]
    ds_read_b128 a[204:207], v223 offset:8192
    v_exp_f32 v199, v55
    v_add_f32 v242, v242, v198
    v_mfma_f32_32x32x16_bf16 v[112:127], a[212:215], v[92:95], v[112:127]
    ds_read_b128 a[208:211], v224 offset:8192
    v_exp_f32 v196, v56
    v_add_f32 v242, v242, v199
    v_cvt_pk_bf16_f32 v163, v198, v199
    v_mfma_f32_32x32x16_bf16 v[112:127], a[216:219], v[96:99], v[112:127]
    ds_read_b128 a[212:215], v225 offset:8192
    v_exp_f32 v197, v57
    v_add_f32 v242, v242, v196
    v_mfma_f32_32x32x16_bf16 v[112:127], a[220:223], v[100:103], v[112:127]
    ds_read_b128 a[216:219], v226 offset:8192
    v_exp_f32 v198, v58
    v_add_f32 v242, v242, v197
    v_cvt_pk_bf16_f32 v164, v196, v197
    v_mfma_f32_32x32x16_bf16 a[64:79], a[224:227], v[168:171], a[64:79]
    ds_read_b128 a[220:223], v227 offset:8192
    v_exp_f32 v199, v59
    v_add_f32 v242, v242, v198
    v_mfma_f32_32x32x16_bf16 a[80:95], a[228:231], v[168:171], a[80:95]
    ds_read_b64_tr_b16 a[224:225], v228 offset:24576
    ds_read_b64_tr_b16 a[226:227], v228 offset:26624
    buffer_load_dwordx4 v235, s[16:19], s36 offen offset:3072 nt lds
    v_exp_f32 v196, v60
    v_add_f32 v242, v242, v199
    v_cvt_pk_bf16_f32 v165, v198, v199
    v_mfma_f32_32x32x16_bf16 a[96:111], a[232:235], v[168:171], a[96:111]
    ds_read_b64_tr_b16 a[228:229], v229 offset:24576
    ds_read_b64_tr_b16 a[230:231], v229 offset:26624
    v_exp_f32 v197, v61
    v_add_f32 v242, v242, v196
    v_mfma_f32_32x32x16_bf16 a[112:127], a[236:239], v[168:171], a[112:127]
    ds_read_b64_tr_b16 a[232:233], v230 offset:24576
    ds_read_b64_tr_b16 a[234:235], v230 offset:26624
    s_add_u32 s36, s36, 16384
    v_exp_f32 v198, v62
    v_add_f32 v242, v242, v197
    v_cvt_pk_bf16_f32 v166, v196, v197
    v_mfma_f32_32x32x16_bf16 a[64:79], a[240:243], v[172:175], a[64:79]
    ds_read_b64_tr_b16 a[236:237], v231 offset:24576
    ds_read_b64_tr_b16 a[238:239], v231 offset:26624
    v_exp_f32 v199, v63
    v_add_f32 v242, v242, v198
    v_mfma_f32_32x32x16_bf16 a[80:95], a[244:247], v[172:175], a[80:95]
    ds_read_b64_tr_b16 a[240:241], v228 offset:28672
    ds_read_b64_tr_b16 a[242:243], v228 offset:30720
    v_add_f32 v242, v242, v199
    v_cvt_pk_bf16_f32 v167, v198, v199
    v_cmp_lt_f32 vcc, s35, v242
    v_exp_f32 v196, v112
    v_mfma_f32_32x32x16_bf16 a[96:111], a[248:251], v[172:175], a[96:111]
    ds_read_b64_tr_b16 a[244:245], v229 offset:28672
    ds_read_b64_tr_b16 a[246:247], v229 offset:30720
    v_exp_f32 v197, v113
    v_mfma_f32_32x32x16_bf16 a[112:127], a[252:255], v[172:175], a[112:127]
    ds_read_b64_tr_b16 a[248:249], v230 offset:28672
    ds_read_b64_tr_b16 a[250:251], v230 offset:30720
    s_cbranch_vccnz FX28
FX28_RET:
    v_add_f32 v239, v239, v242
    v_exp_f32 v198, v114
    v_add_f32 v243, v196, v197
    v_cvt_pk_bf16_f32 v168, v196, v197
    s_waitcnt lgkmcnt(14)
    v_mfma_f32_32x32x16_bf16 v[48:63], a[192:195], v[40:43], v[64:79]
    ds_read_b64_tr_b16 a[252:253], v231 offset:28672
    ds_read_b64_tr_b16 a[254:255], v231 offset:30720
    v_exp_f32 v199, v115
    v_add_f32 v243, v243, v198
    v_mfma_f32_32x32x16_bf16 v[48:63], a[196:199], v[44:47], v[48:63]
    s_add_u32 m0, s38, s86
    v_exp_f32 v196, v116
    v_add_f32 v243, v243, v199
    v_cvt_pk_bf16_f32 v169, v198, v199
    v_mfma_f32_32x32x16_bf16 v[48:63], a[200:203], v[16:19], v[48:63]
    v_exp_f32 v197, v117
    v_add_f32 v243, v243, v196
    v_mfma_f32_32x32x16_bf16 v[48:63], a[204:207], v[20:23], v[48:63]
    buffer_load_dwordx4 v236, s[20:23], s37 offen nt lds
    v_exp_f32 v198, v118
    v_add_f32 v243, v243, v197
    v_cvt_pk_bf16_f32 v170, v196, v197
    v_mfma_f32_32x32x16_bf16 v[48:63], a[208:211], v[24:27], v[48:63]
    v_exp_f32 v199, v119
    v_add_f32 v243, v243, v198
    v_mfma_f32_32x32x16_bf16 v[48:63], a[212:215], v[28:31], v[48:63]
    v_exp_f32 v196, v120
    v_add_f32 v243, v243, v199
    v_cvt_pk_bf16_f32 v171, v198, v199
    v_mfma_f32_32x32x16_bf16 v[48:63], a[216:219], v[32:35], v[48:63]
    buffer_load_dwordx4 v236, s[20:23], s37 offen offset:1024 nt lds
    v_exp_f32 v197, v121
    v_add_f32 v243, v243, v196
    v_mfma_f32_32x32x16_bf16 v[48:63], a[220:223], v[36:39], v[48:63]
    v_exp_f32 v198, v122
    v_add_f32 v243, v243, v197
    v_cvt_pk_bf16_f32 v172, v196, v197
    s_waitcnt lgkmcnt(0)
    v_mfma_f32_32x32x16_bf16 a[0:15], a[224:227], v[160:163], a[0:15]
    v_exp_f32 v199, v123
    v_add_f32 v243, v243, v198
    v_mfma_f32_32x32x16_bf16 a[16:31], a[228:231], v[160:163], a[16:31]
    ds_read_b128 v[184:187], v237
    buffer_load_dwordx4 v236, s[20:23], s37 offen offset:2048 nt lds
    v_exp_f32 v196, v124
    v_add_f32 v243, v243, v199
    v_cvt_pk_bf16_f32 v173, v198, v199
    v_mfma_f32_32x32x16_bf16 a[32:47], a[232:235], v[160:163], a[32:47]
    ds_read_b128 v[188:191], v237 offset:1024
    v_exp_f32 v197, v125
    v_add_f32 v243, v243, v196
    v_mfma_f32_32x32x16_bf16 a[48:63], a[236:239], v[160:163], a[48:63]
    ds_read_b128 v[192:195], v237 offset:2048
    v_exp_f32 v198, v126
    v_add_f32 v243, v243, v197
    v_cvt_pk_bf16_f32 v174, v196, v197
    v_mfma_f32_32x32x16_bf16 a[0:15], a[240:243], v[164:167], a[0:15]
    buffer_load_dwordx4 v236, s[20:23], s37 offen offset:3072 nt lds
    v_exp_f32 v199, v127
    v_add_f32 v243, v243, v198
    v_mfma_f32_32x32x16_bf16 a[16:31], a[244:247], v[164:167], a[16:31]
    v_add_f32 v243, v243, v199
    v_cvt_pk_bf16_f32 v175, v198, v199
    v_cmp_lt_f32 vcc, s35, v243
    v_exp_f32 v196, v48
    v_mfma_f32_32x32x16_bf16 a[32:47], a[248:251], v[164:167], a[32:47]
    s_add_u32 s37, s37, 16384
    v_exp_f32 v197, v49
    v_mfma_f32_32x32x16_bf16 a[48:63], a[252:255], v[164:167], a[48:63]
    s_add_u32 s38, s38, 32768
    s_and_b32 s38, s38, 131071
    s_cbranch_vccnz FX29
FX29_RET:
    v_add_f32 v240, v240, v243
    v_exp_f32 v198, v50
    v_add_f32 v242, v196, v197
    v_cvt_pk_bf16_f32 v160, v196, v197
    s_waitcnt lgkmcnt(2)
    v_mfma_f32_32x32x16_bf16 v[144:159], a[192:195], v[184:187], v[204:219]
    v_exp_f32 v199, v51
    v_add_f32 v242, v242, v198
    s_waitcnt lgkmcnt(1)
    v_mfma_f32_32x32x16_bf16 v[144:159], a[196:199], v[188:191], v[144:159]
    ds_read_b128 v[184:187], v237 offset:3072
    v_exp_f32 v196, v52
    v_add_f32 v242, v242, v199
    v_cvt_pk_bf16_f32 v161, v198, v199
    s_waitcnt lgkmcnt(1)
    v_mfma_f32_32x32x16_bf16 v[144:159], a[200:203], v[192:195], v[144:159]
    ds_read_b128 v[188:191], v237 offset:4096
    v_exp_f32 v197, v53
    v_add_f32 v242, v242, v196
    s_waitcnt lgkmcnt(1)
    v_mfma_f32_32x32x16_bf16 v[144:159], a[204:207], v[184:187], v[144:159]
    ds_read_b128 v[192:195], v237 offset:5120
    v_exp_f32 v198, v54
    v_add_f32 v242, v242, v197
    v_cvt_pk_bf16_f32 v162, v196, v197
    s_waitcnt lgkmcnt(1)
    v_mfma_f32_32x32x16_bf16 v[144:159], a[208:211], v[188:191], v[144:159]
    ds_read_b128 v[184:187], v237 offset:6144
    v_exp_f32 v199, v55
    v_add_f32 v242, v242, v198
    s_waitcnt lgkmcnt(1)
    v_mfma_f32_32x32x16_bf16 v[144:159], a[212:215], v[192:195], v[144:159]
    ds_read_b128 v[188:191], v237 offset:7168
    v_exp_f32 v196, v56
    v_add_f32 v242, v242, v199
    v_cvt_pk_bf16_f32 v163, v198, v199
    s_waitcnt lgkmcnt(1)
    v_mfma_f32_32x32x16_bf16 v[144:159], a[216:219], v[184:187], v[144:159]
    v_exp_f32 v197, v57
    v_add_f32 v242, v242, v196
    s_waitcnt lgkmcnt(0)
    v_mfma_f32_32x32x16_bf16 v[144:159], a[220:223], v[188:191], v[144:159]
    v_exp_f32 v198, v58
    v_add_f32 v242, v242, v197
    v_cvt_pk_bf16_f32 v164, v196, v197
    v_mfma_f32_32x32x16_bf16 v[112:127], a[192:195], v[104:107], v[128:143]
    v_exp_f32 v199, v59
    v_add_f32 v242, v242, v198
    v_mfma_f32_32x32x16_bf16 v[112:127], a[196:199], v[108:111], v[112:127]
    v_exp_f32 v196, v60
    v_add_f32 v242, v242, v199
    v_cvt_pk_bf16_f32 v165, v198, v199
    s_waitcnt vmcnt(16)
    s_barrier
    ds_read_b128 a[192:195], v220 offset:32768
    v_mfma_f32_32x32x16_bf16 v[112:127], a[200:203], v[80:83], v[112:127]
    ds_read_b128 a[196:199], v221 offset:32768
    v_exp_f32 v197, v61
    v_add_f32 v242, v242, v196
    v_mfma_f32_32x32x16_bf16 v[112:127], a[204:207], v[84:87], v[112:127]
    ds_read_b128 a[200:203], v222 offset:32768
    v_exp_f32 v198, v62
    v_add_f32 v242, v242, v197
    v_cvt_pk_bf16_f32 v166, v196, v197
    v_mfma_f32_32x32x16_bf16 v[112:127], a[208:211], v[88:91], v[112:127]
    ds_read_b128 a[204:207], v223 offset:32768
    v_exp_f32 v199, v63
    v_add_f32 v242, v242, v198
    v_mfma_f32_32x32x16_bf16 v[112:127], a[212:215], v[92:95], v[112:127]
    ds_read_b128 a[208:211], v224 offset:32768
    v_add_f32 v242, v242, v199
    v_cvt_pk_bf16_f32 v167, v198, v199
    v_cmp_lt_f32 vcc, s35, v242
    v_exp_f32 v196, v144
    v_mfma_f32_32x32x16_bf16 v[112:127], a[216:219], v[96:99], v[112:127]
    ds_read_b128 a[212:215], v225 offset:32768
    v_exp_f32 v197, v145
    v_mfma_f32_32x32x16_bf16 v[112:127], a[220:223], v[100:103], v[112:127]
    ds_read_b128 a[216:219], v226 offset:32768
    s_cbranch_vccnz FX30
FX30_RET:
    v_add_f32 v239, v239, v242
    v_exp_f32 v198, v146
    v_add_f32 v244, v196, v197
    v_cvt_pk_bf16_f32 v176, v196, v197
    v_mfma_f32_32x32x16_bf16 a[64:79], a[224:227], v[168:171], a[64:79]
    ds_read_b128 a[220:223], v227 offset:32768
    v_exp_f32 v199, v147
    v_add_f32 v244, v244, v198
    v_mfma_f32_32x32x16_bf16 a[80:95], a[228:231], v[168:171], a[80:95]
    ds_read_b64_tr_b16 a[224:225], v228 offset:49152
    ds_read_b64_tr_b16 a[226:227], v228 offset:51200
    v_exp_f32 v196, v148
    v_add_f32 v244, v244, v199
    v_cvt_pk_bf16_f32 v177, v198, v199
    v_mfma_f32_32x32x16_bf16 a[96:111], a[232:235], v[168:171], a[96:111]
    ds_read_b64_tr_b16 a[228:229], v229 offset:49152
    ds_read_b64_tr_b16 a[230:231], v229 offset:51200
    v_exp_f32 v197, v149
    v_add_f32 v244, v244, v196
    v_mfma_f32_32x32x16_bf16 a[112:127], a[236:239], v[168:171], a[112:127]
    ds_read_b64_tr_b16 a[232:233], v230 offset:49152
    ds_read_b64_tr_b16 a[234:235], v230 offset:51200
    v_exp_f32 v198, v150
    v_add_f32 v244, v244, v197
    v_cvt_pk_bf16_f32 v178, v196, v197
    v_mfma_f32_32x32x16_bf16 a[64:79], a[240:243], v[172:175], a[64:79]
    ds_read_b64_tr_b16 a[236:237], v231 offset:49152
    ds_read_b64_tr_b16 a[238:239], v231 offset:51200
    v_exp_f32 v199, v151
    v_add_f32 v244, v244, v198
    v_mfma_f32_32x32x16_bf16 a[80:95], a[244:247], v[172:175], a[80:95]
    ds_read_b64_tr_b16 a[240:241], v228 offset:53248
    ds_read_b64_tr_b16 a[242:243], v228 offset:55296
    v_add_f32 v244, v244, v199
    v_cvt_pk_bf16_f32 v179, v198, v199
    v_exp_f32 v196, v112
    v_mfma_f32_32x32x16_bf16 a[96:111], a[248:251], v[172:175], a[96:111]
    ds_read_b64_tr_b16 a[244:245], v229 offset:53248
    ds_read_b64_tr_b16 a[246:247], v229 offset:55296
    v_exp_f32 v197, v113
    v_mfma_f32_32x32x16_bf16 a[112:127], a[252:255], v[172:175], a[112:127]
    ds_read_b64_tr_b16 a[248:249], v230 offset:53248
    ds_read_b64_tr_b16 a[250:251], v230 offset:55296
    v_exp_f32 v198, v114
    v_add_f32 v243, v196, v197
    v_cvt_pk_bf16_f32 v168, v196, v197
    s_waitcnt lgkmcnt(14)
    v_mfma_f32_32x32x16_bf16 v[48:63], a[192:195], v[40:43], v[64:79]
    ds_read_b64_tr_b16 a[252:253], v231 offset:53248
    ds_read_b64_tr_b16 a[254:255], v231 offset:55296
    v_exp_f32 v199, v115
    v_add_f32 v243, v243, v198
    v_mfma_f32_32x32x16_bf16 v[48:63], a[196:199], v[44:47], v[48:63]
    v_exp_f32 v196, v116
    v_add_f32 v243, v243, v199
    v_cvt_pk_bf16_f32 v169, v198, v199
    v_mfma_f32_32x32x16_bf16 v[48:63], a[200:203], v[16:19], v[48:63]
    v_exp_f32 v197, v117
    v_add_f32 v243, v243, v196
    v_mfma_f32_32x32x16_bf16 v[48:63], a[204:207], v[20:23], v[48:63]
    s_add_u32 m0, s38, s82
    v_exp_f32 v198, v118
    v_add_f32 v243, v243, v197
    v_cvt_pk_bf16_f32 v170, v196, v197
    v_mfma_f32_32x32x16_bf16 v[48:63], a[208:211], v[24:27], v[48:63]
    buffer_load_dwordx4 v232, s[16:19], s36 offen nt lds
    v_exp_f32 v199, v119
    v_add_f32 v243, v243, v198
    v_mfma_f32_32x32x16_bf16 v[48:63], a[212:215], v[28:31], v[48:63]
    v_exp_f32 v196, v120
    v_add_f32 v243, v243, v199
    v_cvt_pk_bf16_f32 v171, v198, v199
    v_mfma_f32_32x32x16_bf16 v[48:63], a[216:219], v[32:35], v[48:63]
    v_exp_f32 v197, v121
    v_add_f32 v243, v243, v196
    v_mfma_f32_32x32x16_bf16 v[48:63], a[220:223], v[36:39], v[48:63]
    v_exp_f32 v198, v122
    v_add_f32 v243, v243, v197
    v_cvt_pk_bf16_f32 v172, v196, v197
    s_waitcnt lgkmcnt(0)
    v_mfma_f32_32x32x16_bf16 a[0:15], a[224:227], v[160:163], a[0:15]
    v_exp_f32 v199, v123
    v_add_f32 v243, v243, v198
    v_mfma_f32_32x32x16_bf16 a[16:31], a[228:231], v[160:163], a[16:31]
    v_exp_f32 v196, v124
    v_add_f32 v243, v243, v199
    v_cvt_pk_bf16_f32 v173, v198, v199
    v_mfma_f32_32x32x16_bf16 a[32:47], a[232:235], v[160:163], a[32:47]
    v_exp_f32 v197, v125
    v_add_f32 v243, v243, v196
    v_mfma_f32_32x32x16_bf16 a[48:63], a[236:239], v[160:163], a[48:63]
    buffer_load_dwordx4 v233, s[16:19], s36 offen offset:1024 nt lds
    v_exp_f32 v198, v126
    v_add_f32 v243, v243, v197
    v_cvt_pk_bf16_f32 v174, v196, v197
    v_mfma_f32_32x32x16_bf16 a[0:15], a[240:243], v[164:167], a[0:15]
    v_exp_f32 v199, v127
    v_add_f32 v243, v243, v198
    v_mfma_f32_32x32x16_bf16 a[16:31], a[244:247], v[164:167], a[16:31]
    v_add_f32 v243, v243, v199
    v_cvt_pk_bf16_f32 v175, v198, v199
    v_cmp_lt_f32 vcc, s35, v243
    v_exp_f32 v196, v152
    v_mfma_f32_32x32x16_bf16 a[32:47], a[248:251], v[164:167], a[32:47]
    v_exp_f32 v197, v153
    v_add_f32 v244, v244, v196
    v_mfma_f32_32x32x16_bf16 a[48:63], a[252:255], v[164:167], a[48:63]
    s_cbranch_vccnz FX31
FX31_RET:
    v_add_f32 v240, v240, v243
    v_exp_f32 v198, v154
    v_add_f32 v244, v244, v197
    v_cvt_pk_bf16_f32 v180, v196, v197
    v_mfma_f32_32x32x16_bf16 v[112:127], a[192:195], v[104:107], v[128:143]
    v_exp_f32 v199, v155
    v_add_f32 v244, v244, v198
    v_mfma_f32_32x32x16_bf16 v[112:127], a[196:199], v[108:111], v[112:127]
    ds_read_b128 a[192:195], v220 offset:40960
    v_exp_f32 v196, v156
    v_add_f32 v244, v244, v199
    v_cvt_pk_bf16_f32 v181, v198, v199
    v_mfma_f32_32x32x16_bf16 v[112:127], a[200:203], v[80:83], v[112:127]
    ds_read_b128 a[196:199], v221 offset:40960
    buffer_load_dwordx4 v234, s[16:19], s36 offen offset:2048 nt lds
    v_exp_f32 v197, v157
    v_add_f32 v244, v244, v196
    v_mfma_f32_32x32x16_bf16 v[112:127], a[204:207], v[84:87], v[112:127]
    ds_read_b128 a[200:203], v222 offset:40960
    v_exp_f32 v198, v158
    v_add_f32 v244, v244, v197
    v_cvt_pk_bf16_f32 v182, v196, v197
    v_mfma_f32_32x32x16_bf16 v[112:127], a[208:211], v[88:91], v[112:127]
    ds_read_b128 a[204:207], v223 offset:40960
    v_exp_f32 v199, v159
    v_add_f32 v244, v244, v198
    v_mfma_f32_32x32x16_bf16 v[112:127], a[212:215], v[92:95], v[112:127]
    ds_read_b128 a[208:211], v224 offset:40960
    v_add_f32 v244, v244, v199
    v_cvt_pk_bf16_f32 v183, v198, v199
    v_cmp_lt_f32 vcc, s35, v244
    v_exp_f32 v196, v48
    v_mfma_f32_32x32x16_bf16 v[112:127], a[216:219], v[96:99], v[112:127]
    ds_read_b128 a[212:215], v225 offset:40960
    v_exp_f32 v197, v49
    v_mfma_f32_32x32x16_bf16 v[112:127], a[220:223], v[100:103], v[112:127]
    ds_read_b128 a[216:219], v226 offset:40960
    s_cbranch_vccnz FX32
FX32_RET:
    v_add_f32 v241, v241, v244
    v_exp_f32 v198, v50
    v_add_f32 v242, v196, v197
    v_cvt_pk_bf16_f32 v160, v196, v197
    v_mfma_f32_32x32x16_bf16 a[128:143], a[224:227], v[176:179], a[128:143]
    ds_read_b128 a[220:223], v227 offset:40960
    v_exp_f32 v199, v51
    v_add_f32 v242, v242, v198
    v_mfma_f32_32x32x16_bf16 a[144:159], a[228:231], v[176:179], a[144:159]
    buffer_load_dwordx4 v235, s[16:19], s36 offen offset:3072 nt lds
    v_exp_f32 v196, v52
    v_add_f32 v242, v242, v199
    v_cvt_pk_bf16_f32 v161, v198, v199
    v_mfma_f32_32x32x16_bf16 a[160:175], a[232:235], v[176:179], a[160:175]
    v_exp_f32 v197, v53
    v_add_f32 v242, v242, v196
    v_mfma_f32_32x32x16_bf16 a[176:191], a[236:239], v[176:179], a[176:191]
    s_add_u32 s36, s36, 16384
    v_exp_f32 v198, v54
    v_add_f32 v242, v242, v197
    v_cvt_pk_bf16_f32 v162, v196, v197
    v_mfma_f32_32x32x16_bf16 a[128:143], a[240:243], v[180:183], a[128:143]
    v_exp_f32 v199, v55
    v_add_f32 v242, v242, v198
    v_mfma_f32_32x32x16_bf16 a[144:159], a[244:247], v[180:183], a[144:159]
    v_exp_f32 v196, v56
    v_add_f32 v242, v242, v199
    v_cvt_pk_bf16_f32 v163, v198, v199
    v_mfma_f32_32x32x16_bf16 a[160:175], a[248:251], v[180:183], a[160:175]
    v_exp_f32 v197, v57
    v_add_f32 v242, v242, v196
    v_mfma_f32_32x32x16_bf16 a[176:191], a[252:255], v[180:183], a[176:191]
    v_exp_f32 v198, v58
    v_add_f32 v242, v242, v197
    v_cvt_pk_bf16_f32 v164, v196, v197
    v_mfma_f32_32x32x16_bf16 a[64:79], a[224:227], v[168:171], a[64:79]
    v_exp_f32 v199, v59
    v_add_f32 v242, v242, v198
    v_mfma_f32_32x32x16_bf16 a[80:95], a[228:231], v[168:171], a[80:95]
    ds_read_b64_tr_b16 a[224:225], v228 offset:57344
    ds_read_b64_tr_b16 a[226:227], v228 offset:59392
    v_exp_f32 v196, v60
    v_add_f32 v242, v242, v199
    v_cvt_pk_bf16_f32 v165, v198, v199
    v_mfma_f32_32x32x16_bf16 a[96:111], a[232:235], v[168:171], a[96:111]
    ds_read_b64_tr_b16 a[228:229], v229 offset:57344
    ds_read_b64_tr_b16 a[230:231], v229 offset:59392
    v_exp_f32 v197, v61
    v_add_f32 v242, v242, v196
    v_mfma_f32_32x32x16_bf16 a[112:127], a[236:239], v[168:171], a[112:127]
    ds_read_b64_tr_b16 a[232:233], v230 offset:57344
    ds_read_b64_tr_b16 a[234:235], v230 offset:59392
    v_exp_f32 v198, v62
    v_add_f32 v242, v242, v197
    v_cvt_pk_bf16_f32 v166, v196, v197
    v_mfma_f32_32x32x16_bf16 a[64:79], a[240:243], v[172:175], a[64:79]
    ds_read_b64_tr_b16 a[236:237], v231 offset:57344
    ds_read_b64_tr_b16 a[238:239], v231 offset:59392
    v_exp_f32 v199, v63
    v_add_f32 v242, v242, v198
    v_mfma_f32_32x32x16_bf16 a[80:95], a[244:247], v[172:175], a[80:95]
    ds_read_b64_tr_b16 a[240:241], v228 offset:61440
    ds_read_b64_tr_b16 a[242:243], v228 offset:63488
    v_add_f32 v242, v242, v199
    v_cvt_pk_bf16_f32 v167, v198, v199
    v_cmp_lt_f32 vcc, s35, v242
    v_exp_f32 v196, v112
    v_mfma_f32_32x32x16_bf16 a[96:111], a[248:251], v[172:175], a[96:111]
    ds_read_b64_tr_b16 a[244:245], v229 offset:61440
    ds_read_b64_tr_b16 a[246:247], v229 offset:63488
    v_exp_f32 v197, v113
    v_mfma_f32_32x32x16_bf16 a[112:127], a[252:255], v[172:175], a[112:127]
    ds_read_b64_tr_b16 a[248:249], v230 offset:61440
    ds_read_b64_tr_b16 a[250:251], v230 offset:63488
    s_cbranch_vccnz FX33
FX33_RET:
    v_add_f32 v239, v239, v242
    v_exp_f32 v198, v114
    v_add_f32 v243, v196, v197
    v_cvt_pk_bf16_f32 v168, v196, v197
    s_waitcnt lgkmcnt(14)
    v_mfma_f32_32x32x16_bf16 v[48:63], a[192:195], v[40:43], v[64:79]
    ds_read_b64_tr_b16 a[252:253], v231 offset:61440
    ds_read_b64_tr_b16 a[254:255], v231 offset:63488
    v_exp_f32 v199, v115
    v_add_f32 v243, v243, v198
    v_mfma_f32_32x32x16_bf16 v[48:63], a[196:199], v[44:47], v[48:63]
    s_add_u32 m0, s38, s86
    v_exp_f32 v196, v116
    v_add_f32 v243, v243, v199
    v_cvt_pk_bf16_f32 v169, v198, v199
    v_mfma_f32_32x32x16_bf16 v[48:63], a[200:203], v[16:19], v[48:63]
    v_exp_f32 v197, v117
    v_add_f32 v243, v243, v196
    v_xor_b32 v220, 65536, v220
    v_mfma_f32_32x32x16_bf16 v[48:63], a[204:207], v[20:23], v[48:63]
    buffer_load_dwordx4 v236, s[20:23], s37 offen nt lds
    v_exp_f32 v198, v118
    v_add_f32 v243, v243, v197
    v_cvt_pk_bf16_f32 v170, v196, v197
    v_xor_b32 v221, 65536, v221
    v_mfma_f32_32x32x16_bf16 v[48:63], a[208:211], v[24:27], v[48:63]
    v_exp_f32 v199, v119
    v_add_f32 v243, v243, v198
    v_xor_b32 v222, 65536, v222
    v_mfma_f32_32x32x16_bf16 v[48:63], a[212:215], v[28:31], v[48:63]
    v_exp_f32 v196, v120
    v_add_f32 v243, v243, v199
    v_cvt_pk_bf16_f32 v171, v198, v199
    v_xor_b32 v223, 65536, v223
    v_mfma_f32_32x32x16_bf16 v[48:63], a[216:219], v[32:35], v[48:63]
    buffer_load_dwordx4 v236, s[20:23], s37 offen offset:1024 nt lds
    v_exp_f32 v197, v121
    v_add_f32 v243, v243, v196
    v_xor_b32 v224, 65536, v224
    v_mfma_f32_32x32x16_bf16 v[48:63], a[220:223], v[36:39], v[48:63]
    v_exp_f32 v198, v122
    v_add_f32 v243, v243, v197
    v_cvt_pk_bf16_f32 v172, v196, v197
    v_xor_b32 v225, 65536, v225
    s_waitcnt lgkmcnt(0)
    v_mfma_f32_32x32x16_bf16 a[0:15], a[224:227], v[160:163], a[0:15]
    v_exp_f32 v199, v123
    v_add_f32 v243, v243, v198
    v_xor_b32 v226, 65536, v226
    v_mfma_f32_32x32x16_bf16 a[16:31], a[228:231], v[160:163], a[16:31]
    buffer_load_dwordx4 v236, s[20:23], s37 offen offset:2048 nt lds
    v_exp_f32 v196, v124
    v_add_f32 v243, v243, v199
    v_cvt_pk_bf16_f32 v173, v198, v199
    v_xor_b32 v227, 65536, v227
    v_mfma_f32_32x32x16_bf16 a[32:47], a[232:235], v[160:163], a[32:47]
    v_exp_f32 v197, v125
    v_add_f32 v243, v243, v196
    v_xor_b32 v228, 65536, v228
    v_mfma_f32_32x32x16_bf16 a[48:63], a[236:239], v[160:163], a[48:63]
    v_exp_f32 v198, v126
    v_add_f32 v243, v243, v197
    v_cvt_pk_bf16_f32 v174, v196, v197
    v_xor_b32 v229, 65536, v229
    v_mfma_f32_32x32x16_bf16 a[0:15], a[240:243], v[164:167], a[0:15]
    buffer_load_dwordx4 v236, s[20:23], s37 offen offset:3072 nt lds
    v_exp_f32 v199, v127
    v_add_f32 v243, v243, v198
    v_xor_b32 v230, 65536, v230
    v_mfma_f32_32x32x16_bf16 a[16:31], a[244:247], v[164:167], a[16:31]
    v_add_f32 v243, v243, v199
    v_cvt_pk_bf16_f32 v175, v198, v199
    v_cmp_lt_f32 vcc, s35, v243
    v_exp_f32 v196, v48
    v_xor_b32 v231, 65536, v231
    v_mfma_f32_32x32x16_bf16 a[32:47], a[248:251], v[164:167], a[32:47]
    s_add_u32 s37, s37, 16384
    v_exp_f32 v197, v49
    v_mfma_f32_32x32x16_bf16 a[48:63], a[252:255], v[164:167], a[48:63]
    s_add_u32 s38, s38, 32768
    s_and_b32 s38, s38, 131071
    s_cbranch_vccnz FX34
FX34_RET:
    v_add_f32 v240, v240, v243
    v_exp_f32 v198, v50
    v_add_f32 v242, v196, v197
    v_cvt_pk_bf16_f32 v160, v196, v197
    v_mfma_f32_32x32x16_bf16 v[112:127], a[192:195], v[104:107], v[128:143]
    v_exp_f32 v199, v51
    v_add_f32 v242, v242, v198
    v_mfma_f32_32x32x16_bf16 v[112:127], a[196:199], v[108:111], v[112:127]
    v_exp_f32 v196, v52
    v_add_f32 v242, v242, v199
    v_cvt_pk_bf16_f32 v161, v198, v199
    s_waitcnt vmcnt(16)
    s_barrier
    ds_read_b128 a[192:195], v220
    v_mfma_f32_32x32x16_bf16 v[112:127], a[200:203], v[80:83], v[112:127]
    ds_read_b128 a[196:199], v221
    v_exp_f32 v197, v53
    v_add_f32 v242, v242, v196
    v_mfma_f32_32x32x16_bf16 v[112:127], a[204:207], v[84:87], v[112:127]
    ds_read_b128 a[200:203], v222
    v_exp_f32 v198, v54
    v_add_f32 v242, v242, v197
    v_cvt_pk_bf16_f32 v162, v196, v197
    v_mfma_f32_32x32x16_bf16 v[112:127], a[208:211], v[88:91], v[112:127]
    ds_read_b128 a[204:207], v223
    v_exp_f32 v199, v55
    v_add_f32 v242, v242, v198
    v_mfma_f32_32x32x16_bf16 v[112:127], a[212:215], v[92:95], v[112:127]
    ds_read_b128 a[208:211], v224
    v_exp_f32 v196, v56
    v_add_f32 v242, v242, v199
    v_cvt_pk_bf16_f32 v163, v198, v199
    v_mfma_f32_32x32x16_bf16 v[112:127], a[216:219], v[96:99], v[112:127]
    ds_read_b128 a[212:215], v225
    v_exp_f32 v197, v57
    v_add_f32 v242, v242, v196
    v_mfma_f32_32x32x16_bf16 v[112:127], a[220:223], v[100:103], v[112:127]
    ds_read_b128 a[216:219], v226
    v_exp_f32 v198, v58
    v_add_f32 v242, v242, v197
    v_cvt_pk_bf16_f32 v164, v196, v197
    v_mfma_f32_32x32x16_bf16 a[64:79], a[224:227], v[168:171], a[64:79]
    ds_read_b128 a[220:223], v227
    v_exp_f32 v199, v59
    v_add_f32 v242, v242, v198
    v_mfma_f32_32x32x16_bf16 a[80:95], a[228:231], v[168:171], a[80:95]
    ds_read_b64_tr_b16 a[224:225], v228 offset:16384
    ds_read_b64_tr_b16 a[226:227], v228 offset:18432
    v_exp_f32 v196, v60
    v_add_f32 v242, v242, v199
    v_cvt_pk_bf16_f32 v165, v198, v199
    v_mfma_f32_32x32x16_bf16 a[96:111], a[232:235], v[168:171], a[96:111]
    ds_read_b64_tr_b16 a[228:229], v229 offset:16384
    ds_read_b64_tr_b16 a[230:231], v229 offset:18432
    v_exp_f32 v197, v61
    v_add_f32 v242, v242, v196
    v_mfma_f32_32x32x16_bf16 a[112:127], a[236:239], v[168:171], a[112:127]
    ds_read_b64_tr_b16 a[232:233], v230 offset:16384
    ds_read_b64_tr_b16 a[234:235], v230 offset:18432
    v_exp_f32 v198, v62
    v_add_f32 v242, v242, v197
    v_cvt_pk_bf16_f32 v166, v196, v197
    v_mfma_f32_32x32x16_bf16 a[64:79], a[240:243], v[172:175], a[64:79]
    ds_read_b64_tr_b16 a[236:237], v231 offset:16384
    ds_read_b64_tr_b16 a[238:239], v231 offset:18432
    v_exp_f32 v199, v63
    v_add_f32 v242, v242, v198
    v_mfma_f32_32x32x16_bf16 a[80:95], a[244:247], v[172:175], a[80:95]
    ds_read_b64_tr_b16 a[240:241], v228 offset:20480
    ds_read_b64_tr_b16 a[242:243], v228 offset:22528
    v_add_f32 v242, v242, v199
    v_cvt_pk_bf16_f32 v167, v198, v199
    v_cmp_lt_f32 vcc, s35, v242
    v_exp_f32 v196, v112
    v_mfma_f32_32x32x16_bf16 a[96:111], a[248:251], v[172:175], a[96:111]
    ds_read_b64_tr_b16 a[244:245], v229 offset:20480
    ds_read_b64_tr_b16 a[246:247], v229 offset:22528
    v_exp_f32 v197, v113
    v_mfma_f32_32x32x16_bf16 a[112:127], a[252:255], v[172:175], a[112:127]
    ds_read_b64_tr_b16 a[248:249], v230 offset:20480
    ds_read_b64_tr_b16 a[250:251], v230 offset:22528
    s_cbranch_vccnz FX35
FX35_RET:
    v_add_f32 v239, v239, v242
    v_exp_f32 v198, v114
    v_add_f32 v243, v196, v197
    v_cvt_pk_bf16_f32 v168, v196, v197
    s_sub_u32 s39, s39, 1
    s_cmp_lg_u32 s39, 0
    s_cbranch_scc1 W1_AL
    ds_read_b64_tr_b16 a[252:253], v231 offset:20480
    ds_read_b64_tr_b16 a[254:255], v231 offset:22528
    s_add_u32 s46, s54, 0
    v_exp_f32 v199, v115
    v_add_f32 v243, v243, v198
    buffer_load_dwordx4 v[16:19], v245, s[24:27], s46 offen
    v_exp_f32 v196, v116
    v_add_f32 v243, v243, v199
    v_cvt_pk_bf16_f32 v169, v198, v199
    v_exp_f32 v197, v117
    v_add_f32 v243, v243, v196
    buffer_load_dwordx4 v[20:23], v245, s[24:27], s46 offen offset:1024
    v_exp_f32 v198, v118
    v_add_f32 v243, v243, v197
    v_cvt_pk_bf16_f32 v170, v196, v197
    buffer_load_dwordx4 v[24:27], v245, s[24:27], s46 offen offset:2048
    v_exp_f32 v199, v119
    v_add_f32 v243, v243, v198
    v_exp_f32 v196, v120
    v_add_f32 v243, v243, v199
    v_cvt_pk_bf16_f32 v171, v198, v199
    buffer_load_dwordx4 v[28:31], v245, s[24:27], s46 offen offset:3072
    v_exp_f32 v197, v121
    v_add_f32 v243, v243, v196
    v_exp_f32 v198, v122
    v_add_f32 v243, v243, v197
    v_cvt_pk_bf16_f32 v172, v196, v197
    s_waitcnt lgkmcnt(0)
    v_mfma_f32_32x32x16_bf16 a[0:15], a[224:227], v[160:163], a[0:15]
    s_add_u32 s46, s54, 4096
    v_exp_f32 v199, v123
    v_add_f32 v243, v243, v198
    v_mfma_f32_32x32x16_bf16 a[16:31], a[228:231], v[160:163], a[16:31]
    buffer_load_dwordx4 v[32:35], v245, s[24:27], s46 offen
    v_exp_f32 v196, v124
    v_add_f32 v243, v243, v199
    v_cvt_pk_bf16_f32 v173, v198, v199
    v_mfma_f32_32x32x16_bf16 a[32:47], a[232:235], v[160:163], a[32:47]
    v_exp_f32 v197, v125
    v_add_f32 v243, v243, v196
    v_mfma_f32_32x32x16_bf16 a[48:63], a[236:239], v[160:163], a[48:63]
    buffer_load_dwordx4 v[36:39], v245, s[24:27], s46 offen offset:1024
    v_exp_f32 v198, v126
    v_add_f32 v243, v243, v197
    v_cvt_pk_bf16_f32 v174, v196, v197
    v_mfma_f32_32x32x16_bf16 a[0:15], a[240:243], v[164:167], a[0:15]
    buffer_load_dwordx4 v[40:43], v245, s[24:27], s46 offen offset:2048
    v_exp_f32 v199, v127
    v_add_f32 v243, v243, v198
    v_mfma_f32_32x32x16_bf16 a[16:31], a[244:247], v[164:167], a[16:31]
    v_add_f32 v243, v243, v199
    v_cvt_pk_bf16_f32 v175, v198, v199
    v_cmp_lt_f32 vcc, s35, v243
    v_mfma_f32_32x32x16_bf16 a[32:47], a[248:251], v[164:167], a[32:47]
    buffer_load_dwordx4 v[44:47], v245, s[24:27], s46 offen offset:3072
    v_mfma_f32_32x32x16_bf16 a[48:63], a[252:255], v[164:167], a[48:63]
    s_cbranch_vccnz FX36
FX36_RET:
    v_add_f32 v240, v240, v243
    s_add_u32 s46, s54, 8192
    buffer_load_dwordx4 v[80:83], v245, s[24:27], s46 offen
    buffer_load_dwordx4 v[84:87], v245, s[24:27], s46 offen offset:1024
    buffer_load_dwordx4 v[88:91], v245, s[24:27], s46 offen offset:2048
    buffer_load_dwordx4 v[92:95], v245, s[24:27], s46 offen offset:3072
    v_mfma_f32_32x32x16_bf16 a[64:79], a[224:227], v[168:171], a[64:79]
    s_add_u32 s46, s54, 12288
    v_mfma_f32_32x32x16_bf16 a[80:95], a[228:231], v[168:171], a[80:95]
    buffer_load_dwordx4 v[96:99], v245, s[24:27], s46 offen
    v_mfma_f32_32x32x16_bf16 a[96:111], a[232:235], v[168:171], a[96:111]
    v_mfma_f32_32x32x16_bf16 a[112:127], a[236:239], v[168:171], a[112:127]
    buffer_load_dwordx4 v[100:103], v245, s[24:27], s46 offen offset:1024
    v_mfma_f32_32x32x16_bf16 a[64:79], a[240:243], v[172:175], a[64:79]
    buffer_load_dwordx4 v[104:107], v245, s[24:27], s46 offen offset:2048
    v_mfma_f32_32x32x16_bf16 a[80:95], a[244:247], v[172:175], a[80:95]
    v_mfma_f32_32x32x16_bf16 a[96:111], a[248:251], v[172:175], a[96:111]
    buffer_load_dwordx4 v[108:111], v245, s[24:27], s46 offen offset:3072
    v_mfma_f32_32x32x16_bf16 a[112:127], a[252:255], v[172:175], a[112:127]
    v_mov_b32 v2, v241
    s_nop 1
    v_permlane32_swap_b32 v241, v2
    v_add_f32 v241, v241, v2
    v_mov_b32 v2, v239
    s_nop 1
    v_permlane32_swap_b32 v239, v2
    v_add_f32 v239, v239, v2
    v_mov_b32 v2, v240
    s_nop 1
    v_permlane32_swap_b32 v240, v2
    v_add_f32 v240, v240, v2
    v_and_b32 v2, 31, v1
    v_lshlrev_b32 v2, 2, v2
    v_add_u32 v2, 159744, v2
    v_sub_f32 v3, 0, v204
    ds_write_b32 v2, v3 offset:256
    ds_write_b32 v2, v241 offset:384
    v_rcp_f32 v48, v239
    s_nop 0
    v_mov_b32 v49, v48
    v_rcp_f32 v50, v240
    s_nop 0
    v_mov_b32 v51, v50
    s_add_u32 s42, s53, 4096
    v_accvgpr_read_b32 v112, a0
    v_accvgpr_read_b32 v113, a1
    v_accvgpr_read_b32 v114, a2
    v_accvgpr_read_b32 v115, a3
    v_accvgpr_read_b32 v116, a4
    v_accvgpr_read_b32 v117, a5
    v_accvgpr_read_b32 v118, a6
    v_accvgpr_read_b32 v119, a7
    v_pk_mul_f32 v[112:113], v[112:113], v[48:49]
    v_pk_mul_f32 v[114:115], v[114:115], v[48:49]
    v_pk_mul_f32 v[116:117], v[116:117], v[48:49]
    v_pk_mul_f32 v[118:119], v[118:119], v[48:49]
    v_cvt_pk_bf16_f32 v176, v112, v113
    v_cvt_pk_bf16_f32 v177, v114, v115
    v_cvt_pk_bf16_f32 v178, v116, v117
    v_cvt_pk_bf16_f32 v179, v118, v119
    buffer_store_dwordx4 v[176:179], v238, s[24:27], s42 offen sc1
    v_accvgpr_read_b32 v120, a8
    v_accvgpr_read_b32 v121, a9
    v_accvgpr_read_b32 v122, a10
    v_accvgpr_read_b32 v123, a11
    v_accvgpr_read_b32 v124, a12
    v_accvgpr_read_b32 v125, a13
    v_accvgpr_read_b32 v126, a14
    v_accvgpr_read_b32 v127, a15
    v_pk_mul_f32 v[120:121], v[120:121], v[48:49]
    v_pk_mul_f32 v[122:123], v[122:123], v[48:49]
    v_pk_mul_f32 v[124:125], v[124:125], v[48:49]
    v_pk_mul_f32 v[126:127], v[126:127], v[48:49]
    v_cvt_pk_bf16_f32 v180, v120, v121
    v_cvt_pk_bf16_f32 v181, v122, v123
    v_cvt_pk_bf16_f32 v182, v124, v125
    v_cvt_pk_bf16_f32 v183, v126, v127
    buffer_store_dwordx4 v[180:183], v238, s[24:27], s42 offen offset:512 sc1
    s_add_u32 s42, s53, 151552
    v_accvgpr_read_b32 v112, a16
    v_accvgpr_read_b32 v113, a17
    v_accvgpr_read_b32 v114, a18
    v_accvgpr_read_b32 v115, a19
    v_accvgpr_read_b32 v116, a20
    v_accvgpr_read_b32 v117, a21
    v_accvgpr_read_b32 v118, a22
    v_accvgpr_read_b32 v119, a23
    v_pk_mul_f32 v[112:113], v[112:113], v[48:49]
    v_pk_mul_f32 v[114:115], v[114:115], v[48:49]
    v_pk_mul_f32 v[116:117], v[116:117], v[48:49]
    v_pk_mul_f32 v[118:119], v[118:119], v[48:49]
    v_cvt_pk_bf16_f32 v184, v112, v113
    v_cvt_pk_bf16_f32 v185, v114, v115
    v_cvt_pk_bf16_f32 v186, v116, v117
    v_cvt_pk_bf16_f32 v187, v118, v119
    buffer_store_dwordx4 v[184:187], v238, s[24:27], s42 offen sc1
    v_accvgpr_read_b32 v120, a24
    v_accvgpr_read_b32 v121, a25
    v_accvgpr_read_b32 v122, a26
    v_accvgpr_read_b32 v123, a27
    v_accvgpr_read_b32 v124, a28
    v_accvgpr_read_b32 v125, a29
    v_accvgpr_read_b32 v126, a30
    v_accvgpr_read_b32 v127, a31
    v_pk_mul_f32 v[120:121], v[120:121], v[48:49]
    v_pk_mul_f32 v[122:123], v[122:123], v[48:49]
    v_pk_mul_f32 v[124:125], v[124:125], v[48:49]
    v_pk_mul_f32 v[126:127], v[126:127], v[48:49]
    v_cvt_pk_bf16_f32 v188, v120, v121
    v_cvt_pk_bf16_f32 v189, v122, v123
    v_cvt_pk_bf16_f32 v190, v124, v125
    v_cvt_pk_bf16_f32 v191, v126, v127
    buffer_store_dwordx4 v[188:191], v238, s[24:27], s42 offen offset:512 sc1
    s_add_u32 s42, s53, 299008
    v_accvgpr_read_b32 v112, a32
    v_accvgpr_read_b32 v113, a33
    v_accvgpr_read_b32 v114, a34
    v_accvgpr_read_b32 v115, a35
    v_accvgpr_read_b32 v116, a36
    v_accvgpr_read_b32 v117, a37
    v_accvgpr_read_b32 v118, a38
    v_accvgpr_read_b32 v119, a39
    v_pk_mul_f32 v[112:113], v[112:113], v[48:49]
    v_pk_mul_f32 v[114:115], v[114:115], v[48:49]
    v_pk_mul_f32 v[116:117], v[116:117], v[48:49]
    v_pk_mul_f32 v[118:119], v[118:119], v[48:49]
    v_cvt_pk_bf16_f32 v176, v112, v113
    v_cvt_pk_bf16_f32 v177, v114, v115
    v_cvt_pk_bf16_f32 v178, v116, v117
    v_cvt_pk_bf16_f32 v179, v118, v119
    buffer_store_dwordx4 v[176:179], v238, s[24:27], s42 offen sc1
    v_accvgpr_read_b32 v120, a40
    v_accvgpr_read_b32 v121, a41
    v_accvgpr_read_b32 v122, a42
    v_accvgpr_read_b32 v123, a43
    v_accvgpr_read_b32 v124, a44
    v_accvgpr_read_b32 v125, a45
    v_accvgpr_read_b32 v126, a46
    v_accvgpr_read_b32 v127, a47
    v_pk_mul_f32 v[120:121], v[120:121], v[48:49]
    v_pk_mul_f32 v[122:123], v[122:123], v[48:49]
    v_pk_mul_f32 v[124:125], v[124:125], v[48:49]
    v_pk_mul_f32 v[126:127], v[126:127], v[48:49]
    v_cvt_pk_bf16_f32 v180, v120, v121
    v_cvt_pk_bf16_f32 v181, v122, v123
    v_cvt_pk_bf16_f32 v182, v124, v125
    v_cvt_pk_bf16_f32 v183, v126, v127
    buffer_store_dwordx4 v[180:183], v238, s[24:27], s42 offen offset:512 sc1
    s_add_u32 s42, s53, 446464
    v_accvgpr_read_b32 v112, a48
    v_accvgpr_read_b32 v113, a49
    v_accvgpr_read_b32 v114, a50
    v_accvgpr_read_b32 v115, a51
    v_accvgpr_read_b32 v116, a52
    v_accvgpr_read_b32 v117, a53
    v_accvgpr_read_b32 v118, a54
    v_accvgpr_read_b32 v119, a55
    v_pk_mul_f32 v[112:113], v[112:113], v[48:49]
    v_pk_mul_f32 v[114:115], v[114:115], v[48:49]
    v_pk_mul_f32 v[116:117], v[116:117], v[48:49]
    v_pk_mul_f32 v[118:119], v[118:119], v[48:49]
    v_cvt_pk_bf16_f32 v184, v112, v113
    v_cvt_pk_bf16_f32 v185, v114, v115
    v_cvt_pk_bf16_f32 v186, v116, v117
    v_cvt_pk_bf16_f32 v187, v118, v119
    buffer_store_dwordx4 v[184:187], v238, s[24:27], s42 offen sc1
    v_accvgpr_read_b32 v120, a56
    v_accvgpr_read_b32 v121, a57
    v_accvgpr_read_b32 v122, a58
    v_accvgpr_read_b32 v123, a59
    v_accvgpr_read_b32 v124, a60
    v_accvgpr_read_b32 v125, a61
    v_accvgpr_read_b32 v126, a62
    v_accvgpr_read_b32 v127, a63
    v_pk_mul_f32 v[120:121], v[120:121], v[48:49]
    v_pk_mul_f32 v[122:123], v[122:123], v[48:49]
    v_pk_mul_f32 v[124:125], v[124:125], v[48:49]
    v_pk_mul_f32 v[126:127], v[126:127], v[48:49]
    v_cvt_pk_bf16_f32 v188, v120, v121
    v_cvt_pk_bf16_f32 v189, v122, v123
    v_cvt_pk_bf16_f32 v190, v124, v125
    v_cvt_pk_bf16_f32 v191, v126, v127
    buffer_store_dwordx4 v[188:191], v238, s[24:27], s42 offen offset:512 sc1
    s_waitcnt lgkmcnt(0)
    s_barrier
    ds_read_b32 v52, v2
    ds_read_b32 v56, v2 offset:128
    ds_read_b32 v53, v2 offset:256
    ds_read_b32 v57, v2 offset:384
    ds_read_b32 v54, v2 offset:512
    ds_read_b32 v58, v2 offset:640
    ds_read_b32 v55, v2 offset:768
    ds_read_b32 v59, v2 offset:896
    ds_write_b128 v254, v[246:249]
    ds_write_b128 v254, v[250:253] offset:1024
    s_waitcnt lgkmcnt(5)
    v_max3_f32 v4, v52, v53, v54
    s_waitcnt lgkmcnt(3)
    v_max_f32 v4, v4, v55
    v_sub_f32 v52, v52, v4
    v_exp_f32 v52, v52
    v_sub_f32 v53, v53, v4
    v_exp_f32 v53, v53
    v_sub_f32 v54, v54, v4
    v_exp_f32 v54, v54
    v_sub_f32 v55, v55, v4
    v_exp_f32 v55, v55
    v_mul_f32 v60, v52, v56
    v_fma_f32 v60, v53, v57, v60
    v_fma_f32 v60, v54, v58, v60
    s_waitcnt lgkmcnt(2)
    v_fma_f32 v60, v55, v59, v60
    v_rcp_f32 v60, v60
    s_nop 0
    v_mul_f32 v60, v60, v53
    v_mov_b32 v61, v60
    v_add_u32 v6, 98304, v245
    v_accvgpr_read_b32 v128, a128
    v_accvgpr_read_b32 v129, a129
    v_accvgpr_read_b32 v130, a130
    v_accvgpr_read_b32 v131, a131
    v_pk_mul_f32 v[128:129], v[128:129], v[60:61]
    v_pk_mul_f32 v[130:131], v[130:131], v[60:61]
    ds_write_b128 v6, v[128:131]
    v_accvgpr_read_b32 v132, a132
    v_accvgpr_read_b32 v133, a133
    v_accvgpr_read_b32 v134, a134
    v_accvgpr_read_b32 v135, a135
    v_pk_mul_f32 v[132:133], v[132:133], v[60:61]
    v_pk_mul_f32 v[134:135], v[134:135], v[60:61]
    ds_write_b128 v6, v[132:135] offset:1024
    v_accvgpr_read_b32 v136, a136
    v_accvgpr_read_b32 v137, a137
    v_accvgpr_read_b32 v138, a138
    v_accvgpr_read_b32 v139, a139
    v_pk_mul_f32 v[136:137], v[136:137], v[60:61]
    v_pk_mul_f32 v[138:139], v[138:139], v[60:61]
    ds_write_b128 v6, v[136:139] offset:2048
    v_accvgpr_read_b32 v140, a140
    v_accvgpr_read_b32 v141, a141
    v_accvgpr_read_b32 v142, a142
    v_accvgpr_read_b32 v143, a143
    v_pk_mul_f32 v[140:141], v[140:141], v[60:61]
    v_pk_mul_f32 v[142:143], v[142:143], v[60:61]
    ds_write_b128 v6, v[140:143] offset:3072
    v_accvgpr_read_b32 v128, a160
    v_accvgpr_read_b32 v129, a161
    v_accvgpr_read_b32 v130, a162
    v_accvgpr_read_b32 v131, a163
    v_pk_mul_f32 v[128:129], v[128:129], v[60:61]
    v_pk_mul_f32 v[130:131], v[130:131], v[60:61]
    ds_write_b128 v6, v[128:131] offset:40960
    v_accvgpr_read_b32 v132, a164
    v_accvgpr_read_b32 v133, a165
    v_accvgpr_read_b32 v134, a166
    v_accvgpr_read_b32 v135, a167
    v_pk_mul_f32 v[132:133], v[132:133], v[60:61]
    v_pk_mul_f32 v[134:135], v[134:135], v[60:61]
    ds_write_b128 v6, v[132:135] offset:41984
    v_accvgpr_read_b32 v136, a168
    v_accvgpr_read_b32 v137, a169
    v_accvgpr_read_b32 v138, a170
    v_accvgpr_read_b32 v139, a171
    v_pk_mul_f32 v[136:137], v[136:137], v[60:61]
    v_pk_mul_f32 v[138:139], v[138:139], v[60:61]
    ds_write_b128 v6, v[136:139] offset:43008
    v_accvgpr_read_b32 v140, a172
    v_accvgpr_read_b32 v141, a173
    v_accvgpr_read_b32 v142, a174
    v_accvgpr_read_b32 v143, a175
    v_pk_mul_f32 v[140:141], v[140:141], v[60:61]
    v_pk_mul_f32 v[142:143], v[142:143], v[60:61]
    ds_write_b128 v6, v[140:143] offset:44032
    v_accvgpr_read_b32 v128, a176
    v_accvgpr_read_b32 v129, a177
    v_accvgpr_read_b32 v130, a178
    v_accvgpr_read_b32 v131, a179
    v_pk_mul_f32 v[128:129], v[128:129], v[60:61]
    v_pk_mul_f32 v[130:131], v[130:131], v[60:61]
    ds_write_b128 v6, v[128:131] offset:49152
    v_accvgpr_read_b32 v132, a180
    v_accvgpr_read_b32 v133, a181
    v_accvgpr_read_b32 v134, a182
    v_accvgpr_read_b32 v135, a183
    v_pk_mul_f32 v[132:133], v[132:133], v[60:61]
    v_pk_mul_f32 v[134:135], v[134:135], v[60:61]
    ds_write_b128 v6, v[132:135] offset:50176
    v_accvgpr_read_b32 v136, a184
    v_accvgpr_read_b32 v137, a185
    v_accvgpr_read_b32 v138, a186
    v_accvgpr_read_b32 v139, a187
    v_pk_mul_f32 v[136:137], v[136:137], v[60:61]
    v_pk_mul_f32 v[138:139], v[138:139], v[60:61]
    ds_write_b128 v6, v[136:139] offset:51200
    v_accvgpr_read_b32 v140, a188
    v_accvgpr_read_b32 v141, a189
    v_accvgpr_read_b32 v142, a190
    v_accvgpr_read_b32 v143, a191
    v_pk_mul_f32 v[140:141], v[140:141], v[60:61]
    v_pk_mul_f32 v[142:143], v[142:143], v[60:61]
    ds_write_b128 v6, v[140:143] offset:52224
    v_accvgpr_read_b32 v64, a144
    v_accvgpr_read_b32 v65, a145
    v_accvgpr_read_b32 v66, a146
    v_accvgpr_read_b32 v67, a147
    v_pk_mul_f32 v[64:65], v[64:65], v[60:61]
    v_pk_mul_f32 v[66:67], v[66:67], v[60:61]
    v_accvgpr_read_b32 v68, a148
    v_accvgpr_read_b32 v69, a149
    v_accvgpr_read_b32 v70, a150
    v_accvgpr_read_b32 v71, a151
    v_pk_mul_f32 v[68:69], v[68:69], v[60:61]
    v_pk_mul_f32 v[70:71], v[70:71], v[60:61]
    v_accvgpr_read_b32 v72, a152
    v_accvgpr_read_b32 v73, a153
    v_accvgpr_read_b32 v74, a154
    v_accvgpr_read_b32 v75, a155
    v_pk_mul_f32 v[72:73], v[72:73], v[60:61]
    v_pk_mul_f32 v[74:75], v[74:75], v[60:61]
    v_accvgpr_read_b32 v76, a156
    v_accvgpr_read_b32 v77, a157
    v_accvgpr_read_b32 v78, a158
    v_accvgpr_read_b32 v79, a159
    v_pk_mul_f32 v[76:77], v[76:77], v[60:61]
    v_pk_mul_f32 v[78:79], v[78:79], v[60:61]
    s_waitcnt lgkmcnt(0)
    s_barrier
    ds_read_b128 v[128:131], v6 offset:12288
    ds_read_b128 v[132:135], v6 offset:13312
    ds_read_b128 v[136:139], v6 offset:14336
    ds_read_b128 v[140:143], v6 offset:15360
    ds_read_b128 v[144:147], v6 offset:16384
    ds_read_b128 v[148:151], v6 offset:17408
    ds_read_b128 v[152:155], v6 offset:18432
    ds_read_b128 v[156:159], v6 offset:19456
    ds_read_b128 v[160:163], v6 offset:20480
    ds_read_b128 v[164:167], v6 offset:21504
    ds_read_b128 v[168:171], v6 offset:22528
    ds_read_b128 v[172:175], v6 offset:23552
    s_add_u32 s42, s53, 6144
    v_accvgpr_read_b32 v112, a64
    v_accvgpr_read_b32 v113, a65
    v_accvgpr_read_b32 v114, a66
    v_accvgpr_read_b32 v115, a67
    v_accvgpr_read_b32 v116, a68
    v_accvgpr_read_b32 v117, a69
    v_accvgpr_read_b32 v118, a70
    v_accvgpr_read_b32 v119, a71
    v_pk_mul_f32 v[112:113], v[112:113], v[50:51]
    v_pk_mul_f32 v[114:115], v[114:115], v[50:51]
    v_pk_mul_f32 v[116:117], v[116:117], v[50:51]
    v_pk_mul_f32 v[118:119], v[118:119], v[50:51]
    v_cvt_pk_bf16_f32 v176, v112, v113
    v_cvt_pk_bf16_f32 v177, v114, v115
    v_cvt_pk_bf16_f32 v178, v116, v117
    v_cvt_pk_bf16_f32 v179, v118, v119
    buffer_store_dwordx4 v[176:179], v238, s[24:27], s42 offen sc1
    v_accvgpr_read_b32 v120, a72
    v_accvgpr_read_b32 v121, a73
    v_accvgpr_read_b32 v122, a74
    v_accvgpr_read_b32 v123, a75
    v_accvgpr_read_b32 v124, a76
    v_accvgpr_read_b32 v125, a77
    v_accvgpr_read_b32 v126, a78
    v_accvgpr_read_b32 v127, a79
    v_pk_mul_f32 v[120:121], v[120:121], v[50:51]
    v_pk_mul_f32 v[122:123], v[122:123], v[50:51]
    v_pk_mul_f32 v[124:125], v[124:125], v[50:51]
    v_pk_mul_f32 v[126:127], v[126:127], v[50:51]
    v_cvt_pk_bf16_f32 v180, v120, v121
    v_cvt_pk_bf16_f32 v181, v122, v123
    v_cvt_pk_bf16_f32 v182, v124, v125
    v_cvt_pk_bf16_f32 v183, v126, v127
    buffer_store_dwordx4 v[180:183], v238, s[24:27], s42 offen offset:512 sc1
    s_add_u32 s42, s53, 153600
    v_accvgpr_read_b32 v112, a80
    v_accvgpr_read_b32 v113, a81
    v_accvgpr_read_b32 v114, a82
    v_accvgpr_read_b32 v115, a83
    v_accvgpr_read_b32 v116, a84
    v_accvgpr_read_b32 v117, a85
    v_accvgpr_read_b32 v118, a86
    v_accvgpr_read_b32 v119, a87
    v_pk_mul_f32 v[112:113], v[112:113], v[50:51]
    v_pk_mul_f32 v[114:115], v[114:115], v[50:51]
    v_pk_mul_f32 v[116:117], v[116:117], v[50:51]
    v_pk_mul_f32 v[118:119], v[118:119], v[50:51]
    v_cvt_pk_bf16_f32 v184, v112, v113
    v_cvt_pk_bf16_f32 v185, v114, v115
    v_cvt_pk_bf16_f32 v186, v116, v117
    v_cvt_pk_bf16_f32 v187, v118, v119
    buffer_store_dwordx4 v[184:187], v238, s[24:27], s42 offen sc1
    v_accvgpr_read_b32 v120, a88
    v_accvgpr_read_b32 v121, a89
    v_accvgpr_read_b32 v122, a90
    v_accvgpr_read_b32 v123, a91
    v_accvgpr_read_b32 v124, a92
    v_accvgpr_read_b32 v125, a93
    v_accvgpr_read_b32 v126, a94
    v_accvgpr_read_b32 v127, a95
    v_pk_mul_f32 v[120:121], v[120:121], v[50:51]
    v_pk_mul_f32 v[122:123], v[122:123], v[50:51]
    v_pk_mul_f32 v[124:125], v[124:125], v[50:51]
    v_pk_mul_f32 v[126:127], v[126:127], v[50:51]
    v_cvt_pk_bf16_f32 v188, v120, v121
    v_cvt_pk_bf16_f32 v189, v122, v123
    v_cvt_pk_bf16_f32 v190, v124, v125
    v_cvt_pk_bf16_f32 v191, v126, v127
    buffer_store_dwordx4 v[188:191], v238, s[24:27], s42 offen offset:512 sc1
    s_add_u32 s42, s53, 301056
    v_accvgpr_read_b32 v112, a96
    v_accvgpr_read_b32 v113, a97
    v_accvgpr_read_b32 v114, a98
    v_accvgpr_read_b32 v115, a99
    v_accvgpr_read_b32 v116, a100
    v_accvgpr_read_b32 v117, a101
    v_accvgpr_read_b32 v118, a102
    v_accvgpr_read_b32 v119, a103
    v_pk_mul_f32 v[112:113], v[112:113], v[50:51]
    v_pk_mul_f32 v[114:115], v[114:115], v[50:51]
    v_pk_mul_f32 v[116:117], v[116:117], v[50:51]
    v_pk_mul_f32 v[118:119], v[118:119], v[50:51]
    v_cvt_pk_bf16_f32 v176, v112, v113
    v_cvt_pk_bf16_f32 v177, v114, v115
    v_cvt_pk_bf16_f32 v178, v116, v117
    v_cvt_pk_bf16_f32 v179, v118, v119
    buffer_store_dwordx4 v[176:179], v238, s[24:27], s42 offen sc1
    v_accvgpr_read_b32 v120, a104
    v_accvgpr_read_b32 v121, a105
    v_accvgpr_read_b32 v122, a106
    v_accvgpr_read_b32 v123, a107
    v_accvgpr_read_b32 v124, a108
    v_accvgpr_read_b32 v125, a109
    v_accvgpr_read_b32 v126, a110
    v_accvgpr_read_b32 v127, a111
    v_pk_mul_f32 v[120:121], v[120:121], v[50:51]
    v_pk_mul_f32 v[122:123], v[122:123], v[50:51]
    v_pk_mul_f32 v[124:125], v[124:125], v[50:51]
    v_pk_mul_f32 v[126:127], v[126:127], v[50:51]
    v_cvt_pk_bf16_f32 v180, v120, v121
    v_cvt_pk_bf16_f32 v181, v122, v123
    v_cvt_pk_bf16_f32 v182, v124, v125
    v_cvt_pk_bf16_f32 v183, v126, v127
    buffer_store_dwordx4 v[180:183], v238, s[24:27], s42 offen offset:512 sc1
    s_add_u32 s42, s53, 448512
    v_accvgpr_read_b32 v112, a112
    v_accvgpr_read_b32 v113, a113
    v_accvgpr_read_b32 v114, a114
    v_accvgpr_read_b32 v115, a115
    v_accvgpr_read_b32 v116, a116
    v_accvgpr_read_b32 v117, a117
    v_accvgpr_read_b32 v118, a118
    v_accvgpr_read_b32 v119, a119
    v_pk_mul_f32 v[112:113], v[112:113], v[50:51]
    v_pk_mul_f32 v[114:115], v[114:115], v[50:51]
    v_pk_mul_f32 v[116:117], v[116:117], v[50:51]
    v_pk_mul_f32 v[118:119], v[118:119], v[50:51]
    v_cvt_pk_bf16_f32 v184, v112, v113
    v_cvt_pk_bf16_f32 v185, v114, v115
    v_cvt_pk_bf16_f32 v186, v116, v117
    v_cvt_pk_bf16_f32 v187, v118, v119
    buffer_store_dwordx4 v[184:187], v238, s[24:27], s42 offen sc1
    v_accvgpr_read_b32 v120, a120
    v_accvgpr_read_b32 v121, a121
    v_accvgpr_read_b32 v122, a122
    v_accvgpr_read_b32 v123, a123
    v_accvgpr_read_b32 v124, a124
    v_accvgpr_read_b32 v125, a125
    v_accvgpr_read_b32 v126, a126
    v_accvgpr_read_b32 v127, a127
    v_pk_mul_f32 v[120:121], v[120:121], v[50:51]
    v_pk_mul_f32 v[122:123], v[122:123], v[50:51]
    v_pk_mul_f32 v[124:125], v[124:125], v[50:51]
    v_pk_mul_f32 v[126:127], v[126:127], v[50:51]
    v_cvt_pk_bf16_f32 v188, v120, v121
    v_cvt_pk_bf16_f32 v189, v122, v123
    v_cvt_pk_bf16_f32 v190, v124, v125
    v_cvt_pk_bf16_f32 v191, v126, v127
    buffer_store_dwordx4 v[188:191], v238, s[24:27], s42 offen offset:512 sc1
    s_waitcnt lgkmcnt(11)
    v_pk_add_f32 v[64:65], v[64:65], v[128:129]
    v_pk_add_f32 v[66:67], v[66:67], v[130:131]
    s_waitcnt lgkmcnt(10)
    v_pk_add_f32 v[68:69], v[68:69], v[132:133]
    v_pk_add_f32 v[70:71], v[70:71], v[134:135]
    s_waitcnt lgkmcnt(9)
    v_pk_add_f32 v[72:73], v[72:73], v[136:137]
    v_pk_add_f32 v[74:75], v[74:75], v[138:139]
    s_waitcnt lgkmcnt(8)
    v_pk_add_f32 v[76:77], v[76:77], v[140:141]
    v_pk_add_f32 v[78:79], v[78:79], v[142:143]
    s_waitcnt lgkmcnt(7)
    v_pk_add_f32 v[64:65], v[64:65], v[144:145]
    v_pk_add_f32 v[66:67], v[66:67], v[146:147]
    s_waitcnt lgkmcnt(6)
    v_pk_add_f32 v[68:69], v[68:69], v[148:149]
    v_pk_add_f32 v[70:71], v[70:71], v[150:151]
    s_waitcnt lgkmcnt(5)
    v_pk_add_f32 v[72:73], v[72:73], v[152:153]
    v_pk_add_f32 v[74:75], v[74:75], v[154:155]
    s_waitcnt lgkmcnt(4)
    v_pk_add_f32 v[76:77], v[76:77], v[156:157]
    v_pk_add_f32 v[78:79], v[78:79], v[158:159]
    s_waitcnt lgkmcnt(3)
    v_pk_add_f32 v[64:65], v[64:65], v[160:161]
    v_pk_add_f32 v[66:67], v[66:67], v[162:163]
    s_waitcnt lgkmcnt(2)
    v_pk_add_f32 v[68:69], v[68:69], v[164:165]
    v_pk_add_f32 v[70:71], v[70:71], v[166:167]
    s_waitcnt lgkmcnt(1)
    v_pk_add_f32 v[72:73], v[72:73], v[168:169]
    v_pk_add_f32 v[74:75], v[74:75], v[170:171]
    s_waitcnt lgkmcnt(0)
    v_pk_add_f32 v[76:77], v[76:77], v[172:173]
    v_pk_add_f32 v[78:79], v[78:79], v[174:175]
    s_waitcnt lgkmcnt(0)
    s_barrier
    s_add_u32 s42, s53, 163840
    v_cvt_pk_bf16_f32 v192, v64, v65
    v_cvt_pk_bf16_f32 v193, v66, v67
    v_cvt_pk_bf16_f32 v194, v68, v69
    v_cvt_pk_bf16_f32 v195, v70, v71
    buffer_store_dwordx4 v[192:195], v238, s[24:27], s42 offen sc1
    v_cvt_pk_bf16_f32 v196, v72, v73
    v_cvt_pk_bf16_f32 v197, v74, v75
    v_cvt_pk_bf16_f32 v198, v76, v77
    v_cvt_pk_bf16_f32 v199, v78, v79
    buffer_store_dwordx4 v[196:199], v238, s[24:27], s42 offen offset:512 sc1
    s_add_u32 s53, s53, 589824
    s_add_u32 s4, s4, 1
    s_cmp_lt_u32 s4, 2
    s_cbranch_scc1 W1_ITEM
    s_branch K1_END
WAVE2:
W2_ITEM:
    v_mov_b32 v239, 0
    v_mov_b32 v240, 0
    v_mov_b32 v241, 0
    s_waitcnt vmcnt(29)
    v_mfma_f32_32x32x16_bf16 v[48:63], a[192:195], v[32:35], 0
    s_waitcnt vmcnt(28)
    v_mfma_f32_32x32x16_bf16 v[48:63], a[196:199], v[36:39], v[48:63]
    s_waitcnt vmcnt(27)
    v_mfma_f32_32x32x16_bf16 v[48:63], a[200:203], v[40:43], v[48:63]
    s_waitcnt vmcnt(26)
    v_mfma_f32_32x32x16_bf16 v[48:63], a[204:207], v[44:47], v[48:63]
    v_mfma_f32_32x32x16_bf16 v[48:63], a[208:211], v[16:19], v[48:63]
    s_add_u32 m0, s38, s82
    v_mfma_f32_32x32x16_bf16 v[48:63], a[212:215], v[20:23], v[48:63]
    buffer_load_dwordx4 v232, s[16:19], s36 offen nt lds
    v_mfma_f32_32x32x16_bf16 v[48:63], a[216:219], v[24:27], v[48:63]
    v_mfma_f32_32x32x16_bf16 v[48:63], a[220:223], v[28:31], v[48:63]
    s_nop 11
    v_max3_f32 v2, v48, v49, v50
    v_max3_f32 v2, v2, v51, v52
    v_max3_f32 v2, v2, v53, v54
    v_max3_f32 v2, v2, v55, v56
    v_max3_f32 v2, v2, v57, v58
    v_max3_f32 v2, v2, v59, v60
    v_max3_f32 v2, v2, v61, v62
    v_max_f32 v2, v2, v63
    v_mov_b32 v3, v2
    s_nop 1
    v_permlane32_swap_b32 v2, v3
    v_max_f32 v2, v2, v3
    v_sub_f32 v64, 0, v2
    v_sub_f32 v65, 0, v2
    v_sub_f32 v66, 0, v2
    v_sub_f32 v67, 0, v2
    v_sub_f32 v68, 0, v2
    v_sub_f32 v69, 0, v2
    v_sub_f32 v70, 0, v2
    v_sub_f32 v71, 0, v2
    v_sub_f32 v72, 0, v2
    v_sub_f32 v73, 0, v2
    v_sub_f32 v74, 0, v2
    v_sub_f32 v75, 0, v2
    v_sub_f32 v76, 0, v2
    v_sub_f32 v77, 0, v2
    v_sub_f32 v78, 0, v2
    v_sub_f32 v79, 0, v2
    v_sub_f32 v48, v48, v2
    v_sub_f32 v49, v49, v2
    v_sub_f32 v50, v50, v2
    v_sub_f32 v51, v51, v2
    v_sub_f32 v52, v52, v2
    v_sub_f32 v53, v53, v2
    v_sub_f32 v54, v54, v2
    v_sub_f32 v55, v55, v2
    v_sub_f32 v56, v56, v2
    v_sub_f32 v57, v57, v2
    v_sub_f32 v58, v58, v2
    v_sub_f32 v59, v59, v2
    v_sub_f32 v60, v60, v2
    v_sub_f32 v61, v61, v2
    v_sub_f32 v62, v62, v2
    v_sub_f32 v63, v63, v2
    buffer_load_dwordx4 v233, s[16:19], s36 offen offset:1024 nt lds
    v_exp_f32 v196, v48
    v_exp_f32 v197, v49
    v_exp_f32 v198, v50
    v_add_f32 v242, v196, v197
    v_cvt_pk_bf16_f32 v160, v196, v197
    s_waitcnt vmcnt(23)
    v_mfma_f32_32x32x16_bf16 v[112:127], a[192:195], v[96:99], 0
    v_exp_f32 v199, v51
    v_add_f32 v242, v242, v198
    s_waitcnt vmcnt(22)
    v_mfma_f32_32x32x16_bf16 v[112:127], a[196:199], v[100:103], v[112:127]
    ds_read_b128 a[192:195], v220 offset:8192
    v_exp_f32 v196, v52
    v_add_f32 v242, v242, v199
    v_cvt_pk_bf16_f32 v161, v198, v199
    s_waitcnt vmcnt(21)
    v_mfma_f32_32x32x16_bf16 v[112:127], a[200:203], v[104:107], v[112:127]
    ds_read_b128 a[196:199], v221 offset:8192
    v_exp_f32 v197, v53
    v_add_f32 v242, v242, v196
    s_waitcnt vmcnt(20)
    v_mfma_f32_32x32x16_bf16 v[112:127], a[204:207], v[108:111], v[112:127]
    ds_read_b128 a[200:203], v222 offset:8192
    buffer_load_dwordx4 v234, s[16:19], s36 offen offset:2048 nt lds
    v_exp_f32 v198, v54
    v_add_f32 v242, v242, v197
    v_cvt_pk_bf16_f32 v162, v196, v197
    v_mfma_f32_32x32x16_bf16 v[112:127], a[208:211], v[80:83], v[112:127]
    ds_read_b128 a[204:207], v223 offset:8192
    v_exp_f32 v199, v55
    v_add_f32 v242, v242, v198
    v_mfma_f32_32x32x16_bf16 v[112:127], a[212:215], v[84:87], v[112:127]
    ds_read_b128 a[208:211], v224 offset:8192
    v_exp_f32 v196, v56
    v_add_f32 v242, v242, v199
    v_cvt_pk_bf16_f32 v163, v198, v199
    v_mfma_f32_32x32x16_bf16 v[112:127], a[216:219], v[88:91], v[112:127]
    ds_read_b128 a[212:215], v225 offset:8192
    v_exp_f32 v197, v57
    v_add_f32 v242, v242, v196
    v_mfma_f32_32x32x16_bf16 v[112:127], a[220:223], v[92:95], v[112:127]
    ds_read_b128 a[216:219], v226 offset:8192
    v_exp_f32 v198, v58
    v_add_f32 v242, v242, v197
    v_cvt_pk_bf16_f32 v164, v196, v197
    ds_read_b128 a[220:223], v227 offset:8192
    v_exp_f32 v199, v59
    v_add_f32 v242, v242, v198
    ds_read_b64_tr_b16 a[224:225], v228 offset:24576
    ds_read_b64_tr_b16 a[226:227], v228 offset:26624
    v_exp_f32 v196, v60
    v_add_f32 v242, v242, v199
    v_cvt_pk_bf16_f32 v165, v198, v199
    ds_read_b64_tr_b16 a[228:229], v229 offset:24576
    ds_read_b64_tr_b16 a[230:231], v229 offset:26624
    buffer_load_dwordx4 v235, s[16:19], s36 offen offset:3072 nt lds
    v_exp_f32 v197, v61
    v_add_f32 v242, v242, v196
    ds_read_b64_tr_b16 a[232:233], v230 offset:24576
    ds_read_b64_tr_b16 a[234:235], v230 offset:26624
    v_exp_f32 v198, v62
    v_add_f32 v242, v242, v197
    v_cvt_pk_bf16_f32 v166, v196, v197
    ds_read_b64_tr_b16 a[236:237], v231 offset:24576
    ds_read_b64_tr_b16 a[238:239], v231 offset:26624
    s_add_u32 s36, s36, 16384
    v_exp_f32 v199, v63
    v_add_f32 v242, v242, v198
    v_max3_f32 v2, v112, v113, v114
    v_max3_f32 v2, v2, v115, v116
    v_max3_f32 v2, v2, v117, v118
    v_max3_f32 v2, v2, v119, v120
    v_max3_f32 v2, v2, v121, v122
    v_max3_f32 v2, v2, v123, v124
    v_max3_f32 v2, v2, v125, v126
    v_max_f32 v2, v2, v127
    v_mov_b32 v3, v2
    s_nop 1
    v_permlane32_swap_b32 v2, v3
    v_max_f32 v2, v2, v3
    v_sub_f32 v128, 0, v2
    v_sub_f32 v129, 0, v2
    v_sub_f32 v130, 0, v2
    v_sub_f32 v131, 0, v2
    v_sub_f32 v132, 0, v2
    v_sub_f32 v133, 0, v2
    v_sub_f32 v134, 0, v2
    v_sub_f32 v135, 0, v2
    v_sub_f32 v136, 0, v2
    v_sub_f32 v137, 0, v2
    v_sub_f32 v138, 0, v2
    v_sub_f32 v139, 0, v2
    v_sub_f32 v140, 0, v2
    v_sub_f32 v141, 0, v2
    v_sub_f32 v142, 0, v2
    v_sub_f32 v143, 0, v2
    v_sub_f32 v112, v112, v2
    v_sub_f32 v113, v113, v2
    v_sub_f32 v114, v114, v2
    v_sub_f32 v115, v115, v2
    v_sub_f32 v116, v116, v2
    v_sub_f32 v117, v117, v2
    v_sub_f32 v118, v118, v2
    v_sub_f32 v119, v119, v2
    v_sub_f32 v120, v120, v2
    v_sub_f32 v121, v121, v2
    v_sub_f32 v122, v122, v2
    v_sub_f32 v123, v123, v2
    v_sub_f32 v124, v124, v2
    v_sub_f32 v125, v125, v2
    v_sub_f32 v126, v126, v2
    v_sub_f32 v127, v127, v2
    ds_read_b64_tr_b16 a[240:241], v228 offset:28672
    ds_read_b64_tr_b16 a[242:243], v228 offset:30720
    v_add_f32 v242, v242, v199
    v_cvt_pk_bf16_f32 v167, v198, v199
    v_cmp_lt_f32 vcc, s35, v242
    v_exp_f32 v196, v112
    ds_read_b64_tr_b16 a[244:245], v229 offset:28672
    ds_read_b64_tr_b16 a[246:247], v229 offset:30720
    v_exp_f32 v197, v113
    ds_read_b64_tr_b16 a[248:249], v230 offset:28672
    ds_read_b64_tr_b16 a[250:251], v230 offset:30720
    s_cbranch_vccnz FX37
FX37_RET:
    v_add_f32 v239, v239, v242
    v_exp_f32 v198, v114
    v_add_f32 v243, v196, v197
    v_cvt_pk_bf16_f32 v168, v196, v197
    s_waitcnt lgkmcnt(14)
    v_mfma_f32_32x32x16_bf16 v[48:63], a[192:195], v[32:35], v[64:79]
    ds_read_b64_tr_b16 a[252:253], v231 offset:28672
    ds_read_b64_tr_b16 a[254:255], v231 offset:30720
    v_exp_f32 v199, v115
    v_add_f32 v243, v243, v198
    v_mfma_f32_32x32x16_bf16 v[48:63], a[196:199], v[36:39], v[48:63]
    s_add_u32 m0, s38, s86
    v_exp_f32 v196, v116
    v_add_f32 v243, v243, v199
    v_cvt_pk_bf16_f32 v169, v198, v199
    v_mfma_f32_32x32x16_bf16 v[48:63], a[200:203], v[40:43], v[48:63]
    v_exp_f32 v197, v117
    v_add_f32 v243, v243, v196
    v_mfma_f32_32x32x16_bf16 v[48:63], a[204:207], v[44:47], v[48:63]
    buffer_load_dwordx4 v236, s[20:23], s37 offen nt lds
    v_exp_f32 v198, v118
    v_add_f32 v243, v243, v197
    v_cvt_pk_bf16_f32 v170, v196, v197
    v_mfma_f32_32x32x16_bf16 v[48:63], a[208:211], v[16:19], v[48:63]
    v_exp_f32 v199, v119
    v_add_f32 v243, v243, v198
    v_mfma_f32_32x32x16_bf16 v[48:63], a[212:215], v[20:23], v[48:63]
    v_exp_f32 v196, v120
    v_add_f32 v243, v243, v199
    v_cvt_pk_bf16_f32 v171, v198, v199
    v_mfma_f32_32x32x16_bf16 v[48:63], a[216:219], v[24:27], v[48:63]
    buffer_load_dwordx4 v236, s[20:23], s37 offen offset:1024 nt lds
    v_exp_f32 v197, v121
    v_add_f32 v243, v243, v196
    v_mfma_f32_32x32x16_bf16 v[48:63], a[220:223], v[28:31], v[48:63]
    v_exp_f32 v198, v122
    v_add_f32 v243, v243, v197
    v_cvt_pk_bf16_f32 v172, v196, v197
    s_waitcnt lgkmcnt(0)
    v_mfma_f32_32x32x16_bf16 a[0:15], a[224:227], v[160:163], 0
    v_exp_f32 v199, v123
    v_add_f32 v243, v243, v198
    v_mfma_f32_32x32x16_bf16 a[16:31], a[228:231], v[160:163], 0
    buffer_load_dwordx4 v236, s[20:23], s37 offen offset:2048 nt lds
    v_exp_f32 v196, v124
    v_add_f32 v243, v243, v199
    v_cvt_pk_bf16_f32 v173, v198, v199
    v_mfma_f32_32x32x16_bf16 a[32:47], a[232:235], v[160:163], 0
    v_exp_f32 v197, v125
    v_add_f32 v243, v243, v196
    v_mfma_f32_32x32x16_bf16 a[48:63], a[236:239], v[160:163], 0
    v_exp_f32 v198, v126
    v_add_f32 v243, v243, v197
    v_cvt_pk_bf16_f32 v174, v196, v197
    v_mfma_f32_32x32x16_bf16 a[0:15], a[240:243], v[164:167], a[0:15]
    buffer_load_dwordx4 v236, s[20:23], s37 offen offset:3072 nt lds
    v_exp_f32 v199, v127
    v_add_f32 v243, v243, v198
    v_mfma_f32_32x32x16_bf16 a[16:31], a[244:247], v[164:167], a[16:31]
    v_add_f32 v243, v243, v199
    v_cvt_pk_bf16_f32 v175, v198, v199
    v_cmp_lt_f32 vcc, s35, v243
    v_exp_f32 v196, v48
    v_mfma_f32_32x32x16_bf16 a[32:47], a[248:251], v[164:167], a[32:47]
    s_add_u32 s37, s37, 16384
    v_exp_f32 v197, v49
    v_mfma_f32_32x32x16_bf16 a[48:63], a[252:255], v[164:167], a[48:63]
    s_add_u32 s38, s38, 32768
    s_and_b32 s38, s38, 131071
    s_cbranch_vccnz FX38
FX38_RET:
    v_add_f32 v240, v240, v243
    v_exp_f32 v198, v50
    v_add_f32 v242, v196, v197
    v_cvt_pk_bf16_f32 v160, v196, v197
    v_mfma_f32_32x32x16_bf16 v[112:127], a[192:195], v[96:99], v[128:143]
    v_exp_f32 v199, v51
    v_add_f32 v242, v242, v198
    v_mfma_f32_32x32x16_bf16 v[112:127], a[196:199], v[100:103], v[112:127]
    v_exp_f32 v196, v52
    v_add_f32 v242, v242, v199
    v_cvt_pk_bf16_f32 v161, v198, v199
    s_waitcnt vmcnt(16)
    s_barrier
    ds_read_b128 a[192:195], v220 offset:32768
    v_mfma_f32_32x32x16_bf16 v[112:127], a[200:203], v[104:107], v[112:127]
    ds_read_b128 a[196:199], v221 offset:32768
    v_exp_f32 v197, v53
    v_add_f32 v242, v242, v196
    v_mfma_f32_32x32x16_bf16 v[112:127], a[204:207], v[108:111], v[112:127]
    ds_read_b128 a[200:203], v222 offset:32768
    v_exp_f32 v198, v54
    v_add_f32 v242, v242, v197
    v_cvt_pk_bf16_f32 v162, v196, v197
    v_mfma_f32_32x32x16_bf16 v[112:127], a[208:211], v[80:83], v[112:127]
    ds_read_b128 a[204:207], v223 offset:32768
    v_exp_f32 v199, v55
    v_add_f32 v242, v242, v198
    v_mfma_f32_32x32x16_bf16 v[112:127], a[212:215], v[84:87], v[112:127]
    ds_read_b128 a[208:211], v224 offset:32768
    v_exp_f32 v196, v56
    v_add_f32 v242, v242, v199
    v_cvt_pk_bf16_f32 v163, v198, v199
    v_mfma_f32_32x32x16_bf16 v[112:127], a[216:219], v[88:91], v[112:127]
    ds_read_b128 a[212:215], v225 offset:32768
    v_exp_f32 v197, v57
    v_add_f32 v242, v242, v196
    v_mfma_f32_32x32x16_bf16 v[112:127], a[220:223], v[92:95], v[112:127]
    ds_read_b128 a[216:219], v226 offset:32768
    v_exp_f32 v198, v58
    v_add_f32 v242, v242, v197
    v_cvt_pk_bf16_f32 v164, v196, v197
    v_mfma_f32_32x32x16_bf16 a[64:79], a[224:227], v[168:171], 0
    ds_read_b128 a[220:223], v227 offset:32768
    v_exp_f32 v199, v59
    v_add_f32 v242, v242, v198
    v_mfma_f32_32x32x16_bf16 a[80:95], a[228:231], v[168:171], 0
    ds_read_b64_tr_b16 a[224:225], v228 offset:49152
    ds_read_b64_tr_b16 a[226:227], v228 offset:51200
    v_exp_f32 v196, v60
    v_add_f32 v242, v242, v199
    v_cvt_pk_bf16_f32 v165, v198, v199
    v_mfma_f32_32x32x16_bf16 a[96:111], a[232:235], v[168:171], 0
    ds_read_b64_tr_b16 a[228:229], v229 offset:49152
    ds_read_b64_tr_b16 a[230:231], v229 offset:51200
    v_exp_f32 v197, v61
    v_add_f32 v242, v242, v196
    v_mfma_f32_32x32x16_bf16 a[112:127], a[236:239], v[168:171], 0
    ds_read_b64_tr_b16 a[232:233], v230 offset:49152
    ds_read_b64_tr_b16 a[234:235], v230 offset:51200
    v_exp_f32 v198, v62
    v_add_f32 v242, v242, v197
    v_cvt_pk_bf16_f32 v166, v196, v197
    v_mfma_f32_32x32x16_bf16 a[64:79], a[240:243], v[172:175], a[64:79]
    ds_read_b64_tr_b16 a[236:237], v231 offset:49152
    ds_read_b64_tr_b16 a[238:239], v231 offset:51200
    v_exp_f32 v199, v63
    v_add_f32 v242, v242, v198
    v_mfma_f32_32x32x16_bf16 a[80:95], a[244:247], v[172:175], a[80:95]
    ds_read_b64_tr_b16 a[240:241], v228 offset:53248
    ds_read_b64_tr_b16 a[242:243], v228 offset:55296
    v_add_f32 v242, v242, v199
    v_cvt_pk_bf16_f32 v167, v198, v199
    v_cmp_lt_f32 vcc, s35, v242
    v_exp_f32 v196, v112
    v_mfma_f32_32x32x16_bf16 a[96:111], a[248:251], v[172:175], a[96:111]
    ds_read_b64_tr_b16 a[244:245], v229 offset:53248
    ds_read_b64_tr_b16 a[246:247], v229 offset:55296
    v_exp_f32 v197, v113
    v_mfma_f32_32x32x16_bf16 a[112:127], a[252:255], v[172:175], a[112:127]
    ds_read_b64_tr_b16 a[248:249], v230 offset:53248
    ds_read_b64_tr_b16 a[250:251], v230 offset:55296
    s_cbranch_vccnz FX39
FX39_RET:
    v_add_f32 v239, v239, v242
    v_exp_f32 v198, v114
    v_add_f32 v243, v196, v197
    v_cvt_pk_bf16_f32 v168, v196, v197
    s_waitcnt lgkmcnt(14)
    v_mfma_f32_32x32x16_bf16 v[48:63], a[192:195], v[32:35], v[64:79]
    ds_read_b64_tr_b16 a[252:253], v231 offset:53248
    ds_read_b64_tr_b16 a[254:255], v231 offset:55296
    s_add_u32 s46, s54, 16384
    v_exp_f32 v199, v115
    v_add_f32 v243, v243, v198
    v_mfma_f32_32x32x16_bf16 v[48:63], a[196:199], v[36:39], v[48:63]
    v_exp_f32 v196, v116
    v_add_f32 v243, v243, v199
    v_cvt_pk_bf16_f32 v169, v198, v199
    v_mfma_f32_32x32x16_bf16 v[48:63], a[200:203], v[40:43], v[48:63]
    v_exp_f32 v197, v117
    v_add_f32 v243, v243, v196
    v_mfma_f32_32x32x16_bf16 v[48:63], a[204:207], v[44:47], v[48:63]
    v_exp_f32 v198, v118
    v_add_f32 v243, v243, v197
    v_cvt_pk_bf16_f32 v170, v196, v197
    v_mfma_f32_32x32x16_bf16 v[48:63], a[208:211], v[16:19], v[48:63]
    s_add_u32 m0, s38, s82
    v_exp_f32 v199, v119
    v_add_f32 v243, v243, v198
    v_mfma_f32_32x32x16_bf16 v[48:63], a[212:215], v[20:23], v[48:63]
    buffer_load_dwordx4 v232, s[16:19], s36 offen nt lds
    v_exp_f32 v196, v120
    v_add_f32 v243, v243, v199
    v_cvt_pk_bf16_f32 v171, v198, v199
    v_mfma_f32_32x32x16_bf16 v[48:63], a[216:219], v[24:27], v[48:63]
    v_exp_f32 v197, v121
    v_add_f32 v243, v243, v196
    v_mfma_f32_32x32x16_bf16 v[48:63], a[220:223], v[28:31], v[48:63]
    v_exp_f32 v198, v122
    v_add_f32 v243, v243, v197
    v_cvt_pk_bf16_f32 v172, v196, v197
    s_waitcnt lgkmcnt(0)
    v_mfma_f32_32x32x16_bf16 a[0:15], a[224:227], v[160:163], a[0:15]
    v_exp_f32 v199, v123
    v_add_f32 v243, v243, v198
    v_mfma_f32_32x32x16_bf16 a[16:31], a[228:231], v[160:163], a[16:31]
    ds_read_b128 v[184:187], v237
    v_exp_f32 v196, v124
    v_add_f32 v243, v243, v199
    v_cvt_pk_bf16_f32 v173, v198, v199
    v_mfma_f32_32x32x16_bf16 a[32:47], a[232:235], v[160:163], a[32:47]
    ds_read_b128 v[188:191], v237 offset:1024
    v_exp_f32 v197, v125
    v_add_f32 v243, v243, v196
    v_mfma_f32_32x32x16_bf16 a[48:63], a[236:239], v[160:163], a[48:63]
    ds_read_b128 v[192:195], v237 offset:2048
    v_exp_f32 v198, v126
    v_add_f32 v243, v243, v197
    v_cvt_pk_bf16_f32 v174, v196, v197
    v_mfma_f32_32x32x16_bf16 a[0:15], a[240:243], v[164:167], a[0:15]
    buffer_load_dwordx4 v233, s[16:19], s36 offen offset:1024 nt lds
    v_exp_f32 v199, v127
    v_add_f32 v243, v243, v198
    v_mfma_f32_32x32x16_bf16 a[16:31], a[244:247], v[164:167], a[16:31]
    buffer_load_dwordx4 v[246:249], v245, s[24:27], s46 offen
    v_add_f32 v243, v243, v199
    v_cvt_pk_bf16_f32 v175, v198, v199
    v_cmp_lt_f32 vcc, s35, v243
    v_exp_f32 v196, v48
    v_mfma_f32_32x32x16_bf16 a[32:47], a[248:251], v[164:167], a[32:47]
    v_exp_f32 v197, v49
    v_mfma_f32_32x32x16_bf16 a[48:63], a[252:255], v[164:167], a[48:63]
    s_cbranch_vccnz FX40
FX40_RET:
    v_add_f32 v240, v240, v243
    v_exp_f32 v198, v50
    v_add_f32 v242, v196, v197
    v_cvt_pk_bf16_f32 v160, v196, v197
    s_waitcnt lgkmcnt(2)
    v_mfma_f32_32x32x16_bf16 v[144:159], a[192:195], v[184:187], 0
    v_exp_f32 v199, v51
    v_add_f32 v242, v242, v198
    s_waitcnt lgkmcnt(1)
    v_mfma_f32_32x32x16_bf16 v[144:159], a[196:199], v[188:191], v[144:159]
    ds_read_b128 v[184:187], v237 offset:3072
    v_exp_f32 v196, v52
    v_add_f32 v242, v242, v199
    v_cvt_pk_bf16_f32 v161, v198, v199
    s_waitcnt lgkmcnt(1)
    v_mfma_f32_32x32x16_bf16 v[144:159], a[200:203], v[192:195], v[144:159]
    ds_read_b128 v[188:191], v237 offset:4096
    v_exp_f32 v197, v53
    v_add_f32 v242, v242, v196
    s_waitcnt lgkmcnt(1)
    v_mfma_f32_32x32x16_bf16 v[144:159], a[204:207], v[184:187], v[144:159]
    ds_read_b128 v[192:195], v237 offset:5120
    buffer_load_dwordx4 v234, s[16:19], s36 offen offset:2048 nt lds
    v_exp_f32 v198, v54
    v_add_f32 v242, v242, v197
    v_cvt_pk_bf16_f32 v162, v196, v197
    s_waitcnt lgkmcnt(1)
    v_mfma_f32_32x32x16_bf16 v[144:159], a[208:211], v[188:191], v[144:159]
    ds_read_b128 v[184:187], v237 offset:6144
    v_exp_f32 v199, v55
    v_add_f32 v242, v242, v198
    s_waitcnt lgkmcnt(1)
    v_mfma_f32_32x32x16_bf16 v[144:159], a[212:215], v[192:195], v[144:159]
    ds_read_b128 v[188:191], v237 offset:7168
    v_exp_f32 v196, v56
    v_add_f32 v242, v242, v199
    v_cvt_pk_bf16_f32 v163, v198, v199
    s_waitcnt lgkmcnt(1)
    v_mfma_f32_32x32x16_bf16 v[144:159], a[216:219], v[184:187], v[144:159]
    v_exp_f32 v197, v57
    v_add_f32 v242, v242, v196
    s_waitcnt lgkmcnt(0)
    v_mfma_f32_32x32x16_bf16 v[144:159], a[220:223], v[188:191], v[144:159]
    v_exp_f32 v198, v58
    v_add_f32 v242, v242, v197
    v_cvt_pk_bf16_f32 v164, v196, v197
    v_mfma_f32_32x32x16_bf16 v[112:127], a[192:195], v[96:99], v[128:143]
    v_exp_f32 v199, v59
    v_add_f32 v242, v242, v198
    v_mfma_f32_32x32x16_bf16 v[112:127], a[196:199], v[100:103], v[112:127]
    ds_read_b128 a[192:195], v220 offset:40960
    v_exp_f32 v196, v60
    v_add_f32 v242, v242, v199
    v_cvt_pk_bf16_f32 v165, v198, v199
    v_mfma_f32_32x32x16_bf16 v[112:127], a[200:203], v[104:107], v[112:127]
    ds_read_b128 a[196:199], v221 offset:40960
    buffer_load_dwordx4 v235, s[16:19], s36 offen offset:3072 nt lds
    buffer_load_dwordx4 v[250:253], v245, s[24:27], s46 offen offset:1024
    v_exp_f32 v197, v61
    v_add_f32 v242, v242, v196
    v_mfma_f32_32x32x16_bf16 v[112:127], a[204:207], v[108:111], v[112:127]
    ds_read_b128 a[200:203], v222 offset:40960
    v_exp_f32 v198, v62
    v_add_f32 v242, v242, v197
    v_cvt_pk_bf16_f32 v166, v196, v197
    v_mfma_f32_32x32x16_bf16 v[112:127], a[208:211], v[80:83], v[112:127]
    v_exp_f32 v199, v63
    v_add_f32 v242, v242, v198
    s_nop 7
    v_max3_f32 v2, v144, v145, v146
    v_max3_f32 v2, v2, v147, v148
    v_max3_f32 v2, v2, v149, v150
    v_max3_f32 v2, v2, v151, v152
    v_max3_f32 v2, v2, v153, v154
    v_max3_f32 v2, v2, v155, v156
    v_max3_f32 v2, v2, v157, v158
    v_max_f32 v2, v2, v159
    v_mov_b32 v3, v2
    s_nop 1
    v_permlane32_swap_b32 v2, v3
    v_max_f32 v2, v2, v3
    v_sub_f32 v204, 0, v2
    v_sub_f32 v205, 0, v2
    v_sub_f32 v206, 0, v2
    v_sub_f32 v207, 0, v2
    v_sub_f32 v208, 0, v2
    v_sub_f32 v209, 0, v2
    v_sub_f32 v210, 0, v2
    v_sub_f32 v211, 0, v2
    v_sub_f32 v212, 0, v2
    v_sub_f32 v213, 0, v2
    v_sub_f32 v214, 0, v2
    v_sub_f32 v215, 0, v2
    v_sub_f32 v216, 0, v2
    v_sub_f32 v217, 0, v2
    v_sub_f32 v218, 0, v2
    v_sub_f32 v219, 0, v2
    v_sub_f32 v144, v144, v2
    v_sub_f32 v145, v145, v2
    v_sub_f32 v146, v146, v2
    v_sub_f32 v147, v147, v2
    v_sub_f32 v148, v148, v2
    v_sub_f32 v149, v149, v2
    v_sub_f32 v150, v150, v2
    v_sub_f32 v151, v151, v2
    v_sub_f32 v152, v152, v2
    v_sub_f32 v153, v153, v2
    v_sub_f32 v154, v154, v2
    v_sub_f32 v155, v155, v2
    v_sub_f32 v156, v156, v2
    v_sub_f32 v157, v157, v2
    v_sub_f32 v158, v158, v2
    v_sub_f32 v159, v159, v2
    ds_read_b128 a[204:207], v223 offset:40960
    s_add_u32 s36, s36, 16384
    v_mfma_f32_32x32x16_bf16 v[112:127], a[212:215], v[84:87], v[112:127]
    ds_read_b128 a[208:211], v224 offset:40960
    v_add_f32 v242, v242, v199
    v_cvt_pk_bf16_f32 v167, v198, v199
    v_cmp_lt_f32 vcc, s35, v242
    v_exp_f32 v196, v144
    v_mfma_f32_32x32x16_bf16 v[112:127], a[216:219], v[88:91], v[112:127]
    ds_read_b128 a[212:215], v225 offset:40960
    v_exp_f32 v197, v145
    v_mfma_f32_32x32x16_bf16 v[112:127], a[220:223], v[92:95], v[112:127]
    ds_read_b128 a[216:219], v226 offset:40960
    s_cbranch_vccnz FX41
FX41_RET:
    v_add_f32 v239, v239, v242
    v_exp_f32 v198, v146
    v_add_f32 v244, v196, v197
    v_cvt_pk_bf16_f32 v176, v196, v197
    v_mfma_f32_32x32x16_bf16 a[64:79], a[224:227], v[168:171], a[64:79]
    ds_read_b128 a[220:223], v227 offset:40960
    v_exp_f32 v199, v147
    v_add_f32 v244, v244, v198
    v_mfma_f32_32x32x16_bf16 a[80:95], a[228:231], v[168:171], a[80:95]
    ds_read_b64_tr_b16 a[224:225], v228 offset:57344
    ds_read_b64_tr_b16 a[226:227], v228 offset:59392
    v_exp_f32 v196, v148
    v_add_f32 v244, v244, v199
    v_cvt_pk_bf16_f32 v177, v198, v199
    v_mfma_f32_32x32x16_bf16 a[96:111], a[232:235], v[168:171], a[96:111]
    ds_read_b64_tr_b16 a[228:229], v229 offset:57344
    ds_read_b64_tr_b16 a[230:231], v229 offset:59392
    v_exp_f32 v197, v149
    v_add_f32 v244, v244, v196
    v_mfma_f32_32x32x16_bf16 a[112:127], a[236:239], v[168:171], a[112:127]
    ds_read_b64_tr_b16 a[232:233], v230 offset:57344
    ds_read_b64_tr_b16 a[234:235], v230 offset:59392
    v_exp_f32 v198, v150
    v_add_f32 v244, v244, v197
    v_cvt_pk_bf16_f32 v178, v196, v197
    v_mfma_f32_32x32x16_bf16 a[64:79], a[240:243], v[172:175], a[64:79]
    ds_read_b64_tr_b16 a[236:237], v231 offset:57344
    ds_read_b64_tr_b16 a[238:239], v231 offset:59392
    v_exp_f32 v199, v151
    v_add_f32 v244, v244, v198
    v_mfma_f32_32x32x16_bf16 a[80:95], a[244:247], v[172:175], a[80:95]
    ds_read_b64_tr_b16 a[240:241], v228 offset:61440
    ds_read_b64_tr_b16 a[242:243], v228 offset:63488
    v_add_f32 v244, v244, v199
    v_cvt_pk_bf16_f32 v179, v198, v199
    v_exp_f32 v196, v112
    v_mfma_f32_32x32x16_bf16 a[96:111], a[248:251], v[172:175], a[96:111]
    ds_read_b64_tr_b16 a[244:245], v229 offset:61440
    ds_read_b64_tr_b16 a[246:247], v229 offset:63488
    v_exp_f32 v197, v113
    v_mfma_f32_32x32x16_bf16 a[112:127], a[252:255], v[172:175], a[112:127]
    ds_read_b64_tr_b16 a[248:249], v230 offset:61440
    ds_read_b64_tr_b16 a[250:251], v230 offset:63488
    v_exp_f32 v198, v114
    v_add_f32 v243, v196, v197
    v_cvt_pk_bf16_f32 v168, v196, v197
    s_waitcnt lgkmcnt(14)
    v_mfma_f32_32x32x16_bf16 v[48:63], a[192:195], v[32:35], v[64:79]
    ds_read_b64_tr_b16 a[252:253], v231 offset:61440
    ds_read_b64_tr_b16 a[254:255], v231 offset:63488
    v_exp_f32 v199, v115
    v_add_f32 v243, v243, v198
    v_mfma_f32_32x32x16_bf16 v[48:63], a[196:199], v[36:39], v[48:63]
    s_add_u32 m0, s38, s86
    v_exp_f32 v196, v116
    v_add_f32 v243, v243, v199
    v_cvt_pk_bf16_f32 v169, v198, v199
    v_mfma_f32_32x32x16_bf16 v[48:63], a[200:203], v[40:43], v[48:63]
    v_exp_f32 v197, v117
    v_add_f32 v243, v243, v196
    v_xor_b32 v220, 65536, v220
    v_mfma_f32_32x32x16_bf16 v[48:63], a[204:207], v[44:47], v[48:63]
    buffer_load_dwordx4 v236, s[20:23], s37 offen nt lds
    v_exp_f32 v198, v118
    v_add_f32 v243, v243, v197
    v_cvt_pk_bf16_f32 v170, v196, v197
    v_xor_b32 v221, 65536, v221
    v_mfma_f32_32x32x16_bf16 v[48:63], a[208:211], v[16:19], v[48:63]
    v_exp_f32 v199, v119
    v_add_f32 v243, v243, v198
    v_xor_b32 v222, 65536, v222
    v_mfma_f32_32x32x16_bf16 v[48:63], a[212:215], v[20:23], v[48:63]
    v_exp_f32 v196, v120
    v_add_f32 v243, v243, v199
    v_cvt_pk_bf16_f32 v171, v198, v199
    v_xor_b32 v223, 65536, v223
    v_mfma_f32_32x32x16_bf16 v[48:63], a[216:219], v[24:27], v[48:63]
    buffer_load_dwordx4 v236, s[20:23], s37 offen offset:1024 nt lds
    v_exp_f32 v197, v121
    v_add_f32 v243, v243, v196
    v_xor_b32 v224, 65536, v224
    v_mfma_f32_32x32x16_bf16 v[48:63], a[220:223], v[28:31], v[48:63]
    v_exp_f32 v198, v122
    v_add_f32 v243, v243, v197
    v_cvt_pk_bf16_f32 v172, v196, v197
    v_xor_b32 v225, 65536, v225
    s_waitcnt lgkmcnt(0)
    v_mfma_f32_32x32x16_bf16 a[0:15], a[224:227], v[160:163], a[0:15]
    v_exp_f32 v199, v123
    v_add_f32 v243, v243, v198
    v_xor_b32 v226, 65536, v226
    v_mfma_f32_32x32x16_bf16 a[16:31], a[228:231], v[160:163], a[16:31]
    buffer_load_dwordx4 v236, s[20:23], s37 offen offset:2048 nt lds
    v_exp_f32 v196, v124
    v_add_f32 v243, v243, v199
    v_cvt_pk_bf16_f32 v173, v198, v199
    v_xor_b32 v227, 65536, v227
    v_mfma_f32_32x32x16_bf16 a[32:47], a[232:235], v[160:163], a[32:47]
    v_exp_f32 v197, v125
    v_add_f32 v243, v243, v196
    v_xor_b32 v228, 65536, v228
    v_mfma_f32_32x32x16_bf16 a[48:63], a[236:239], v[160:163], a[48:63]
    v_exp_f32 v198, v126
    v_add_f32 v243, v243, v197
    v_cvt_pk_bf16_f32 v174, v196, v197
    v_xor_b32 v229, 65536, v229
    v_mfma_f32_32x32x16_bf16 a[0:15], a[240:243], v[164:167], a[0:15]
    buffer_load_dwordx4 v236, s[20:23], s37 offen offset:3072 nt lds
    v_exp_f32 v199, v127
    v_add_f32 v243, v243, v198
    v_xor_b32 v230, 65536, v230
    v_mfma_f32_32x32x16_bf16 a[16:31], a[244:247], v[164:167], a[16:31]
    v_add_f32 v243, v243, v199
    v_cvt_pk_bf16_f32 v175, v198, v199
    v_cmp_lt_f32 vcc, s35, v243
    v_exp_f32 v196, v152
    v_xor_b32 v231, 65536, v231
    v_mfma_f32_32x32x16_bf16 a[32:47], a[248:251], v[164:167], a[32:47]
    s_add_u32 s37, s37, 16384
    v_exp_f32 v197, v153
    v_add_f32 v244, v244, v196
    v_mfma_f32_32x32x16_bf16 a[48:63], a[252:255], v[164:167], a[48:63]
    s_add_u32 s38, s38, 32768
    s_and_b32 s38, s38, 131071
    s_cbranch_vccnz FX42
FX42_RET:
    v_add_f32 v240, v240, v243
    v_exp_f32 v198, v154
    v_add_f32 v244, v244, v197
    v_cvt_pk_bf16_f32 v180, v196, v197
    v_mfma_f32_32x32x16_bf16 v[112:127], a[192:195], v[96:99], v[128:143]
    v_exp_f32 v199, v155
    v_add_f32 v244, v244, v198
    v_mfma_f32_32x32x16_bf16 v[112:127], a[196:199], v[100:103], v[112:127]
    v_exp_f32 v196, v156
    v_add_f32 v244, v244, v199
    v_cvt_pk_bf16_f32 v181, v198, v199
    s_waitcnt vmcnt(16)
    s_barrier
    ds_read_b128 a[192:195], v220
    v_mfma_f32_32x32x16_bf16 v[112:127], a[200:203], v[104:107], v[112:127]
    ds_read_b128 a[196:199], v221
    v_exp_f32 v197, v157
    v_add_f32 v244, v244, v196
    v_mfma_f32_32x32x16_bf16 v[112:127], a[204:207], v[108:111], v[112:127]
    ds_read_b128 a[200:203], v222
    v_exp_f32 v198, v158
    v_add_f32 v244, v244, v197
    v_cvt_pk_bf16_f32 v182, v196, v197
    v_mfma_f32_32x32x16_bf16 v[112:127], a[208:211], v[80:83], v[112:127]
    ds_read_b128 a[204:207], v223
    v_exp_f32 v199, v159
    v_add_f32 v244, v244, v198
    v_mfma_f32_32x32x16_bf16 v[112:127], a[212:215], v[84:87], v[112:127]
    ds_read_b128 a[208:211], v224
    v_add_f32 v244, v244, v199
    v_cvt_pk_bf16_f32 v183, v198, v199
    v_cmp_lt_f32 vcc, s35, v244
    v_exp_f32 v196, v48
    v_mfma_f32_32x32x16_bf16 v[112:127], a[216:219], v[88:91], v[112:127]
    ds_read_b128 a[212:215], v225
    v_exp_f32 v197, v49
    v_mfma_f32_32x32x16_bf16 v[112:127], a[220:223], v[92:95], v[112:127]
    ds_read_b128 a[216:219], v226
    s_cbranch_vccnz FX43
FX43_RET:
    v_add_f32 v241, v241, v244
    v_exp_f32 v198, v50
    v_add_f32 v242, v196, v197
    v_cvt_pk_bf16_f32 v160, v196, v197
    v_mfma_f32_32x32x16_bf16 a[128:143], a[224:227], v[176:179], 0
    ds_read_b128 a[220:223], v227
    v_exp_f32 v199, v51
    v_add_f32 v242, v242, v198
    v_mfma_f32_32x32x16_bf16 a[144:159], a[228:231], v[176:179], 0
    v_exp_f32 v196, v52
    v_add_f32 v242, v242, v199
    v_cvt_pk_bf16_f32 v161, v198, v199
    v_mfma_f32_32x32x16_bf16 a[160:175], a[232:235], v[176:179], 0
    v_exp_f32 v197, v53
    v_add_f32 v242, v242, v196
    v_mfma_f32_32x32x16_bf16 a[176:191], a[236:239], v[176:179], 0
    v_exp_f32 v198, v54
    v_add_f32 v242, v242, v197
    v_cvt_pk_bf16_f32 v162, v196, v197
    v_mfma_f32_32x32x16_bf16 a[128:143], a[240:243], v[180:183], a[128:143]
    v_exp_f32 v199, v55
    v_add_f32 v242, v242, v198
    v_mfma_f32_32x32x16_bf16 a[144:159], a[244:247], v[180:183], a[144:159]
    v_exp_f32 v196, v56
    v_add_f32 v242, v242, v199
    v_cvt_pk_bf16_f32 v163, v198, v199
    v_mfma_f32_32x32x16_bf16 a[160:175], a[248:251], v[180:183], a[160:175]
    v_exp_f32 v197, v57
    v_add_f32 v242, v242, v196
    v_mfma_f32_32x32x16_bf16 a[176:191], a[252:255], v[180:183], a[176:191]
    v_exp_f32 v198, v58
    v_add_f32 v242, v242, v197
    v_cvt_pk_bf16_f32 v164, v196, v197
    v_mfma_f32_32x32x16_bf16 a[64:79], a[224:227], v[168:171], a[64:79]
    v_exp_f32 v199, v59
    v_add_f32 v242, v242, v198
    v_mfma_f32_32x32x16_bf16 a[80:95], a[228:231], v[168:171], a[80:95]
    ds_read_b64_tr_b16 a[224:225], v228 offset:16384
    ds_read_b64_tr_b16 a[226:227], v228 offset:18432
    v_exp_f32 v196, v60
    v_add_f32 v242, v242, v199
    v_cvt_pk_bf16_f32 v165, v198, v199
    v_mfma_f32_32x32x16_bf16 a[96:111], a[232:235], v[168:171], a[96:111]
    ds_read_b64_tr_b16 a[228:229], v229 offset:16384
    ds_read_b64_tr_b16 a[230:231], v229 offset:18432
    v_exp_f32 v197, v61
    v_add_f32 v242, v242, v196
    v_mfma_f32_32x32x16_bf16 a[112:127], a[236:239], v[168:171], a[112:127]
    ds_read_b64_tr_b16 a[232:233], v230 offset:16384
    ds_read_b64_tr_b16 a[234:235], v230 offset:18432
    v_exp_f32 v198, v62
    v_add_f32 v242, v242, v197
    v_cvt_pk_bf16_f32 v166, v196, v197
    v_mfma_f32_32x32x16_bf16 a[64:79], a[240:243], v[172:175], a[64:79]
    ds_read_b64_tr_b16 a[236:237], v231 offset:16384
    ds_read_b64_tr_b16 a[238:239], v231 offset:18432
    v_exp_f32 v199, v63
    v_add_f32 v242, v242, v198
    v_mfma_f32_32x32x16_bf16 a[80:95], a[244:247], v[172:175], a[80:95]
    ds_read_b64_tr_b16 a[240:241], v228 offset:20480
    ds_read_b64_tr_b16 a[242:243], v228 offset:22528
    v_add_f32 v242, v242, v199
    v_cvt_pk_bf16_f32 v167, v198, v199
    v_cmp_lt_f32 vcc, s35, v242
    v_exp_f32 v196, v112
    v_mfma_f32_32x32x16_bf16 a[96:111], a[248:251], v[172:175], a[96:111]
    ds_read_b64_tr_b16 a[244:245], v229 offset:20480
    ds_read_b64_tr_b16 a[246:247], v229 offset:22528
    v_exp_f32 v197, v113
    v_mfma_f32_32x32x16_bf16 a[112:127], a[252:255], v[172:175], a[112:127]
    ds_read_b64_tr_b16 a[248:249], v230 offset:20480
    ds_read_b64_tr_b16 a[250:251], v230 offset:22528
    s_cbranch_vccnz FX44
FX44_RET:
    v_add_f32 v239, v239, v242
    v_exp_f32 v198, v114
    v_add_f32 v243, v196, v197
    v_cvt_pk_bf16_f32 v168, v196, v197
    s_mov_b32 s39, 7
W2_AL:
    s_waitcnt lgkmcnt(14)
    v_mfma_f32_32x32x16_bf16 v[48:63], a[192:195], v[32:35], v[64:79]
    ds_read_b64_tr_b16 a[252:253], v231 offset:20480
    ds_read_b64_tr_b16 a[254:255], v231 offset:22528
    v_exp_f32 v199, v115
    v_add_f32 v243, v243, v198
    v_mfma_f32_32x32x16_bf16 v[48:63], a[196:199], v[36:39], v[48:63]
    v_exp_f32 v196, v116
    v_add_f32 v243, v243, v199
    v_cvt_pk_bf16_f32 v169, v198, v199
    v_mfma_f32_32x32x16_bf16 v[48:63], a[200:203], v[40:43], v[48:63]
    v_exp_f32 v197, v117
    v_add_f32 v243, v243, v196
    v_mfma_f32_32x32x16_bf16 v[48:63], a[204:207], v[44:47], v[48:63]
    v_exp_f32 v198, v118
    v_add_f32 v243, v243, v197
    v_cvt_pk_bf16_f32 v170, v196, v197
    v_mfma_f32_32x32x16_bf16 v[48:63], a[208:211], v[16:19], v[48:63]
    s_add_u32 m0, s38, s82
    v_exp_f32 v199, v119
    v_add_f32 v243, v243, v198
    v_mfma_f32_32x32x16_bf16 v[48:63], a[212:215], v[20:23], v[48:63]
    buffer_load_dwordx4 v232, s[16:19], s36 offen nt lds
    v_exp_f32 v196, v120
    v_add_f32 v243, v243, v199
    v_cvt_pk_bf16_f32 v171, v198, v199
    v_mfma_f32_32x32x16_bf16 v[48:63], a[216:219], v[24:27], v[48:63]
    v_exp_f32 v197, v121
    v_add_f32 v243, v243, v196
    v_mfma_f32_32x32x16_bf16 v[48:63], a[220:223], v[28:31], v[48:63]
    v_exp_f32 v198, v122
    v_add_f32 v243, v243, v197
    v_cvt_pk_bf16_f32 v172, v196, v197
    s_waitcnt lgkmcnt(0)
    v_mfma_f32_32x32x16_bf16 a[0:15], a[224:227], v[160:163], a[0:15]
    v_exp_f32 v199, v123
    v_add_f32 v243, v243, v198
    v_mfma_f32_32x32x16_bf16 a[16:31], a[228:231], v[160:163], a[16:31]
    v_exp_f32 v196, v124
    v_add_f32 v243, v243, v199
    v_cvt_pk_bf16_f32 v173, v198, v199
    v_mfma_f32_32x32x16_bf16 a[32:47], a[232:235], v[160:163], a[32:47]
    v_exp_f32 v197, v125
    v_add_f32 v243, v243, v196
    v_mfma_f32_32x32x16_bf16 a[48:63], a[236:239], v[160:163], a[48:63]
    v_exp_f32 v198, v126
    v_add_f32 v243, v243, v197
    v_cvt_pk_bf16_f32 v174, v196, v197
    v_mfma_f32_32x32x16_bf16 a[0:15], a[240:243], v[164:167], a[0:15]
    buffer_load_dwordx4 v233, s[16:19], s36 offen offset:1024 nt lds
    v_exp_f32 v199, v127
    v_add_f32 v243, v243, v198
    v_mfma_f32_32x32x16_bf16 a[16:31], a[244:247], v[164:167], a[16:31]
    v_add_f32 v243, v243, v199
    v_cvt_pk_bf16_f32 v175, v198, v199
    v_cmp_lt_f32 vcc, s35, v243
    v_exp_f32 v196, v48
    v_mfma_f32_32x32x16_bf16 a[32:47], a[248:251], v[164:167], a[32:47]
    v_exp_f32 v197, v49
    v_mfma_f32_32x32x16_bf16 a[48:63], a[252:255], v[164:167], a[48:63]
    s_cbranch_vccnz FX45
FX45_RET:
    v_add_f32 v240, v240, v243
    v_exp_f32 v198, v50
    v_add_f32 v242, v196, v197
    v_cvt_pk_bf16_f32 v160, v196, v197
    v_mfma_f32_32x32x16_bf16 v[112:127], a[192:195], v[96:99], v[128:143]
    v_exp_f32 v199, v51
    v_add_f32 v242, v242, v198
    v_mfma_f32_32x32x16_bf16 v[112:127], a[196:199], v[100:103], v[112:127]
    ds_read_b128 a[192:195], v220 offset:8192
    v_exp_f32 v196, v52
    v_add_f32 v242, v242, v199
    v_cvt_pk_bf16_f32 v161, v198, v199
    v_mfma_f32_32x32x16_bf16 v[112:127], a[200:203], v[104:107], v[112:127]
    ds_read_b128 a[196:199], v221 offset:8192
    v_exp_f32 v197, v53
    v_add_f32 v242, v242, v196
    v_mfma_f32_32x32x16_bf16 v[112:127], a[204:207], v[108:111], v[112:127]
    ds_read_b128 a[200:203], v222 offset:8192
    buffer_load_dwordx4 v234, s[16:19], s36 offen offset:2048 nt lds
    v_exp_f32 v198, v54
    v_add_f32 v242, v242, v197
    v_cvt_pk_bf16_f32 v162, v196, v197
    v_mfma_f32_32x32x16_bf16 v[112:127], a[208:211], v[80:83], v[112:127]
    ds_read_b128 a[204:207], v223 offset:8192
    v_exp_f32 v199, v55
    v_add_f32 v242, v242, v198
    v_mfma_f32_32x32x16_bf16 v[112:127], a[212:215], v[84:87], v[112:127]
    ds_read_b128 a[208:211], v224 offset:8192
    v_exp_f32 v196, v56
    v_add_f32 v242, v242, v199
    v_cvt_pk_bf16_f32 v163, v198, v199
    v_mfma_f32_32x32x16_bf16 v[112:127], a[216:219], v[88:91], v[112:127]
    ds_read_b128 a[212:215], v225 offset:8192
    v_exp_f32 v197, v57
    v_add_f32 v242, v242, v196
    v_mfma_f32_32x32x16_bf16 v[112:127], a[220:223], v[92:95], v[112:127]
    ds_read_b128 a[216:219], v226 offset:8192
    v_exp_f32 v198, v58
    v_add_f32 v242, v242, v197
    v_cvt_pk_bf16_f32 v164, v196, v197
    v_mfma_f32_32x32x16_bf16 a[64:79], a[224:227], v[168:171], a[64:79]
    ds_read_b128 a[220:223], v227 offset:8192
    v_exp_f32 v199, v59
    v_add_f32 v242, v242, v198
    v_mfma_f32_32x32x16_bf16 a[80:95], a[228:231], v[168:171], a[80:95]
    ds_read_b64_tr_b16 a[224:225], v228 offset:24576
    ds_read_b64_tr_b16 a[226:227], v228 offset:26624
    v_exp_f32 v196, v60
    v_add_f32 v242, v242, v199
    v_cvt_pk_bf16_f32 v165, v198, v199
    v_mfma_f32_32x32x16_bf16 a[96:111], a[232:235], v[168:171], a[96:111]
    ds_read_b64_tr_b16 a[228:229], v229 offset:24576
    ds_read_b64_tr_b16 a[230:231], v229 offset:26624
    buffer_load_dwordx4 v235, s[16:19], s36 offen offset:3072 nt lds
    v_exp_f32 v197, v61
    v_add_f32 v242, v242, v196
    v_mfma_f32_32x32x16_bf16 a[112:127], a[236:239], v[168:171], a[112:127]
    ds_read_b64_tr_b16 a[232:233], v230 offset:24576
    ds_read_b64_tr_b16 a[234:235], v230 offset:26624
    v_exp_f32 v198, v62
    v_add_f32 v242, v242, v197
    v_cvt_pk_bf16_f32 v166, v196, v197
    v_mfma_f32_32x32x16_bf16 a[64:79], a[240:243], v[172:175], a[64:79]
    ds_read_b64_tr_b16 a[236:237], v231 offset:24576
    ds_read_b64_tr_b16 a[238:239], v231 offset:26624
    s_add_u32 s36, s36, 16384
    v_exp_f32 v199, v63
    v_add_f32 v242, v242, v198
    v_mfma_f32_32x32x16_bf16 a[80:95], a[244:247], v[172:175], a[80:95]
    ds_read_b64_tr_b16 a[240:241], v228 offset:28672
    ds_read_b64_tr_b16 a[242:243], v228 offset:30720
    v_add_f32 v242, v242, v199
    v_cvt_pk_bf16_f32 v167, v198, v199
    v_cmp_lt_f32 vcc, s35, v242
    v_exp_f32 v196, v112
    v_mfma_f32_32x32x16_bf16 a[96:111], a[248:251], v[172:175], a[96:111]
    ds_read_b64_tr_b16 a[244:245], v229 offset:28672
    ds_read_b64_tr_b16 a[246:247], v229 offset:30720
    v_exp_f32 v197, v113
    v_mfma_f32_32x32x16_bf16 a[112:127], a[252:255], v[172:175], a[112:127]
    ds_read_b64_tr_b16 a[248:249], v230 offset:28672
    ds_read_b64_tr_b16 a[250:251], v230 offset:30720
    s_cbranch_vccnz FX46
FX46_RET:
    v_add_f32 v239, v239, v242
    v_exp_f32 v198, v114
    v_add_f32 v243, v196, v197
    v_cvt_pk_bf16_f32 v168, v196, v197
    s_waitcnt lgkmcnt(14)
    v_mfma_f32_32x32x16_bf16 v[48:63], a[192:195], v[32:35], v[64:79]
    ds_read_b64_tr_b16 a[252:253], v231 offset:28672
    ds_read_b64_tr_b16 a[254:255], v231 offset:30720
    v_exp_f32 v199, v115
    v_add_f32 v243, v243, v198
    v_mfma_f32_32x32x16_bf16 v[48:63], a[196:199], v[36:39], v[48:63]
    s_add_u32 m0, s38, s86
    v_exp_f32 v196, v116
    v_add_f32 v243, v243, v199
    v_cvt_pk_bf16_f32 v169, v198, v199
    v_mfma_f32_32x32x16_bf16 v[48:63], a[200:203], v[40:43], v[48:63]
    v_exp_f32 v197, v117
    v_add_f32 v243, v243, v196
    v_mfma_f32_32x32x16_bf16 v[48:63], a[204:207], v[44:47], v[48:63]
    buffer_load_dwordx4 v236, s[20:23], s37 offen nt lds
    v_exp_f32 v198, v118
    v_add_f32 v243, v243, v197
    v_cvt_pk_bf16_f32 v170, v196, v197
    v_mfma_f32_32x32x16_bf16 v[48:63], a[208:211], v[16:19], v[48:63]
    v_exp_f32 v199, v119
    v_add_f32 v243, v243, v198
    v_mfma_f32_32x32x16_bf16 v[48:63], a[212:215], v[20:23], v[48:63]
    v_exp_f32 v196, v120
    v_add_f32 v243, v243, v199
    v_cvt_pk_bf16_f32 v171, v198, v199
    v_mfma_f32_32x32x16_bf16 v[48:63], a[216:219], v[24:27], v[48:63]
    buffer_load_dwordx4 v236, s[20:23], s37 offen offset:1024 nt lds
    v_exp_f32 v197, v121
    v_add_f32 v243, v243, v196
    v_mfma_f32_32x32x16_bf16 v[48:63], a[220:223], v[28:31], v[48:63]
    v_exp_f32 v198, v122
    v_add_f32 v243, v243, v197
    v_cvt_pk_bf16_f32 v172, v196, v197
    s_waitcnt lgkmcnt(0)
    v_mfma_f32_32x32x16_bf16 a[0:15], a[224:227], v[160:163], a[0:15]
    v_exp_f32 v199, v123
    v_add_f32 v243, v243, v198
    v_mfma_f32_32x32x16_bf16 a[16:31], a[228:231], v[160:163], a[16:31]
    buffer_load_dwordx4 v236, s[20:23], s37 offen offset:2048 nt lds
    v_exp_f32 v196, v124
    v_add_f32 v243, v243, v199
    v_cvt_pk_bf16_f32 v173, v198, v199
    v_mfma_f32_32x32x16_bf16 a[32:47], a[232:235], v[160:163], a[32:47]
    v_exp_f32 v197, v125
    v_add_f32 v243, v243, v196
    v_mfma_f32_32x32x16_bf16 a[48:63], a[236:239], v[160:163], a[48:63]
    v_exp_f32 v198, v126
    v_add_f32 v243, v243, v197
    v_cvt_pk_bf16_f32 v174, v196, v197
    v_mfma_f32_32x32x16_bf16 a[0:15], a[240:243], v[164:167], a[0:15]
    buffer_load_dwordx4 v236, s[20:23], s37 offen offset:3072 nt lds
    v_exp_f32 v199, v127
    v_add_f32 v243, v243, v198
    v_mfma_f32_32x32x16_bf16 a[16:31], a[244:247], v[164:167], a[16:31]
    v_add_f32 v243, v243, v199
    v_cvt_pk_bf16_f32 v175, v198, v199
    v_cmp_lt_f32 vcc, s35, v243
    v_exp_f32 v196, v48
    v_mfma_f32_32x32x16_bf16 a[32:47], a[248:251], v[164:167], a[32:47]
    s_add_u32 s37, s37, 16384
    v_exp_f32 v197, v49
    v_mfma_f32_32x32x16_bf16 a[48:63], a[252:255], v[164:167], a[48:63]
    s_add_u32 s38, s38, 32768
    s_and_b32 s38, s38, 131071
    s_cbranch_vccnz FX47
FX47_RET:
    v_add_f32 v240, v240, v243
    v_exp_f32 v198, v50
    v_add_f32 v242, v196, v197
    v_cvt_pk_bf16_f32 v160, v196, v197
    v_mfma_f32_32x32x16_bf16 v[112:127], a[192:195], v[96:99], v[128:143]
    v_exp_f32 v199, v51
    v_add_f32 v242, v242, v198
    v_mfma_f32_32x32x16_bf16 v[112:127], a[196:199], v[100:103], v[112:127]
    v_exp_f32 v196, v52
    v_add_f32 v242, v242, v199
    v_cvt_pk_bf16_f32 v161, v198, v199
    s_waitcnt vmcnt(16)
    s_barrier
    ds_read_b128 a[192:195], v220 offset:32768
    v_mfma_f32_32x32x16_bf16 v[112:127], a[200:203], v[104:107], v[112:127]
    ds_read_b128 a[196:199], v221 offset:32768
    v_exp_f32 v197, v53
    v_add_f32 v242, v242, v196
    v_mfma_f32_32x32x16_bf16 v[112:127], a[204:207], v[108:111], v[112:127]
    ds_read_b128 a[200:203], v222 offset:32768
    v_exp_f32 v198, v54
    v_add_f32 v242, v242, v197
    v_cvt_pk_bf16_f32 v162, v196, v197
    v_mfma_f32_32x32x16_bf16 v[112:127], a[208:211], v[80:83], v[112:127]
    ds_read_b128 a[204:207], v223 offset:32768
    v_exp_f32 v199, v55
    v_add_f32 v242, v242, v198
    v_mfma_f32_32x32x16_bf16 v[112:127], a[212:215], v[84:87], v[112:127]
    ds_read_b128 a[208:211], v224 offset:32768
    v_exp_f32 v196, v56
    v_add_f32 v242, v242, v199
    v_cvt_pk_bf16_f32 v163, v198, v199
    v_mfma_f32_32x32x16_bf16 v[112:127], a[216:219], v[88:91], v[112:127]
    ds_read_b128 a[212:215], v225 offset:32768
    v_exp_f32 v197, v57
    v_add_f32 v242, v242, v196
    v_mfma_f32_32x32x16_bf16 v[112:127], a[220:223], v[92:95], v[112:127]
    ds_read_b128 a[216:219], v226 offset:32768
    v_exp_f32 v198, v58
    v_add_f32 v242, v242, v197
    v_cvt_pk_bf16_f32 v164, v196, v197
    v_mfma_f32_32x32x16_bf16 a[64:79], a[224:227], v[168:171], a[64:79]
    ds_read_b128 a[220:223], v227 offset:32768
    v_exp_f32 v199, v59
    v_add_f32 v242, v242, v198
    v_mfma_f32_32x32x16_bf16 a[80:95], a[228:231], v[168:171], a[80:95]
    ds_read_b64_tr_b16 a[224:225], v228 offset:49152
    ds_read_b64_tr_b16 a[226:227], v228 offset:51200
    v_exp_f32 v196, v60
    v_add_f32 v242, v242, v199
    v_cvt_pk_bf16_f32 v165, v198, v199
    v_mfma_f32_32x32x16_bf16 a[96:111], a[232:235], v[168:171], a[96:111]
    ds_read_b64_tr_b16 a[228:229], v229 offset:49152
    ds_read_b64_tr_b16 a[230:231], v229 offset:51200
    v_exp_f32 v197, v61
    v_add_f32 v242, v242, v196
    v_mfma_f32_32x32x16_bf16 a[112:127], a[236:239], v[168:171], a[112:127]
    ds_read_b64_tr_b16 a[232:233], v230 offset:49152
    ds_read_b64_tr_b16 a[234:235], v230 offset:51200
    v_exp_f32 v198, v62
    v_add_f32 v242, v242, v197
    v_cvt_pk_bf16_f32 v166, v196, v197
    v_mfma_f32_32x32x16_bf16 a[64:79], a[240:243], v[172:175], a[64:79]
    ds_read_b64_tr_b16 a[236:237], v231 offset:49152
    ds_read_b64_tr_b16 a[238:239], v231 offset:51200
    v_exp_f32 v199, v63
    v_add_f32 v242, v242, v198
    v_mfma_f32_32x32x16_bf16 a[80:95], a[244:247], v[172:175], a[80:95]
    ds_read_b64_tr_b16 a[240:241], v228 offset:53248
    ds_read_b64_tr_b16 a[242:243], v228 offset:55296
    v_add_f32 v242, v242, v199
    v_cvt_pk_bf16_f32 v167, v198, v199
    v_cmp_lt_f32 vcc, s35, v242
    v_exp_f32 v196, v112
    v_mfma_f32_32x32x16_bf16 a[96:111], a[248:251], v[172:175], a[96:111]
    ds_read_b64_tr_b16 a[244:245], v229 offset:53248
    ds_read_b64_tr_b16 a[246:247], v229 offset:55296
    v_exp_f32 v197, v113
    v_mfma_f32_32x32x16_bf16 a[112:127], a[252:255], v[172:175], a[112:127]
    ds_read_b64_tr_b16 a[248:249], v230 offset:53248
    ds_read_b64_tr_b16 a[250:251], v230 offset:55296
    s_cbranch_vccnz FX48
FX48_RET:
    v_add_f32 v239, v239, v242
    v_exp_f32 v198, v114
    v_add_f32 v243, v196, v197
    v_cvt_pk_bf16_f32 v168, v196, v197
    s_waitcnt lgkmcnt(14)
    v_mfma_f32_32x32x16_bf16 v[48:63], a[192:195], v[32:35], v[64:79]
    ds_read_b64_tr_b16 a[252:253], v231 offset:53248
    ds_read_b64_tr_b16 a[254:255], v231 offset:55296
    v_exp_f32 v199, v115
    v_add_f32 v243, v243, v198
    v_mfma_f32_32x32x16_bf16 v[48:63], a[196:199], v[36:39], v[48:63]
    v_exp_f32 v196, v116
    v_add_f32 v243, v243, v199
    v_cvt_pk_bf16_f32 v169, v198, v199
    v_mfma_f32_32x32x16_bf16 v[48:63], a[200:203], v[40:43], v[48:63]
    v_exp_f32 v197, v117
    v_add_f32 v243, v243, v196
    v_mfma_f32_32x32x16_bf16 v[48:63], a[204:207], v[44:47], v[48:63]
    v_exp_f32 v198, v118
    v_add_f32 v243, v243, v197
    v_cvt_pk_bf16_f32 v170, v196, v197
    v_mfma_f32_32x32x16_bf16 v[48:63], a[208:211], v[16:19], v[48:63]
    s_add_u32 m0, s38, s82
    v_exp_f32 v199, v119
    v_add_f32 v243, v243, v198
    v_mfma_f32_32x32x16_bf16 v[48:63], a[212:215], v[20:23], v[48:63]
    buffer_load_dwordx4 v232, s[16:19], s36 offen nt lds
    v_exp_f32 v196, v120
    v_add_f32 v243, v243, v199
    v_cvt_pk_bf16_f32 v171, v198, v199
    v_mfma_f32_32x32x16_bf16 v[48:63], a[216:219], v[24:27], v[48:63]
    v_exp_f32 v197, v121
    v_add_f32 v243, v243, v196
    v_mfma_f32_32x32x16_bf16 v[48:63], a[220:223], v[28:31], v[48:63]
    v_exp_f32 v198, v122
    v_add_f32 v243, v243, v197
    v_cvt_pk_bf16_f32 v172, v196, v197
    s_waitcnt lgkmcnt(0)
    v_mfma_f32_32x32x16_bf16 a[0:15], a[224:227], v[160:163], a[0:15]
    v_exp_f32 v199, v123
    v_add_f32 v243, v243, v198
    v_mfma_f32_32x32x16_bf16 a[16:31], a[228:231], v[160:163], a[16:31]
    ds_read_b128 v[184:187], v237
    v_exp_f32 v196, v124
    v_add_f32 v243, v243, v199
    v_cvt_pk_bf16_f32 v173, v198, v199
    v_mfma_f32_32x32x16_bf16 a[32:47], a[232:235], v[160:163], a[32:47]
    ds_read_b128 v[188:191], v237 offset:1024
    v_exp_f32 v197, v125
    v_add_f32 v243, v243, v196
    v_mfma_f32_32x32x16_bf16 a[48:63], a[236:239], v[160:163], a[48:63]
    ds_read_b128 v[192:195], v237 offset:2048
    v_exp_f32 v198, v126
    v_add_f32 v243, v243, v197
    v_cvt_pk_bf16_f32 v174, v196, v197
    v_mfma_f32_32x32x16_bf16 a[0:15], a[240:243], v[164:167], a[0:15]
    buffer_load_dwordx4 v233, s[16:19], s36 offen offset:1024 nt lds
    v_exp_f32 v199, v127
    v_add_f32 v243, v243, v198
    v_mfma_f32_32x32x16_bf16 a[16:31], a[244:247], v[164:167], a[16:31]
    v_add_f32 v243, v243, v199
    v_cvt_pk_bf16_f32 v175, v198, v199
    v_cmp_lt_f32 vcc, s35, v243
    v_exp_f32 v196, v48
    v_mfma_f32_32x32x16_bf16 a[32:47], a[248:251], v[164:167], a[32:47]
    v_exp_f32 v197, v49
    v_mfma_f32_32x32x16_bf16 a[48:63], a[252:255], v[164:167], a[48:63]
    s_cbranch_vccnz FX49
FX49_RET:
    v_add_f32 v240, v240, v243
    v_exp_f32 v198, v50
    v_add_f32 v242, v196, v197
    v_cvt_pk_bf16_f32 v160, v196, v197
    s_waitcnt lgkmcnt(2)
    v_mfma_f32_32x32x16_bf16 v[144:159], a[192:195], v[184:187], v[204:219]
    v_exp_f32 v199, v51
    v_add_f32 v242, v242, v198
    s_waitcnt lgkmcnt(1)
    v_mfma_f32_32x32x16_bf16 v[144:159], a[196:199], v[188:191], v[144:159]
    ds_read_b128 v[184:187], v237 offset:3072
    v_exp_f32 v196, v52
    v_add_f32 v242, v242, v199
    v_cvt_pk_bf16_f32 v161, v198, v199
    s_waitcnt lgkmcnt(1)
    v_mfma_f32_32x32x16_bf16 v[144:159], a[200:203], v[192:195], v[144:159]
    ds_read_b128 v[188:191], v237 offset:4096
    v_exp_f32 v197, v53
    v_add_f32 v242, v242, v196
    s_waitcnt lgkmcnt(1)
    v_mfma_f32_32x32x16_bf16 v[144:159], a[204:207], v[184:187], v[144:159]
    ds_read_b128 v[192:195], v237 offset:5120
    buffer_load_dwordx4 v234, s[16:19], s36 offen offset:2048 nt lds
    v_exp_f32 v198, v54
    v_add_f32 v242, v242, v197
    v_cvt_pk_bf16_f32 v162, v196, v197
    s_waitcnt lgkmcnt(1)
    v_mfma_f32_32x32x16_bf16 v[144:159], a[208:211], v[188:191], v[144:159]
    ds_read_b128 v[184:187], v237 offset:6144
    v_exp_f32 v199, v55
    v_add_f32 v242, v242, v198
    s_waitcnt lgkmcnt(1)
    v_mfma_f32_32x32x16_bf16 v[144:159], a[212:215], v[192:195], v[144:159]
    ds_read_b128 v[188:191], v237 offset:7168
    v_exp_f32 v196, v56
    v_add_f32 v242, v242, v199
    v_cvt_pk_bf16_f32 v163, v198, v199
    s_waitcnt lgkmcnt(1)
    v_mfma_f32_32x32x16_bf16 v[144:159], a[216:219], v[184:187], v[144:159]
    v_exp_f32 v197, v57
    v_add_f32 v242, v242, v196
    s_waitcnt lgkmcnt(0)
    v_mfma_f32_32x32x16_bf16 v[144:159], a[220:223], v[188:191], v[144:159]
    v_exp_f32 v198, v58
    v_add_f32 v242, v242, v197
    v_cvt_pk_bf16_f32 v164, v196, v197
    v_mfma_f32_32x32x16_bf16 v[112:127], a[192:195], v[96:99], v[128:143]
    v_exp_f32 v199, v59
    v_add_f32 v242, v242, v198
    v_mfma_f32_32x32x16_bf16 v[112:127], a[196:199], v[100:103], v[112:127]
    ds_read_b128 a[192:195], v220 offset:40960
    v_exp_f32 v196, v60
    v_add_f32 v242, v242, v199
    v_cvt_pk_bf16_f32 v165, v198, v199
    v_mfma_f32_32x32x16_bf16 v[112:127], a[200:203], v[104:107], v[112:127]
    ds_read_b128 a[196:199], v221 offset:40960
    buffer_load_dwordx4 v235, s[16:19], s36 offen offset:3072 nt lds
    v_exp_f32 v197, v61
    v_add_f32 v242, v242, v196
    v_mfma_f32_32x32x16_bf16 v[112:127], a[204:207], v[108:111], v[112:127]
    ds_read_b128 a[200:203], v222 offset:40960
    v_exp_f32 v198, v62
    v_add_f32 v242, v242, v197
    v_cvt_pk_bf16_f32 v166, v196, v197
    v_mfma_f32_32x32x16_bf16 v[112:127], a[208:211], v[80:83], v[112:127]
    ds_read_b128 a[204:207], v223 offset:40960
    s_add_u32 s36, s36, 16384
    v_exp_f32 v199, v63
    v_add_f32 v242, v242, v198
    v_mfma_f32_32x32x16_bf16 v[112:127], a[212:215], v[84:87], v[112:127]
    ds_read_b128 a[208:211], v224 offset:40960
    v_add_f32 v242, v242, v199
    v_cvt_pk_bf16_f32 v167, v198, v199
    v_cmp_lt_f32 vcc, s35, v242
    v_exp_f32 v196, v144
    v_mfma_f32_32x32x16_bf16 v[112:127], a[216:219], v[88:91], v[112:127]
    ds_read_b128 a[212:215], v225 offset:40960
    v_exp_f32 v197, v145
    v_mfma_f32_32x32x16_bf16 v[112:127], a[220:223], v[92:95], v[112:127]
    ds_read_b128 a[216:219], v226 offset:40960
    s_cbranch_vccnz FX50
FX50_RET:
    v_add_f32 v239, v239, v242
    v_exp_f32 v198, v146
    v_add_f32 v244, v196, v197
    v_cvt_pk_bf16_f32 v176, v196, v197
    v_mfma_f32_32x32x16_bf16 a[64:79], a[224:227], v[168:171], a[64:79]
    ds_read_b128 a[220:223], v227 offset:40960
    v_exp_f32 v199, v147
    v_add_f32 v244, v244, v198
    v_mfma_f32_32x32x16_bf16 a[80:95], a[228:231], v[168:171], a[80:95]
    ds_read_b64_tr_b16 a[224:225], v228 offset:57344
    ds_read_b64_tr_b16 a[226:227], v228 offset:59392
    v_exp_f32 v196, v148
    v_add_f32 v244, v244, v199
    v_cvt_pk_bf16_f32 v177, v198, v199
    v_mfma_f32_32x32x16_bf16 a[96:111], a[232:235], v[168:171], a[96:111]
    ds_read_b64_tr_b16 a[228:229], v229 offset:57344
    ds_read_b64_tr_b16 a[230:231], v229 offset:59392
    v_exp_f32 v197, v149
    v_add_f32 v244, v244, v196
    v_mfma_f32_32x32x16_bf16 a[112:127], a[236:239], v[168:171], a[112:127]
    ds_read_b64_tr_b16 a[232:233], v230 offset:57344
    ds_read_b64_tr_b16 a[234:235], v230 offset:59392
    v_exp_f32 v198, v150
    v_add_f32 v244, v244, v197
    v_cvt_pk_bf16_f32 v178, v196, v197
    v_mfma_f32_32x32x16_bf16 a[64:79], a[240:243], v[172:175], a[64:79]
    ds_read_b64_tr_b16 a[236:237], v231 offset:57344
    ds_read_b64_tr_b16 a[238:239], v231 offset:59392
    v_exp_f32 v199, v151
    v_add_f32 v244, v244, v198
    v_mfma_f32_32x32x16_bf16 a[80:95], a[244:247], v[172:175], a[80:95]
    ds_read_b64_tr_b16 a[240:241], v228 offset:61440
    ds_read_b64_tr_b16 a[242:243], v228 offset:63488
    v_add_f32 v244, v244, v199
    v_cvt_pk_bf16_f32 v179, v198, v199
    v_exp_f32 v196, v112
    v_mfma_f32_32x32x16_bf16 a[96:111], a[248:251], v[172:175], a[96:111]
    ds_read_b64_tr_b16 a[244:245], v229 offset:61440
    ds_read_b64_tr_b16 a[246:247], v229 offset:63488
    v_exp_f32 v197, v113
    v_mfma_f32_32x32x16_bf16 a[112:127], a[252:255], v[172:175], a[112:127]
    ds_read_b64_tr_b16 a[248:249], v230 offset:61440
    ds_read_b64_tr_b16 a[250:251], v230 offset:63488
    v_exp_f32 v198, v114
    v_add_f32 v243, v196, v197
    v_cvt_pk_bf16_f32 v168, v196, v197
    s_waitcnt lgkmcnt(14)
    v_mfma_f32_32x32x16_bf16 v[48:63], a[192:195], v[32:35], v[64:79]
    ds_read_b64_tr_b16 a[252:253], v231 offset:61440
    ds_read_b64_tr_b16 a[254:255], v231 offset:63488
    v_exp_f32 v199, v115
    v_add_f32 v243, v243, v198
    v_mfma_f32_32x32x16_bf16 v[48:63], a[196:199], v[36:39], v[48:63]
    s_add_u32 m0, s38, s86
    v_exp_f32 v196, v116
    v_add_f32 v243, v243, v199
    v_cvt_pk_bf16_f32 v169, v198, v199
    v_mfma_f32_32x32x16_bf16 v[48:63], a[200:203], v[40:43], v[48:63]
    v_exp_f32 v197, v117
    v_add_f32 v243, v243, v196
    v_xor_b32 v220, 65536, v220
    v_mfma_f32_32x32x16_bf16 v[48:63], a[204:207], v[44:47], v[48:63]
    buffer_load_dwordx4 v236, s[20:23], s37 offen nt lds
    v_exp_f32 v198, v118
    v_add_f32 v243, v243, v197
    v_cvt_pk_bf16_f32 v170, v196, v197
    v_xor_b32 v221, 65536, v221
    v_mfma_f32_32x32x16_bf16 v[48:63], a[208:211], v[16:19], v[48:63]
    v_exp_f32 v199, v119
    v_add_f32 v243, v243, v198
    v_xor_b32 v222, 65536, v222
    v_mfma_f32_32x32x16_bf16 v[48:63], a[212:215], v[20:23], v[48:63]
    v_exp_f32 v196, v120
    v_add_f32 v243, v243, v199
    v_cvt_pk_bf16_f32 v171, v198, v199
    v_xor_b32 v223, 65536, v223
    v_mfma_f32_32x32x16_bf16 v[48:63], a[216:219], v[24:27], v[48:63]
    buffer_load_dwordx4 v236, s[20:23], s37 offen offset:1024 nt lds
    v_exp_f32 v197, v121
    v_add_f32 v243, v243, v196
    v_xor_b32 v224, 65536, v224
    v_mfma_f32_32x32x16_bf16 v[48:63], a[220:223], v[28:31], v[48:63]
    v_exp_f32 v198, v122
    v_add_f32 v243, v243, v197
    v_cvt_pk_bf16_f32 v172, v196, v197
    v_xor_b32 v225, 65536, v225
    s_waitcnt lgkmcnt(0)
    v_mfma_f32_32x32x16_bf16 a[0:15], a[224:227], v[160:163], a[0:15]
    v_exp_f32 v199, v123
    v_add_f32 v243, v243, v198
    v_xor_b32 v226, 65536, v226
    v_mfma_f32_32x32x16_bf16 a[16:31], a[228:231], v[160:163], a[16:31]
    buffer_load_dwordx4 v236, s[20:23], s37 offen offset:2048 nt lds
    v_exp_f32 v196, v124
    v_add_f32 v243, v243, v199
    v_cvt_pk_bf16_f32 v173, v198, v199
    v_xor_b32 v227, 65536, v227
    v_mfma_f32_32x32x16_bf16 a[32:47], a[232:235], v[160:163], a[32:47]
    v_exp_f32 v197, v125
    v_add_f32 v243, v243, v196
    v_xor_b32 v228, 65536, v228
    v_mfma_f32_32x32x16_bf16 a[48:63], a[236:239], v[160:163], a[48:63]
    v_exp_f32 v198, v126
    v_add_f32 v243, v243, v197
    v_cvt_pk_bf16_f32 v174, v196, v197
    v_xor_b32 v229, 65536, v229
    v_mfma_f32_32x32x16_bf16 a[0:15], a[240:243], v[164:167], a[0:15]
    buffer_load_dwordx4 v236, s[20:23], s37 offen offset:3072 nt lds
    v_exp_f32 v199, v127
    v_add_f32 v243, v243, v198
    v_xor_b32 v230, 65536, v230
    v_mfma_f32_32x32x16_bf16 a[16:31], a[244:247], v[164:167], a[16:31]
    v_add_f32 v243, v243, v199
    v_cvt_pk_bf16_f32 v175, v198, v199
    v_cmp_lt_f32 vcc, s35, v243
    v_exp_f32 v196, v152
    v_xor_b32 v231, 65536, v231
    v_mfma_f32_32x32x16_bf16 a[32:47], a[248:251], v[164:167], a[32:47]
    s_add_u32 s37, s37, 16384
    v_exp_f32 v197, v153
    v_add_f32 v244, v244, v196
    v_mfma_f32_32x32x16_bf16 a[48:63], a[252:255], v[164:167], a[48:63]
    s_add_u32 s38, s38, 32768
    s_and_b32 s38, s38, 131071
    s_cbranch_vccnz FX51
FX51_RET:
    v_add_f32 v240, v240, v243
    v_exp_f32 v198, v154
    v_add_f32 v244, v244, v197
    v_cvt_pk_bf16_f32 v180, v196, v197
    v_mfma_f32_32x32x16_bf16 v[112:127], a[192:195], v[96:99], v[128:143]
    v_exp_f32 v199, v155
    v_add_f32 v244, v244, v198
    v_mfma_f32_32x32x16_bf16 v[112:127], a[196:199], v[100:103], v[112:127]
    v_exp_f32 v196, v156
    v_add_f32 v244, v244, v199
    v_cvt_pk_bf16_f32 v181, v198, v199
    s_waitcnt vmcnt(16)
    s_barrier
    ds_read_b128 a[192:195], v220
    v_mfma_f32_32x32x16_bf16 v[112:127], a[200:203], v[104:107], v[112:127]
    ds_read_b128 a[196:199], v221
    v_exp_f32 v197, v157
    v_add_f32 v244, v244, v196
    v_mfma_f32_32x32x16_bf16 v[112:127], a[204:207], v[108:111], v[112:127]
    ds_read_b128 a[200:203], v222
    v_exp_f32 v198, v158
    v_add_f32 v244, v244, v197
    v_cvt_pk_bf16_f32 v182, v196, v197
    v_mfma_f32_32x32x16_bf16 v[112:127], a[208:211], v[80:83], v[112:127]
    ds_read_b128 a[204:207], v223
    v_exp_f32 v199, v159
    v_add_f32 v244, v244, v198
    v_mfma_f32_32x32x16_bf16 v[112:127], a[212:215], v[84:87], v[112:127]
    ds_read_b128 a[208:211], v224
    v_add_f32 v244, v244, v199
    v_cvt_pk_bf16_f32 v183, v198, v199
    v_cmp_lt_f32 vcc, s35, v244
    v_exp_f32 v196, v48
    v_mfma_f32_32x32x16_bf16 v[112:127], a[216:219], v[88:91], v[112:127]
    ds_read_b128 a[212:215], v225
    v_exp_f32 v197, v49
    v_mfma_f32_32x32x16_bf16 v[112:127], a[220:223], v[92:95], v[112:127]
    ds_read_b128 a[216:219], v226
    s_cbranch_vccnz FX52
FX52_RET:
    v_add_f32 v241, v241, v244
    v_exp_f32 v198, v50
    v_add_f32 v242, v196, v197
    v_cvt_pk_bf16_f32 v160, v196, v197
    v_mfma_f32_32x32x16_bf16 a[128:143], a[224:227], v[176:179], a[128:143]
    ds_read_b128 a[220:223], v227
    v_exp_f32 v199, v51
    v_add_f32 v242, v242, v198
    v_mfma_f32_32x32x16_bf16 a[144:159], a[228:231], v[176:179], a[144:159]
    v_exp_f32 v196, v52
    v_add_f32 v242, v242, v199
    v_cvt_pk_bf16_f32 v161, v198, v199
    v_mfma_f32_32x32x16_bf16 a[160:175], a[232:235], v[176:179], a[160:175]
    v_exp_f32 v197, v53
    v_add_f32 v242, v242, v196
    v_mfma_f32_32x32x16_bf16 a[176:191], a[236:239], v[176:179], a[176:191]
    v_exp_f32 v198, v54
    v_add_f32 v242, v242, v197
    v_cvt_pk_bf16_f32 v162, v196, v197
    v_mfma_f32_32x32x16_bf16 a[128:143], a[240:243], v[180:183], a[128:143]
    v_exp_f32 v199, v55
    v_add_f32 v242, v242, v198
    v_mfma_f32_32x32x16_bf16 a[144:159], a[244:247], v[180:183], a[144:159]
    v_exp_f32 v196, v56
    v_add_f32 v242, v242, v199
    v_cvt_pk_bf16_f32 v163, v198, v199
    v_mfma_f32_32x32x16_bf16 a[160:175], a[248:251], v[180:183], a[160:175]
    v_exp_f32 v197, v57
    v_add_f32 v242, v242, v196
    v_mfma_f32_32x32x16_bf16 a[176:191], a[252:255], v[180:183], a[176:191]
    v_exp_f32 v198, v58
    v_add_f32 v242, v242, v197
    v_cvt_pk_bf16_f32 v164, v196, v197
    v_mfma_f32_32x32x16_bf16 a[64:79], a[224:227], v[168:171], a[64:79]
    v_exp_f32 v199, v59
    v_add_f32 v242, v242, v198
    v_mfma_f32_32x32x16_bf16 a[80:95], a[228:231], v[168:171], a[80:95]
    ds_read_b64_tr_b16 a[224:225], v228 offset:16384
    ds_read_b64_tr_b16 a[226:227], v228 offset:18432
    v_exp_f32 v196, v60
    v_add_f32 v242, v242, v199
    v_cvt_pk_bf16_f32 v165, v198, v199
    v_mfma_f32_32x32x16_bf16 a[96:111], a[232:235], v[168:171], a[96:111]
    ds_read_b64_tr_b16 a[228:229], v229 offset:16384
    ds_read_b64_tr_b16 a[230:231], v229 offset:18432
    v_exp_f32 v197, v61
    v_add_f32 v242, v242, v196
    v_mfma_f32_32x32x16_bf16 a[112:127], a[236:239], v[168:171], a[112:127]
    ds_read_b64_tr_b16 a[232:233], v230 offset:16384
    ds_read_b64_tr_b16 a[234:235], v230 offset:18432
    v_exp_f32 v198, v62
    v_add_f32 v242, v242, v197
    v_cvt_pk_bf16_f32 v166, v196, v197
    v_mfma_f32_32x32x16_bf16 a[64:79], a[240:243], v[172:175], a[64:79]
    ds_read_b64_tr_b16 a[236:237], v231 offset:16384
    ds_read_b64_tr_b16 a[238:239], v231 offset:18432
    v_exp_f32 v199, v63
    v_add_f32 v242, v242, v198
    v_mfma_f32_32x32x16_bf16 a[80:95], a[244:247], v[172:175], a[80:95]
    ds_read_b64_tr_b16 a[240:241], v228 offset:20480
    ds_read_b64_tr_b16 a[242:243], v228 offset:22528
    v_add_f32 v242, v242, v199
    v_cvt_pk_bf16_f32 v167, v198, v199
    v_cmp_lt_f32 vcc, s35, v242
    v_exp_f32 v196, v112
    v_mfma_f32_32x32x16_bf16 a[96:111], a[248:251], v[172:175], a[96:111]
    ds_read_b64_tr_b16 a[244:245], v229 offset:20480
    ds_read_b64_tr_b16 a[246:247], v229 offset:22528
    v_exp_f32 v197, v113
    v_mfma_f32_32x32x16_bf16 a[112:127], a[252:255], v[172:175], a[112:127]
    ds_read_b64_tr_b16 a[248:249], v230 offset:20480
    ds_read_b64_tr_b16 a[250:251], v230 offset:22528
    s_cbranch_vccnz FX53
FX53_RET:
    v_add_f32 v239, v239, v242
    v_exp_f32 v198, v114
    v_add_f32 v243, v196, v197
    v_cvt_pk_bf16_f32 v168, v196, v197
    s_sub_u32 s39, s39, 1
    s_cmp_lg_u32 s39, 0
    s_cbranch_scc1 W2_AL
    ds_read_b64_tr_b16 a[252:253], v231 offset:20480
    ds_read_b64_tr_b16 a[254:255], v231 offset:22528
    s_add_u32 s46, s54, 0
    v_exp_f32 v199, v115
    v_add_f32 v243, v243, v198
    buffer_load_dwordx4 v[16:19], v245, s[24:27], s46 offen
    v_exp_f32 v196, v116
    v_add_f32 v243, v243, v199
    v_cvt_pk_bf16_f32 v169, v198, v199
    v_exp_f32 v197, v117
    v_add_f32 v243, v243, v196
    buffer_load_dwordx4 v[20:23], v245, s[24:27], s46 offen offset:1024
    v_exp_f32 v198, v118
    v_add_f32 v243, v243, v197
    v_cvt_pk_bf16_f32 v170, v196, v197
    buffer_load_dwordx4 v[24:27], v245, s[24:27], s46 offen offset:2048
    v_exp_f32 v199, v119
    v_add_f32 v243, v243, v198
    v_exp_f32 v196, v120
    v_add_f32 v243, v243, v199
    v_cvt_pk_bf16_f32 v171, v198, v199
    buffer_load_dwordx4 v[28:31], v245, s[24:27], s46 offen offset:3072
    v_exp_f32 v197, v121
    v_add_f32 v243, v243, v196
    v_exp_f32 v198, v122
    v_add_f32 v243, v243, v197
    v_cvt_pk_bf16_f32 v172, v196, v197
    s_waitcnt lgkmcnt(0)
    v_mfma_f32_32x32x16_bf16 a[0:15], a[224:227], v[160:163], a[0:15]
    s_add_u32 s46, s54, 4096
    v_exp_f32 v199, v123
    v_add_f32 v243, v243, v198
    v_mfma_f32_32x32x16_bf16 a[16:31], a[228:231], v[160:163], a[16:31]
    buffer_load_dwordx4 v[32:35], v245, s[24:27], s46 offen
    v_exp_f32 v196, v124
    v_add_f32 v243, v243, v199
    v_cvt_pk_bf16_f32 v173, v198, v199
    v_mfma_f32_32x32x16_bf16 a[32:47], a[232:235], v[160:163], a[32:47]
    v_exp_f32 v197, v125
    v_add_f32 v243, v243, v196
    v_mfma_f32_32x32x16_bf16 a[48:63], a[236:239], v[160:163], a[48:63]
    buffer_load_dwordx4 v[36:39], v245, s[24:27], s46 offen offset:1024
    v_exp_f32 v198, v126
    v_add_f32 v243, v243, v197
    v_cvt_pk_bf16_f32 v174, v196, v197
    v_mfma_f32_32x32x16_bf16 a[0:15], a[240:243], v[164:167], a[0:15]
    buffer_load_dwordx4 v[40:43], v245, s[24:27], s46 offen offset:2048
    v_exp_f32 v199, v127
    v_add_f32 v243, v243, v198
    v_mfma_f32_32x32x16_bf16 a[16:31], a[244:247], v[164:167], a[16:31]
    v_add_f32 v243, v243, v199
    v_cvt_pk_bf16_f32 v175, v198, v199
    v_cmp_lt_f32 vcc, s35, v243
    v_mfma_f32_32x32x16_bf16 a[32:47], a[248:251], v[164:167], a[32:47]
    buffer_load_dwordx4 v[44:47], v245, s[24:27], s46 offen offset:3072
    v_mfma_f32_32x32x16_bf16 a[48:63], a[252:255], v[164:167], a[48:63]
    s_cbranch_vccnz FX54
FX54_RET:
    v_add_f32 v240, v240, v243
    s_add_u32 s46, s54, 8192
    buffer_load_dwordx4 v[80:83], v245, s[24:27], s46 offen
    buffer_load_dwordx4 v[84:87], v245, s[24:27], s46 offen offset:1024
    buffer_load_dwordx4 v[88:91], v245, s[24:27], s46 offen offset:2048
    buffer_load_dwordx4 v[92:95], v245, s[24:27], s46 offen offset:3072
    v_mfma_f32_32x32x16_bf16 a[64:79], a[224:227], v[168:171], a[64:79]
    s_add_u32 s46, s54, 12288
    v_mfma_f32_32x32x16_bf16 a[80:95], a[228:231], v[168:171], a[80:95]
    buffer_load_dwordx4 v[96:99], v245, s[24:27], s46 offen
    v_mfma_f32_32x32x16_bf16 a[96:111], a[232:235], v[168:171], a[96:111]
    v_mfma_f32_32x32x16_bf16 a[112:127], a[236:239], v[168:171], a[112:127]
    buffer_load_dwordx4 v[100:103], v245, s[24:27], s46 offen offset:1024
    v_mfma_f32_32x32x16_bf16 a[64:79], a[240:243], v[172:175], a[64:79]
    buffer_load_dwordx4 v[104:107], v245, s[24:27], s46 offen offset:2048
    v_mfma_f32_32x32x16_bf16 a[80:95], a[244:247], v[172:175], a[80:95]
    v_mfma_f32_32x32x16_bf16 a[96:111], a[248:251], v[172:175], a[96:111]
    buffer_load_dwordx4 v[108:111], v245, s[24:27], s46 offen offset:3072
    v_mfma_f32_32x32x16_bf16 a[112:127], a[252:255], v[172:175], a[112:127]
    v_mov_b32 v2, v241
    s_nop 1
    v_permlane32_swap_b32 v241, v2
    v_add_f32 v241, v241, v2
    v_mov_b32 v2, v239
    s_nop 1
    v_permlane32_swap_b32 v239, v2
    v_add_f32 v239, v239, v2
    v_mov_b32 v2, v240
    s_nop 1
    v_permlane32_swap_b32 v240, v2
    v_add_f32 v240, v240, v2
    v_and_b32 v2, 31, v1
    v_lshlrev_b32 v2, 2, v2
    v_add_u32 v2, 159744, v2
    v_sub_f32 v3, 0, v204
    ds_write_b32 v2, v3 offset:512
    ds_write_b32 v2, v241 offset:640
    v_rcp_f32 v48, v239
    s_nop 0
    v_mov_b32 v49, v48
    v_rcp_f32 v50, v240
    s_nop 0
    v_mov_b32 v51, v50
    s_add_u32 s42, s53, 8192
    v_accvgpr_read_b32 v112, a0
    v_accvgpr_read_b32 v113, a1
    v_accvgpr_read_b32 v114, a2
    v_accvgpr_read_b32 v115, a3
    v_accvgpr_read_b32 v116, a4
    v_accvgpr_read_b32 v117, a5
    v_accvgpr_read_b32 v118, a6
    v_accvgpr_read_b32 v119, a7
    v_pk_mul_f32 v[112:113], v[112:113], v[48:49]
    v_pk_mul_f32 v[114:115], v[114:115], v[48:49]
    v_pk_mul_f32 v[116:117], v[116:117], v[48:49]
    v_pk_mul_f32 v[118:119], v[118:119], v[48:49]
    v_cvt_pk_bf16_f32 v176, v112, v113
    v_cvt_pk_bf16_f32 v177, v114, v115
    v_cvt_pk_bf16_f32 v178, v116, v117
    v_cvt_pk_bf16_f32 v179, v118, v119
    buffer_store_dwordx4 v[176:179], v238, s[24:27], s42 offen sc1
    v_accvgpr_read_b32 v120, a8
    v_accvgpr_read_b32 v121, a9
    v_accvgpr_read_b32 v122, a10
    v_accvgpr_read_b32 v123, a11
    v_accvgpr_read_b32 v124, a12
    v_accvgpr_read_b32 v125, a13
    v_accvgpr_read_b32 v126, a14
    v_accvgpr_read_b32 v127, a15
    v_pk_mul_f32 v[120:121], v[120:121], v[48:49]
    v_pk_mul_f32 v[122:123], v[122:123], v[48:49]
    v_pk_mul_f32 v[124:125], v[124:125], v[48:49]
    v_pk_mul_f32 v[126:127], v[126:127], v[48:49]
    v_cvt_pk_bf16_f32 v180, v120, v121
    v_cvt_pk_bf16_f32 v181, v122, v123
    v_cvt_pk_bf16_f32 v182, v124, v125
    v_cvt_pk_bf16_f32 v183, v126, v127
    buffer_store_dwordx4 v[180:183], v238, s[24:27], s42 offen offset:512 sc1
    s_add_u32 s42, s53, 155648
    v_accvgpr_read_b32 v112, a16
    v_accvgpr_read_b32 v113, a17
    v_accvgpr_read_b32 v114, a18
    v_accvgpr_read_b32 v115, a19
    v_accvgpr_read_b32 v116, a20
    v_accvgpr_read_b32 v117, a21
    v_accvgpr_read_b32 v118, a22
    v_accvgpr_read_b32 v119, a23
    v_pk_mul_f32 v[112:113], v[112:113], v[48:49]
    v_pk_mul_f32 v[114:115], v[114:115], v[48:49]
    v_pk_mul_f32 v[116:117], v[116:117], v[48:49]
    v_pk_mul_f32 v[118:119], v[118:119], v[48:49]
    v_cvt_pk_bf16_f32 v184, v112, v113
    v_cvt_pk_bf16_f32 v185, v114, v115
    v_cvt_pk_bf16_f32 v186, v116, v117
    v_cvt_pk_bf16_f32 v187, v118, v119
    buffer_store_dwordx4 v[184:187], v238, s[24:27], s42 offen sc1
    v_accvgpr_read_b32 v120, a24
    v_accvgpr_read_b32 v121, a25
    v_accvgpr_read_b32 v122, a26
    v_accvgpr_read_b32 v123, a27
    v_accvgpr_read_b32 v124, a28
    v_accvgpr_read_b32 v125, a29
    v_accvgpr_read_b32 v126, a30
    v_accvgpr_read_b32 v127, a31
    v_pk_mul_f32 v[120:121], v[120:121], v[48:49]
    v_pk_mul_f32 v[122:123], v[122:123], v[48:49]
    v_pk_mul_f32 v[124:125], v[124:125], v[48:49]
    v_pk_mul_f32 v[126:127], v[126:127], v[48:49]
    v_cvt_pk_bf16_f32 v188, v120, v121
    v_cvt_pk_bf16_f32 v189, v122, v123
    v_cvt_pk_bf16_f32 v190, v124, v125
    v_cvt_pk_bf16_f32 v191, v126, v127
    buffer_store_dwordx4 v[188:191], v238, s[24:27], s42 offen offset:512 sc1
    s_add_u32 s42, s53, 303104
    v_accvgpr_read_b32 v112, a32
    v_accvgpr_read_b32 v113, a33
    v_accvgpr_read_b32 v114, a34
    v_accvgpr_read_b32 v115, a35
    v_accvgpr_read_b32 v116, a36
    v_accvgpr_read_b32 v117, a37
    v_accvgpr_read_b32 v118, a38
    v_accvgpr_read_b32 v119, a39
    v_pk_mul_f32 v[112:113], v[112:113], v[48:49]
    v_pk_mul_f32 v[114:115], v[114:115], v[48:49]
    v_pk_mul_f32 v[116:117], v[116:117], v[48:49]
    v_pk_mul_f32 v[118:119], v[118:119], v[48:49]
    v_cvt_pk_bf16_f32 v176, v112, v113
    v_cvt_pk_bf16_f32 v177, v114, v115
    v_cvt_pk_bf16_f32 v178, v116, v117
    v_cvt_pk_bf16_f32 v179, v118, v119
    buffer_store_dwordx4 v[176:179], v238, s[24:27], s42 offen sc1
    v_accvgpr_read_b32 v120, a40
    v_accvgpr_read_b32 v121, a41
    v_accvgpr_read_b32 v122, a42
    v_accvgpr_read_b32 v123, a43
    v_accvgpr_read_b32 v124, a44
    v_accvgpr_read_b32 v125, a45
    v_accvgpr_read_b32 v126, a46
    v_accvgpr_read_b32 v127, a47
    v_pk_mul_f32 v[120:121], v[120:121], v[48:49]
    v_pk_mul_f32 v[122:123], v[122:123], v[48:49]
    v_pk_mul_f32 v[124:125], v[124:125], v[48:49]
    v_pk_mul_f32 v[126:127], v[126:127], v[48:49]
    v_cvt_pk_bf16_f32 v180, v120, v121
    v_cvt_pk_bf16_f32 v181, v122, v123
    v_cvt_pk_bf16_f32 v182, v124, v125
    v_cvt_pk_bf16_f32 v183, v126, v127
    buffer_store_dwordx4 v[180:183], v238, s[24:27], s42 offen offset:512 sc1
    s_add_u32 s42, s53, 450560
    v_accvgpr_read_b32 v112, a48
    v_accvgpr_read_b32 v113, a49
    v_accvgpr_read_b32 v114, a50
    v_accvgpr_read_b32 v115, a51
    v_accvgpr_read_b32 v116, a52
    v_accvgpr_read_b32 v117, a53
    v_accvgpr_read_b32 v118, a54
    v_accvgpr_read_b32 v119, a55
    v_pk_mul_f32 v[112:113], v[112:113], v[48:49]
    v_pk_mul_f32 v[114:115], v[114:115], v[48:49]
    v_pk_mul_f32 v[116:117], v[116:117], v[48:49]
    v_pk_mul_f32 v[118:119], v[118:119], v[48:49]
    v_cvt_pk_bf16_f32 v184, v112, v113
    v_cvt_pk_bf16_f32 v185, v114, v115
    v_cvt_pk_bf16_f32 v186, v116, v117
    v_cvt_pk_bf16_f32 v187, v118, v119
    buffer_store_dwordx4 v[184:187], v238, s[24:27], s42 offen sc1
    v_accvgpr_read_b32 v120, a56
    v_accvgpr_read_b32 v121, a57
    v_accvgpr_read_b32 v122, a58
    v_accvgpr_read_b32 v123, a59
    v_accvgpr_read_b32 v124, a60
    v_accvgpr_read_b32 v125, a61
    v_accvgpr_read_b32 v126, a62
    v_accvgpr_read_b32 v127, a63
    v_pk_mul_f32 v[120:121], v[120:121], v[48:49]
    v_pk_mul_f32 v[122:123], v[122:123], v[48:49]
    v_pk_mul_f32 v[124:125], v[124:125], v[48:49]
    v_pk_mul_f32 v[126:127], v[126:127], v[48:49]
    v_cvt_pk_bf16_f32 v188, v120, v121
    v_cvt_pk_bf16_f32 v189, v122, v123
    v_cvt_pk_bf16_f32 v190, v124, v125
    v_cvt_pk_bf16_f32 v191, v126, v127
    buffer_store_dwordx4 v[188:191], v238, s[24:27], s42 offen offset:512 sc1
    s_waitcnt lgkmcnt(0)
    s_barrier
    ds_read_b32 v52, v2
    ds_read_b32 v56, v2 offset:128
    ds_read_b32 v53, v2 offset:256
    ds_read_b32 v57, v2 offset:384
    ds_read_b32 v54, v2 offset:512
    ds_read_b32 v58, v2 offset:640
    ds_read_b32 v55, v2 offset:768
    ds_read_b32 v59, v2 offset:896
    ds_write_b128 v254, v[246:249]
    ds_write_b128 v254, v[250:253] offset:1024
    s_waitcnt lgkmcnt(5)
    v_max3_f32 v4, v52, v53, v54
    s_waitcnt lgkmcnt(3)
    v_max_f32 v4, v4, v55
    v_sub_f32 v52, v52, v4
    v_exp_f32 v52, v52
    v_sub_f32 v53, v53, v4
    v_exp_f32 v53, v53
    v_sub_f32 v54, v54, v4
    v_exp_f32 v54, v54
    v_sub_f32 v55, v55, v4
    v_exp_f32 v55, v55
    v_mul_f32 v60, v52, v56
    v_fma_f32 v60, v53, v57, v60
    v_fma_f32 v60, v54, v58, v60
    s_waitcnt lgkmcnt(2)
    v_fma_f32 v60, v55, v59, v60
    v_rcp_f32 v60, v60
    s_nop 0
    v_mul_f32 v60, v60, v54
    v_mov_b32 v61, v60
    v_add_u32 v6, 98304, v245
    v_accvgpr_read_b32 v128, a128
    v_accvgpr_read_b32 v129, a129
    v_accvgpr_read_b32 v130, a130
    v_accvgpr_read_b32 v131, a131
    v_pk_mul_f32 v[128:129], v[128:129], v[60:61]
    v_pk_mul_f32 v[130:131], v[130:131], v[60:61]
    ds_write_b128 v6, v[128:131] offset:4096
    v_accvgpr_read_b32 v132, a132
    v_accvgpr_read_b32 v133, a133
    v_accvgpr_read_b32 v134, a134
    v_accvgpr_read_b32 v135, a135
    v_pk_mul_f32 v[132:133], v[132:133], v[60:61]
    v_pk_mul_f32 v[134:135], v[134:135], v[60:61]
    ds_write_b128 v6, v[132:135] offset:5120
    v_accvgpr_read_b32 v136, a136
    v_accvgpr_read_b32 v137, a137
    v_accvgpr_read_b32 v138, a138
    v_accvgpr_read_b32 v139, a139
    v_pk_mul_f32 v[136:137], v[136:137], v[60:61]
    v_pk_mul_f32 v[138:139], v[138:139], v[60:61]
    ds_write_b128 v6, v[136:139] offset:6144
    v_accvgpr_read_b32 v140, a140
    v_accvgpr_read_b32 v141, a141
    v_accvgpr_read_b32 v142, a142
    v_accvgpr_read_b32 v143, a143
    v_pk_mul_f32 v[140:141], v[140:141], v[60:61]
    v_pk_mul_f32 v[142:143], v[142:143], v[60:61]
    ds_write_b128 v6, v[140:143] offset:7168
    v_accvgpr_read_b32 v128, a144
    v_accvgpr_read_b32 v129, a145
    v_accvgpr_read_b32 v130, a146
    v_accvgpr_read_b32 v131, a147
    v_pk_mul_f32 v[128:129], v[128:129], v[60:61]
    v_pk_mul_f32 v[130:131], v[130:131], v[60:61]
    ds_write_b128 v6, v[128:131] offset:20480
    v_accvgpr_read_b32 v132, a148
    v_accvgpr_read_b32 v133, a149
    v_accvgpr_read_b32 v134, a150
    v_accvgpr_read_b32 v135, a151
    v_pk_mul_f32 v[132:133], v[132:133], v[60:61]
    v_pk_mul_f32 v[134:135], v[134:135], v[60:61]
    ds_write_b128 v6, v[132:135] offset:21504
    v_accvgpr_read_b32 v136, a152
    v_accvgpr_read_b32 v137, a153
    v_accvgpr_read_b32 v138, a154
    v_accvgpr_read_b32 v139, a155
    v_pk_mul_f32 v[136:137], v[136:137], v[60:61]
    v_pk_mul_f32 v[138:139], v[138:139], v[60:61]
    ds_write_b128 v6, v[136:139] offset:22528
    v_accvgpr_read_b32 v140, a156
    v_accvgpr_read_b32 v141, a157
    v_accvgpr_read_b32 v142, a158
    v_accvgpr_read_b32 v143, a159
    v_pk_mul_f32 v[140:141], v[140:141], v[60:61]
    v_pk_mul_f32 v[142:143], v[142:143], v[60:61]
    ds_write_b128 v6, v[140:143] offset:23552
    v_accvgpr_read_b32 v128, a176
    v_accvgpr_read_b32 v129, a177
    v_accvgpr_read_b32 v130, a178
    v_accvgpr_read_b32 v131, a179
    v_pk_mul_f32 v[128:129], v[128:129], v[60:61]
    v_pk_mul_f32 v[130:131], v[130:131], v[60:61]
    ds_write_b128 v6, v[128:131] offset:45056
    v_accvgpr_read_b32 v132, a180
    v_accvgpr_read_b32 v133, a181
    v_accvgpr_read_b32 v134, a182
    v_accvgpr_read_b32 v135, a183
    v_pk_mul_f32 v[132:133], v[132:133], v[60:61]
    v_pk_mul_f32 v[134:135], v[134:135], v[60:61]
    ds_write_b128 v6, v[132:135] offset:46080
    v_accvgpr_read_b32 v136, a184
    v_accvgpr_read_b32 v137, a185
    v_accvgpr_read_b32 v138, a186
    v_accvgpr_read_b32 v139, a187
    v_pk_mul_f32 v[136:137], v[136:137], v[60:61]
    v_pk_mul_f32 v[138:139], v[138:139], v[60:61]
    ds_write_b128 v6, v[136:139] offset:47104
    v_accvgpr_read_b32 v140, a188
    v_accvgpr_read_b32 v141, a189
    v_accvgpr_read_b32 v142, a190
    v_accvgpr_read_b32 v143, a191
    v_pk_mul_f32 v[140:141], v[140:141], v[60:61]
    v_pk_mul_f32 v[142:143], v[142:143], v[60:61]
    ds_write_b128 v6, v[140:143] offset:48128
    v_accvgpr_read_b32 v64, a160
    v_accvgpr_read_b32 v65, a161
    v_accvgpr_read_b32 v66, a162
    v_accvgpr_read_b32 v67, a163
    v_pk_mul_f32 v[64:65], v[64:65], v[60:61]
    v_pk_mul_f32 v[66:67], v[66:67], v[60:61]
    v_accvgpr_read_b32 v68, a164
    v_accvgpr_read_b32 v69, a165
    v_accvgpr_read_b32 v70, a166
    v_accvgpr_read_b32 v71, a167
    v_pk_mul_f32 v[68:69], v[68:69], v[60:61]
    v_pk_mul_f32 v[70:71], v[70:71], v[60:61]
    v_accvgpr_read_b32 v72, a168
    v_accvgpr_read_b32 v73, a169
    v_accvgpr_read_b32 v74, a170
    v_accvgpr_read_b32 v75, a171
    v_pk_mul_f32 v[72:73], v[72:73], v[60:61]
    v_pk_mul_f32 v[74:75], v[74:75], v[60:61]
    v_accvgpr_read_b32 v76, a172
    v_accvgpr_read_b32 v77, a173
    v_accvgpr_read_b32 v78, a174
    v_accvgpr_read_b32 v79, a175
    v_pk_mul_f32 v[76:77], v[76:77], v[60:61]
    v_pk_mul_f32 v[78:79], v[78:79], v[60:61]
    s_waitcnt lgkmcnt(0)
    s_barrier
    ds_read_b128 v[128:131], v6 offset:24576
    ds_read_b128 v[132:135], v6 offset:25600
    ds_read_b128 v[136:139], v6 offset:26624
    ds_read_b128 v[140:143], v6 offset:27648
    ds_read_b128 v[144:147], v6 offset:28672
    ds_read_b128 v[148:151], v6 offset:29696
    ds_read_b128 v[152:155], v6 offset:30720
    ds_read_b128 v[156:159], v6 offset:31744
    ds_read_b128 v[160:163], v6 offset:40960
    ds_read_b128 v[164:167], v6 offset:41984
    ds_read_b128 v[168:171], v6 offset:43008
    ds_read_b128 v[172:175], v6 offset:44032
    s_add_u32 s42, s53, 10240
    v_accvgpr_read_b32 v112, a64
    v_accvgpr_read_b32 v113, a65
    v_accvgpr_read_b32 v114, a66
    v_accvgpr_read_b32 v115, a67
    v_accvgpr_read_b32 v116, a68
    v_accvgpr_read_b32 v117, a69
    v_accvgpr_read_b32 v118, a70
    v_accvgpr_read_b32 v119, a71
    v_pk_mul_f32 v[112:113], v[112:113], v[50:51]
    v_pk_mul_f32 v[114:115], v[114:115], v[50:51]
    v_pk_mul_f32 v[116:117], v[116:117], v[50:51]
    v_pk_mul_f32 v[118:119], v[118:119], v[50:51]
    v_cvt_pk_bf16_f32 v176, v112, v113
    v_cvt_pk_bf16_f32 v177, v114, v115
    v_cvt_pk_bf16_f32 v178, v116, v117
    v_cvt_pk_bf16_f32 v179, v118, v119
    buffer_store_dwordx4 v[176:179], v238, s[24:27], s42 offen sc1
    v_accvgpr_read_b32 v120, a72
    v_accvgpr_read_b32 v121, a73
    v_accvgpr_read_b32 v122, a74
    v_accvgpr_read_b32 v123, a75
    v_accvgpr_read_b32 v124, a76
    v_accvgpr_read_b32 v125, a77
    v_accvgpr_read_b32 v126, a78
    v_accvgpr_read_b32 v127, a79
    v_pk_mul_f32 v[120:121], v[120:121], v[50:51]
    v_pk_mul_f32 v[122:123], v[122:123], v[50:51]
    v_pk_mul_f32 v[124:125], v[124:125], v[50:51]
    v_pk_mul_f32 v[126:127], v[126:127], v[50:51]
    v_cvt_pk_bf16_f32 v180, v120, v121
    v_cvt_pk_bf16_f32 v181, v122, v123
    v_cvt_pk_bf16_f32 v182, v124, v125
    v_cvt_pk_bf16_f32 v183, v126, v127
    buffer_store_dwordx4 v[180:183], v238, s[24:27], s42 offen offset:512 sc1
    s_add_u32 s42, s53, 157696
    v_accvgpr_read_b32 v112, a80
    v_accvgpr_read_b32 v113, a81
    v_accvgpr_read_b32 v114, a82
    v_accvgpr_read_b32 v115, a83
    v_accvgpr_read_b32 v116, a84
    v_accvgpr_read_b32 v117, a85
    v_accvgpr_read_b32 v118, a86
    v_accvgpr_read_b32 v119, a87
    v_pk_mul_f32 v[112:113], v[112:113], v[50:51]
    v_pk_mul_f32 v[114:115], v[114:115], v[50:51]
    v_pk_mul_f32 v[116:117], v[116:117], v[50:51]
    v_pk_mul_f32 v[118:119], v[118:119], v[50:51]
    v_cvt_pk_bf16_f32 v184, v112, v113
    v_cvt_pk_bf16_f32 v185, v114, v115
    v_cvt_pk_bf16_f32 v186, v116, v117
    v_cvt_pk_bf16_f32 v187, v118, v119
    buffer_store_dwordx4 v[184:187], v238, s[24:27], s42 offen sc1
    v_accvgpr_read_b32 v120, a88
    v_accvgpr_read_b32 v121, a89
    v_accvgpr_read_b32 v122, a90
    v_accvgpr_read_b32 v123, a91
    v_accvgpr_read_b32 v124, a92
    v_accvgpr_read_b32 v125, a93
    v_accvgpr_read_b32 v126, a94
    v_accvgpr_read_b32 v127, a95
    v_pk_mul_f32 v[120:121], v[120:121], v[50:51]
    v_pk_mul_f32 v[122:123], v[122:123], v[50:51]
    v_pk_mul_f32 v[124:125], v[124:125], v[50:51]
    v_pk_mul_f32 v[126:127], v[126:127], v[50:51]
    v_cvt_pk_bf16_f32 v188, v120, v121
    v_cvt_pk_bf16_f32 v189, v122, v123
    v_cvt_pk_bf16_f32 v190, v124, v125
    v_cvt_pk_bf16_f32 v191, v126, v127
    buffer_store_dwordx4 v[188:191], v238, s[24:27], s42 offen offset:512 sc1
    s_add_u32 s42, s53, 305152
    v_accvgpr_read_b32 v112, a96
    v_accvgpr_read_b32 v113, a97
    v_accvgpr_read_b32 v114, a98
    v_accvgpr_read_b32 v115, a99
    v_accvgpr_read_b32 v116, a100
    v_accvgpr_read_b32 v117, a101
    v_accvgpr_read_b32 v118, a102
    v_accvgpr_read_b32 v119, a103
    v_pk_mul_f32 v[112:113], v[112:113], v[50:51]
    v_pk_mul_f32 v[114:115], v[114:115], v[50:51]
    v_pk_mul_f32 v[116:117], v[116:117], v[50:51]
    v_pk_mul_f32 v[118:119], v[118:119], v[50:51]
    v_cvt_pk_bf16_f32 v176, v112, v113
    v_cvt_pk_bf16_f32 v177, v114, v115
    v_cvt_pk_bf16_f32 v178, v116, v117
    v_cvt_pk_bf16_f32 v179, v118, v119
    buffer_store_dwordx4 v[176:179], v238, s[24:27], s42 offen sc1
    v_accvgpr_read_b32 v120, a104
    v_accvgpr_read_b32 v121, a105
    v_accvgpr_read_b32 v122, a106
    v_accvgpr_read_b32 v123, a107
    v_accvgpr_read_b32 v124, a108
    v_accvgpr_read_b32 v125, a109
    v_accvgpr_read_b32 v126, a110
    v_accvgpr_read_b32 v127, a111
    v_pk_mul_f32 v[120:121], v[120:121], v[50:51]
    v_pk_mul_f32 v[122:123], v[122:123], v[50:51]
    v_pk_mul_f32 v[124:125], v[124:125], v[50:51]
    v_pk_mul_f32 v[126:127], v[126:127], v[50:51]
    v_cvt_pk_bf16_f32 v180, v120, v121
    v_cvt_pk_bf16_f32 v181, v122, v123
    v_cvt_pk_bf16_f32 v182, v124, v125
    v_cvt_pk_bf16_f32 v183, v126, v127
    buffer_store_dwordx4 v[180:183], v238, s[24:27], s42 offen offset:512 sc1
    s_add_u32 s42, s53, 452608
    v_accvgpr_read_b32 v112, a112
    v_accvgpr_read_b32 v113, a113
    v_accvgpr_read_b32 v114, a114
    v_accvgpr_read_b32 v115, a115
    v_accvgpr_read_b32 v116, a116
    v_accvgpr_read_b32 v117, a117
    v_accvgpr_read_b32 v118, a118
    v_accvgpr_read_b32 v119, a119
    v_pk_mul_f32 v[112:113], v[112:113], v[50:51]
    v_pk_mul_f32 v[114:115], v[114:115], v[50:51]
    v_pk_mul_f32 v[116:117], v[116:117], v[50:51]
    v_pk_mul_f32 v[118:119], v[118:119], v[50:51]
    v_cvt_pk_bf16_f32 v184, v112, v113
    v_cvt_pk_bf16_f32 v185, v114, v115
    v_cvt_pk_bf16_f32 v186, v116, v117
    v_cvt_pk_bf16_f32 v187, v118, v119
    buffer_store_dwordx4 v[184:187], v238, s[24:27], s42 offen sc1
    v_accvgpr_read_b32 v120, a120
    v_accvgpr_read_b32 v121, a121
    v_accvgpr_read_b32 v122, a122
    v_accvgpr_read_b32 v123, a123
    v_accvgpr_read_b32 v124, a124
    v_accvgpr_read_b32 v125, a125
    v_accvgpr_read_b32 v126, a126
    v_accvgpr_read_b32 v127, a127
    v_pk_mul_f32 v[120:121], v[120:121], v[50:51]
    v_pk_mul_f32 v[122:123], v[122:123], v[50:51]
    v_pk_mul_f32 v[124:125], v[124:125], v[50:51]
    v_pk_mul_f32 v[126:127], v[126:127], v[50:51]
    v_cvt_pk_bf16_f32 v188, v120, v121
    v_cvt_pk_bf16_f32 v189, v122, v123
    v_cvt_pk_bf16_f32 v190, v124, v125
    v_cvt_pk_bf16_f32 v191, v126, v127
    buffer_store_dwordx4 v[188:191], v238, s[24:27], s42 offen offset:512 sc1
    s_waitcnt lgkmcnt(11)
    v_pk_add_f32 v[64:65], v[64:65], v[128:129]
    v_pk_add_f32 v[66:67], v[66:67], v[130:131]
    s_waitcnt lgkmcnt(10)
    v_pk_add_f32 v[68:69], v[68:69], v[132:133]
    v_pk_add_f32 v[70:71], v[70:71], v[134:135]
    s_waitcnt lgkmcnt(9)
    v_pk_add_f32 v[72:73], v[72:73], v[136:137]
    v_pk_add_f32 v[74:75], v[74:75], v[138:139]
    s_waitcnt lgkmcnt(8)
    v_pk_add_f32 v[76:77], v[76:77], v[140:141]
    v_pk_add_f32 v[78:79], v[78:79], v[142:143]
    s_waitcnt lgkmcnt(7)
    v_pk_add_f32 v[64:65], v[64:65], v[144:145]
    v_pk_add_f32 v[66:67], v[66:67], v[146:147]
    s_waitcnt lgkmcnt(6)
    v_pk_add_f32 v[68:69], v[68:69], v[148:149]
    v_pk_add_f32 v[70:71], v[70:71], v[150:151]
    s_waitcnt lgkmcnt(5)
    v_pk_add_f32 v[72:73], v[72:73], v[152:153]
    v_pk_add_f32 v[74:75], v[74:75], v[154:155]
    s_waitcnt lgkmcnt(4)
    v_pk_add_f32 v[76:77], v[76:77], v[156:157]
    v_pk_add_f32 v[78:79], v[78:79], v[158:159]
    s_waitcnt lgkmcnt(3)
    v_pk_add_f32 v[64:65], v[64:65], v[160:161]
    v_pk_add_f32 v[66:67], v[66:67], v[162:163]
    s_waitcnt lgkmcnt(2)
    v_pk_add_f32 v[68:69], v[68:69], v[164:165]
    v_pk_add_f32 v[70:71], v[70:71], v[166:167]
    s_waitcnt lgkmcnt(1)
    v_pk_add_f32 v[72:73], v[72:73], v[168:169]
    v_pk_add_f32 v[74:75], v[74:75], v[170:171]
    s_waitcnt lgkmcnt(0)
    v_pk_add_f32 v[76:77], v[76:77], v[172:173]
    v_pk_add_f32 v[78:79], v[78:79], v[174:175]
    s_waitcnt lgkmcnt(0)
    s_barrier
    s_add_u32 s42, s53, 311296
    v_cvt_pk_bf16_f32 v192, v64, v65
    v_cvt_pk_bf16_f32 v193, v66, v67
    v_cvt_pk_bf16_f32 v194, v68, v69
    v_cvt_pk_bf16_f32 v195, v70, v71
    buffer_store_dwordx4 v[192:195], v238, s[24:27], s42 offen sc1
    v_cvt_pk_bf16_f32 v196, v72, v73
    v_cvt_pk_bf16_f32 v197, v74, v75
    v_cvt_pk_bf16_f32 v198, v76, v77
    v_cvt_pk_bf16_f32 v199, v78, v79
    buffer_store_dwordx4 v[196:199], v238, s[24:27], s42 offen offset:512 sc1
    s_add_u32 s53, s53, 589824
    s_add_u32 s4, s4, 1
    s_cmp_lt_u32 s4, 2
    s_cbranch_scc1 W2_ITEM
    s_branch K1_END
WAVE3:
W3_ITEM:
    v_mov_b32 v239, 0
    v_mov_b32 v240, 0
    v_mov_b32 v241, 0
    s_waitcnt vmcnt(31)
    v_mfma_f32_32x32x16_bf16 v[48:63], a[192:195], v[24:27], 0
    s_waitcnt vmcnt(30)
    v_mfma_f32_32x32x16_bf16 v[48:63], a[196:199], v[28:31], v[48:63]
    s_waitcnt vmcnt(29)
    v_mfma_f32_32x32x16_bf16 v[48:63], a[200:203], v[32:35], v[48:63]
    s_waitcnt vmcnt(28)
    v_mfma_f32_32x32x16_bf16 v[48:63], a[204:207], v[36:39], v[48:63]
    s_waitcnt vmcnt(27)
    v_mfma_f32_32x32x16_bf16 v[48:63], a[208:211], v[40:43], v[48:63]
    s_waitcnt vmcnt(26)
    v_mfma_f32_32x32x16_bf16 v[48:63], a[212:215], v[44:47], v[48:63]
    s_add_u32 m0, s38, s82
    v_mfma_f32_32x32x16_bf16 v[48:63], a[216:219], v[16:19], v[48:63]
    buffer_load_dwordx4 v232, s[16:19], s36 offen nt lds
    v_mfma_f32_32x32x16_bf16 v[48:63], a[220:223], v[20:23], v[48:63]
    s_nop 11
    v_max3_f32 v2, v48, v49, v50
    v_max3_f32 v2, v2, v51, v52
    v_max3_f32 v2, v2, v53, v54
    v_max3_f32 v2, v2, v55, v56
    v_max3_f32 v2, v2, v57, v58
    v_max3_f32 v2, v2, v59, v60
    v_max3_f32 v2, v2, v61, v62
    v_max_f32 v2, v2, v63
    v_mov_b32 v3, v2
    s_nop 1
    v_permlane32_swap_b32 v2, v3
    v_max_f32 v2, v2, v3
    v_sub_f32 v64, 0, v2
    v_sub_f32 v65, 0, v2
    v_sub_f32 v66, 0, v2
    v_sub_f32 v67, 0, v2
    v_sub_f32 v68, 0, v2
    v_sub_f32 v69, 0, v2
    v_sub_f32 v70, 0, v2
    v_sub_f32 v71, 0, v2
    v_sub_f32 v72, 0, v2
    v_sub_f32 v73, 0, v2
    v_sub_f32 v74, 0, v2
    v_sub_f32 v75, 0, v2
    v_sub_f32 v76, 0, v2
    v_sub_f32 v77, 0, v2
    v_sub_f32 v78, 0, v2
    v_sub_f32 v79, 0, v2
    v_sub_f32 v48, v48, v2
    v_sub_f32 v49, v49, v2
    v_sub_f32 v50, v50, v2
    v_sub_f32 v51, v51, v2
    v_sub_f32 v52, v52, v2
    v_sub_f32 v53, v53, v2
    v_sub_f32 v54, v54, v2
    v_sub_f32 v55, v55, v2
    v_sub_f32 v56, v56, v2
    v_sub_f32 v57, v57, v2
    v_sub_f32 v58, v58, v2
    v_sub_f32 v59, v59, v2
    v_sub_f32 v60, v60, v2
    v_sub_f32 v61, v61, v2
    v_sub_f32 v62, v62, v2
    v_sub_f32 v63, v63, v2
    buffer_load_dwordx4 v233, s[16:19], s36 offen offset:1024 nt lds
    v_exp_f32 v196, v48
    v_exp_f32 v197, v49
    v_exp_f32 v198, v50
    v_add_f32 v242, v196, v197
    v_cvt_pk_bf16_f32 v160, v196, v197
    s_waitcnt vmcnt(25)
    v_mfma_f32_32x32x16_bf16 v[112:127], a[192:195], v[88:91], 0
    v_exp_f32 v199, v51
    v_add_f32 v242, v242, v198
    s_waitcnt vmcnt(24)
    v_mfma_f32_32x32x16_bf16 v[112:127], a[196:199], v[92:95], v[112:127]
    ds_read_b128 a[192:195], v220 offset:8192
    v_exp_f32 v196, v52
    v_add_f32 v242, v242, v199
    v_cvt_pk_bf16_f32 v161, v198, v199
    s_waitcnt vmcnt(23)
    v_mfma_f32_32x32x16_bf16 v[112:127], a[200:203], v[96:99], v[112:127]
    ds_read_b128 a[196:199], v221 offset:8192
    v_exp_f32 v197, v53
    v_add_f32 v242, v242, v196
    s_waitcnt vmcnt(22)
    v_mfma_f32_32x32x16_bf16 v[112:127], a[204:207], v[100:103], v[112:127]
    ds_read_b128 a[200:203], v222 offset:8192
    v_exp_f32 v198, v54
    v_add_f32 v242, v242, v197
    v_cvt_pk_bf16_f32 v162, v196, v197
    s_waitcnt vmcnt(21)
    v_mfma_f32_32x32x16_bf16 v[112:127], a[208:211], v[104:107], v[112:127]
    ds_read_b128 a[204:207], v223 offset:8192
    buffer_load_dwordx4 v234, s[16:19], s36 offen offset:2048 nt lds
    v_exp_f32 v199, v55
    v_add_f32 v242, v242, v198
    s_waitcnt vmcnt(21)
    v_mfma_f32_32x32x16_bf16 v[112:127], a[212:215], v[108:111], v[112:127]
    ds_read_b128 a[208:211], v224 offset:8192
    v_exp_f32 v196, v56
    v_add_f32 v242, v242, v199
    v_cvt_pk_bf16_f32 v163, v198, v199
    v_mfma_f32_32x32x16_bf16 v[112:127], a[216:219], v[80:83], v[112:127]
    ds_read_b128 a[212:215], v225 offset:8192
    v_exp_f32 v197, v57
    v_add_f32 v242, v242, v196
    v_mfma_f32_32x32x16_bf16 v[112:127], a[220:223], v[84:87], v[112:127]
    ds_read_b128 a[216:219], v226 offset:8192
    v_exp_f32 v198, v58
    v_add_f32 v242, v242, v197
    v_cvt_pk_bf16_f32 v164, v196, v197
    ds_read_b128 a[220:223], v227 offset:8192
    v_exp_f32 v199, v59
    v_add_f32 v242, v242, v198
    ds_read_b64_tr_b16 a[224:225], v228 offset:24576
    ds_read_b64_tr_b16 a[226:227], v228 offset:26624
    v_exp_f32 v196, v60
    v_add_f32 v242, v242, v199
    v_cvt_pk_bf16_f32 v165, v198, v199
    ds_read_b64_tr_b16 a[228:229], v229 offset:24576
    ds_read_b64_tr_b16 a[230:231], v229 offset:26624
    v_exp_f32 v197, v61
    v_add_f32 v242, v242, v196
    ds_read_b64_tr_b16 a[232:233], v230 offset:24576
    ds_read_b64_tr_b16 a[234:235], v230 offset:26624
    buffer_load_dwordx4 v235, s[16:19], s36 offen offset:3072 nt lds
    v_exp_f32 v198, v62
    v_add_f32 v242, v242, v197
    v_cvt_pk_bf16_f32 v166, v196, v197
    ds_read_b64_tr_b16 a[236:237], v231 offset:24576
    ds_read_b64_tr_b16 a[238:239], v231 offset:26624
    v_exp_f32 v199, v63
    v_add_f32 v242, v242, v198
    v_max3_f32 v2, v112, v113, v114
    v_max3_f32 v2, v2, v115, v116
    v_max3_f32 v2, v2, v117, v118
    v_max3_f32 v2, v2, v119, v120
    v_max3_f32 v2, v2, v121, v122
    v_max3_f32 v2, v2, v123, v124
    v_max3_f32 v2, v2, v125, v126
    v_max_f32 v2, v2, v127
    v_mov_b32 v3, v2
    s_nop 1
    v_permlane32_swap_b32 v2, v3
    v_max_f32 v2, v2, v3
    v_sub_f32 v128, 0, v2
    v_sub_f32 v129, 0, v2
    v_sub_f32 v130, 0, v2
    v_sub_f32 v131, 0, v2
    v_sub_f32 v132, 0, v2
    v_sub_f32 v133, 0, v2
    v_sub_f32 v134, 0, v2
    v_sub_f32 v135, 0, v2
    v_sub_f32 v136, 0, v2
    v_sub_f32 v137, 0, v2
    v_sub_f32 v138, 0, v2
    v_sub_f32 v139, 0, v2
    v_sub_f32 v140, 0, v2
    v_sub_f32 v141, 0, v2
    v_sub_f32 v142, 0, v2
    v_sub_f32 v143, 0, v2
    v_sub_f32 v112, v112, v2
    v_sub_f32 v113, v113, v2
    v_sub_f32 v114, v114, v2
    v_sub_f32 v115, v115, v2
    v_sub_f32 v116, v116, v2
    v_sub_f32 v117, v117, v2
    v_sub_f32 v118, v118, v2
    v_sub_f32 v119, v119, v2
    v_sub_f32 v120, v120, v2
    v_sub_f32 v121, v121, v2
    v_sub_f32 v122, v122, v2
    v_sub_f32 v123, v123, v2
    v_sub_f32 v124, v124, v2
    v_sub_f32 v125, v125, v2
    v_sub_f32 v126, v126, v2
    v_sub_f32 v127, v127, v2
    ds_read_b64_tr_b16 a[240:241], v228 offset:28672
    ds_read_b64_tr_b16 a[242:243], v228 offset:30720
    s_add_u32 s36, s36, 16384
    v_add_f32 v242, v242, v199
    v_cvt_pk_bf16_f32 v167, v198, v199
    v_cmp_lt_f32 vcc, s35, v242
    v_exp_f32 v196, v112
    ds_read_b64_tr_b16 a[244:245], v229 offset:28672
    ds_read_b64_tr_b16 a[246:247], v229 offset:30720
    v_exp_f32 v197, v113
    ds_read_b64_tr_b16 a[248:249], v230 offset:28672
    ds_read_b64_tr_b16 a[250:251], v230 offset:30720
    s_cbranch_vccnz FX55
FX55_RET:
    v_add_f32 v239, v239, v242
    v_exp_f32 v198, v114
    v_add_f32 v243, v196, v197
    v_cvt_pk_bf16_f32 v168, v196, v197
    s_waitcnt lgkmcnt(14)
    v_mfma_f32_32x32x16_bf16 v[48:63], a[192:195], v[24:27], v[64:79]
    ds_read_b64_tr_b16 a[252:253], v231 offset:28672
    ds_read_b64_tr_b16 a[254:255], v231 offset:30720
    v_exp_f32 v199, v115
    v_add_f32 v243, v243, v198
    v_accvgpr_write_b32 a128, 0
    v_accvgpr_write_b32 a129, 0
    v_mfma_f32_32x32x16_bf16 v[48:63], a[196:199], v[28:31], v[48:63]
    s_add_u32 m0, s38, s86
    v_exp_f32 v196, v116
    v_add_f32 v243, v243, v199
    v_cvt_pk_bf16_f32 v169, v198, v199
    v_accvgpr_write_b32 a130, 0
    v_accvgpr_write_b32 a131, 0
    v_mfma_f32_32x32x16_bf16 v[48:63], a[200:203], v[32:35], v[48:63]
    v_exp_f32 v197, v117
    v_add_f32 v243, v243, v196
    v_accvgpr_write_b32 a132, 0
    v_accvgpr_write_b32 a133, 0
    v_mfma_f32_32x32x16_bf16 v[48:63], a[204:207], v[36:39], v[48:63]
    v_exp_f32 v198, v118
    v_add_f32 v243, v243, v197
    v_cvt_pk_bf16_f32 v170, v196, v197
    v_accvgpr_write_b32 a134, 0
    v_accvgpr_write_b32 a135, 0
    v_mfma_f32_32x32x16_bf16 v[48:63], a[208:211], v[40:43], v[48:63]
    buffer_load_dwordx4 v236, s[20:23], s37 offen nt lds
    v_exp_f32 v199, v119
    v_add_f32 v243, v243, v198
    v_accvgpr_write_b32 a136, 0
    v_accvgpr_write_b32 a137, 0
    v_mfma_f32_32x32x16_bf16 v[48:63], a[212:215], v[44:47], v[48:63]
    v_exp_f32 v196, v120
    v_add_f32 v243, v243, v199
    v_cvt_pk_bf16_f32 v171, v198, v199
    v_accvgpr_write_b32 a138, 0
    v_accvgpr_write_b32 a139, 0
    v_mfma_f32_32x32x16_bf16 v[48:63], a[216:219], v[16:19], v[48:63]
    v_exp_f32 v197, v121
    v_add_f32 v243, v243, v196
    v_accvgpr_write_b32 a140, 0
    v_accvgpr_write_b32 a141, 0
    v_mfma_f32_32x32x16_bf16 v[48:63], a[220:223], v[20:23], v[48:63]
    buffer_load_dwordx4 v236, s[20:23], s37 offen offset:1024 nt lds
    v_exp_f32 v198, v122
    v_add_f32 v243, v243, v197
    v_cvt_pk_bf16_f32 v172, v196, v197
    v_accvgpr_write_b32 a142, 0
    v_accvgpr_write_b32 a143, 0
    s_waitcnt lgkmcnt(0)
    v_mfma_f32_32x32x16_bf16 a[0:15], a[224:227], v[160:163], 0
    v_exp_f32 v199, v123
    v_add_f32 v243, v243, v198
    v_accvgpr_write_b32 a144, 0
    v_accvgpr_write_b32 a145, 0
    v_mfma_f32_32x32x16_bf16 a[16:31], a[228:231], v[160:163], 0
    v_exp_f32 v196, v124
    v_add_f32 v243, v243, v199
    v_cvt_pk_bf16_f32 v173, v198, v199
    v_accvgpr_write_b32 a146, 0
    v_accvgpr_write_b32 a147, 0
    v_mfma_f32_32x32x16_bf16 a[32:47], a[232:235], v[160:163], 0
    buffer_load_dwordx4 v236, s[20:23], s37 offen offset:2048 nt lds
    v_exp_f32 v197, v125
    v_add_f32 v243, v243, v196
    v_accvgpr_write_b32 a148, 0
    v_accvgpr_write_b32 a149, 0
    v_mfma_f32_32x32x16_bf16 a[48:63], a[236:239], v[160:163], 0
    v_exp_f32 v198, v126
    v_add_f32 v243, v243, v197
    v_cvt_pk_bf16_f32 v174, v196, v197
    v_accvgpr_write_b32 a150, 0
    v_accvgpr_write_b32 a151, 0
    v_mfma_f32_32x32x16_bf16 a[0:15], a[240:243], v[164:167], a[0:15]
    v_exp_f32 v199, v127
    v_add_f32 v243, v243, v198
    v_accvgpr_write_b32 a152, 0
    v_accvgpr_write_b32 a153, 0
    v_mfma_f32_32x32x16_bf16 a[16:31], a[244:247], v[164:167], a[16:31]
    buffer_load_dwordx4 v236, s[20:23], s37 offen offset:3072 nt lds
    v_add_f32 v243, v243, v199
    v_cvt_pk_bf16_f32 v175, v198, v199
    v_cmp_lt_f32 vcc, s35, v243
    v_exp_f32 v196, v48
    v_accvgpr_write_b32 a154, 0
    v_accvgpr_write_b32 a155, 0
    v_mfma_f32_32x32x16_bf16 a[32:47], a[248:251], v[164:167], a[32:47]
    s_add_u32 s37, s37, 16384
    v_exp_f32 v197, v49
    v_accvgpr_write_b32 a156, 0
    v_accvgpr_write_b32 a157, 0
    v_mfma_f32_32x32x16_bf16 a[48:63], a[252:255], v[164:167], a[48:63]
    s_add_u32 s38, s38, 32768
    s_and_b32 s38, s38, 131071
    s_cbranch_vccnz FX56
FX56_RET:
    v_add_f32 v240, v240, v243
    v_exp_f32 v198, v50
    v_add_f32 v242, v196, v197
    v_cvt_pk_bf16_f32 v160, v196, v197
    v_accvgpr_write_b32 a158, 0
    v_accvgpr_write_b32 a159, 0
    v_mfma_f32_32x32x16_bf16 v[112:127], a[192:195], v[88:91], v[128:143]
    v_exp_f32 v199, v51
    v_add_f32 v242, v242, v198
    v_accvgpr_write_b32 a160, 0
    v_accvgpr_write_b32 a161, 0
    v_mfma_f32_32x32x16_bf16 v[112:127], a[196:199], v[92:95], v[112:127]
    v_exp_f32 v196, v52
    v_add_f32 v242, v242, v199
    v_cvt_pk_bf16_f32 v161, v198, v199
    s_waitcnt vmcnt(16)
    s_barrier
    ds_read_b128 a[192:195], v220 offset:32768
    v_accvgpr_write_b32 a162, 0
    v_accvgpr_write_b32 a163, 0
    v_mfma_f32_32x32x16_bf16 v[112:127], a[200:203], v[96:99], v[112:127]
    ds_read_b128 a[196:199], v221 offset:32768
    v_exp_f32 v197, v53
    v_add_f32 v242, v242, v196
    v_accvgpr_write_b32 a164, 0
    v_accvgpr_write_b32 a165, 0
    v_mfma_f32_32x32x16_bf16 v[112:127], a[204:207], v[100:103], v[112:127]
    ds_read_b128 a[200:203], v222 offset:32768
    v_exp_f32 v198, v54
    v_add_f32 v242, v242, v197
    v_cvt_pk_bf16_f32 v162, v196, v197
    v_accvgpr_write_b32 a166, 0
    v_accvgpr_write_b32 a167, 0
    v_mfma_f32_32x32x16_bf16 v[112:127], a[208:211], v[104:107], v[112:127]
    ds_read_b128 a[204:207], v223 offset:32768
    v_exp_f32 v199, v55
    v_add_f32 v242, v242, v198
    v_accvgpr_write_b32 a168, 0
    v_accvgpr_write_b32 a169, 0
    v_mfma_f32_32x32x16_bf16 v[112:127], a[212:215], v[108:111], v[112:127]
    ds_read_b128 a[208:211], v224 offset:32768
    v_exp_f32 v196, v56
    v_add_f32 v242, v242, v199
    v_cvt_pk_bf16_f32 v163, v198, v199
    v_accvgpr_write_b32 a170, 0
    v_accvgpr_write_b32 a171, 0
    v_mfma_f32_32x32x16_bf16 v[112:127], a[216:219], v[80:83], v[112:127]
    ds_read_b128 a[212:215], v225 offset:32768
    v_exp_f32 v197, v57
    v_add_f32 v242, v242, v196
    v_accvgpr_write_b32 a172, 0
    v_accvgpr_write_b32 a173, 0
    v_mfma_f32_32x32x16_bf16 v[112:127], a[220:223], v[84:87], v[112:127]
    ds_read_b128 a[216:219], v226 offset:32768
    v_exp_f32 v198, v58
    v_add_f32 v242, v242, v197
    v_cvt_pk_bf16_f32 v164, v196, v197
    v_accvgpr_write_b32 a174, 0
    v_accvgpr_write_b32 a175, 0
    v_mfma_f32_32x32x16_bf16 a[64:79], a[224:227], v[168:171], 0
    ds_read_b128 a[220:223], v227 offset:32768
    v_exp_f32 v199, v59
    v_add_f32 v242, v242, v198
    v_accvgpr_write_b32 a176, 0
    v_accvgpr_write_b32 a177, 0
    v_mfma_f32_32x32x16_bf16 a[80:95], a[228:231], v[168:171], 0
    ds_read_b64_tr_b16 a[224:225], v228 offset:49152
    ds_read_b64_tr_b16 a[226:227], v228 offset:51200
    v_exp_f32 v196, v60
    v_add_f32 v242, v242, v199
    v_cvt_pk_bf16_f32 v165, v198, v199
    v_accvgpr_write_b32 a178, 0
    v_accvgpr_write_b32 a179, 0
    v_mfma_f32_32x32x16_bf16 a[96:111], a[232:235], v[168:171], 0
    ds_read_b64_tr_b16 a[228:229], v229 offset:49152
    ds_read_b64_tr_b16 a[230:231], v229 offset:51200
    v_exp_f32 v197, v61
    v_add_f32 v242, v242, v196
    v_accvgpr_write_b32 a180, 0
    v_accvgpr_write_b32 a181, 0
    v_mfma_f32_32x32x16_bf16 a[112:127], a[236:239], v[168:171], 0
    ds_read_b64_tr_b16 a[232:233], v230 offset:49152
    ds_read_b64_tr_b16 a[234:235], v230 offset:51200
    v_exp_f32 v198, v62
    v_add_f32 v242, v242, v197
    v_cvt_pk_bf16_f32 v166, v196, v197
    v_accvgpr_write_b32 a182, 0
    v_accvgpr_write_b32 a183, 0
    v_mfma_f32_32x32x16_bf16 a[64:79], a[240:243], v[172:175], a[64:79]
    ds_read_b64_tr_b16 a[236:237], v231 offset:49152
    ds_read_b64_tr_b16 a[238:239], v231 offset:51200
    v_exp_f32 v199, v63
    v_add_f32 v242, v242, v198
    v_accvgpr_write_b32 a184, 0
    v_accvgpr_write_b32 a185, 0
    v_mfma_f32_32x32x16_bf16 a[80:95], a[244:247], v[172:175], a[80:95]
    ds_read_b64_tr_b16 a[240:241], v228 offset:53248
    ds_read_b64_tr_b16 a[242:243], v228 offset:55296
    v_add_f32 v242, v242, v199
    v_cvt_pk_bf16_f32 v167, v198, v199
    v_cmp_lt_f32 vcc, s35, v242
    v_exp_f32 v196, v112
    v_accvgpr_write_b32 a186, 0
    v_accvgpr_write_b32 a187, 0
    v_mfma_f32_32x32x16_bf16 a[96:111], a[248:251], v[172:175], a[96:111]
    ds_read_b64_tr_b16 a[244:245], v229 offset:53248
    ds_read_b64_tr_b16 a[246:247], v229 offset:55296
    v_exp_f32 v197, v113
    v_accvgpr_write_b32 a188, 0
    v_accvgpr_write_b32 a189, 0
    v_mfma_f32_32x32x16_bf16 a[112:127], a[252:255], v[172:175], a[112:127]
    ds_read_b64_tr_b16 a[248:249], v230 offset:53248
    ds_read_b64_tr_b16 a[250:251], v230 offset:55296
    s_cbranch_vccnz FX57
FX57_RET:
    v_add_f32 v239, v239, v242
    v_exp_f32 v198, v114
    v_add_f32 v243, v196, v197
    v_cvt_pk_bf16_f32 v168, v196, v197
    v_accvgpr_write_b32 a190, 0
    v_accvgpr_write_b32 a191, 0
    s_waitcnt lgkmcnt(14)
    v_mfma_f32_32x32x16_bf16 v[48:63], a[192:195], v[24:27], v[64:79]
    ds_read_b64_tr_b16 a[252:253], v231 offset:53248
    ds_read_b64_tr_b16 a[254:255], v231 offset:55296
    s_add_u32 s46, s54, 16384
    v_exp_f32 v199, v115
    v_add_f32 v243, v243, v198
    v_mfma_f32_32x32x16_bf16 v[48:63], a[196:199], v[28:31], v[48:63]
    v_exp_f32 v196, v116
    v_add_f32 v243, v243, v199
    v_cvt_pk_bf16_f32 v169, v198, v199
    v_mfma_f32_32x32x16_bf16 v[48:63], a[200:203], v[32:35], v[48:63]
    v_exp_f32 v197, v117
    v_add_f32 v243, v243, v196
    v_mfma_f32_32x32x16_bf16 v[48:63], a[204:207], v[36:39], v[48:63]
    v_exp_f32 v198, v118
    v_add_f32 v243, v243, v197
    v_cvt_pk_bf16_f32 v170, v196, v197
    v_mfma_f32_32x32x16_bf16 v[48:63], a[208:211], v[40:43], v[48:63]
    v_exp_f32 v199, v119
    v_add_f32 v243, v243, v198
    v_mfma_f32_32x32x16_bf16 v[48:63], a[212:215], v[44:47], v[48:63]
    s_add_u32 m0, s38, s82
    v_exp_f32 v196, v120
    v_add_f32 v243, v243, v199
    v_cvt_pk_bf16_f32 v171, v198, v199
    v_mfma_f32_32x32x16_bf16 v[48:63], a[216:219], v[16:19], v[48:63]
    buffer_load_dwordx4 v232, s[16:19], s36 offen nt lds
    v_exp_f32 v197, v121
    v_add_f32 v243, v243, v196
    v_mfma_f32_32x32x16_bf16 v[48:63], a[220:223], v[20:23], v[48:63]
    v_exp_f32 v198, v122
    v_add_f32 v243, v243, v197
    v_cvt_pk_bf16_f32 v172, v196, v197
    s_waitcnt lgkmcnt(0)
    v_mfma_f32_32x32x16_bf16 a[0:15], a[224:227], v[160:163], a[0:15]
    v_exp_f32 v199, v123
    v_add_f32 v243, v243, v198
    v_mfma_f32_32x32x16_bf16 a[16:31], a[228:231], v[160:163], a[16:31]
    v_exp_f32 v196, v124
    v_add_f32 v243, v243, v199
    v_cvt_pk_bf16_f32 v173, v198, v199
    v_mfma_f32_32x32x16_bf16 a[32:47], a[232:235], v[160:163], a[32:47]
    buffer_load_dwordx4 v[246:249], v245, s[24:27], s46 offen
    v_exp_f32 v197, v125
    v_add_f32 v243, v243, v196
    v_mfma_f32_32x32x16_bf16 a[48:63], a[236:239], v[160:163], a[48:63]
    v_exp_f32 v198, v126
    v_add_f32 v243, v243, v197
    v_cvt_pk_bf16_f32 v174, v196, v197
    v_mfma_f32_32x32x16_bf16 a[0:15], a[240:243], v[164:167], a[0:15]
    v_exp_f32 v199, v127
    v_add_f32 v243, v243, v198
    v_mfma_f32_32x32x16_bf16 a[16:31], a[244:247], v[164:167], a[16:31]
    buffer_load_dwordx4 v233, s[16:19], s36 offen offset:1024 nt lds
    v_add_f32 v243, v243, v199
    v_cvt_pk_bf16_f32 v175, v198, v199
    v_cmp_lt_f32 vcc, s35, v243
    v_exp_f32 v196, v48
    v_mfma_f32_32x32x16_bf16 a[32:47], a[248:251], v[164:167], a[32:47]
    v_exp_f32 v197, v49
    v_mfma_f32_32x32x16_bf16 a[48:63], a[252:255], v[164:167], a[48:63]
    s_cbranch_vccnz FX58
FX58_RET:
    v_add_f32 v240, v240, v243
    v_exp_f32 v198, v50
    v_add_f32 v242, v196, v197
    v_cvt_pk_bf16_f32 v160, v196, v197
    v_mfma_f32_32x32x16_bf16 v[112:127], a[192:195], v[88:91], v[128:143]
    v_exp_f32 v199, v51
    v_add_f32 v242, v242, v198
    v_mfma_f32_32x32x16_bf16 v[112:127], a[196:199], v[92:95], v[112:127]
    ds_read_b128 a[192:195], v220 offset:40960
    v_exp_f32 v196, v52
    v_add_f32 v242, v242, v199
    v_cvt_pk_bf16_f32 v161, v198, v199
    v_mfma_f32_32x32x16_bf16 v[112:127], a[200:203], v[96:99], v[112:127]
    ds_read_b128 a[196:199], v221 offset:40960
    v_exp_f32 v197, v53
    v_add_f32 v242, v242, v196
    v_mfma_f32_32x32x16_bf16 v[112:127], a[204:207], v[100:103], v[112:127]
    ds_read_b128 a[200:203], v222 offset:40960
    v_exp_f32 v198, v54
    v_add_f32 v242, v242, v197
    v_cvt_pk_bf16_f32 v162, v196, v197
    v_mfma_f32_32x32x16_bf16 v[112:127], a[208:211], v[104:107], v[112:127]
    ds_read_b128 a[204:207], v223 offset:40960
    buffer_load_dwordx4 v234, s[16:19], s36 offen offset:2048 nt lds
    v_exp_f32 v199, v55
    v_add_f32 v242, v242, v198
    v_mfma_f32_32x32x16_bf16 v[112:127], a[212:215], v[108:111], v[112:127]
    ds_read_b128 a[208:211], v224 offset:40960
    buffer_load_dwordx4 v[250:253], v245, s[24:27], s46 offen offset:1024
    v_exp_f32 v196, v56
    v_add_f32 v242, v242, v199
    v_cvt_pk_bf16_f32 v163, v198, v199
    v_mfma_f32_32x32x16_bf16 v[112:127], a[216:219], v[80:83], v[112:127]
    ds_read_b128 a[212:215], v225 offset:40960
    v_exp_f32 v197, v57
    v_add_f32 v242, v242, v196
    v_mfma_f32_32x32x16_bf16 v[112:127], a[220:223], v[84:87], v[112:127]
    ds_read_b128 a[216:219], v226 offset:40960
    v_exp_f32 v198, v58
    v_add_f32 v242, v242, v197
    v_cvt_pk_bf16_f32 v164, v196, v197
    v_mfma_f32_32x32x16_bf16 a[64:79], a[224:227], v[168:171], a[64:79]
    ds_read_b128 a[220:223], v227 offset:40960
    v_exp_f32 v199, v59
    v_add_f32 v242, v242, v198
    v_mfma_f32_32x32x16_bf16 a[80:95], a[228:231], v[168:171], a[80:95]
    ds_read_b64_tr_b16 a[224:225], v228 offset:57344
    ds_read_b64_tr_b16 a[226:227], v228 offset:59392
    v_exp_f32 v196, v60
    v_add_f32 v242, v242, v199
    v_cvt_pk_bf16_f32 v165, v198, v199
    v_mfma_f32_32x32x16_bf16 a[96:111], a[232:235], v[168:171], a[96:111]
    ds_read_b64_tr_b16 a[228:229], v229 offset:57344
    ds_read_b64_tr_b16 a[230:231], v229 offset:59392
    v_exp_f32 v197, v61
    v_add_f32 v242, v242, v196
    v_mfma_f32_32x32x16_bf16 a[112:127], a[236:239], v[168:171], a[112:127]
    ds_read_b64_tr_b16 a[232:233], v230 offset:57344
    ds_read_b64_tr_b16 a[234:235], v230 offset:59392
    buffer_load_dwordx4 v235, s[16:19], s36 offen offset:3072 nt lds
    v_exp_f32 v198, v62
    v_add_f32 v242, v242, v197
    v_cvt_pk_bf16_f32 v166, v196, v197
    v_mfma_f32_32x32x16_bf16 a[64:79], a[240:243], v[172:175], a[64:79]
    ds_read_b64_tr_b16 a[236:237], v231 offset:57344
    ds_read_b64_tr_b16 a[238:239], v231 offset:59392
    v_exp_f32 v199, v63
    v_add_f32 v242, v242, v198
    v_mfma_f32_32x32x16_bf16 a[80:95], a[244:247], v[172:175], a[80:95]
    ds_read_b64_tr_b16 a[240:241], v228 offset:61440
    ds_read_b64_tr_b16 a[242:243], v228 offset:63488
    s_add_u32 s36, s36, 16384
    v_add_f32 v242, v242, v199
    v_cvt_pk_bf16_f32 v167, v198, v199
    v_cmp_lt_f32 vcc, s35, v242
    v_exp_f32 v196, v112
    v_mfma_f32_32x32x16_bf16 a[96:111], a[248:251], v[172:175], a[96:111]
    ds_read_b64_tr_b16 a[244:245], v229 offset:61440
    ds_read_b64_tr_b16 a[246:247], v229 offset:63488
    v_exp_f32 v197, v113
    v_mfma_f32_32x32x16_bf16 a[112:127], a[252:255], v[172:175], a[112:127]
    ds_read_b64_tr_b16 a[248:249], v230 offset:61440
    ds_read_b64_tr_b16 a[250:251], v230 offset:63488
    s_cbranch_vccnz FX59
FX59_RET:
    v_add_f32 v239, v239, v242
    v_exp_f32 v198, v114
    v_add_f32 v243, v196, v197
    v_cvt_pk_bf16_f32 v168, v196, v197
    s_waitcnt lgkmcnt(14)
    v_mfma_f32_32x32x16_bf16 v[48:63], a[192:195], v[24:27], v[64:79]
    ds_read_b64_tr_b16 a[252:253], v231 offset:61440
    ds_read_b64_tr_b16 a[254:255], v231 offset:63488
    v_exp_f32 v199, v115
    v_add_f32 v243, v243, v198
    v_mfma_f32_32x32x16_bf16 v[48:63], a[196:199], v[28:31], v[48:63]
    s_add_u32 m0, s38, s86
    v_exp_f32 v196, v116
    v_add_f32 v243, v243, v199
    v_cvt_pk_bf16_f32 v169, v198, v199
    v_mfma_f32_32x32x16_bf16 v[48:63], a[200:203], v[32:35], v[48:63]
    v_exp_f32 v197, v117
    v_add_f32 v243, v243, v196
    v_xor_b32 v220, 65536, v220
    v_mfma_f32_32x32x16_bf16 v[48:63], a[204:207], v[36:39], v[48:63]
    v_exp_f32 v198, v118
    v_add_f32 v243, v243, v197
    v_cvt_pk_bf16_f32 v170, v196, v197
    v_xor_b32 v221, 65536, v221
    v_mfma_f32_32x32x16_bf16 v[48:63], a[208:211], v[40:43], v[48:63]
    buffer_load_dwordx4 v236, s[20:23], s37 offen nt lds
    v_exp_f32 v199, v119
    v_add_f32 v243, v243, v198
    v_xor_b32 v222, 65536, v222
    v_mfma_f32_32x32x16_bf16 v[48:63], a[212:215], v[44:47], v[48:63]
    v_exp_f32 v196, v120
    v_add_f32 v243, v243, v199
    v_cvt_pk_bf16_f32 v171, v198, v199
    v_xor_b32 v223, 65536, v223
    v_mfma_f32_32x32x16_bf16 v[48:63], a[216:219], v[16:19], v[48:63]
    v_exp_f32 v197, v121
    v_add_f32 v243, v243, v196
    v_xor_b32 v224, 65536, v224
    v_mfma_f32_32x32x16_bf16 v[48:63], a[220:223], v[20:23], v[48:63]
    buffer_load_dwordx4 v236, s[20:23], s37 offen offset:1024 nt lds
    v_exp_f32 v198, v122
    v_add_f32 v243, v243, v197
    v_cvt_pk_bf16_f32 v172, v196, v197
    v_xor_b32 v225, 65536, v225
    s_waitcnt lgkmcnt(0)
    v_mfma_f32_32x32x16_bf16 a[0:15], a[224:227], v[160:163], a[0:15]
    v_exp_f32 v199, v123
    v_add_f32 v243, v243, v198
    v_xor_b32 v226, 65536, v226
    v_mfma_f32_32x32x16_bf16 a[16:31], a[228:231], v[160:163], a[16:31]
    ds_read_b128 v[184:187], v237
    v_exp_f32 v196, v124
    v_add_f32 v243, v243, v199
    v_cvt_pk_bf16_f32 v173, v198, v199
    v_xor_b32 v227, 65536, v227
    v_mfma_f32_32x32x16_bf16 a[32:47], a[232:235], v[160:163], a[32:47]
    ds_read_b128 v[188:191], v237 offset:1024
    buffer_load_dwordx4 v236, s[20:23], s37 offen offset:2048 nt lds
    v_exp_f32 v197, v125
    v_add_f32 v243, v243, v196
    v_xor_b32 v228, 65536, v228
    v_mfma_f32_32x32x16_bf16 a[48:63], a[236:239], v[160:163], a[48:63]
    ds_read_b128 v[192:195], v237 offset:2048
    v_exp_f32 v198, v126
    v_add_f32 v243, v243, v197
    v_cvt_pk_bf16_f32 v174, v196, v197
    v_xor_b32 v229, 65536, v229
    v_mfma_f32_32x32x16_bf16 a[0:15], a[240:243], v[164:167], a[0:15]
    v_exp_f32 v199, v127
    v_add_f32 v243, v243, v198
    v_xor_b32 v230, 65536, v230
    v_mfma_f32_32x32x16_bf16 a[16:31], a[244:247], v[164:167], a[16:31]
    buffer_load_dwordx4 v236, s[20:23], s37 offen offset:3072 nt lds
    v_add_f32 v243, v243, v199
    v_cvt_pk_bf16_f32 v175, v198, v199
    v_cmp_lt_f32 vcc, s35, v243
    v_exp_f32 v196, v48
    v_xor_b32 v231, 65536, v231
    v_mfma_f32_32x32x16_bf16 a[32:47], a[248:251], v[164:167], a[32:47]
    s_add_u32 s37, s37, 16384
    v_exp_f32 v197, v49
    v_mfma_f32_32x32x16_bf16 a[48:63], a[252:255], v[164:167], a[48:63]
    s_add_u32 s38, s38, 32768
    s_and_b32 s38, s38, 131071
    s_cbranch_vccnz FX60
FX60_RET:
    v_add_f32 v240, v240, v243
    v_exp_f32 v198, v50
    v_add_f32 v242, v196, v197
    v_cvt_pk_bf16_f32 v160, v196, v197
    s_waitcnt lgkmcnt(2)
    v_mfma_f32_32x32x16_bf16 v[144:159], a[192:195], v[184:187], 0
    v_exp_f32 v199, v51
    v_add_f32 v242, v242, v198
    s_waitcnt lgkmcnt(1)
    v_mfma_f32_32x32x16_bf16 v[144:159], a[196:199], v[188:191], v[144:159]
    ds_read_b128 v[184:187], v237 offset:3072
    v_exp_f32 v196, v52
    v_add_f32 v242, v242, v199
    v_cvt_pk_bf16_f32 v161, v198, v199
    s_waitcnt lgkmcnt(1)
    v_mfma_f32_32x32x16_bf16 v[144:159], a[200:203], v[192:195], v[144:159]
    ds_read_b128 v[188:191], v237 offset:4096
    v_exp_f32 v197, v53
    v_add_f32 v242, v242, v196
    s_waitcnt lgkmcnt(1)
    v_mfma_f32_32x32x16_bf16 v[144:159], a[204:207], v[184:187], v[144:159]
    ds_read_b128 v[192:195], v237 offset:5120
    v_exp_f32 v198, v54
    v_add_f32 v242, v242, v197
    v_cvt_pk_bf16_f32 v162, v196, v197
    s_waitcnt lgkmcnt(1)
    v_mfma_f32_32x32x16_bf16 v[144:159], a[208:211], v[188:191], v[144:159]
    ds_read_b128 v[184:187], v237 offset:6144
    v_exp_f32 v199, v55
    v_add_f32 v242, v242, v198
    s_waitcnt lgkmcnt(1)
    v_mfma_f32_32x32x16_bf16 v[144:159], a[212:215], v[192:195], v[144:159]
    ds_read_b128 v[188:191], v237 offset:7168
    v_exp_f32 v196, v56
    v_add_f32 v242, v242, v199
    v_cvt_pk_bf16_f32 v163, v198, v199
    s_waitcnt lgkmcnt(1)
    v_mfma_f32_32x32x16_bf16 v[144:159], a[216:219], v[184:187], v[144:159]
    v_exp_f32 v197, v57
    v_add_f32 v242, v242, v196
    s_waitcnt lgkmcnt(0)
    v_mfma_f32_32x32x16_bf16 v[144:159], a[220:223], v[188:191], v[144:159]
    v_exp_f32 v198, v58
    v_add_f32 v242, v242, v197
    v_cvt_pk_bf16_f32 v164, v196, v197
    v_mfma_f32_32x32x16_bf16 v[112:127], a[192:195], v[88:91], v[128:143]
    v_exp_f32 v199, v59
    v_add_f32 v242, v242, v198
    v_mfma_f32_32x32x16_bf16 v[112:127], a[196:199], v[92:95], v[112:127]
    v_exp_f32 v196, v60
    v_add_f32 v242, v242, v199
    v_cvt_pk_bf16_f32 v165, v198, v199
    s_waitcnt vmcnt(16)
    s_barrier
    ds_read_b128 a[192:195], v220
    v_mfma_f32_32x32x16_bf16 v[112:127], a[200:203], v[96:99], v[112:127]
    ds_read_b128 a[196:199], v221
    v_exp_f32 v197, v61
    v_add_f32 v242, v242, v196
    v_mfma_f32_32x32x16_bf16 v[112:127], a[204:207], v[100:103], v[112:127]
    ds_read_b128 a[200:203], v222
    v_exp_f32 v198, v62
    v_add_f32 v242, v242, v197
    v_cvt_pk_bf16_f32 v166, v196, v197
    v_mfma_f32_32x32x16_bf16 v[112:127], a[208:211], v[104:107], v[112:127]
    v_exp_f32 v199, v63
    v_add_f32 v242, v242, v198
    s_nop 7
    v_max3_f32 v2, v144, v145, v146
    v_max3_f32 v2, v2, v147, v148
    v_max3_f32 v2, v2, v149, v150
    v_max3_f32 v2, v2, v151, v152
    v_max3_f32 v2, v2, v153, v154
    v_max3_f32 v2, v2, v155, v156
    v_max3_f32 v2, v2, v157, v158
    v_max_f32 v2, v2, v159
    v_mov_b32 v3, v2
    s_nop 1
    v_permlane32_swap_b32 v2, v3
    v_max_f32 v2, v2, v3
    v_sub_f32 v204, 0, v2
    v_sub_f32 v205, 0, v2
    v_sub_f32 v206, 0, v2
    v_sub_f32 v207, 0, v2
    v_sub_f32 v208, 0, v2
    v_sub_f32 v209, 0, v2
    v_sub_f32 v210, 0, v2
    v_sub_f32 v211, 0, v2
    v_sub_f32 v212, 0, v2
    v_sub_f32 v213, 0, v2
    v_sub_f32 v214, 0, v2
    v_sub_f32 v215, 0, v2
    v_sub_f32 v216, 0, v2
    v_sub_f32 v217, 0, v2
    v_sub_f32 v218, 0, v2
    v_sub_f32 v219, 0, v2
    v_sub_f32 v144, v144, v2
    v_sub_f32 v145, v145, v2
    v_sub_f32 v146, v146, v2
    v_sub_f32 v147, v147, v2
    v_sub_f32 v148, v148, v2
    v_sub_f32 v149, v149, v2
    v_sub_f32 v150, v150, v2
    v_sub_f32 v151, v151, v2
    v_sub_f32 v152, v152, v2
    v_sub_f32 v153, v153, v2
    v_sub_f32 v154, v154, v2
    v_sub_f32 v155, v155, v2
    v_sub_f32 v156, v156, v2
    v_sub_f32 v157, v157, v2
    v_sub_f32 v158, v158, v2
    v_sub_f32 v159, v159, v2
    ds_read_b128 a[204:207], v223
    v_mfma_f32_32x32x16_bf16 v[112:127], a[212:215], v[108:111], v[112:127]
    ds_read_b128 a[208:211], v224
    v_add_f32 v242, v242, v199
    v_cvt_pk_bf16_f32 v167, v198, v199
    v_cmp_lt_f32 vcc, s35, v242
    v_exp_f32 v196, v144
    v_mfma_f32_32x32x16_bf16 v[112:127], a[216:219], v[80:83], v[112:127]
    ds_read_b128 a[212:215], v225
    v_exp_f32 v197, v145
    v_mfma_f32_32x32x16_bf16 v[112:127], a[220:223], v[84:87], v[112:127]
    ds_read_b128 a[216:219], v226
    s_cbranch_vccnz FX61
FX61_RET:
    v_add_f32 v239, v239, v242
    v_exp_f32 v198, v146
    v_add_f32 v244, v196, v197
    v_cvt_pk_bf16_f32 v176, v196, v197
    v_mfma_f32_32x32x16_bf16 a[64:79], a[224:227], v[168:171], a[64:79]
    ds_read_b128 a[220:223], v227
    v_exp_f32 v199, v147
    v_add_f32 v244, v244, v198
    v_mfma_f32_32x32x16_bf16 a[80:95], a[228:231], v[168:171], a[80:95]
    ds_read_b64_tr_b16 a[224:225], v228 offset:16384
    ds_read_b64_tr_b16 a[226:227], v228 offset:18432
    v_exp_f32 v196, v148
    v_add_f32 v244, v244, v199
    v_cvt_pk_bf16_f32 v177, v198, v199
    v_mfma_f32_32x32x16_bf16 a[96:111], a[232:235], v[168:171], a[96:111]
    ds_read_b64_tr_b16 a[228:229], v229 offset:16384
    ds_read_b64_tr_b16 a[230:231], v229 offset:18432
    v_exp_f32 v197, v149
    v_add_f32 v244, v244, v196
    v_mfma_f32_32x32x16_bf16 a[112:127], a[236:239], v[168:171], a[112:127]
    ds_read_b64_tr_b16 a[232:233], v230 offset:16384
    ds_read_b64_tr_b16 a[234:235], v230 offset:18432
    v_exp_f32 v198, v150
    v_add_f32 v244, v244, v197
    v_cvt_pk_bf16_f32 v178, v196, v197
    v_mfma_f32_32x32x16_bf16 a[64:79], a[240:243], v[172:175], a[64:79]
    ds_read_b64_tr_b16 a[236:237], v231 offset:16384
    ds_read_b64_tr_b16 a[238:239], v231 offset:18432
    v_exp_f32 v199, v151
    v_add_f32 v244, v244, v198
    v_mfma_f32_32x32x16_bf16 a[80:95], a[244:247], v[172:175], a[80:95]
    ds_read_b64_tr_b16 a[240:241], v228 offset:20480
    ds_read_b64_tr_b16 a[242:243], v228 offset:22528
    v_add_f32 v244, v244, v199
    v_cvt_pk_bf16_f32 v179, v198, v199
    v_exp_f32 v196, v112
    v_mfma_f32_32x32x16_bf16 a[96:111], a[248:251], v[172:175], a[96:111]
    ds_read_b64_tr_b16 a[244:245], v229 offset:20480
    ds_read_b64_tr_b16 a[246:247], v229 offset:22528
    v_exp_f32 v197, v113
    v_mfma_f32_32x32x16_bf16 a[112:127], a[252:255], v[172:175], a[112:127]
    ds_read_b64_tr_b16 a[248:249], v230 offset:20480
    ds_read_b64_tr_b16 a[250:251], v230 offset:22528
    v_exp_f32 v198, v114
    v_add_f32 v243, v196, v197
    v_cvt_pk_bf16_f32 v168, v196, v197
    s_mov_b32 s39, 7
W3_AL:
    s_waitcnt lgkmcnt(14)
    v_mfma_f32_32x32x16_bf16 v[48:63], a[192:195], v[24:27], v[64:79]
    ds_read_b64_tr_b16 a[252:253], v231 offset:20480
    ds_read_b64_tr_b16 a[254:255], v231 offset:22528
    v_exp_f32 v199, v115
    v_add_f32 v243, v243, v198
    v_mfma_f32_32x32x16_bf16 v[48:63], a[196:199], v[28:31], v[48:63]
    v_exp_f32 v196, v116
    v_add_f32 v243, v243, v199
    v_cvt_pk_bf16_f32 v169, v198, v199
    v_mfma_f32_32x32x16_bf16 v[48:63], a[200:203], v[32:35], v[48:63]
    v_exp_f32 v197, v117
    v_add_f32 v243, v243, v196
    v_mfma_f32_32x32x16_bf16 v[48:63], a[204:207], v[36:39], v[48:63]
    v_exp_f32 v198, v118
    v_add_f32 v243, v243, v197
    v_cvt_pk_bf16_f32 v170, v196, v197
    v_mfma_f32_32x32x16_bf16 v[48:63], a[208:211], v[40:43], v[48:63]
    v_exp_f32 v199, v119
    v_add_f32 v243, v243, v198
    v_mfma_f32_32x32x16_bf16 v[48:63], a[212:215], v[44:47], v[48:63]
    s_add_u32 m0, s38, s82
    v_exp_f32 v196, v120
    v_add_f32 v243, v243, v199
    v_cvt_pk_bf16_f32 v171, v198, v199
    v_mfma_f32_32x32x16_bf16 v[48:63], a[216:219], v[16:19], v[48:63]
    buffer_load_dwordx4 v232, s[16:19], s36 offen nt lds
    v_exp_f32 v197, v121
    v_add_f32 v243, v243, v196
    v_mfma_f32_32x32x16_bf16 v[48:63], a[220:223], v[20:23], v[48:63]
    v_exp_f32 v198, v122
    v_add_f32 v243, v243, v197
    v_cvt_pk_bf16_f32 v172, v196, v197
    s_waitcnt lgkmcnt(0)
    v_mfma_f32_32x32x16_bf16 a[0:15], a[224:227], v[160:163], a[0:15]
    v_exp_f32 v199, v123
    v_add_f32 v243, v243, v198
    v_mfma_f32_32x32x16_bf16 a[16:31], a[228:231], v[160:163], a[16:31]
    v_exp_f32 v196, v124
    v_add_f32 v243, v243, v199
    v_cvt_pk_bf16_f32 v173, v198, v199
    v_mfma_f32_32x32x16_bf16 a[32:47], a[232:235], v[160:163], a[32:47]
    v_exp_f32 v197, v125
    v_add_f32 v243, v243, v196
    v_mfma_f32_32x32x16_bf16 a[48:63], a[236:239], v[160:163], a[48:63]
    v_exp_f32 v198, v126
    v_add_f32 v243, v243, v197
    v_cvt_pk_bf16_f32 v174, v196, v197
    v_mfma_f32_32x32x16_bf16 a[0:15], a[240:243], v[164:167], a[0:15]
    v_exp_f32 v199, v127
    v_add_f32 v243, v243, v198
    v_mfma_f32_32x32x16_bf16 a[16:31], a[244:247], v[164:167], a[16:31]
    buffer_load_dwordx4 v233, s[16:19], s36 offen offset:1024 nt lds
    v_add_f32 v243, v243, v199
    v_cvt_pk_bf16_f32 v175, v198, v199
    v_cmp_lt_f32 vcc, s35, v243
    v_exp_f32 v196, v152
    v_mfma_f32_32x32x16_bf16 a[32:47], a[248:251], v[164:167], a[32:47]
    v_exp_f32 v197, v153
    v_add_f32 v244, v244, v196
    v_mfma_f32_32x32x16_bf16 a[48:63], a[252:255], v[164:167], a[48:63]
    s_cbranch_vccnz FX62
FX62_RET:
    v_add_f32 v240, v240, v243
    v_exp_f32 v198, v154
    v_add_f32 v244, v244, v197
    v_cvt_pk_bf16_f32 v180, v196, v197
    v_mfma_f32_32x32x16_bf16 v[112:127], a[192:195], v[88:91], v[128:143]
    v_exp_f32 v199, v155
    v_add_f32 v244, v244, v198
    v_mfma_f32_32x32x16_bf16 v[112:127], a[196:199], v[92:95], v[112:127]
    ds_read_b128 a[192:195], v220 offset:8192
    v_exp_f32 v196, v156
    v_add_f32 v244, v244, v199
    v_cvt_pk_bf16_f32 v181, v198, v199
    v_mfma_f32_32x32x16_bf16 v[112:127], a[200:203], v[96:99], v[112:127]
    ds_read_b128 a[196:199], v221 offset:8192
    v_exp_f32 v197, v157
    v_add_f32 v244, v244, v196
    v_mfma_f32_32x32x16_bf16 v[112:127], a[204:207], v[100:103], v[112:127]
    ds_read_b128 a[200:203], v222 offset:8192
    v_exp_f32 v198, v158
    v_add_f32 v244, v244, v197
    v_cvt_pk_bf16_f32 v182, v196, v197
    v_mfma_f32_32x32x16_bf16 v[112:127], a[208:211], v[104:107], v[112:127]
    ds_read_b128 a[204:207], v223 offset:8192
    buffer_load_dwordx4 v234, s[16:19], s36 offen offset:2048 nt lds
    v_exp_f32 v199, v159
    v_add_f32 v244, v244, v198
    v_mfma_f32_32x32x16_bf16 v[112:127], a[212:215], v[108:111], v[112:127]
    ds_read_b128 a[208:211], v224 offset:8192
    v_add_f32 v244, v244, v199
    v_cvt_pk_bf16_f32 v183, v198, v199
    v_cmp_lt_f32 vcc, s35, v244
    v_exp_f32 v196, v48
    v_mfma_f32_32x32x16_bf16 v[112:127], a[216:219], v[80:83], v[112:127]
    ds_read_b128 a[212:215], v225 offset:8192
    v_exp_f32 v197, v49
    v_mfma_f32_32x32x16_bf16 v[112:127], a[220:223], v[84:87], v[112:127]
    ds_read_b128 a[216:219], v226 offset:8192
    s_cbranch_vccnz FX63
FX63_RET:
    v_add_f32 v241, v241, v244
    v_exp_f32 v198, v50
    v_add_f32 v242, v196, v197
    v_cvt_pk_bf16_f32 v160, v196, v197
    v_mfma_f32_32x32x16_bf16 a[128:143], a[224:227], v[176:179], a[128:143]
    ds_read_b128 a[220:223], v227 offset:8192
    v_exp_f32 v199, v51
    v_add_f32 v242, v242, v198
    v_mfma_f32_32x32x16_bf16 a[144:159], a[228:231], v[176:179], a[144:159]
    v_exp_f32 v196, v52
    v_add_f32 v242, v242, v199
    v_cvt_pk_bf16_f32 v161, v198, v199
    v_mfma_f32_32x32x16_bf16 a[160:175], a[232:235], v[176:179], a[160:175]
    v_exp_f32 v197, v53
    v_add_f32 v242, v242, v196
    v_mfma_f32_32x32x16_bf16 a[176:191], a[236:239], v[176:179], a[176:191]
    buffer_load_dwordx4 v235, s[16:19], s36 offen offset:3072 nt lds
    v_exp_f32 v198, v54
    v_add_f32 v242, v242, v197
    v_cvt_pk_bf16_f32 v162, v196, v197
    v_mfma_f32_32x32x16_bf16 a[128:143], a[240:243], v[180:183], a[128:143]
    v_exp_f32 v199, v55
    v_add_f32 v242, v242, v198
    v_mfma_f32_32x32x16_bf16 a[144:159], a[244:247], v[180:183], a[144:159]
    s_add_u32 s36, s36, 16384
    v_exp_f32 v196, v56
    v_add_f32 v242, v242, v199
    v_cvt_pk_bf16_f32 v163, v198, v199
    v_mfma_f32_32x32x16_bf16 a[160:175], a[248:251], v[180:183], a[160:175]
    v_exp_f32 v197, v57
    v_add_f32 v242, v242, v196
    v_mfma_f32_32x32x16_bf16 a[176:191], a[252:255], v[180:183], a[176:191]
    v_exp_f32 v198, v58
    v_add_f32 v242, v242, v197
    v_cvt_pk_bf16_f32 v164, v196, v197
    v_mfma_f32_32x32x16_bf16 a[64:79], a[224:227], v[168:171], a[64:79]
    v_exp_f32 v199, v59
    v_add_f32 v242, v242, v198
    v_mfma_f32_32x32x16_bf16 a[80:95], a[228:231], v[168:171], a[80:95]
    ds_read_b64_tr_b16 a[224:225], v228 offset:24576
    ds_read_b64_tr_b16 a[226:227], v228 offset:26624
    v_exp_f32 v196, v60
    v_add_f32 v242, v242, v199
    v_cvt_pk_bf16_f32 v165, v198, v199
    v_mfma_f32_32x32x16_bf16 a[96:111], a[232:235], v[168:171], a[96:111]
    ds_read_b64_tr_b16 a[228:229], v229 offset:24576
    ds_read_b64_tr_b16 a[230:231], v229 offset:26624
    v_exp_f32 v197, v61
    v_add_f32 v242, v242, v196
    v_mfma_f32_32x32x16_bf16 a[112:127], a[236:239], v[168:171], a[112:127]
    ds_read_b64_tr_b16 a[232:233], v230 offset:24576
    ds_read_b64_tr_b16 a[234:235], v230 offset:26624
    v_exp_f32 v198, v62
    v_add_f32 v242, v242, v197
    v_cvt_pk_bf16_f32 v166, v196, v197
    v_mfma_f32_32x32x16_bf16 a[64:79], a[240:243], v[172:175], a[64:79]
    ds_read_b64_tr_b16 a[236:237], v231 offset:24576
    ds_read_b64_tr_b16 a[238:239], v231 offset:26624
    v_exp_f32 v199, v63
    v_add_f32 v242, v242, v198
    v_mfma_f32_32x32x16_bf16 a[80:95], a[244:247], v[172:175], a[80:95]
    ds_read_b64_tr_b16 a[240:241], v228 offset:28672
    ds_read_b64_tr_b16 a[242:243], v228 offset:30720
    v_add_f32 v242, v242, v199
    v_cvt_pk_bf16_f32 v167, v198, v199
    v_cmp_lt_f32 vcc, s35, v242
    v_exp_f32 v196, v112
    v_mfma_f32_32x32x16_bf16 a[96:111], a[248:251], v[172:175], a[96:111]
    ds_read_b64_tr_b16 a[244:245], v229 offset:28672
    ds_read_b64_tr_b16 a[246:247], v229 offset:30720
    v_exp_f32 v197, v113
    v_mfma_f32_32x32x16_bf16 a[112:127], a[252:255], v[172:175], a[112:127]
    ds_read_b64_tr_b16 a[248:249], v230 offset:28672
    ds_read_b64_tr_b16 a[250:251], v230 offset:30720
    s_cbranch_vccnz FX64
FX64_RET:
    v_add_f32 v239, v239, v242
    v_exp_f32 v198, v114
    v_add_f32 v243, v196, v197
    v_cvt_pk_bf16_f32 v168, v196, v197
    s_waitcnt lgkmcnt(14)
    v_mfma_f32_32x32x16_bf16 v[48:63], a[192:195], v[24:27], v[64:79]
    ds_read_b64_tr_b16 a[252:253], v231 offset:28672
    ds_read_b64_tr_b16 a[254:255], v231 offset:30720
    v_exp_f32 v199, v115
    v_add_f32 v243, v243, v198
    v_mfma_f32_32x32x16_bf16 v[48:63], a[196:199], v[28:31], v[48:63]
    s_add_u32 m0, s38, s86
    v_exp_f32 v196, v116
    v_add_f32 v243, v243, v199
    v_cvt_pk_bf16_f32 v169, v198, v199
    v_mfma_f32_32x32x16_bf16 v[48:63], a[200:203], v[32:35], v[48:63]
    v_exp_f32 v197, v117
    v_add_f32 v243, v243, v196
    v_mfma_f32_32x32x16_bf16 v[48:63], a[204:207], v[36:39], v[48:63]
    v_exp_f32 v198, v118
    v_add_f32 v243, v243, v197
    v_cvt_pk_bf16_f32 v170, v196, v197
    v_mfma_f32_32x32x16_bf16 v[48:63], a[208:211], v[40:43], v[48:63]
    buffer_load_dwordx4 v236, s[20:23], s37 offen nt lds
    v_exp_f32 v199, v119
    v_add_f32 v243, v243, v198
    v_mfma_f32_32x32x16_bf16 v[48:63], a[212:215], v[44:47], v[48:63]
    v_exp_f32 v196, v120
    v_add_f32 v243, v243, v199
    v_cvt_pk_bf16_f32 v171, v198, v199
    v_mfma_f32_32x32x16_bf16 v[48:63], a[216:219], v[16:19], v[48:63]
    v_exp_f32 v197, v121
    v_add_f32 v243, v243, v196
    v_mfma_f32_32x32x16_bf16 v[48:63], a[220:223], v[20:23], v[48:63]
    buffer_load_dwordx4 v236, s[20:23], s37 offen offset:1024 nt lds
    v_exp_f32 v198, v122
    v_add_f32 v243, v243, v197
    v_cvt_pk_bf16_f32 v172, v196, v197
    s_waitcnt lgkmcnt(0)
    v_mfma_f32_32x32x16_bf16 a[0:15], a[224:227], v[160:163], a[0:15]
    v_exp_f32 v199, v123
    v_add_f32 v243, v243, v198
    v_mfma_f32_32x32x16_bf16 a[16:31], a[228:231], v[160:163], a[16:31]
    v_exp_f32 v196, v124
    v_add_f32 v243, v243, v199
    v_cvt_pk_bf16_f32 v173, v198, v199
    v_mfma_f32_32x32x16_bf16 a[32:47], a[232:235], v[160:163], a[32:47]
    buffer_load_dwordx4 v236, s[20:23], s37 offen offset:2048 nt lds
    v_exp_f32 v197, v125
    v_add_f32 v243, v243, v196
    v_mfma_f32_32x32x16_bf16 a[48:63], a[236:239], v[160:163], a[48:63]
    v_exp_f32 v198, v126
    v_add_f32 v243, v243, v197
    v_cvt_pk_bf16_f32 v174, v196, v197
    v_mfma_f32_32x32x16_bf16 a[0:15], a[240:243], v[164:167], a[0:15]
    v_exp_f32 v199, v127
    v_add_f32 v243, v243, v198
    v_mfma_f32_32x32x16_bf16 a[16:31], a[244:247], v[164:167], a[16:31]
    buffer_load_dwordx4 v236, s[20:23], s37 offen offset:3072 nt lds
    v_add_f32 v243, v243, v199
    v_cvt_pk_bf16_f32 v175, v198, v199
    v_cmp_lt_f32 vcc, s35, v243
    v_exp_f32 v196, v48
    v_mfma_f32_32x32x16_bf16 a[32:47], a[248:251], v[164:167], a[32:47]
    s_add_u32 s37, s37, 16384
    v_exp_f32 v197, v49
    v_mfma_f32_32x32x16_bf16 a[48:63], a[252:255], v[164:167], a[48:63]
    s_add_u32 s38, s38, 32768
    s_and_b32 s38, s38, 131071
    s_cbranch_vccnz FX65
FX65_RET:
    v_add_f32 v240, v240, v243
    v_exp_f32 v198, v50
    v_add_f32 v242, v196, v197
    v_cvt_pk_bf16_f32 v160, v196, v197
    v_mfma_f32_32x32x16_bf16 v[112:127], a[192:195], v[88:91], v[128:143]
    v_exp_f32 v199, v51
    v_add_f32 v242, v242, v198
    v_mfma_f32_32x32x16_bf16 v[112:127], a[196:199], v[92:95], v[112:127]
    v_exp_f32 v196, v52
    v_add_f32 v242, v242, v199
    v_cvt_pk_bf16_f32 v161, v198, v199
    s_waitcnt vmcnt(16)
    s_barrier
    ds_read_b128 a[192:195], v220 offset:32768
    v_mfma_f32_32x32x16_bf16 v[112:127], a[200:203], v[96:99], v[112:127]
    ds_read_b128 a[196:199], v221 offset:32768
    v_exp_f32 v197, v53
    v_add_f32 v242, v242, v196
    v_mfma_f32_32x32x16_bf16 v[112:127], a[204:207], v[100:103], v[112:127]
    ds_read_b128 a[200:203], v222 offset:32768
    v_exp_f32 v198, v54
    v_add_f32 v242, v242, v197
    v_cvt_pk_bf16_f32 v162, v196, v197
    v_mfma_f32_32x32x16_bf16 v[112:127], a[208:211], v[104:107], v[112:127]
    ds_read_b128 a[204:207], v223 offset:32768
    v_exp_f32 v199, v55
    v_add_f32 v242, v242, v198
    v_mfma_f32_32x32x16_bf16 v[112:127], a[212:215], v[108:111], v[112:127]
    ds_read_b128 a[208:211], v224 offset:32768
    v_exp_f32 v196, v56
    v_add_f32 v242, v242, v199
    v_cvt_pk_bf16_f32 v163, v198, v199
    v_mfma_f32_32x32x16_bf16 v[112:127], a[216:219], v[80:83], v[112:127]
    ds_read_b128 a[212:215], v225 offset:32768
    v_exp_f32 v197, v57
    v_add_f32 v242, v242, v196
    v_mfma_f32_32x32x16_bf16 v[112:127], a[220:223], v[84:87], v[112:127]
    ds_read_b128 a[216:219], v226 offset:32768
    v_exp_f32 v198, v58
    v_add_f32 v242, v242, v197
    v_cvt_pk_bf16_f32 v164, v196, v197
    v_mfma_f32_32x32x16_bf16 a[64:79], a[224:227], v[168:171], a[64:79]
    ds_read_b128 a[220:223], v227 offset:32768
    v_exp_f32 v199, v59
    v_add_f32 v242, v242, v198
    v_mfma_f32_32x32x16_bf16 a[80:95], a[228:231], v[168:171], a[80:95]
    ds_read_b64_tr_b16 a[224:225], v228 offset:49152
    ds_read_b64_tr_b16 a[226:227], v228 offset:51200
    v_exp_f32 v196, v60
    v_add_f32 v242, v242, v199
    v_cvt_pk_bf16_f32 v165, v198, v199
    v_mfma_f32_32x32x16_bf16 a[96:111], a[232:235], v[168:171], a[96:111]
    ds_read_b64_tr_b16 a[228:229], v229 offset:49152
    ds_read_b64_tr_b16 a[230:231], v229 offset:51200
    v_exp_f32 v197, v61
    v_add_f32 v242, v242, v196
    v_mfma_f32_32x32x16_bf16 a[112:127], a[236:239], v[168:171], a[112:127]
    ds_read_b64_tr_b16 a[232:233], v230 offset:49152
    ds_read_b64_tr_b16 a[234:235], v230 offset:51200
    v_exp_f32 v198, v62
    v_add_f32 v242, v242, v197
    v_cvt_pk_bf16_f32 v166, v196, v197
    v_mfma_f32_32x32x16_bf16 a[64:79], a[240:243], v[172:175], a[64:79]
    ds_read_b64_tr_b16 a[236:237], v231 offset:49152
    ds_read_b64_tr_b16 a[238:239], v231 offset:51200
    v_exp_f32 v199, v63
    v_add_f32 v242, v242, v198
    v_mfma_f32_32x32x16_bf16 a[80:95], a[244:247], v[172:175], a[80:95]
    ds_read_b64_tr_b16 a[240:241], v228 offset:53248
    ds_read_b64_tr_b16 a[242:243], v228 offset:55296
    v_add_f32 v242, v242, v199
    v_cvt_pk_bf16_f32 v167, v198, v199
    v_cmp_lt_f32 vcc, s35, v242
    v_exp_f32 v196, v112
    v_mfma_f32_32x32x16_bf16 a[96:111], a[248:251], v[172:175], a[96:111]
    ds_read_b64_tr_b16 a[244:245], v229 offset:53248
    ds_read_b64_tr_b16 a[246:247], v229 offset:55296
    v_exp_f32 v197, v113
    v_mfma_f32_32x32x16_bf16 a[112:127], a[252:255], v[172:175], a[112:127]
    ds_read_b64_tr_b16 a[248:249], v230 offset:53248
    ds_read_b64_tr_b16 a[250:251], v230 offset:55296
    s_cbranch_vccnz FX66
FX66_RET:
    v_add_f32 v239, v239, v242
    v_exp_f32 v198, v114
    v_add_f32 v243, v196, v197
    v_cvt_pk_bf16_f32 v168, v196, v197
    s_waitcnt lgkmcnt(14)
    v_mfma_f32_32x32x16_bf16 v[48:63], a[192:195], v[24:27], v[64:79]
    ds_read_b64_tr_b16 a[252:253], v231 offset:53248
    ds_read_b64_tr_b16 a[254:255], v231 offset:55296
    v_exp_f32 v199, v115
    v_add_f32 v243, v243, v198
    v_mfma_f32_32x32x16_bf16 v[48:63], a[196:199], v[28:31], v[48:63]
    v_exp_f32 v196, v116
    v_add_f32 v243, v243, v199
    v_cvt_pk_bf16_f32 v169, v198, v199
    v_mfma_f32_32x32x16_bf16 v[48:63], a[200:203], v[32:35], v[48:63]
    v_exp_f32 v197, v117
    v_add_f32 v243, v243, v196
    v_mfma_f32_32x32x16_bf16 v[48:63], a[204:207], v[36:39], v[48:63]
    v_exp_f32 v198, v118
    v_add_f32 v243, v243, v197
    v_cvt_pk_bf16_f32 v170, v196, v197
    v_mfma_f32_32x32x16_bf16 v[48:63], a[208:211], v[40:43], v[48:63]
    v_exp_f32 v199, v119
    v_add_f32 v243, v243, v198
    v_mfma_f32_32x32x16_bf16 v[48:63], a[212:215], v[44:47], v[48:63]
    s_add_u32 m0, s38, s82
    v_exp_f32 v196, v120
    v_add_f32 v243, v243, v199
    v_cvt_pk_bf16_f32 v171, v198, v199
    v_mfma_f32_32x32x16_bf16 v[48:63], a[216:219], v[16:19], v[48:63]
    buffer_load_dwordx4 v232, s[16:19], s36 offen nt lds
    v_exp_f32 v197, v121
    v_add_f32 v243, v243, v196
    v_mfma_f32_32x32x16_bf16 v[48:63], a[220:223], v[20:23], v[48:63]
    v_exp_f32 v198, v122
    v_add_f32 v243, v243, v197
    v_cvt_pk_bf16_f32 v172, v196, v197
    s_waitcnt lgkmcnt(0)
    v_mfma_f32_32x32x16_bf16 a[0:15], a[224:227], v[160:163], a[0:15]
    v_exp_f32 v199, v123
    v_add_f32 v243, v243, v198
    v_mfma_f32_32x32x16_bf16 a[16:31], a[228:231], v[160:163], a[16:31]
    v_exp_f32 v196, v124
    v_add_f32 v243, v243, v199
    v_cvt_pk_bf16_f32 v173, v198, v199
    v_mfma_f32_32x32x16_bf16 a[32:47], a[232:235], v[160:163], a[32:47]
    v_exp_f32 v197, v125
    v_add_f32 v243, v243, v196
    v_mfma_f32_32x32x16_bf16 a[48:63], a[236:239], v[160:163], a[48:63]
    v_exp_f32 v198, v126
    v_add_f32 v243, v243, v197
    v_cvt_pk_bf16_f32 v174, v196, v197
    v_mfma_f32_32x32x16_bf16 a[0:15], a[240:243], v[164:167], a[0:15]
    v_exp_f32 v199, v127
    v_add_f32 v243, v243, v198
    v_mfma_f32_32x32x16_bf16 a[16:31], a[244:247], v[164:167], a[16:31]
    buffer_load_dwordx4 v233, s[16:19], s36 offen offset:1024 nt lds
    v_add_f32 v243, v243, v199
    v_cvt_pk_bf16_f32 v175, v198, v199
    v_cmp_lt_f32 vcc, s35, v243
    v_exp_f32 v196, v48
    v_mfma_f32_32x32x16_bf16 a[32:47], a[248:251], v[164:167], a[32:47]
    v_exp_f32 v197, v49
    v_mfma_f32_32x32x16_bf16 a[48:63], a[252:255], v[164:167], a[48:63]
    s_cbranch_vccnz FX67
FX67_RET:
    v_add_f32 v240, v240, v243
    v_exp_f32 v198, v50
    v_add_f32 v242, v196, v197
    v_cvt_pk_bf16_f32 v160, v196, v197
    v_mfma_f32_32x32x16_bf16 v[112:127], a[192:195], v[88:91], v[128:143]
    v_exp_f32 v199, v51
    v_add_f32 v242, v242, v198
    v_mfma_f32_32x32x16_bf16 v[112:127], a[196:199], v[92:95], v[112:127]
    ds_read_b128 a[192:195], v220 offset:40960
    v_exp_f32 v196, v52
    v_add_f32 v242, v242, v199
    v_cvt_pk_bf16_f32 v161, v198, v199
    v_mfma_f32_32x32x16_bf16 v[112:127], a[200:203], v[96:99], v[112:127]
    ds_read_b128 a[196:199], v221 offset:40960
    v_exp_f32 v197, v53
    v_add_f32 v242, v242, v196
    v_mfma_f32_32x32x16_bf16 v[112:127], a[204:207], v[100:103], v[112:127]
    ds_read_b128 a[200:203], v222 offset:40960
    v_exp_f32 v198, v54
    v_add_f32 v242, v242, v197
    v_cvt_pk_bf16_f32 v162, v196, v197
    v_mfma_f32_32x32x16_bf16 v[112:127], a[208:211], v[104:107], v[112:127]
    ds_read_b128 a[204:207], v223 offset:40960
    buffer_load_dwordx4 v234, s[16:19], s36 offen offset:2048 nt lds
    v_exp_f32 v199, v55
    v_add_f32 v242, v242, v198
    v_mfma_f32_32x32x16_bf16 v[112:127], a[212:215], v[108:111], v[112:127]
    ds_read_b128 a[208:211], v224 offset:40960
    v_exp_f32 v196, v56
    v_add_f32 v242, v242, v199
    v_cvt_pk_bf16_f32 v163, v198, v199
    v_mfma_f32_32x32x16_bf16 v[112:127], a[216:219], v[80:83], v[112:127]
    ds_read_b128 a[212:215], v225 offset:40960
    v_exp_f32 v197, v57
    v_add_f32 v242, v242, v196
    v_mfma_f32_32x32x16_bf16 v[112:127], a[220:223], v[84:87], v[112:127]
    ds_read_b128 a[216:219], v226 offset:40960
    v_exp_f32 v198, v58
    v_add_f32 v242, v242, v197
    v_cvt_pk_bf16_f32 v164, v196, v197
    v_mfma_f32_32x32x16_bf16 a[64:79], a[224:227], v[168:171], a[64:79]
    ds_read_b128 a[220:223], v227 offset:40960
    v_exp_f32 v199, v59
    v_add_f32 v242, v242, v198
    v_mfma_f32_32x32x16_bf16 a[80:95], a[228:231], v[168:171], a[80:95]
    ds_read_b64_tr_b16 a[224:225], v228 offset:57344
    ds_read_b64_tr_b16 a[226:227], v228 offset:59392
    v_exp_f32 v196, v60
    v_add_f32 v242, v242, v199
    v_cvt_pk_bf16_f32 v165, v198, v199
    v_mfma_f32_32x32x16_bf16 a[96:111], a[232:235], v[168:171], a[96:111]
    ds_read_b64_tr_b16 a[228:229], v229 offset:57344
    ds_read_b64_tr_b16 a[230:231], v229 offset:59392
    v_exp_f32 v197, v61
    v_add_f32 v242, v242, v196
    v_mfma_f32_32x32x16_bf16 a[112:127], a[236:239], v[168:171], a[112:127]
    ds_read_b64_tr_b16 a[232:233], v230 offset:57344
    ds_read_b64_tr_b16 a[234:235], v230 offset:59392
    buffer_load_dwordx4 v235, s[16:19], s36 offen offset:3072 nt lds
    v_exp_f32 v198, v62
    v_add_f32 v242, v242, v197
    v_cvt_pk_bf16_f32 v166, v196, v197
    v_mfma_f32_32x32x16_bf16 a[64:79], a[240:243], v[172:175], a[64:79]
    ds_read_b64_tr_b16 a[236:237], v231 offset:57344
    ds_read_b64_tr_b16 a[238:239], v231 offset:59392
    v_exp_f32 v199, v63
    v_add_f32 v242, v242, v198
    v_mfma_f32_32x32x16_bf16 a[80:95], a[244:247], v[172:175], a[80:95]
    ds_read_b64_tr_b16 a[240:241], v228 offset:61440
    ds_read_b64_tr_b16 a[242:243], v228 offset:63488
    s_add_u32 s36, s36, 16384
    v_add_f32 v242, v242, v199
    v_cvt_pk_bf16_f32 v167, v198, v199
    v_cmp_lt_f32 vcc, s35, v242
    v_exp_f32 v196, v112
    v_mfma_f32_32x32x16_bf16 a[96:111], a[248:251], v[172:175], a[96:111]
    ds_read_b64_tr_b16 a[244:245], v229 offset:61440
    ds_read_b64_tr_b16 a[246:247], v229 offset:63488
    v_exp_f32 v197, v113
    v_mfma_f32_32x32x16_bf16 a[112:127], a[252:255], v[172:175], a[112:127]
    ds_read_b64_tr_b16 a[248:249], v230 offset:61440
    ds_read_b64_tr_b16 a[250:251], v230 offset:63488
    s_cbranch_vccnz FX68
FX68_RET:
    v_add_f32 v239, v239, v242
    v_exp_f32 v198, v114
    v_add_f32 v243, v196, v197
    v_cvt_pk_bf16_f32 v168, v196, v197
    s_waitcnt lgkmcnt(14)
    v_mfma_f32_32x32x16_bf16 v[48:63], a[192:195], v[24:27], v[64:79]
    ds_read_b64_tr_b16 a[252:253], v231 offset:61440
    ds_read_b64_tr_b16 a[254:255], v231 offset:63488
    v_exp_f32 v199, v115
    v_add_f32 v243, v243, v198
    v_mfma_f32_32x32x16_bf16 v[48:63], a[196:199], v[28:31], v[48:63]
    s_add_u32 m0, s38, s86
    v_exp_f32 v196, v116
    v_add_f32 v243, v243, v199
    v_cvt_pk_bf16_f32 v169, v198, v199
    v_mfma_f32_32x32x16_bf16 v[48:63], a[200:203], v[32:35], v[48:63]
    v_exp_f32 v197, v117
    v_add_f32 v243, v243, v196
    v_xor_b32 v220, 65536, v220
    v_mfma_f32_32x32x16_bf16 v[48:63], a[204:207], v[36:39], v[48:63]
    v_exp_f32 v198, v118
    v_add_f32 v243, v243, v197
    v_cvt_pk_bf16_f32 v170, v196, v197
    v_xor_b32 v221, 65536, v221
    v_mfma_f32_32x32x16_bf16 v[48:63], a[208:211], v[40:43], v[48:63]
    buffer_load_dwordx4 v236, s[20:23], s37 offen nt lds
    v_exp_f32 v199, v119
    v_add_f32 v243, v243, v198
    v_xor_b32 v222, 65536, v222
    v_mfma_f32_32x32x16_bf16 v[48:63], a[212:215], v[44:47], v[48:63]
    v_exp_f32 v196, v120
    v_add_f32 v243, v243, v199
    v_cvt_pk_bf16_f32 v171, v198, v199
    v_xor_b32 v223, 65536, v223
    v_mfma_f32_32x32x16_bf16 v[48:63], a[216:219], v[16:19], v[48:63]
    v_exp_f32 v197, v121
    v_add_f32 v243, v243, v196
    v_xor_b32 v224, 65536, v224
    v_mfma_f32_32x32x16_bf16 v[48:63], a[220:223], v[20:23], v[48:63]
    buffer_load_dwordx4 v236, s[20:23], s37 offen offset:1024 nt lds
    v_exp_f32 v198, v122
    v_add_f32 v243, v243, v197
    v_cvt_pk_bf16_f32 v172, v196, v197
    v_xor_b32 v225, 65536, v225
    s_waitcnt lgkmcnt(0)
    v_mfma_f32_32x32x16_bf16 a[0:15], a[224:227], v[160:163], a[0:15]
    v_exp_f32 v199, v123
    v_add_f32 v243, v243, v198
    v_xor_b32 v226, 65536, v226
    v_mfma_f32_32x32x16_bf16 a[16:31], a[228:231], v[160:163], a[16:31]
    ds_read_b128 v[184:187], v237
    v_exp_f32 v196, v124
    v_add_f32 v243, v243, v199
    v_cvt_pk_bf16_f32 v173, v198, v199
    v_xor_b32 v227, 65536, v227
    v_mfma_f32_32x32x16_bf16 a[32:47], a[232:235], v[160:163], a[32:47]
    ds_read_b128 v[188:191], v237 offset:1024
    buffer_load_dwordx4 v236, s[20:23], s37 offen offset:2048 nt lds
    v_exp_f32 v197, v125
    v_add_f32 v243, v243, v196
    v_xor_b32 v228, 65536, v228
    v_mfma_f32_32x32x16_bf16 a[48:63], a[236:239], v[160:163], a[48:63]
    ds_read_b128 v[192:195], v237 offset:2048
    v_exp_f32 v198, v126
    v_add_f32 v243, v243, v197
    v_cvt_pk_bf16_f32 v174, v196, v197
    v_xor_b32 v229, 65536, v229
    v_mfma_f32_32x32x16_bf16 a[0:15], a[240:243], v[164:167], a[0:15]
    v_exp_f32 v199, v127
    v_add_f32 v243, v243, v198
    v_xor_b32 v230, 65536, v230
    v_mfma_f32_32x32x16_bf16 a[16:31], a[244:247], v[164:167], a[16:31]
    buffer_load_dwordx4 v236, s[20:23], s37 offen offset:3072 nt lds
    v_add_f32 v243, v243, v199
    v_cvt_pk_bf16_f32 v175, v198, v199
    v_cmp_lt_f32 vcc, s35, v243
    v_exp_f32 v196, v48
    v_xor_b32 v231, 65536, v231
    v_mfma_f32_32x32x16_bf16 a[32:47], a[248:251], v[164:167], a[32:47]
    s_add_u32 s37, s37, 16384
    v_exp_f32 v197, v49
    v_mfma_f32_32x32x16_bf16 a[48:63], a[252:255], v[164:167], a[48:63]
    s_add_u32 s38, s38, 32768
    s_and_b32 s38, s38, 131071
    s_cbranch_vccnz FX69
FX69_RET:
    v_add_f32 v240, v240, v243
    v_exp_f32 v198, v50
    v_add_f32 v242, v196, v197
    v_cvt_pk_bf16_f32 v160, v196, v197
    s_waitcnt lgkmcnt(2)
    v_mfma_f32_32x32x16_bf16 v[144:159], a[192:195], v[184:187], v[204:219]
    v_exp_f32 v199, v51
    v_add_f32 v242, v242, v198
    s_waitcnt lgkmcnt(1)
    v_mfma_f32_32x32x16_bf16 v[144:159], a[196:199], v[188:191], v[144:159]
    ds_read_b128 v[184:187], v237 offset:3072
    v_exp_f32 v196, v52
    v_add_f32 v242, v242, v199
    v_cvt_pk_bf16_f32 v161, v198, v199
    s_waitcnt lgkmcnt(1)
    v_mfma_f32_32x32x16_bf16 v[144:159], a[200:203], v[192:195], v[144:159]
    ds_read_b128 v[188:191], v237 offset:4096
    v_exp_f32 v197, v53
    v_add_f32 v242, v242, v196
    s_waitcnt lgkmcnt(1)
    v_mfma_f32_32x32x16_bf16 v[144:159], a[204:207], v[184:187], v[144:159]
    ds_read_b128 v[192:195], v237 offset:5120
    v_exp_f32 v198, v54
    v_add_f32 v242, v242, v197
    v_cvt_pk_bf16_f32 v162, v196, v197
    s_waitcnt lgkmcnt(1)
    v_mfma_f32_32x32x16_bf16 v[144:159], a[208:211], v[188:191], v[144:159]
    ds_read_b128 v[184:187], v237 offset:6144
    v_exp_f32 v199, v55
    v_add_f32 v242, v242, v198
    s_waitcnt lgkmcnt(1)
    v_mfma_f32_32x32x16_bf16 v[144:159], a[212:215], v[192:195], v[144:159]
    ds_read_b128 v[188:191], v237 offset:7168
    v_exp_f32 v196, v56
    v_add_f32 v242, v242, v199
    v_cvt_pk_bf16_f32 v163, v198, v199
    s_waitcnt lgkmcnt(1)
    v_mfma_f32_32x32x16_bf16 v[144:159], a[216:219], v[184:187], v[144:159]
    v_exp_f32 v197, v57
    v_add_f32 v242, v242, v196
    s_waitcnt lgkmcnt(0)
    v_mfma_f32_32x32x16_bf16 v[144:159], a[220:223], v[188:191], v[144:159]
    v_exp_f32 v198, v58
    v_add_f32 v242, v242, v197
    v_cvt_pk_bf16_f32 v164, v196, v197
    v_mfma_f32_32x32x16_bf16 v[112:127], a[192:195], v[88:91], v[128:143]
    v_exp_f32 v199, v59
    v_add_f32 v242, v242, v198
    v_mfma_f32_32x32x16_bf16 v[112:127], a[196:199], v[92:95], v[112:127]
    v_exp_f32 v196, v60
    v_add_f32 v242, v242, v199
    v_cvt_pk_bf16_f32 v165, v198, v199
    s_waitcnt vmcnt(16)
    s_barrier
    ds_read_b128 a[192:195], v220
    v_mfma_f32_32x32x16_bf16 v[112:127], a[200:203], v[96:99], v[112:127]
    ds_read_b128 a[196:199], v221
    v_exp_f32 v197, v61
    v_add_f32 v242, v242, v196
    v_mfma_f32_32x32x16_bf16 v[112:127], a[204:207], v[100:103], v[112:127]
    ds_read_b128 a[200:203], v222
    v_exp_f32 v198, v62
    v_add_f32 v242, v242, v197
    v_cvt_pk_bf16_f32 v166, v196, v197
    v_mfma_f32_32x32x16_bf16 v[112:127], a[208:211], v[104:107], v[112:127]
    ds_read_b128 a[204:207], v223
    v_exp_f32 v199, v63
    v_add_f32 v242, v242, v198
    v_mfma_f32_32x32x16_bf16 v[112:127], a[212:215], v[108:111], v[112:127]
    ds_read_b128 a[208:211], v224
    v_add_f32 v242, v242, v199
    v_cvt_pk_bf16_f32 v167, v198, v199
    v_cmp_lt_f32 vcc, s35, v242
    v_exp_f32 v196, v144
    v_mfma_f32_32x32x16_bf16 v[112:127], a[216:219], v[80:83], v[112:127]
    ds_read_b128 a[212:215], v225
    v_exp_f32 v197, v145
    v_mfma_f32_32x32x16_bf16 v[112:127], a[220:223], v[84:87], v[112:127]
    ds_read_b128 a[216:219], v226
    s_cbranch_vccnz FX70
FX70_RET:
    v_add_f32 v239, v239, v242
    v_exp_f32 v198, v146
    v_add_f32 v244, v196, v197
    v_cvt_pk_bf16_f32 v176, v196, v197
    v_mfma_f32_32x32x16_bf16 a[64:79], a[224:227], v[168:171], a[64:79]
    ds_read_b128 a[220:223], v227
    v_exp_f32 v199, v147
    v_add_f32 v244, v244, v198
    v_mfma_f32_32x32x16_bf16 a[80:95], a[228:231], v[168:171], a[80:95]
    ds_read_b64_tr_b16 a[224:225], v228 offset:16384
    ds_read_b64_tr_b16 a[226:227], v228 offset:18432
    v_exp_f32 v196, v148
    v_add_f32 v244, v244, v199
    v_cvt_pk_bf16_f32 v177, v198, v199
    v_mfma_f32_32x32x16_bf16 a[96:111], a[232:235], v[168:171], a[96:111]
    ds_read_b64_tr_b16 a[228:229], v229 offset:16384
    ds_read_b64_tr_b16 a[230:231], v229 offset:18432
    v_exp_f32 v197, v149
    v_add_f32 v244, v244, v196
    v_mfma_f32_32x32x16_bf16 a[112:127], a[236:239], v[168:171], a[112:127]
    ds_read_b64_tr_b16 a[232:233], v230 offset:16384
    ds_read_b64_tr_b16 a[234:235], v230 offset:18432
    v_exp_f32 v198, v150
    v_add_f32 v244, v244, v197
    v_cvt_pk_bf16_f32 v178, v196, v197
    v_mfma_f32_32x32x16_bf16 a[64:79], a[240:243], v[172:175], a[64:79]
    ds_read_b64_tr_b16 a[236:237], v231 offset:16384
    ds_read_b64_tr_b16 a[238:239], v231 offset:18432
    v_exp_f32 v199, v151
    v_add_f32 v244, v244, v198
    v_mfma_f32_32x32x16_bf16 a[80:95], a[244:247], v[172:175], a[80:95]
    ds_read_b64_tr_b16 a[240:241], v228 offset:20480
    ds_read_b64_tr_b16 a[242:243], v228 offset:22528
    v_add_f32 v244, v244, v199
    v_cvt_pk_bf16_f32 v179, v198, v199
    v_exp_f32 v196, v112
    v_mfma_f32_32x32x16_bf16 a[96:111], a[248:251], v[172:175], a[96:111]
    ds_read_b64_tr_b16 a[244:245], v229 offset:20480
    ds_read_b64_tr_b16 a[246:247], v229 offset:22528
    v_exp_f32 v197, v113
    v_mfma_f32_32x32x16_bf16 a[112:127], a[252:255], v[172:175], a[112:127]
    ds_read_b64_tr_b16 a[248:249], v230 offset:20480
    ds_read_b64_tr_b16 a[250:251], v230 offset:22528
    v_exp_f32 v198, v114
    v_add_f32 v243, v196, v197
    v_cvt_pk_bf16_f32 v168, v196, v197
    s_sub_u32 s39, s39, 1
    s_cmp_lg_u32 s39, 0
    s_cbranch_scc1 W3_AL
    ds_read_b64_tr_b16 a[252:253], v231 offset:20480
    ds_read_b64_tr_b16 a[254:255], v231 offset:22528
    s_add_u32 s46, s54, 0
    v_exp_f32 v199, v115
    v_add_f32 v243, v243, v198
    v_exp_f32 v196, v116
    v_add_f32 v243, v243, v199
    v_cvt_pk_bf16_f32 v169, v198, v199
    buffer_load_dwordx4 v[16:19], v245, s[24:27], s46 offen
    v_exp_f32 v197, v117
    v_add_f32 v243, v243, v196
    v_exp_f32 v198, v118
    v_add_f32 v243, v243, v197
    v_cvt_pk_bf16_f32 v170, v196, v197
    buffer_load_dwordx4 v[20:23], v245, s[24:27], s46 offen offset:1024
    v_exp_f32 v199, v119
    v_add_f32 v243, v243, v198
    v_exp_f32 v196, v120
    v_add_f32 v243, v243, v199
    v_cvt_pk_bf16_f32 v171, v198, v199
    buffer_load_dwordx4 v[24:27], v245, s[24:27], s46 offen offset:2048
    v_exp_f32 v197, v121
    v_add_f32 v243, v243, v196
    v_exp_f32 v198, v122
    v_add_f32 v243, v243, v197
    v_cvt_pk_bf16_f32 v172, v196, v197
    s_waitcnt lgkmcnt(0)
    v_mfma_f32_32x32x16_bf16 a[0:15], a[224:227], v[160:163], a[0:15]
    buffer_load_dwordx4 v[28:31], v245, s[24:27], s46 offen offset:3072
    v_exp_f32 v199, v123
    v_add_f32 v243, v243, v198
    v_mfma_f32_32x32x16_bf16 a[16:31], a[228:231], v[160:163], a[16:31]
    v_exp_f32 v196, v124
    v_add_f32 v243, v243, v199
    v_cvt_pk_bf16_f32 v173, v198, v199
    v_mfma_f32_32x32x16_bf16 a[32:47], a[232:235], v[160:163], a[32:47]
    s_add_u32 s46, s54, 4096
    v_exp_f32 v197, v125
    v_add_f32 v243, v243, v196
    v_mfma_f32_32x32x16_bf16 a[48:63], a[236:239], v[160:163], a[48:63]
    v_exp_f32 v198, v126
    v_add_f32 v243, v243, v197
    v_cvt_pk_bf16_f32 v174, v196, v197
    v_mfma_f32_32x32x16_bf16 a[0:15], a[240:243], v[164:167], a[0:15]
    buffer_load_dwordx4 v[32:35], v245, s[24:27], s46 offen
    v_exp_f32 v199, v127
    v_add_f32 v243, v243, v198
    v_mfma_f32_32x32x16_bf16 a[16:31], a[244:247], v[164:167], a[16:31]
    v_add_f32 v243, v243, v199
    v_cvt_pk_bf16_f32 v175, v198, v199
    v_cmp_lt_f32 vcc, s35, v243
    v_exp_f32 v196, v152
    v_mfma_f32_32x32x16_bf16 a[32:47], a[248:251], v[164:167], a[32:47]
    buffer_load_dwordx4 v[36:39], v245, s[24:27], s46 offen offset:1024
    v_exp_f32 v197, v153
    v_add_f32 v244, v244, v196
    v_mfma_f32_32x32x16_bf16 a[48:63], a[252:255], v[164:167], a[48:63]
    s_cbranch_vccnz FX71
FX71_RET:
    v_add_f32 v240, v240, v243
    v_exp_f32 v198, v154
    v_add_f32 v244, v244, v197
    v_cvt_pk_bf16_f32 v180, v196, v197
    buffer_load_dwordx4 v[40:43], v245, s[24:27], s46 offen offset:2048
    v_exp_f32 v199, v155
    v_add_f32 v244, v244, v198
    v_exp_f32 v196, v156
    v_add_f32 v244, v244, v199
    v_cvt_pk_bf16_f32 v181, v198, v199
    buffer_load_dwordx4 v[44:47], v245, s[24:27], s46 offen offset:3072
    v_exp_f32 v197, v157
    v_add_f32 v244, v244, v196
    v_exp_f32 v198, v158
    v_add_f32 v244, v244, v197
    v_cvt_pk_bf16_f32 v182, v196, v197
    s_add_u32 s46, s54, 8192
    v_exp_f32 v199, v159
    v_add_f32 v244, v244, v198
    v_add_f32 v244, v244, v199
    v_cvt_pk_bf16_f32 v183, v198, v199
    v_cmp_lt_f32 vcc, s35, v244
    buffer_load_dwordx4 v[80:83], v245, s[24:27], s46 offen
    s_cbranch_vccnz FX72
FX72_RET:
    v_add_f32 v241, v241, v244
    v_mfma_f32_32x32x16_bf16 a[128:143], a[224:227], v[176:179], a[128:143]
    buffer_load_dwordx4 v[84:87], v245, s[24:27], s46 offen offset:1024
    v_mfma_f32_32x32x16_bf16 a[144:159], a[228:231], v[176:179], a[144:159]
    v_mfma_f32_32x32x16_bf16 a[160:175], a[232:235], v[176:179], a[160:175]
    buffer_load_dwordx4 v[88:91], v245, s[24:27], s46 offen offset:2048
    v_mfma_f32_32x32x16_bf16 a[176:191], a[236:239], v[176:179], a[176:191]
    v_mfma_f32_32x32x16_bf16 a[128:143], a[240:243], v[180:183], a[128:143]
    buffer_load_dwordx4 v[92:95], v245, s[24:27], s46 offen offset:3072
    v_mfma_f32_32x32x16_bf16 a[144:159], a[244:247], v[180:183], a[144:159]
    v_mfma_f32_32x32x16_bf16 a[160:175], a[248:251], v[180:183], a[160:175]
    s_add_u32 s46, s54, 12288
    v_mfma_f32_32x32x16_bf16 a[176:191], a[252:255], v[180:183], a[176:191]
    v_mfma_f32_32x32x16_bf16 a[64:79], a[224:227], v[168:171], a[64:79]
    buffer_load_dwordx4 v[96:99], v245, s[24:27], s46 offen
    v_mfma_f32_32x32x16_bf16 a[80:95], a[228:231], v[168:171], a[80:95]
    v_mfma_f32_32x32x16_bf16 a[96:111], a[232:235], v[168:171], a[96:111]
    buffer_load_dwordx4 v[100:103], v245, s[24:27], s46 offen offset:1024
    v_mfma_f32_32x32x16_bf16 a[112:127], a[236:239], v[168:171], a[112:127]
    v_mfma_f32_32x32x16_bf16 a[64:79], a[240:243], v[172:175], a[64:79]
    buffer_load_dwordx4 v[104:107], v245, s[24:27], s46 offen offset:2048
    v_mfma_f32_32x32x16_bf16 a[80:95], a[244:247], v[172:175], a[80:95]
    v_mfma_f32_32x32x16_bf16 a[96:111], a[248:251], v[172:175], a[96:111]
    buffer_load_dwordx4 v[108:111], v245, s[24:27], s46 offen offset:3072
    v_mfma_f32_32x32x16_bf16 a[112:127], a[252:255], v[172:175], a[112:127]
    v_mov_b32 v2, v241
    s_nop 1
    v_permlane32_swap_b32 v241, v2
    v_add_f32 v241, v241, v2
    v_mov_b32 v2, v239
    s_nop 1
    v_permlane32_swap_b32 v239, v2
    v_add_f32 v239, v239, v2
    v_mov_b32 v2, v240
    s_nop 1
    v_permlane32_swap_b32 v240, v2
    v_add_f32 v240, v240, v2
    v_and_b32 v2, 31, v1
    v_lshlrev_b32 v2, 2, v2
    v_add_u32 v2, 159744, v2
    v_sub_f32 v3, 0, v204
    ds_write_b32 v2, v3 offset:768
    ds_write_b32 v2, v241 offset:896
    v_rcp_f32 v48, v239
    s_nop 0
    v_mov_b32 v49, v48
    v_rcp_f32 v50, v240
    s_nop 0
    v_mov_b32 v51, v50
    s_add_u32 s42, s53, 12288
    v_accvgpr_read_b32 v112, a0
    v_accvgpr_read_b32 v113, a1
    v_accvgpr_read_b32 v114, a2
    v_accvgpr_read_b32 v115, a3
    v_accvgpr_read_b32 v116, a4
    v_accvgpr_read_b32 v117, a5
    v_accvgpr_read_b32 v118, a6
    v_accvgpr_read_b32 v119, a7
    v_pk_mul_f32 v[112:113], v[112:113], v[48:49]
    v_pk_mul_f32 v[114:115], v[114:115], v[48:49]
    v_pk_mul_f32 v[116:117], v[116:117], v[48:49]
    v_pk_mul_f32 v[118:119], v[118:119], v[48:49]
    v_cvt_pk_bf16_f32 v176, v112, v113
    v_cvt_pk_bf16_f32 v177, v114, v115
    v_cvt_pk_bf16_f32 v178, v116, v117
    v_cvt_pk_bf16_f32 v179, v118, v119
    buffer_store_dwordx4 v[176:179], v238, s[24:27], s42 offen sc1
    v_accvgpr_read_b32 v120, a8
    v_accvgpr_read_b32 v121, a9
    v_accvgpr_read_b32 v122, a10
    v_accvgpr_read_b32 v123, a11
    v_accvgpr_read_b32 v124, a12
    v_accvgpr_read_b32 v125, a13
    v_accvgpr_read_b32 v126, a14
    v_accvgpr_read_b32 v127, a15
    v_pk_mul_f32 v[120:121], v[120:121], v[48:49]
    v_pk_mul_f32 v[122:123], v[122:123], v[48:49]
    v_pk_mul_f32 v[124:125], v[124:125], v[48:49]
    v_pk_mul_f32 v[126:127], v[126:127], v[48:49]
    v_cvt_pk_bf16_f32 v180, v120, v121
    v_cvt_pk_bf16_f32 v181, v122, v123
    v_cvt_pk_bf16_f32 v182, v124, v125
    v_cvt_pk_bf16_f32 v183, v126, v127
    buffer_store_dwordx4 v[180:183], v238, s[24:27], s42 offen offset:512 sc1
    s_add_u32 s42, s53, 159744
    v_accvgpr_read_b32 v112, a16
    v_accvgpr_read_b32 v113, a17
    v_accvgpr_read_b32 v114, a18
    v_accvgpr_read_b32 v115, a19
    v_accvgpr_read_b32 v116, a20
    v_accvgpr_read_b32 v117, a21
    v_accvgpr_read_b32 v118, a22
    v_accvgpr_read_b32 v119, a23
    v_pk_mul_f32 v[112:113], v[112:113], v[48:49]
    v_pk_mul_f32 v[114:115], v[114:115], v[48:49]
    v_pk_mul_f32 v[116:117], v[116:117], v[48:49]
    v_pk_mul_f32 v[118:119], v[118:119], v[48:49]
    v_cvt_pk_bf16_f32 v184, v112, v113
    v_cvt_pk_bf16_f32 v185, v114, v115
    v_cvt_pk_bf16_f32 v186, v116, v117
    v_cvt_pk_bf16_f32 v187, v118, v119
    buffer_store_dwordx4 v[184:187], v238, s[24:27], s42 offen sc1
    v_accvgpr_read_b32 v120, a24
    v_accvgpr_read_b32 v121, a25
    v_accvgpr_read_b32 v122, a26
    v_accvgpr_read_b32 v123, a27
    v_accvgpr_read_b32 v124, a28
    v_accvgpr_read_b32 v125, a29
    v_accvgpr_read_b32 v126, a30
    v_accvgpr_read_b32 v127, a31
    v_pk_mul_f32 v[120:121], v[120:121], v[48:49]
    v_pk_mul_f32 v[122:123], v[122:123], v[48:49]
    v_pk_mul_f32 v[124:125], v[124:125], v[48:49]
    v_pk_mul_f32 v[126:127], v[126:127], v[48:49]
    v_cvt_pk_bf16_f32 v188, v120, v121
    v_cvt_pk_bf16_f32 v189, v122, v123
    v_cvt_pk_bf16_f32 v190, v124, v125
    v_cvt_pk_bf16_f32 v191, v126, v127
    buffer_store_dwordx4 v[188:191], v238, s[24:27], s42 offen offset:512 sc1
    s_add_u32 s42, s53, 307200
    v_accvgpr_read_b32 v112, a32
    v_accvgpr_read_b32 v113, a33
    v_accvgpr_read_b32 v114, a34
    v_accvgpr_read_b32 v115, a35
    v_accvgpr_read_b32 v116, a36
    v_accvgpr_read_b32 v117, a37
    v_accvgpr_read_b32 v118, a38
    v_accvgpr_read_b32 v119, a39
    v_pk_mul_f32 v[112:113], v[112:113], v[48:49]
    v_pk_mul_f32 v[114:115], v[114:115], v[48:49]
    v_pk_mul_f32 v[116:117], v[116:117], v[48:49]
    v_pk_mul_f32 v[118:119], v[118:119], v[48:49]
    v_cvt_pk_bf16_f32 v176, v112, v113
    v_cvt_pk_bf16_f32 v177, v114, v115
    v_cvt_pk_bf16_f32 v178, v116, v117
    v_cvt_pk_bf16_f32 v179, v118, v119
    buffer_store_dwordx4 v[176:179], v238, s[24:27], s42 offen sc1
    v_accvgpr_read_b32 v120, a40
    v_accvgpr_read_b32 v121, a41
    v_accvgpr_read_b32 v122, a42
    v_accvgpr_read_b32 v123, a43
    v_accvgpr_read_b32 v124, a44
    v_accvgpr_read_b32 v125, a45
    v_accvgpr_read_b32 v126, a46
    v_accvgpr_read_b32 v127, a47
    v_pk_mul_f32 v[120:121], v[120:121], v[48:49]
    v_pk_mul_f32 v[122:123], v[122:123], v[48:49]
    v_pk_mul_f32 v[124:125], v[124:125], v[48:49]
    v_pk_mul_f32 v[126:127], v[126:127], v[48:49]
    v_cvt_pk_bf16_f32 v180, v120, v121
    v_cvt_pk_bf16_f32 v181, v122, v123
    v_cvt_pk_bf16_f32 v182, v124, v125
    v_cvt_pk_bf16_f32 v183, v126, v127
    buffer_store_dwordx4 v[180:183], v238, s[24:27], s42 offen offset:512 sc1
    s_add_u32 s42, s53, 454656
    v_accvgpr_read_b32 v112, a48
    v_accvgpr_read_b32 v113, a49
    v_accvgpr_read_b32 v114, a50
    v_accvgpr_read_b32 v115, a51
    v_accvgpr_read_b32 v116, a52
    v_accvgpr_read_b32 v117, a53
    v_accvgpr_read_b32 v118, a54
    v_accvgpr_read_b32 v119, a55
    v_pk_mul_f32 v[112:113], v[112:113], v[48:49]
    v_pk_mul_f32 v[114:115], v[114:115], v[48:49]
    v_pk_mul_f32 v[116:117], v[116:117], v[48:49]
    v_pk_mul_f32 v[118:119], v[118:119], v[48:49]
    v_cvt_pk_bf16_f32 v184, v112, v113
    v_cvt_pk_bf16_f32 v185, v114, v115
    v_cvt_pk_bf16_f32 v186, v116, v117
    v_cvt_pk_bf16_f32 v187, v118, v119
    buffer_store_dwordx4 v[184:187], v238, s[24:27], s42 offen sc1
    v_accvgpr_read_b32 v120, a56
    v_accvgpr_read_b32 v121, a57
    v_accvgpr_read_b32 v122, a58
    v_accvgpr_read_b32 v123, a59
    v_accvgpr_read_b32 v124, a60
    v_accvgpr_read_b32 v125, a61
    v_accvgpr_read_b32 v126, a62
    v_accvgpr_read_b32 v127, a63
    v_pk_mul_f32 v[120:121], v[120:121], v[48:49]
    v_pk_mul_f32 v[122:123], v[122:123], v[48:49]
    v_pk_mul_f32 v[124:125], v[124:125], v[48:49]
    v_pk_mul_f32 v[126:127], v[126:127], v[48:49]
    v_cvt_pk_bf16_f32 v188, v120, v121
    v_cvt_pk_bf16_f32 v189, v122, v123
    v_cvt_pk_bf16_f32 v190, v124, v125
    v_cvt_pk_bf16_f32 v191, v126, v127
    buffer_store_dwordx4 v[188:191], v238, s[24:27], s42 offen offset:512 sc1
    s_waitcnt lgkmcnt(0)
    s_barrier
    ds_read_b32 v52, v2
    ds_read_b32 v56, v2 offset:128
    ds_read_b32 v53, v2 offset:256
    ds_read_b32 v57, v2 offset:384
    ds_read_b32 v54, v2 offset:512
    ds_read_b32 v58, v2 offset:640
    ds_read_b32 v55, v2 offset:768
    ds_read_b32 v59, v2 offset:896
    ds_write_b128 v254, v[246:249]
    ds_write_b128 v254, v[250:253] offset:1024
    s_waitcnt lgkmcnt(5)
    v_max3_f32 v4, v52, v53, v54
    s_waitcnt lgkmcnt(3)
    v_max_f32 v4, v4, v55
    v_sub_f32 v52, v52, v4
    v_exp_f32 v52, v52
    v_sub_f32 v53, v53, v4
    v_exp_f32 v53, v53
    v_sub_f32 v54, v54, v4
    v_exp_f32 v54, v54
    v_sub_f32 v55, v55, v4
    v_exp_f32 v55, v55
    v_mul_f32 v60, v52, v56
    v_fma_f32 v60, v53, v57, v60
    v_fma_f32 v60, v54, v58, v60
    s_waitcnt lgkmcnt(2)
    v_fma_f32 v60, v55, v59, v60
    v_rcp_f32 v60, v60
    s_nop 0
    v_mul_f32 v60, v60, v55
    v_mov_b32 v61, v60
    v_add_u32 v6, 98304, v245
    v_accvgpr_read_b32 v128, a128
    v_accvgpr_read_b32 v129, a129
    v_accvgpr_read_b32 v130, a130
    v_accvgpr_read_b32 v131, a131
    v_pk_mul_f32 v[128:129], v[128:129], v[60:61]
    v_pk_mul_f32 v[130:131], v[130:131], v[60:61]
    ds_write_b128 v6, v[128:131] offset:8192
    v_accvgpr_read_b32 v132, a132
    v_accvgpr_read_b32 v133, a133
    v_accvgpr_read_b32 v134, a134
    v_accvgpr_read_b32 v135, a135
    v_pk_mul_f32 v[132:133], v[132:133], v[60:61]
    v_pk_mul_f32 v[134:135], v[134:135], v[60:61]
    ds_write_b128 v6, v[132:135] offset:9216
    v_accvgpr_read_b32 v136, a136
    v_accvgpr_read_b32 v137, a137
    v_accvgpr_read_b32 v138, a138
    v_accvgpr_read_b32 v139, a139
    v_pk_mul_f32 v[136:137], v[136:137], v[60:61]
    v_pk_mul_f32 v[138:139], v[138:139], v[60:61]
    ds_write_b128 v6, v[136:139] offset:10240
    v_accvgpr_read_b32 v140, a140
    v_accvgpr_read_b32 v141, a141
    v_accvgpr_read_b32 v142, a142
    v_accvgpr_read_b32 v143, a143
    v_pk_mul_f32 v[140:141], v[140:141], v[60:61]
    v_pk_mul_f32 v[142:143], v[142:143], v[60:61]
    ds_write_b128 v6, v[140:143] offset:11264
    v_accvgpr_read_b32 v128, a144
    v_accvgpr_read_b32 v129, a145
    v_accvgpr_read_b32 v130, a146
    v_accvgpr_read_b32 v131, a147
    v_pk_mul_f32 v[128:129], v[128:129], v[60:61]
    v_pk_mul_f32 v[130:131], v[130:131], v[60:61]
    ds_write_b128 v6, v[128:131] offset:16384
    v_accvgpr_read_b32 v132, a148
    v_accvgpr_read_b32 v133, a149
    v_accvgpr_read_b32 v134, a150
    v_accvgpr_read_b32 v135, a151
    v_pk_mul_f32 v[132:133], v[132:133], v[60:61]
    v_pk_mul_f32 v[134:135], v[134:135], v[60:61]
    ds_write_b128 v6, v[132:135] offset:17408
    v_accvgpr_read_b32 v136, a152
    v_accvgpr_read_b32 v137, a153
    v_accvgpr_read_b32 v138, a154
    v_accvgpr_read_b32 v139, a155
    v_pk_mul_f32 v[136:137], v[136:137], v[60:61]
    v_pk_mul_f32 v[138:139], v[138:139], v[60:61]
    ds_write_b128 v6, v[136:139] offset:18432
    v_accvgpr_read_b32 v140, a156
    v_accvgpr_read_b32 v141, a157
    v_accvgpr_read_b32 v142, a158
    v_accvgpr_read_b32 v143, a159
    v_pk_mul_f32 v[140:141], v[140:141], v[60:61]
    v_pk_mul_f32 v[142:143], v[142:143], v[60:61]
    ds_write_b128 v6, v[140:143] offset:19456
    v_accvgpr_read_b32 v128, a160
    v_accvgpr_read_b32 v129, a161
    v_accvgpr_read_b32 v130, a162
    v_accvgpr_read_b32 v131, a163
    v_pk_mul_f32 v[128:129], v[128:129], v[60:61]
    v_pk_mul_f32 v[130:131], v[130:131], v[60:61]
    ds_write_b128 v6, v[128:131] offset:24576
    v_accvgpr_read_b32 v132, a164
    v_accvgpr_read_b32 v133, a165
    v_accvgpr_read_b32 v134, a166
    v_accvgpr_read_b32 v135, a167
    v_pk_mul_f32 v[132:133], v[132:133], v[60:61]
    v_pk_mul_f32 v[134:135], v[134:135], v[60:61]
    ds_write_b128 v6, v[132:135] offset:25600
    v_accvgpr_read_b32 v136, a168
    v_accvgpr_read_b32 v137, a169
    v_accvgpr_read_b32 v138, a170
    v_accvgpr_read_b32 v139, a171
    v_pk_mul_f32 v[136:137], v[136:137], v[60:61]
    v_pk_mul_f32 v[138:139], v[138:139], v[60:61]
    ds_write_b128 v6, v[136:139] offset:26624
    v_accvgpr_read_b32 v140, a172
    v_accvgpr_read_b32 v141, a173
    v_accvgpr_read_b32 v142, a174
    v_accvgpr_read_b32 v143, a175
    v_pk_mul_f32 v[140:141], v[140:141], v[60:61]
    v_pk_mul_f32 v[142:143], v[142:143], v[60:61]
    ds_write_b128 v6, v[140:143] offset:27648
    v_accvgpr_read_b32 v64, a176
    v_accvgpr_read_b32 v65, a177
    v_accvgpr_read_b32 v66, a178
    v_accvgpr_read_b32 v67, a179
    v_pk_mul_f32 v[64:65], v[64:65], v[60:61]
    v_pk_mul_f32 v[66:67], v[66:67], v[60:61]
    v_accvgpr_read_b32 v68, a180
    v_accvgpr_read_b32 v69, a181
    v_accvgpr_read_b32 v70, a182
    v_accvgpr_read_b32 v71, a183
    v_pk_mul_f32 v[68:69], v[68:69], v[60:61]
    v_pk_mul_f32 v[70:71], v[70:71], v[60:61]
    v_accvgpr_read_b32 v72, a184
    v_accvgpr_read_b32 v73, a185
    v_accvgpr_read_b32 v74, a186
    v_accvgpr_read_b32 v75, a187
    v_pk_mul_f32 v[72:73], v[72:73], v[60:61]
    v_pk_mul_f32 v[74:75], v[74:75], v[60:61]
    v_accvgpr_read_b32 v76, a188
    v_accvgpr_read_b32 v77, a189
    v_accvgpr_read_b32 v78, a190
    v_accvgpr_read_b32 v79, a191
    v_pk_mul_f32 v[76:77], v[76:77], v[60:61]
    v_pk_mul_f32 v[78:79], v[78:79], v[60:61]
    s_waitcnt lgkmcnt(0)
    s_barrier
    ds_read_b128 v[128:131], v6 offset:45056
    ds_read_b128 v[132:135], v6 offset:46080
    ds_read_b128 v[136:139], v6 offset:47104
    ds_read_b128 v[140:143], v6 offset:48128
    ds_read_b128 v[144:147], v6 offset:49152
    ds_read_b128 v[148:151], v6 offset:50176
    ds_read_b128 v[152:155], v6 offset:51200
    ds_read_b128 v[156:159], v6 offset:52224
    ds_read_b128 v[160:163], v6 offset:53248
    ds_read_b128 v[164:167], v6 offset:54272
    ds_read_b128 v[168:171], v6 offset:55296
    ds_read_b128 v[172:175], v6 offset:56320
    s_add_u32 s42, s53, 14336
    v_accvgpr_read_b32 v112, a64
    v_accvgpr_read_b32 v113, a65
    v_accvgpr_read_b32 v114, a66
    v_accvgpr_read_b32 v115, a67
    v_accvgpr_read_b32 v116, a68
    v_accvgpr_read_b32 v117, a69
    v_accvgpr_read_b32 v118, a70
    v_accvgpr_read_b32 v119, a71
    v_pk_mul_f32 v[112:113], v[112:113], v[50:51]
    v_pk_mul_f32 v[114:115], v[114:115], v[50:51]
    v_pk_mul_f32 v[116:117], v[116:117], v[50:51]
    v_pk_mul_f32 v[118:119], v[118:119], v[50:51]
    v_cvt_pk_bf16_f32 v176, v112, v113
    v_cvt_pk_bf16_f32 v177, v114, v115
    v_cvt_pk_bf16_f32 v178, v116, v117
    v_cvt_pk_bf16_f32 v179, v118, v119
    buffer_store_dwordx4 v[176:179], v238, s[24:27], s42 offen sc1
    v_accvgpr_read_b32 v120, a72
    v_accvgpr_read_b32 v121, a73
    v_accvgpr_read_b32 v122, a74
    v_accvgpr_read_b32 v123, a75
    v_accvgpr_read_b32 v124, a76
    v_accvgpr_read_b32 v125, a77
    v_accvgpr_read_b32 v126, a78
    v_accvgpr_read_b32 v127, a79
    v_pk_mul_f32 v[120:121], v[120:121], v[50:51]
    v_pk_mul_f32 v[122:123], v[122:123], v[50:51]
    v_pk_mul_f32 v[124:125], v[124:125], v[50:51]
    v_pk_mul_f32 v[126:127], v[126:127], v[50:51]
    v_cvt_pk_bf16_f32 v180, v120, v121
    v_cvt_pk_bf16_f32 v181, v122, v123
    v_cvt_pk_bf16_f32 v182, v124, v125
    v_cvt_pk_bf16_f32 v183, v126, v127
    buffer_store_dwordx4 v[180:183], v238, s[24:27], s42 offen offset:512 sc1
    s_add_u32 s42, s53, 161792
    v_accvgpr_read_b32 v112, a80
    v_accvgpr_read_b32 v113, a81
    v_accvgpr_read_b32 v114, a82
    v_accvgpr_read_b32 v115, a83
    v_accvgpr_read_b32 v116, a84
    v_accvgpr_read_b32 v117, a85
    v_accvgpr_read_b32 v118, a86
    v_accvgpr_read_b32 v119, a87
    v_pk_mul_f32 v[112:113], v[112:113], v[50:51]
    v_pk_mul_f32 v[114:115], v[114:115], v[50:51]
    v_pk_mul_f32 v[116:117], v[116:117], v[50:51]
    v_pk_mul_f32 v[118:119], v[118:119], v[50:51]
    v_cvt_pk_bf16_f32 v184, v112, v113
    v_cvt_pk_bf16_f32 v185, v114, v115
    v_cvt_pk_bf16_f32 v186, v116, v117
    v_cvt_pk_bf16_f32 v187, v118, v119
    buffer_store_dwordx4 v[184:187], v238, s[24:27], s42 offen sc1
    v_accvgpr_read_b32 v120, a88
    v_accvgpr_read_b32 v121, a89
    v_accvgpr_read_b32 v122, a90
    v_accvgpr_read_b32 v123, a91
    v_accvgpr_read_b32 v124, a92
    v_accvgpr_read_b32 v125, a93
    v_accvgpr_read_b32 v126, a94
    v_accvgpr_read_b32 v127, a95
    v_pk_mul_f32 v[120:121], v[120:121], v[50:51]
    v_pk_mul_f32 v[122:123], v[122:123], v[50:51]
    v_pk_mul_f32 v[124:125], v[124:125], v[50:51]
    v_pk_mul_f32 v[126:127], v[126:127], v[50:51]
    v_cvt_pk_bf16_f32 v188, v120, v121
    v_cvt_pk_bf16_f32 v189, v122, v123
    v_cvt_pk_bf16_f32 v190, v124, v125
    v_cvt_pk_bf16_f32 v191, v126, v127
    buffer_store_dwordx4 v[188:191], v238, s[24:27], s42 offen offset:512 sc1
    s_add_u32 s42, s53, 309248
    v_accvgpr_read_b32 v112, a96
    v_accvgpr_read_b32 v113, a97
    v_accvgpr_read_b32 v114, a98
    v_accvgpr_read_b32 v115, a99
    v_accvgpr_read_b32 v116, a100
    v_accvgpr_read_b32 v117, a101
    v_accvgpr_read_b32 v118, a102
    v_accvgpr_read_b32 v119, a103
    v_pk_mul_f32 v[112:113], v[112:113], v[50:51]
    v_pk_mul_f32 v[114:115], v[114:115], v[50:51]
    v_pk_mul_f32 v[116:117], v[116:117], v[50:51]
    v_pk_mul_f32 v[118:119], v[118:119], v[50:51]
    v_cvt_pk_bf16_f32 v176, v112, v113
    v_cvt_pk_bf16_f32 v177, v114, v115
    v_cvt_pk_bf16_f32 v178, v116, v117
    v_cvt_pk_bf16_f32 v179, v118, v119
    buffer_store_dwordx4 v[176:179], v238, s[24:27], s42 offen sc1
    v_accvgpr_read_b32 v120, a104
    v_accvgpr_read_b32 v121, a105
    v_accvgpr_read_b32 v122, a106
    v_accvgpr_read_b32 v123, a107
    v_accvgpr_read_b32 v124, a108
    v_accvgpr_read_b32 v125, a109
    v_accvgpr_read_b32 v126, a110
    v_accvgpr_read_b32 v127, a111
    v_pk_mul_f32 v[120:121], v[120:121], v[50:51]
    v_pk_mul_f32 v[122:123], v[122:123], v[50:51]
    v_pk_mul_f32 v[124:125], v[124:125], v[50:51]
    v_pk_mul_f32 v[126:127], v[126:127], v[50:51]
    v_cvt_pk_bf16_f32 v180, v120, v121
    v_cvt_pk_bf16_f32 v181, v122, v123
    v_cvt_pk_bf16_f32 v182, v124, v125
    v_cvt_pk_bf16_f32 v183, v126, v127
    buffer_store_dwordx4 v[180:183], v238, s[24:27], s42 offen offset:512 sc1
    s_add_u32 s42, s53, 456704
    v_accvgpr_read_b32 v112, a112
    v_accvgpr_read_b32 v113, a113
    v_accvgpr_read_b32 v114, a114
    v_accvgpr_read_b32 v115, a115
    v_accvgpr_read_b32 v116, a116
    v_accvgpr_read_b32 v117, a117
    v_accvgpr_read_b32 v118, a118
    v_accvgpr_read_b32 v119, a119
    v_pk_mul_f32 v[112:113], v[112:113], v[50:51]
    v_pk_mul_f32 v[114:115], v[114:115], v[50:51]
    v_pk_mul_f32 v[116:117], v[116:117], v[50:51]
    v_pk_mul_f32 v[118:119], v[118:119], v[50:51]
    v_cvt_pk_bf16_f32 v184, v112, v113
    v_cvt_pk_bf16_f32 v185, v114, v115
    v_cvt_pk_bf16_f32 v186, v116, v117
    v_cvt_pk_bf16_f32 v187, v118, v119
    buffer_store_dwordx4 v[184:187], v238, s[24:27], s42 offen sc1
    v_accvgpr_read_b32 v120, a120
    v_accvgpr_read_b32 v121, a121
    v_accvgpr_read_b32 v122, a122
    v_accvgpr_read_b32 v123, a123
    v_accvgpr_read_b32 v124, a124
    v_accvgpr_read_b32 v125, a125
    v_accvgpr_read_b32 v126, a126
    v_accvgpr_read_b32 v127, a127
    v_pk_mul_f32 v[120:121], v[120:121], v[50:51]
    v_pk_mul_f32 v[122:123], v[122:123], v[50:51]
    v_pk_mul_f32 v[124:125], v[124:125], v[50:51]
    v_pk_mul_f32 v[126:127], v[126:127], v[50:51]
    v_cvt_pk_bf16_f32 v188, v120, v121
    v_cvt_pk_bf16_f32 v189, v122, v123
    v_cvt_pk_bf16_f32 v190, v124, v125
    v_cvt_pk_bf16_f32 v191, v126, v127
    buffer_store_dwordx4 v[188:191], v238, s[24:27], s42 offen offset:512 sc1
    s_waitcnt lgkmcnt(11)
    v_pk_add_f32 v[64:65], v[64:65], v[128:129]
    v_pk_add_f32 v[66:67], v[66:67], v[130:131]
    s_waitcnt lgkmcnt(10)
    v_pk_add_f32 v[68:69], v[68:69], v[132:133]
    v_pk_add_f32 v[70:71], v[70:71], v[134:135]
    s_waitcnt lgkmcnt(9)
    v_pk_add_f32 v[72:73], v[72:73], v[136:137]
    v_pk_add_f32 v[74:75], v[74:75], v[138:139]
    s_waitcnt lgkmcnt(8)
    v_pk_add_f32 v[76:77], v[76:77], v[140:141]
    v_pk_add_f32 v[78:79], v[78:79], v[142:143]
    s_waitcnt lgkmcnt(7)
    v_pk_add_f32 v[64:65], v[64:65], v[144:145]
    v_pk_add_f32 v[66:67], v[66:67], v[146:147]
    s_waitcnt lgkmcnt(6)
    v_pk_add_f32 v[68:69], v[68:69], v[148:149]
    v_pk_add_f32 v[70:71], v[70:71], v[150:151]
    s_waitcnt lgkmcnt(5)
    v_pk_add_f32 v[72:73], v[72:73], v[152:153]
    v_pk_add_f32 v[74:75], v[74:75], v[154:155]
    s_waitcnt lgkmcnt(4)
    v_pk_add_f32 v[76:77], v[76:77], v[156:157]
    v_pk_add_f32 v[78:79], v[78:79], v[158:159]
    s_waitcnt lgkmcnt(3)
    v_pk_add_f32 v[64:65], v[64:65], v[160:161]
    v_pk_add_f32 v[66:67], v[66:67], v[162:163]
    s_waitcnt lgkmcnt(2)
    v_pk_add_f32 v[68:69], v[68:69], v[164:165]
    v_pk_add_f32 v[70:71], v[70:71], v[166:167]
    s_waitcnt lgkmcnt(1)
    v_pk_add_f32 v[72:73], v[72:73], v[168:169]
    v_pk_add_f32 v[74:75], v[74:75], v[170:171]
    s_waitcnt lgkmcnt(0)
    v_pk_add_f32 v[76:77], v[76:77], v[172:173]
    v_pk_add_f32 v[78:79], v[78:79], v[174:175]
    s_waitcnt lgkmcnt(0)
    s_barrier
    s_add_u32 s42, s53, 458752
    v_cvt_pk_bf16_f32 v192, v64, v65
    v_cvt_pk_bf16_f32 v193, v66, v67
    v_cvt_pk_bf16_f32 v194, v68, v69
    v_cvt_pk_bf16_f32 v195, v70, v71
    buffer_store_dwordx4 v[192:195], v238, s[24:27], s42 offen sc1
    v_cvt_pk_bf16_f32 v196, v72, v73
    v_cvt_pk_bf16_f32 v197, v74, v75
    v_cvt_pk_bf16_f32 v198, v76, v77
    v_cvt_pk_bf16_f32 v199, v78, v79
    buffer_store_dwordx4 v[196:199], v238, s[24:27], s42 offen offset:512 sc1
    s_add_u32 s53, s53, 589824
    s_add_u32 s4, s4, 1
    s_cmp_lt_u32 s4, 2
    s_cbranch_scc1 W3_ITEM
    s_branch K1_END
FX1:
    s_call_b64 s[40:41], FIX_a
    s_branch FX1_RET
FX2:
    s_call_b64 s[40:41], FIX_b
    s_branch FX2_RET
FX3:
    s_call_b64 s[40:41], FIX_c
    s_branch FX3_RET
FX4:
    s_call_b64 s[40:41], FIX_a
    s_branch FX4_RET
FX5:
    s_call_b64 s[40:41], FIX_b
    s_branch FX5_RET
FX6:
    s_call_b64 s[40:41], FIX_a
    s_branch FX6_RET
FX7:
    s_call_b64 s[40:41], FIX_b
    s_branch FX7_RET
FX8:
    s_call_b64 s[40:41], FIX_a
    s_branch FX8_RET
FX9:
    s_call_b64 s[40:41], FIX_b
    s_branch FX9_RET
FX10:
    s_call_b64 s[40:41], FIX_a
    s_branch FX10_RET
FX11:
    s_call_b64 s[40:41], FIX_b
    s_branch FX11_RET
FX12:
    s_call_b64 s[40:41], FIX_c
    s_branch FX12_RET
FX13:
    s_call_b64 s[40:41], FIX_a
    s_branch FX13_RET
FX14:
    s_call_b64 s[40:41], FIX_b
    s_branch FX14_RET
FX15:
    s_call_b64 s[40:41], FIX_a
    s_branch FX15_RET
FX16:
    s_call_b64 s[40:41], FIX_b
    s_branch FX16_RET
FX17:
    s_call_b64 s[40:41], FIX_a
    s_branch FX17_RET
FX18:
    s_call_b64 s[40:41], FIX_b
    s_branch FX18_RET
FX19:
    s_call_b64 s[40:41], FIX_a
    s_branch FX19_RET
FX20:
    s_call_b64 s[40:41], FIX_b
    s_branch FX20_RET
FX21:
    s_call_b64 s[40:41], FIX_a
    s_branch FX21_RET
FX22:
    s_call_b64 s[40:41], FIX_b
    s_branch FX22_RET
FX23:
    s_call_b64 s[40:41], FIX_c
    s_branch FX23_RET
FX24:
    s_call_b64 s[40:41], FIX_a
    s_branch FX24_RET
FX25:
    s_call_b64 s[40:41], FIX_b
    s_branch FX25_RET
FX26:
    s_call_b64 s[40:41], FIX_a
    s_branch FX26_RET
FX27:
    s_call_b64 s[40:41], FIX_b
    s_branch FX27_RET
FX28:
    s_call_b64 s[40:41], FIX_a
    s_branch FX28_RET
FX29:
    s_call_b64 s[40:41], FIX_b
    s_branch FX29_RET
FX30:
    s_call_b64 s[40:41], FIX_a
    s_branch FX30_RET
FX31:
    s_call_b64 s[40:41], FIX_b
    s_branch FX31_RET
FX32:
    s_call_b64 s[40:41], FIX_c
    s_branch FX32_RET
FX33:
    s_call_b64 s[40:41], FIX_a
    s_branch FX33_RET
FX34:
    s_call_b64 s[40:41], FIX_b
    s_branch FX34_RET
FX35:
    s_call_b64 s[40:41], FIX_a
    s_branch FX35_RET
FX36:
    s_call_b64 s[40:41], FIX_b
    s_branch FX36_RET
FX37:
    s_call_b64 s[40:41], FIX_a
    s_branch FX37_RET
FX38:
    s_call_b64 s[40:41], FIX_b
    s_branch FX38_RET
FX39:
    s_call_b64 s[40:41], FIX_a
    s_branch FX39_RET
FX40:
    s_call_b64 s[40:41], FIX_b
    s_branch FX40_RET
FX41:
    s_call_b64 s[40:41], FIX_a
    s_branch FX41_RET
FX42:
    s_call_b64 s[40:41], FIX_b
    s_branch FX42_RET
FX43:
    s_call_b64 s[40:41], FIX_c
    s_branch FX43_RET
FX44:
    s_call_b64 s[40:41], FIX_a
    s_branch FX44_RET
FX45:
    s_call_b64 s[40:41], FIX_b
    s_branch FX45_RET
FX46:
    s_call_b64 s[40:41], FIX_a
    s_branch FX46_RET
FX47:
    s_call_b64 s[40:41], FIX_b
    s_branch FX47_RET
FX48:
    s_call_b64 s[40:41], FIX_a
    s_branch FX48_RET
FX49:
    s_call_b64 s[40:41], FIX_b
    s_branch FX49_RET
FX50:
    s_call_b64 s[40:41], FIX_a
    s_branch FX50_RET
FX51:
    s_call_b64 s[40:41], FIX_b
    s_branch FX51_RET
FX52:
    s_call_b64 s[40:41], FIX_c
    s_branch FX52_RET
FX53:
    s_call_b64 s[40:41], FIX_a
    s_branch FX53_RET
FX54:
    s_call_b64 s[40:41], FIX_b
    s_branch FX54_RET
FX55:
    s_call_b64 s[40:41], FIX_a
    s_branch FX55_RET
FX56:
    s_call_b64 s[40:41], FIX_b
    s_branch FX56_RET
FX57:
    s_call_b64 s[40:41], FIX_a
    s_branch FX57_RET
FX58:
    s_call_b64 s[40:41], FIX_b
    s_branch FX58_RET
FX59:
    s_call_b64 s[40:41], FIX_a
    s_branch FX59_RET
FX60:
    s_call_b64 s[40:41], FIX_b
    s_branch FX60_RET
FX61:
    s_call_b64 s[40:41], FIX_a
    s_branch FX61_RET
FX62:
    s_call_b64 s[40:41], FIX_b
    s_branch FX62_RET
FX63:
    s_call_b64 s[40:41], FIX_c
    s_branch FX63_RET
FX64:
    s_call_b64 s[40:41], FIX_a
    s_branch FX64_RET
FX65:
    s_call_b64 s[40:41], FIX_b
    s_branch FX65_RET
FX66:
    s_call_b64 s[40:41], FIX_a
    s_branch FX66_RET
FX67:
    s_call_b64 s[40:41], FIX_b
    s_branch FX67_RET
FX68:
    s_call_b64 s[40:41], FIX_a
    s_branch FX68_RET
FX69:
    s_call_b64 s[40:41], FIX_b
    s_branch FX69_RET
FX70:
    s_call_b64 s[40:41], FIX_a
    s_branch FX70_RET
FX71:
    s_call_b64 s[40:41], FIX_b
    s_branch FX71_RET
FX72:
    s_call_b64 s[40:41], FIX_c
    s_branch FX72_RET
FIX_a:
    s_nop 15
    s_nop 15
    v_max3_f32 v2, v48, v49, v50
    v_max3_f32 v2, v2, v51, v52
    v_max3_f32 v2, v2, v53, v54
    v_max3_f32 v2, v2, v55, v56
    v_max3_f32 v2, v2, v57, v58
    v_max3_f32 v2, v2, v59, v60
    v_max3_f32 v2, v2, v61, v62
    v_max_f32 v2, v2, v63
    v_mov_b32 v3, v2
    s_nop 1
    v_permlane32_swap_b32 v2, v3
    v_max_f32 v2, v2, v3
    v_max_f32 v2, 0, v2
    v_sub_f32 v4, 0, v2
    v_exp_f32 v4, v4
    v_sub_f32 v64, v64, v2
    v_sub_f32 v65, v65, v2
    v_sub_f32 v66, v66, v2
    v_sub_f32 v67, v67, v2
    v_sub_f32 v68, v68, v2
    v_sub_f32 v69, v69, v2
    v_sub_f32 v70, v70, v2
    v_sub_f32 v71, v71, v2
    v_sub_f32 v72, v72, v2
    v_sub_f32 v73, v73, v2
    v_sub_f32 v74, v74, v2
    v_sub_f32 v75, v75, v2
    v_sub_f32 v76, v76, v2
    v_sub_f32 v77, v77, v2
    v_sub_f32 v78, v78, v2
    v_sub_f32 v79, v79, v2
    v_accvgpr_read_b32 v6, a0
    v_mul_f32 v6, v6, v4
    v_accvgpr_write_b32 a0, v6
    v_accvgpr_read_b32 v7, a1
    v_mul_f32 v7, v7, v4
    v_accvgpr_write_b32 a1, v7
    v_accvgpr_read_b32 v8, a2
    v_mul_f32 v8, v8, v4
    v_accvgpr_write_b32 a2, v8
    v_accvgpr_read_b32 v9, a3
    v_mul_f32 v9, v9, v4
    v_accvgpr_write_b32 a3, v9
    v_accvgpr_read_b32 v6, a4
    v_mul_f32 v6, v6, v4
    v_accvgpr_write_b32 a4, v6
    v_accvgpr_read_b32 v7, a5
    v_mul_f32 v7, v7, v4
    v_accvgpr_write_b32 a5, v7
    v_accvgpr_read_b32 v8, a6
    v_mul_f32 v8, v8, v4
    v_accvgpr_write_b32 a6, v8
    v_accvgpr_read_b32 v9, a7
    v_mul_f32 v9, v9, v4
    v_accvgpr_write_b32 a7, v9
    v_accvgpr_read_b32 v6, a8
    v_mul_f32 v6, v6, v4
    v_accvgpr_write_b32 a8, v6
    v_accvgpr_read_b32 v7, a9
    v_mul_f32 v7, v7, v4
    v_accvgpr_write_b32 a9, v7
    v_accvgpr_read_b32 v8, a10
    v_mul_f32 v8, v8, v4
    v_accvgpr_write_b32 a10, v8
    v_accvgpr_read_b32 v9, a11
    v_mul_f32 v9, v9, v4
    v_accvgpr_write_b32 a11, v9
    v_accvgpr_read_b32 v6, a12
    v_mul_f32 v6, v6, v4
    v_accvgpr_write_b32 a12, v6
    v_accvgpr_read_b32 v7, a13
    v_mul_f32 v7, v7, v4
    v_accvgpr_write_b32 a13, v7
    v_accvgpr_read_b32 v8, a14
    v_mul_f32 v8, v8, v4
    v_accvgpr_write_b32 a14, v8
    v_accvgpr_read_b32 v9, a15
    v_mul_f32 v9, v9, v4
    v_accvgpr_write_b32 a15, v9
    v_accvgpr_read_b32 v6, a16
    v_mul_f32 v6, v6, v4
    v_accvgpr_write_b32 a16, v6
    v_accvgpr_read_b32 v7, a17
    v_mul_f32 v7, v7, v4
    v_accvgpr_write_b32 a17, v7
    v_accvgpr_read_b32 v8, a18
    v_mul_f32 v8, v8, v4
    v_accvgpr_write_b32 a18, v8
    v_accvgpr_read_b32 v9, a19
    v_mul_f32 v9, v9, v4
    v_accvgpr_write_b32 a19, v9
    v_accvgpr_read_b32 v6, a20
    v_mul_f32 v6, v6, v4
    v_accvgpr_write_b32 a20, v6
    v_accvgpr_read_b32 v7, a21
    v_mul_f32 v7, v7, v4
    v_accvgpr_write_b32 a21, v7
    v_accvgpr_read_b32 v8, a22
    v_mul_f32 v8, v8, v4
    v_accvgpr_write_b32 a22, v8
    v_accvgpr_read_b32 v9, a23
    v_mul_f32 v9, v9, v4
    v_accvgpr_write_b32 a23, v9
    v_accvgpr_read_b32 v6, a24
    v_mul_f32 v6, v6, v4
    v_accvgpr_write_b32 a24, v6
    v_accvgpr_read_b32 v7, a25
    v_mul_f32 v7, v7, v4
    v_accvgpr_write_b32 a25, v7
    v_accvgpr_read_b32 v8, a26
    v_mul_f32 v8, v8, v4
    v_accvgpr_write_b32 a26, v8
    v_accvgpr_read_b32 v9, a27
    v_mul_f32 v9, v9, v4
    v_accvgpr_write_b32 a27, v9
    v_accvgpr_read_b32 v6, a28
    v_mul_f32 v6, v6, v4
    v_accvgpr_write_b32 a28, v6
    v_accvgpr_read_b32 v7, a29
    v_mul_f32 v7, v7, v4
    v_accvgpr_write_b32 a29, v7
    v_accvgpr_read_b32 v8, a30
    v_mul_f32 v8, v8, v4
    v_accvgpr_write_b32 a30, v8
    v_accvgpr_read_b32 v9, a31
    v_mul_f32 v9, v9, v4
    v_accvgpr_write_b32 a31, v9
    v_accvgpr_read_b32 v6, a32
    v_mul_f32 v6, v6, v4
    v_accvgpr_write_b32 a32, v6
    v_accvgpr_read_b32 v7, a33
    v_mul_f32 v7, v7, v4
    v_accvgpr_write_b32 a33, v7
    v_accvgpr_read_b32 v8, a34
    v_mul_f32 v8, v8, v4
    v_accvgpr_write_b32 a34, v8
    v_accvgpr_read_b32 v9, a35
    v_mul_f32 v9, v9, v4
    v_accvgpr_write_b32 a35, v9
    v_accvgpr_read_b32 v6, a36
    v_mul_f32 v6, v6, v4
    v_accvgpr_write_b32 a36, v6
    v_accvgpr_read_b32 v7, a37
    v_mul_f32 v7, v7, v4
    v_accvgpr_write_b32 a37, v7
    v_accvgpr_read_b32 v8, a38
    v_mul_f32 v8, v8, v4
    v_accvgpr_write_b32 a38, v8
    v_accvgpr_read_b32 v9, a39
    v_mul_f32 v9, v9, v4
    v_accvgpr_write_b32 a39, v9
    v_accvgpr_read_b32 v6, a40
    v_mul_f32 v6, v6, v4
    v_accvgpr_write_b32 a40, v6
    v_accvgpr_read_b32 v7, a41
    v_mul_f32 v7, v7, v4
    v_accvgpr_write_b32 a41, v7
    v_accvgpr_read_b32 v8, a42
    v_mul_f32 v8, v8, v4
    v_accvgpr_write_b32 a42, v8
    v_accvgpr_read_b32 v9, a43
    v_mul_f32 v9, v9, v4
    v_accvgpr_write_b32 a43, v9
    v_accvgpr_read_b32 v6, a44
    v_mul_f32 v6, v6, v4
    v_accvgpr_write_b32 a44, v6
    v_accvgpr_read_b32 v7, a45
    v_mul_f32 v7, v7, v4
    v_accvgpr_write_b32 a45, v7
    v_accvgpr_read_b32 v8, a46
    v_mul_f32 v8, v8, v4
    v_accvgpr_write_b32 a46, v8
    v_accvgpr_read_b32 v9, a47
    v_mul_f32 v9, v9, v4
    v_accvgpr_write_b32 a47, v9
    v_accvgpr_read_b32 v6, a48
    v_mul_f32 v6, v6, v4
    v_accvgpr_write_b32 a48, v6
    v_accvgpr_read_b32 v7, a49
    v_mul_f32 v7, v7, v4
    v_accvgpr_write_b32 a49, v7
    v_accvgpr_read_b32 v8, a50
    v_mul_f32 v8, v8, v4
    v_accvgpr_write_b32 a50, v8
    v_accvgpr_read_b32 v9, a51
    v_mul_f32 v9, v9, v4
    v_accvgpr_write_b32 a51, v9
    v_accvgpr_read_b32 v6, a52
    v_mul_f32 v6, v6, v4
    v_accvgpr_write_b32 a52, v6
    v_accvgpr_read_b32 v7, a53
    v_mul_f32 v7, v7, v4
    v_accvgpr_write_b32 a53, v7
    v_accvgpr_read_b32 v8, a54
    v_mul_f32 v8, v8, v4
    v_accvgpr_write_b32 a54, v8
    v_accvgpr_read_b32 v9, a55
    v_mul_f32 v9, v9, v4
    v_accvgpr_write_b32 a55, v9
    v_accvgpr_read_b32 v6, a56
    v_mul_f32 v6, v6, v4
    v_accvgpr_write_b32 a56, v6
    v_accvgpr_read_b32 v7, a57
    v_mul_f32 v7, v7, v4
    v_accvgpr_write_b32 a57, v7
    v_accvgpr_read_b32 v8, a58
    v_mul_f32 v8, v8, v4
    v_accvgpr_write_b32 a58, v8
    v_accvgpr_read_b32 v9, a59
    v_mul_f32 v9, v9, v4
    v_accvgpr_write_b32 a59, v9
    v_accvgpr_read_b32 v6, a60
    v_mul_f32 v6, v6, v4
    v_accvgpr_write_b32 a60, v6
    v_accvgpr_read_b32 v7, a61
    v_mul_f32 v7, v7, v4
    v_accvgpr_write_b32 a61, v7
    v_accvgpr_read_b32 v8, a62
    v_mul_f32 v8, v8, v4
    v_accvgpr_write_b32 a62, v8
    v_accvgpr_read_b32 v9, a63
    v_mul_f32 v9, v9, v4
    v_accvgpr_write_b32 a63, v9
    v_mul_f32 v239, v239, v4
    v_sub_f32 v48, v48, v2
    v_sub_f32 v49, v49, v2
    v_sub_f32 v50, v50, v2
    v_sub_f32 v51, v51, v2
    v_sub_f32 v52, v52, v2
    v_sub_f32 v53, v53, v2
    v_sub_f32 v54, v54, v2
    v_sub_f32 v55, v55, v2
    v_sub_f32 v56, v56, v2
    v_sub_f32 v57, v57, v2
    v_sub_f32 v58, v58, v2
    v_sub_f32 v59, v59, v2
    v_sub_f32 v60, v60, v2
    v_sub_f32 v61, v61, v2
    v_sub_f32 v62, v62, v2
    v_sub_f32 v63, v63, v2
    v_exp_f32 v6, v48
    v_exp_f32 v7, v49
    s_nop 0
    v_add_f32 v242, v6, v7
    v_cvt_pk_bf16_f32 v160, v6, v7
    v_exp_f32 v8, v50
    v_exp_f32 v9, v51
    s_nop 0
    v_add_f32 v242, v242, v8
    v_add_f32 v242, v242, v9
    v_cvt_pk_bf16_f32 v161, v8, v9
    v_exp_f32 v6, v52
    v_exp_f32 v7, v53
    s_nop 0
    v_add_f32 v242, v242, v6
    v_add_f32 v242, v242, v7
    v_cvt_pk_bf16_f32 v162, v6, v7
    v_exp_f32 v8, v54
    v_exp_f32 v9, v55
    s_nop 0
    v_add_f32 v242, v242, v8
    v_add_f32 v242, v242, v9
    v_cvt_pk_bf16_f32 v163, v8, v9
    v_exp_f32 v6, v56
    v_exp_f32 v7, v57
    s_nop 0
    v_add_f32 v242, v242, v6
    v_add_f32 v242, v242, v7
    v_cvt_pk_bf16_f32 v164, v6, v7
    v_exp_f32 v8, v58
    v_exp_f32 v9, v59
    s_nop 0
    v_add_f32 v242, v242, v8
    v_add_f32 v242, v242, v9
    v_cvt_pk_bf16_f32 v165, v8, v9
    v_exp_f32 v6, v60
    v_exp_f32 v7, v61
    s_nop 0
    v_add_f32 v242, v242, v6
    v_add_f32 v242, v242, v7
    v_cvt_pk_bf16_f32 v166, v6, v7
    v_exp_f32 v8, v62
    v_exp_f32 v9, v63
    s_nop 0
    v_add_f32 v242, v242, v8
    v_add_f32 v242, v242, v9
    v_cvt_pk_bf16_f32 v167, v8, v9
    s_nop 3
    s_setpc_b64 s[40:41]
FIX_b:
    s_nop 15
    s_nop 15
    v_max3_f32 v2, v112, v113, v114
    v_max3_f32 v2, v2, v115, v116
    v_max3_f32 v2, v2, v117, v118
    v_max3_f32 v2, v2, v119, v120
    v_max3_f32 v2, v2, v121, v122
    v_max3_f32 v2, v2, v123, v124
    v_max3_f32 v2, v2, v125, v126
    v_max_f32 v2, v2, v127
    v_mov_b32 v3, v2
    s_nop 1
    v_permlane32_swap_b32 v2, v3
    v_max_f32 v2, v2, v3
    v_max_f32 v2, 0, v2
    v_sub_f32 v4, 0, v2
    v_exp_f32 v4, v4
    v_sub_f32 v128, v128, v2
    v_sub_f32 v129, v129, v2
    v_sub_f32 v130, v130, v2
    v_sub_f32 v131, v131, v2
    v_sub_f32 v132, v132, v2
    v_sub_f32 v133, v133, v2
    v_sub_f32 v134, v134, v2
    v_sub_f32 v135, v135, v2
    v_sub_f32 v136, v136, v2
    v_sub_f32 v137, v137, v2
    v_sub_f32 v138, v138, v2
    v_sub_f32 v139, v139, v2
    v_sub_f32 v140, v140, v2
    v_sub_f32 v141, v141, v2
    v_sub_f32 v142, v142, v2
    v_sub_f32 v143, v143, v2
    v_accvgpr_read_b32 v6, a64
    v_mul_f32 v6, v6, v4
    v_accvgpr_write_b32 a64, v6
    v_accvgpr_read_b32 v7, a65
    v_mul_f32 v7, v7, v4
    v_accvgpr_write_b32 a65, v7
    v_accvgpr_read_b32 v8, a66
    v_mul_f32 v8, v8, v4
    v_accvgpr_write_b32 a66, v8
    v_accvgpr_read_b32 v9, a67
    v_mul_f32 v9, v9, v4
    v_accvgpr_write_b32 a67, v9
    v_accvgpr_read_b32 v6, a68
    v_mul_f32 v6, v6, v4
    v_accvgpr_write_b32 a68, v6
    v_accvgpr_read_b32 v7, a69
    v_mul_f32 v7, v7, v4
    v_accvgpr_write_b32 a69, v7
    v_accvgpr_read_b32 v8, a70
    v_mul_f32 v8, v8, v4
    v_accvgpr_write_b32 a70, v8
    v_accvgpr_read_b32 v9, a71
    v_mul_f32 v9, v9, v4
    v_accvgpr_write_b32 a71, v9
    v_accvgpr_read_b32 v6, a72
    v_mul_f32 v6, v6, v4
    v_accvgpr_write_b32 a72, v6
    v_accvgpr_read_b32 v7, a73
    v_mul_f32 v7, v7, v4
    v_accvgpr_write_b32 a73, v7
    v_accvgpr_read_b32 v8, a74
    v_mul_f32 v8, v8, v4
    v_accvgpr_write_b32 a74, v8
    v_accvgpr_read_b32 v9, a75
    v_mul_f32 v9, v9, v4
    v_accvgpr_write_b32 a75, v9
    v_accvgpr_read_b32 v6, a76
    v_mul_f32 v6, v6, v4
    v_accvgpr_write_b32 a76, v6
    v_accvgpr_read_b32 v7, a77
    v_mul_f32 v7, v7, v4
    v_accvgpr_write_b32 a77, v7
    v_accvgpr_read_b32 v8, a78
    v_mul_f32 v8, v8, v4
    v_accvgpr_write_b32 a78, v8
    v_accvgpr_read_b32 v9, a79
    v_mul_f32 v9, v9, v4
    v_accvgpr_write_b32 a79, v9
    v_accvgpr_read_b32 v6, a80
    v_mul_f32 v6, v6, v4
    v_accvgpr_write_b32 a80, v6
    v_accvgpr_read_b32 v7, a81
    v_mul_f32 v7, v7, v4
    v_accvgpr_write_b32 a81, v7
    v_accvgpr_read_b32 v8, a82
    v_mul_f32 v8, v8, v4
    v_accvgpr_write_b32 a82, v8
    v_accvgpr_read_b32 v9, a83
    v_mul_f32 v9, v9, v4
    v_accvgpr_write_b32 a83, v9
    v_accvgpr_read_b32 v6, a84
    v_mul_f32 v6, v6, v4
    v_accvgpr_write_b32 a84, v6
    v_accvgpr_read_b32 v7, a85
    v_mul_f32 v7, v7, v4
    v_accvgpr_write_b32 a85, v7
    v_accvgpr_read_b32 v8, a86
    v_mul_f32 v8, v8, v4
    v_accvgpr_write_b32 a86, v8
    v_accvgpr_read_b32 v9, a87
    v_mul_f32 v9, v9, v4
    v_accvgpr_write_b32 a87, v9
    v_accvgpr_read_b32 v6, a88
    v_mul_f32 v6, v6, v4
    v_accvgpr_write_b32 a88, v6
    v_accvgpr_read_b32 v7, a89
    v_mul_f32 v7, v7, v4
    v_accvgpr_write_b32 a89, v7
    v_accvgpr_read_b32 v8, a90
    v_mul_f32 v8, v8, v4
    v_accvgpr_write_b32 a90, v8
    v_accvgpr_read_b32 v9, a91
    v_mul_f32 v9, v9, v4
    v_accvgpr_write_b32 a91, v9
    v_accvgpr_read_b32 v6, a92
    v_mul_f32 v6, v6, v4
    v_accvgpr_write_b32 a92, v6
    v_accvgpr_read_b32 v7, a93
    v_mul_f32 v7, v7, v4
    v_accvgpr_write_b32 a93, v7
    v_accvgpr_read_b32 v8, a94
    v_mul_f32 v8, v8, v4
    v_accvgpr_write_b32 a94, v8
    v_accvgpr_read_b32 v9, a95
    v_mul_f32 v9, v9, v4
    v_accvgpr_write_b32 a95, v9
    v_accvgpr_read_b32 v6, a96
    v_mul_f32 v6, v6, v4
    v_accvgpr_write_b32 a96, v6
    v_accvgpr_read_b32 v7, a97
    v_mul_f32 v7, v7, v4
    v_accvgpr_write_b32 a97, v7
    v_accvgpr_read_b32 v8, a98
    v_mul_f32 v8, v8, v4
    v_accvgpr_write_b32 a98, v8
    v_accvgpr_read_b32 v9, a99
    v_mul_f32 v9, v9, v4
    v_accvgpr_write_b32 a99, v9
    v_accvgpr_read_b32 v6, a100
    v_mul_f32 v6, v6, v4
    v_accvgpr_write_b32 a100, v6
    v_accvgpr_read_b32 v7, a101
    v_mul_f32 v7, v7, v4
    v_accvgpr_write_b32 a101, v7
    v_accvgpr_read_b32 v8, a102
    v_mul_f32 v8, v8, v4
    v_accvgpr_write_b32 a102, v8
    v_accvgpr_read_b32 v9, a103
    v_mul_f32 v9, v9, v4
    v_accvgpr_write_b32 a103, v9
    v_accvgpr_read_b32 v6, a104
    v_mul_f32 v6, v6, v4
    v_accvgpr_write_b32 a104, v6
    v_accvgpr_read_b32 v7, a105
    v_mul_f32 v7, v7, v4
    v_accvgpr_write_b32 a105, v7
    v_accvgpr_read_b32 v8, a106
    v_mul_f32 v8, v8, v4
    v_accvgpr_write_b32 a106, v8
    v_accvgpr_read_b32 v9, a107
    v_mul_f32 v9, v9, v4
    v_accvgpr_write_b32 a107, v9
    v_accvgpr_read_b32 v6, a108
    v_mul_f32 v6, v6, v4
    v_accvgpr_write_b32 a108, v6
    v_accvgpr_read_b32 v7, a109
    v_mul_f32 v7, v7, v4
    v_accvgpr_write_b32 a109, v7
    v_accvgpr_read_b32 v8, a110
    v_mul_f32 v8, v8, v4
    v_accvgpr_write_b32 a110, v8
    v_accvgpr_read_b32 v9, a111
    v_mul_f32 v9, v9, v4
    v_accvgpr_write_b32 a111, v9
    v_accvgpr_read_b32 v6, a112
    v_mul_f32 v6, v6, v4
    v_accvgpr_write_b32 a112, v6
    v_accvgpr_read_b32 v7, a113
    v_mul_f32 v7, v7, v4
    v_accvgpr_write_b32 a113, v7
    v_accvgpr_read_b32 v8, a114
    v_mul_f32 v8, v8, v4
    v_accvgpr_write_b32 a114, v8
    v_accvgpr_read_b32 v9, a115
    v_mul_f32 v9, v9, v4
    v_accvgpr_write_b32 a115, v9
    v_accvgpr_read_b32 v6, a116
    v_mul_f32 v6, v6, v4
    v_accvgpr_write_b32 a116, v6
    v_accvgpr_read_b32 v7, a117
    v_mul_f32 v7, v7, v4
    v_accvgpr_write_b32 a117, v7
    v_accvgpr_read_b32 v8, a118
    v_mul_f32 v8, v8, v4
    v_accvgpr_write_b32 a118, v8
    v_accvgpr_read_b32 v9, a119
    v_mul_f32 v9, v9, v4
    v_accvgpr_write_b32 a119, v9
    v_accvgpr_read_b32 v6, a120
    v_mul_f32 v6, v6, v4
    v_accvgpr_write_b32 a120, v6
    v_accvgpr_read_b32 v7, a121
    v_mul_f32 v7, v7, v4
    v_accvgpr_write_b32 a121, v7
    v_accvgpr_read_b32 v8, a122
    v_mul_f32 v8, v8, v4
    v_accvgpr_write_b32 a122, v8
    v_accvgpr_read_b32 v9, a123
    v_mul_f32 v9, v9, v4
    v_accvgpr_write_b32 a123, v9
    v_accvgpr_read_b32 v6, a124
    v_mul_f32 v6, v6, v4
    v_accvgpr_write_b32 a124, v6
    v_accvgpr_read_b32 v7, a125
    v_mul_f32 v7, v7, v4
    v_accvgpr_write_b32 a125, v7
    v_accvgpr_read_b32 v8, a126
    v_mul_f32 v8, v8, v4
    v_accvgpr_write_b32 a126, v8
    v_accvgpr_read_b32 v9, a127
    v_mul_f32 v9, v9, v4
    v_accvgpr_write_b32 a127, v9
    v_mul_f32 v240, v240, v4
    v_sub_f32 v112, v112, v2
    v_sub_f32 v113, v113, v2
    v_sub_f32 v114, v114, v2
    v_sub_f32 v115, v115, v2
    v_sub_f32 v116, v116, v2
    v_sub_f32 v117, v117, v2
    v_sub_f32 v118, v118, v2
    v_sub_f32 v119, v119, v2
    v_sub_f32 v120, v120, v2
    v_sub_f32 v121, v121, v2
    v_sub_f32 v122, v122, v2
    v_sub_f32 v123, v123, v2
    v_sub_f32 v124, v124, v2
    v_sub_f32 v125, v125, v2
    v_sub_f32 v126, v126, v2
    v_sub_f32 v127, v127, v2
    v_exp_f32 v6, v112
    v_exp_f32 v7, v113
    s_nop 0
    v_add_f32 v243, v6, v7
    v_cvt_pk_bf16_f32 v168, v6, v7
    v_exp_f32 v8, v114
    v_exp_f32 v9, v115
    s_nop 0
    v_add_f32 v243, v243, v8
    v_add_f32 v243, v243, v9
    v_cvt_pk_bf16_f32 v169, v8, v9
    v_exp_f32 v6, v116
    v_exp_f32 v7, v117
    s_nop 0
    v_add_f32 v243, v243, v6
    v_add_f32 v243, v243, v7
    v_cvt_pk_bf16_f32 v170, v6, v7
    v_exp_f32 v8, v118
    v_exp_f32 v9, v119
    s_nop 0
    v_add_f32 v243, v243, v8
    v_add_f32 v243, v243, v9
    v_cvt_pk_bf16_f32 v171, v8, v9
    v_exp_f32 v6, v120
    v_exp_f32 v7, v121
    s_nop 0
    v_add_f32 v243, v243, v6
    v_add_f32 v243, v243, v7
    v_cvt_pk_bf16_f32 v172, v6, v7
    v_exp_f32 v8, v122
    v_exp_f32 v9, v123
    s_nop 0
    v_add_f32 v243, v243, v8
    v_add_f32 v243, v243, v9
    v_cvt_pk_bf16_f32 v173, v8, v9
    v_exp_f32 v6, v124
    v_exp_f32 v7, v125
    s_nop 0
    v_add_f32 v243, v243, v6
    v_add_f32 v243, v243, v7
    v_cvt_pk_bf16_f32 v174, v6, v7
    v_exp_f32 v8, v126
    v_exp_f32 v9, v127
    s_nop 0
    v_add_f32 v243, v243, v8
    v_add_f32 v243, v243, v9
    v_cvt_pk_bf16_f32 v175, v8, v9
    s_nop 3
    s_setpc_b64 s[40:41]
FIX_c:
    s_nop 15
    s_nop 15
    v_max3_f32 v2, v144, v145, v146
    v_max3_f32 v2, v2, v147, v148
    v_max3_f32 v2, v2, v149, v150
    v_max3_f32 v2, v2, v151, v152
    v_max3_f32 v2, v2, v153, v154
    v_max3_f32 v2, v2, v155, v156
    v_max3_f32 v2, v2, v157, v158
    v_max_f32 v2, v2, v159
    v_mov_b32 v3, v2
    s_nop 1
    v_permlane32_swap_b32 v2, v3
    v_max_f32 v2, v2, v3
    v_max_f32 v2, 0, v2
    v_sub_f32 v4, 0, v2
    v_exp_f32 v4, v4
    v_sub_f32 v204, v204, v2
    v_sub_f32 v205, v205, v2
    v_sub_f32 v206, v206, v2
    v_sub_f32 v207, v207, v2
    v_sub_f32 v208, v208, v2
    v_sub_f32 v209, v209, v2
    v_sub_f32 v210, v210, v2
    v_sub_f32 v211, v211, v2
    v_sub_f32 v212, v212, v2
    v_sub_f32 v213, v213, v2
    v_sub_f32 v214, v214, v2
    v_sub_f32 v215, v215, v2
    v_sub_f32 v216, v216, v2
    v_sub_f32 v217, v217, v2
    v_sub_f32 v218, v218, v2
    v_sub_f32 v219, v219, v2
    v_accvgpr_read_b32 v6, a128
    v_mul_f32 v6, v6, v4
    v_accvgpr_write_b32 a128, v6
    v_accvgpr_read_b32 v7, a129
    v_mul_f32 v7, v7, v4
    v_accvgpr_write_b32 a129, v7
    v_accvgpr_read_b32 v8, a130
    v_mul_f32 v8, v8, v4
    v_accvgpr_write_b32 a130, v8
    v_accvgpr_read_b32 v9, a131
    v_mul_f32 v9, v9, v4
    v_accvgpr_write_b32 a131, v9
    v_accvgpr_read_b32 v6, a132
    v_mul_f32 v6, v6, v4
    v_accvgpr_write_b32 a132, v6
    v_accvgpr_read_b32 v7, a133
    v_mul_f32 v7, v7, v4
    v_accvgpr_write_b32 a133, v7
    v_accvgpr_read_b32 v8, a134
    v_mul_f32 v8, v8, v4
    v_accvgpr_write_b32 a134, v8
    v_accvgpr_read_b32 v9, a135
    v_mul_f32 v9, v9, v4
    v_accvgpr_write_b32 a135, v9
    v_accvgpr_read_b32 v6, a136
    v_mul_f32 v6, v6, v4
    v_accvgpr_write_b32 a136, v6
    v_accvgpr_read_b32 v7, a137
    v_mul_f32 v7, v7, v4
    v_accvgpr_write_b32 a137, v7
    v_accvgpr_read_b32 v8, a138
    v_mul_f32 v8, v8, v4
    v_accvgpr_write_b32 a138, v8
    v_accvgpr_read_b32 v9, a139
    v_mul_f32 v9, v9, v4
    v_accvgpr_write_b32 a139, v9
    v_accvgpr_read_b32 v6, a140
    v_mul_f32 v6, v6, v4
    v_accvgpr_write_b32 a140, v6
    v_accvgpr_read_b32 v7, a141
    v_mul_f32 v7, v7, v4
    v_accvgpr_write_b32 a141, v7
    v_accvgpr_read_b32 v8, a142
    v_mul_f32 v8, v8, v4
    v_accvgpr_write_b32 a142, v8
    v_accvgpr_read_b32 v9, a143
    v_mul_f32 v9, v9, v4
    v_accvgpr_write_b32 a143, v9
    v_accvgpr_read_b32 v6, a144
    v_mul_f32 v6, v6, v4
    v_accvgpr_write_b32 a144, v6
    v_accvgpr_read_b32 v7, a145
    v_mul_f32 v7, v7, v4
    v_accvgpr_write_b32 a145, v7
    v_accvgpr_read_b32 v8, a146
    v_mul_f32 v8, v8, v4
    v_accvgpr_write_b32 a146, v8
    v_accvgpr_read_b32 v9, a147
    v_mul_f32 v9, v9, v4
    v_accvgpr_write_b32 a147, v9
    v_accvgpr_read_b32 v6, a148
    v_mul_f32 v6, v6, v4
    v_accvgpr_write_b32 a148, v6
    v_accvgpr_read_b32 v7, a149
    v_mul_f32 v7, v7, v4
    v_accvgpr_write_b32 a149, v7
    v_accvgpr_read_b32 v8, a150
    v_mul_f32 v8, v8, v4
    v_accvgpr_write_b32 a150, v8
    v_accvgpr_read_b32 v9, a151
    v_mul_f32 v9, v9, v4
    v_accvgpr_write_b32 a151, v9
    v_accvgpr_read_b32 v6, a152
    v_mul_f32 v6, v6, v4
    v_accvgpr_write_b32 a152, v6
    v_accvgpr_read_b32 v7, a153
    v_mul_f32 v7, v7, v4
    v_accvgpr_write_b32 a153, v7
    v_accvgpr_read_b32 v8, a154
    v_mul_f32 v8, v8, v4
    v_accvgpr_write_b32 a154, v8
    v_accvgpr_read_b32 v9, a155
    v_mul_f32 v9, v9, v4
    v_accvgpr_write_b32 a155, v9
    v_accvgpr_read_b32 v6, a156
    v_mul_f32 v6, v6, v4
    v_accvgpr_write_b32 a156, v6
    v_accvgpr_read_b32 v7, a157
    v_mul_f32 v7, v7, v4
    v_accvgpr_write_b32 a157, v7
    v_accvgpr_read_b32 v8, a158
    v_mul_f32 v8, v8, v4
    v_accvgpr_write_b32 a158, v8
    v_accvgpr_read_b32 v9, a159
    v_mul_f32 v9, v9, v4
    v_accvgpr_write_b32 a159, v9
    v_accvgpr_read_b32 v6, a160
    v_mul_f32 v6, v6, v4
    v_accvgpr_write_b32 a160, v6
    v_accvgpr_read_b32 v7, a161
    v_mul_f32 v7, v7, v4
    v_accvgpr_write_b32 a161, v7
    v_accvgpr_read_b32 v8, a162
    v_mul_f32 v8, v8, v4
    v_accvgpr_write_b32 a162, v8
    v_accvgpr_read_b32 v9, a163
    v_mul_f32 v9, v9, v4
    v_accvgpr_write_b32 a163, v9
    v_accvgpr_read_b32 v6, a164
    v_mul_f32 v6, v6, v4
    v_accvgpr_write_b32 a164, v6
    v_accvgpr_read_b32 v7, a165
    v_mul_f32 v7, v7, v4
    v_accvgpr_write_b32 a165, v7
    v_accvgpr_read_b32 v8, a166
    v_mul_f32 v8, v8, v4
    v_accvgpr_write_b32 a166, v8
    v_accvgpr_read_b32 v9, a167
    v_mul_f32 v9, v9, v4
    v_accvgpr_write_b32 a167, v9
    v_accvgpr_read_b32 v6, a168
    v_mul_f32 v6, v6, v4
    v_accvgpr_write_b32 a168, v6
    v_accvgpr_read_b32 v7, a169
    v_mul_f32 v7, v7, v4
    v_accvgpr_write_b32 a169, v7
    v_accvgpr_read_b32 v8, a170
    v_mul_f32 v8, v8, v4
    v_accvgpr_write_b32 a170, v8
    v_accvgpr_read_b32 v9, a171
    v_mul_f32 v9, v9, v4
    v_accvgpr_write_b32 a171, v9
    v_accvgpr_read_b32 v6, a172
    v_mul_f32 v6, v6, v4
    v_accvgpr_write_b32 a172, v6
    v_accvgpr_read_b32 v7, a173
    v_mul_f32 v7, v7, v4
    v_accvgpr_write_b32 a173, v7
    v_accvgpr_read_b32 v8, a174
    v_mul_f32 v8, v8, v4
    v_accvgpr_write_b32 a174, v8
    v_accvgpr_read_b32 v9, a175
    v_mul_f32 v9, v9, v4
    v_accvgpr_write_b32 a175, v9
    v_accvgpr_read_b32 v6, a176
    v_mul_f32 v6, v6, v4
    v_accvgpr_write_b32 a176, v6
    v_accvgpr_read_b32 v7, a177
    v_mul_f32 v7, v7, v4
    v_accvgpr_write_b32 a177, v7
    v_accvgpr_read_b32 v8, a178
    v_mul_f32 v8, v8, v4
    v_accvgpr_write_b32 a178, v8
    v_accvgpr_read_b32 v9, a179
    v_mul_f32 v9, v9, v4
    v_accvgpr_write_b32 a179, v9
    v_accvgpr_read_b32 v6, a180
    v_mul_f32 v6, v6, v4
    v_accvgpr_write_b32 a180, v6
    v_accvgpr_read_b32 v7, a181
    v_mul_f32 v7, v7, v4
    v_accvgpr_write_b32 a181, v7
    v_accvgpr_read_b32 v8, a182
    v_mul_f32 v8, v8, v4
    v_accvgpr_write_b32 a182, v8
    v_accvgpr_read_b32 v9, a183
    v_mul_f32 v9, v9, v4
    v_accvgpr_write_b32 a183, v9
    v_accvgpr_read_b32 v6, a184
    v_mul_f32 v6, v6, v4
    v_accvgpr_write_b32 a184, v6
    v_accvgpr_read_b32 v7, a185
    v_mul_f32 v7, v7, v4
    v_accvgpr_write_b32 a185, v7
    v_accvgpr_read_b32 v8, a186
    v_mul_f32 v8, v8, v4
    v_accvgpr_write_b32 a186, v8
    v_accvgpr_read_b32 v9, a187
    v_mul_f32 v9, v9, v4
    v_accvgpr_write_b32 a187, v9
    v_accvgpr_read_b32 v6, a188
    v_mul_f32 v6, v6, v4
    v_accvgpr_write_b32 a188, v6
    v_accvgpr_read_b32 v7, a189
    v_mul_f32 v7, v7, v4
    v_accvgpr_write_b32 a189, v7
    v_accvgpr_read_b32 v8, a190
    v_mul_f32 v8, v8, v4
    v_accvgpr_write_b32 a190, v8
    v_accvgpr_read_b32 v9, a191
    v_mul_f32 v9, v9, v4
    v_accvgpr_write_b32 a191, v9
    v_mul_f32 v241, v241, v4
    v_sub_f32 v144, v144, v2
    v_sub_f32 v145, v145, v2
    v_sub_f32 v146, v146, v2
    v_sub_f32 v147, v147, v2
    v_sub_f32 v148, v148, v2
    v_sub_f32 v149, v149, v2
    v_sub_f32 v150, v150, v2
    v_sub_f32 v151, v151, v2
    v_sub_f32 v152, v152, v2
    v_sub_f32 v153, v153, v2
    v_sub_f32 v154, v154, v2
    v_sub_f32 v155, v155, v2
    v_sub_f32 v156, v156, v2
    v_sub_f32 v157, v157, v2
    v_sub_f32 v158, v158, v2
    v_sub_f32 v159, v159, v2
    v_exp_f32 v6, v144
    v_exp_f32 v7, v145
    s_nop 0
    v_add_f32 v244, v6, v7
    v_cvt_pk_bf16_f32 v176, v6, v7
    v_exp_f32 v8, v146
    v_exp_f32 v9, v147
    s_nop 0
    v_add_f32 v244, v244, v8
    v_add_f32 v244, v244, v9
    v_cvt_pk_bf16_f32 v177, v8, v9
    v_exp_f32 v6, v148
    v_exp_f32 v7, v149
    s_nop 0
    v_add_f32 v244, v244, v6
    v_add_f32 v244, v244, v7
    v_cvt_pk_bf16_f32 v178, v6, v7
    v_exp_f32 v8, v150
    v_exp_f32 v9, v151
    s_nop 0
    v_add_f32 v244, v244, v8
    v_add_f32 v244, v244, v9
    v_cvt_pk_bf16_f32 v179, v8, v9
    v_exp_f32 v6, v152
    v_exp_f32 v7, v153
    s_nop 0
    v_add_f32 v244, v244, v6
    v_add_f32 v244, v244, v7
    v_cvt_pk_bf16_f32 v180, v6, v7
    v_exp_f32 v8, v154
    v_exp_f32 v9, v155
    s_nop 0
    v_add_f32 v244, v244, v8
    v_add_f32 v244, v244, v9
    v_cvt_pk_bf16_f32 v181, v8, v9
    v_exp_f32 v6, v156
    v_exp_f32 v7, v157
    s_nop 0
    v_add_f32 v244, v244, v6
    v_add_f32 v244, v244, v7
    v_cvt_pk_bf16_f32 v182, v6, v7
    v_exp_f32 v8, v158
    v_exp_f32 v9, v159
    s_nop 0
    v_add_f32 v244, v244, v8
    v_add_f32 v244, v244, v9
    v_cvt_pk_bf16_f32 v183, v8, v9
    s_nop 3
    s_setpc_b64 s[40:41]
K1_END:
    s_endpgm
.globl oproj_kernel
.p2align 8
.type oproj_kernel,@function
oproj_kernel:
    s_cmp_ge_u32 s2, 256
    s_cbranch_scc1 K2_END
    s_load_dwordx2 s[4:5], s[0:1], 96
    s_load_dwordx2 s[6:7], s[0:1], 80
    v_lshrrev_b32 v4, 6, v0
    v_and_b32 v5, 63, v0
    v_readfirstlane_b32 s16, v4
    v_lshlrev_b32 v1, 4, v5
    v_add_u32 v2, 4096, v1
    v_add_u32 v3, 8192, v1
    s_and_b32 s20, s2, 7
    s_lshr_b32 s21, s2, 3
    s_lshr_b32 s22, s20, 2
    s_and_b32 s23, s20, 3
    s_lshl_b32 s30, s23, 2
    s_and_b32 s24, s21, 3
    s_add_u32 s31, s30, s24
    s_lshr_b32 s24, s21, 2
    s_lshl_b32 s25, s22, 7
    s_lshl_b32 s26, s16, 5
    s_add_u32 s25, s25, s26
    s_mul_i32 s17, s25, 144
    s_mul_i32 s26, s31, 9
    s_add_u32 s17, s17, s26
    s_lshl_b32 s17, s17, 10
    s_mul_i32 s18, s25, 40
    s_mul_i32 s26, s24, 5
    s_add_u32 s18, s18, s26
    s_lshl_b32 s18, s18, 10
    s_add_u32 s18, s18, 37748736
    s_mul_i32 s27, s31, 368640
    s_mul_i32 s26, s22, 1280
    s_add_u32 s27, s27, s26
    s_mul_i32 s26, s24, 160
    s_add_u32 s27, s27, s26
    s_waitcnt lgkmcnt(0)
    s_mov_b32 s8, s4
    s_mov_b32 s9, s5
    s_mov_b32 s10, 48234496
    s_mov_b32 s11, 131072
    s_mov_b32 s12, s6
    s_mov_b32 s13, s7
    s_mov_b32 s14, 5898240
    s_mov_b32 s15, 131072
    buffer_load_dwordx4 v[16:19], v1, s[8:11], s18 offen
    buffer_load_dwordx4 v[20:23], v1, s[8:11], s18 offen offset:1024
    buffer_load_dwordx4 v[24:27], v1, s[8:11], s18 offen offset:2048
    buffer_load_dwordx4 v[28:31], v1, s[8:11], s18 offen offset:3072
    buffer_load_dwordx4 v[32:35], v2, s[8:11], s18 offen
    buffer_load_dwordx4 v[36:39], v1, s[8:11], s17 offen
    buffer_load_dwordx4 v[40:43], v1, s[8:11], s17 offen offset:1024
    buffer_load_dwordx4 v[44:47], v1, s[8:11], s17 offen offset:2048
    buffer_load_dwordx4 v[48:51], v1, s[8:11], s17 offen offset:3072
    buffer_load_dwordx4 v[52:55], v2, s[8:11], s17 offen
    buffer_load_dwordx4 v[56:59], v2, s[8:11], s17 offen offset:1024
    buffer_load_dwordx4 v[60:63], v2, s[8:11], s17 offen offset:2048
    buffer_load_dwordx4 v[64:67], v2, s[8:11], s17 offen offset:3072
    buffer_load_dwordx4 v[68:71], v3, s[8:11], s17 offen
    s_add_u32 s17, s17, 147456
    s_add_u32 s18, s18, 40960
    buffer_load_dwordx4 v[72:75], v1, s[8:11], s18 offen
    buffer_load_dwordx4 v[76:79], v1, s[8:11], s18 offen offset:1024
    buffer_load_dwordx4 v[80:83], v1, s[8:11], s18 offen offset:2048
    buffer_load_dwordx4 v[84:87], v1, s[8:11], s18 offen offset:3072
    buffer_load_dwordx4 v[88:91], v2, s[8:11], s18 offen
    buffer_load_dwordx4 v[92:95], v1, s[8:11], s17 offen
    buffer_load_dwordx4 v[96:99], v1, s[8:11], s17 offen offset:1024
    buffer_load_dwordx4 v[100:103], v1, s[8:11], s17 offen offset:2048
    buffer_load_dwordx4 v[104:107], v1, s[8:11], s17 offen offset:3072
    buffer_load_dwordx4 v[108:111], v2, s[8:11], s17 offen
    buffer_load_dwordx4 v[112:115], v2, s[8:11], s17 offen offset:1024
    buffer_load_dwordx4 v[116:119], v2, s[8:11], s17 offen offset:2048
    buffer_load_dwordx4 v[120:123], v2, s[8:11], s17 offen offset:3072
    buffer_load_dwordx4 v[124:127], v3, s[8:11], s17 offen
    s_add_u32 s17, s17, 147456
    s_add_u32 s18, s18, 40960
    buffer_load_dwordx4 v[128:131], v1, s[8:11], s18 offen
    buffer_load_dwordx4 v[132:135], v1, s[8:11], s18 offen offset:1024
    buffer_load_dwordx4 v[136:139], v1, s[8:11], s18 offen offset:2048
    buffer_load_dwordx4 v[140:143], v1, s[8:11], s18 offen offset:3072
    buffer_load_dwordx4 v[144:147], v2, s[8:11], s18 offen
    buffer_load_dwordx4 v[148:151], v1, s[8:11], s17 offen
    buffer_load_dwordx4 v[152:155], v1, s[8:11], s17 offen offset:1024
    buffer_load_dwordx4 v[156:159], v1, s[8:11], s17 offen offset:2048
    buffer_load_dwordx4 v[160:163], v1, s[8:11], s17 offen offset:3072
    buffer_load_dwordx4 v[164:167], v2, s[8:11], s17 offen
    buffer_load_dwordx4 v[168:171], v2, s[8:11], s17 offen offset:1024
    buffer_load_dwordx4 v[172:175], v2, s[8:11], s17 offen offset:2048
    buffer_load_dwordx4 v[176:179], v2, s[8:11], s17 offen offset:3072
    buffer_load_dwordx4 v[180:183], v3, s[8:11], s17 offen
    s_add_u32 s17, s17, 147456
    s_add_u32 s18, s18, 40960
    v_accvgpr_write_b32 a0, 0
    v_accvgpr_write_b32 a1, 0
    v_accvgpr_write_b32 a2, 0
    v_accvgpr_write_b32 a3, 0
    v_accvgpr_write_b32 a4, 0
    v_accvgpr_write_b32 a5, 0
    v_accvgpr_write_b32 a6, 0
    v_accvgpr_write_b32 a7, 0
    v_accvgpr_write_b32 a8, 0
    v_accvgpr_write_b32 a9, 0
    v_accvgpr_write_b32 a10, 0
    v_accvgpr_write_b32 a11, 0
    v_accvgpr_write_b32 a12, 0
    v_accvgpr_write_b32 a13, 0
    v_accvgpr_write_b32 a14, 0
    v_accvgpr_write_b32 a15, 0
    v_accvgpr_write_b32 a16, 0
    v_accvgpr_write_b32 a17, 0
    v_accvgpr_write_b32 a18, 0
    v_accvgpr_write_b32 a19, 0
    v_accvgpr_write_b32 a20, 0
    v_accvgpr_write_b32 a21, 0
    v_accvgpr_write_b32 a22, 0
    v_accvgpr_write_b32 a23, 0
    v_accvgpr_write_b32 a24, 0
    v_accvgpr_write_b32 a25, 0
    v_accvgpr_write_b32 a26, 0
    v_accvgpr_write_b32 a27, 0
    v_accvgpr_write_b32 a28, 0
    v_accvgpr_write_b32 a29, 0
    v_accvgpr_write_b32 a30, 0
    v_accvgpr_write_b32 a31, 0
    v_accvgpr_write_b32 a32, 0
    v_accvgpr_write_b32 a33, 0
    v_accvgpr_write_b32 a34, 0
    v_accvgpr_write_b32 a35, 0
    v_accvgpr_write_b32 a36, 0
    v_accvgpr_write_b32 a37, 0
    v_accvgpr_write_b32 a38, 0
    v_accvgpr_write_b32 a39, 0
    v_accvgpr_write_b32 a40, 0
    v_accvgpr_write_b32 a41, 0
    v_accvgpr_write_b32 a42, 0
    v_accvgpr_write_b32 a43, 0
    v_accvgpr_write_b32 a44, 0
    v_accvgpr_write_b32 a45, 0
    v_accvgpr_write_b32 a46, 0
    v_accvgpr_write_b32 a47, 0
    v_accvgpr_write_b32 a48, 0
    v_accvgpr_write_b32 a49, 0
    v_accvgpr_write_b32 a50, 0
    v_accvgpr_write_b32 a51, 0
    v_accvgpr_write_b32 a52, 0
    v_accvgpr_write_b32 a53, 0
    v_accvgpr_write_b32 a54, 0
    v_accvgpr_write_b32 a55, 0
    v_accvgpr_write_b32 a56, 0
    v_accvgpr_write_b32 a57, 0
    v_accvgpr_write_b32 a58, 0
    v_accvgpr_write_b32 a59, 0
    v_accvgpr_write_b32 a60, 0
    v_accvgpr_write_b32 a61, 0
    v_accvgpr_write_b32 a62, 0
    v_accvgpr_write_b32 a63, 0
    v_accvgpr_write_b32 a64, 0
    v_accvgpr_write_b32 a65, 0
    v_accvgpr_write_b32 a66, 0
    v_accvgpr_write_b32 a67, 0
    v_accvgpr_write_b32 a68, 0
    v_accvgpr_write_b32 a69, 0
    v_accvgpr_write_b32 a70, 0
    v_accvgpr_write_b32 a71, 0
    v_accvgpr_write_b32 a72, 0
    v_accvgpr_write_b32 a73, 0
    v_accvgpr_write_b32 a74, 0
    v_accvgpr_write_b32 a75, 0
    v_accvgpr_write_b32 a76, 0
    v_accvgpr_write_b32 a77, 0
    v_accvgpr_write_b32 a78, 0
    v_accvgpr_write_b32 a79, 0
    v_accvgpr_write_b32 a80, 0
    v_accvgpr_write_b32 a81, 0
    v_accvgpr_write_b32 a82, 0
    v_accvgpr_write_b32 a83, 0
    v_accvgpr_write_b32 a84, 0
    v_accvgpr_write_b32 a85, 0
    v_accvgpr_write_b32 a86, 0
    v_accvgpr_write_b32 a87, 0
    v_accvgpr_write_b32 a88, 0
    v_accvgpr_write_b32 a89, 0
    v_accvgpr_write_b32 a90, 0
    v_accvgpr_write_b32 a91, 0
    v_accvgpr_write_b32 a92, 0
    v_accvgpr_write_b32 a93, 0
    v_accvgpr_write_b32 a94, 0
    v_accvgpr_write_b32 a95, 0
    v_accvgpr_write_b32 a96, 0
    v_accvgpr_write_b32 a97, 0
    v_accvgpr_write_b32 a98, 0
    v_accvgpr_write_b32 a99, 0
    v_accvgpr_write_b32 a100, 0
    v_accvgpr_write_b32 a101, 0
    v_accvgpr_write_b32 a102, 0
    v_accvgpr_write_b32 a103, 0
    v_accvgpr_write_b32 a104, 0
    v_accvgpr_write_b32 a105, 0
    v_accvgpr_write_b32 a106, 0
    v_accvgpr_write_b32 a107, 0
    v_accvgpr_write_b32 a108, 0
    v_accvgpr_write_b32 a109, 0
    v_accvgpr_write_b32 a110, 0
    v_accvgpr_write_b32 a111, 0
    v_accvgpr_write_b32 a112, 0
    v_accvgpr_write_b32 a113, 0
    v_accvgpr_write_b32 a114, 0
    v_accvgpr_write_b32 a115, 0
    v_accvgpr_write_b32 a116, 0
    v_accvgpr_write_b32 a117, 0
    v_accvgpr_write_b32 a118, 0
    v_accvgpr_write_b32 a119, 0
    v_accvgpr_write_b32 a120, 0
    v_accvgpr_write_b32 a121, 0
    v_accvgpr_write_b32 a122, 0
    v_accvgpr_write_b32 a123, 0
    v_accvgpr_write_b32 a124, 0
    v_accvgpr_write_b32 a125, 0
    v_accvgpr_write_b32 a126, 0
    v_accvgpr_write_b32 a127, 0
    v_accvgpr_write_b32 a128, 0
    v_accvgpr_write_b32 a129, 0
    v_accvgpr_write_b32 a130, 0
    v_accvgpr_write_b32 a131, 0
    v_accvgpr_write_b32 a132, 0
    v_accvgpr_write_b32 a133, 0
    v_accvgpr_write_b32 a134, 0
    v_accvgpr_write_b32 a135, 0
    v_accvgpr_write_b32 a136, 0
    v_accvgpr_write_b32 a137, 0
    v_accvgpr_write_b32 a138, 0
    v_accvgpr_write_b32 a139, 0
    v_accvgpr_write_b32 a140, 0
    v_accvgpr_write_b32 a141, 0
    v_accvgpr_write_b32 a142, 0
    v_accvgpr_write_b32 a143, 0
    v_accvgpr_write_b32 a144, 0
    v_accvgpr_write_b32 a145, 0
    v_accvgpr_write_b32 a146, 0
    v_accvgpr_write_b32 a147, 0
    v_accvgpr_write_b32 a148, 0
    v_accvgpr_write_b32 a149, 0
    v_accvgpr_write_b32 a150, 0
    v_accvgpr_write_b32 a151, 0
    v_accvgpr_write_b32 a152, 0
    v_accvgpr_write_b32 a153, 0
    v_accvgpr_write_b32 a154, 0
    v_accvgpr_write_b32 a155, 0
    v_accvgpr_write_b32 a156, 0
    v_accvgpr_write_b32 a157, 0
    v_accvgpr_write_b32 a158, 0
    v_accvgpr_write_b32 a159, 0
    v_accvgpr_write_b32 a160, 0
    v_accvgpr_write_b32 a161, 0
    v_accvgpr_write_b32 a162, 0
    v_accvgpr_write_b32 a163, 0
    v_accvgpr_write_b32 a164, 0
    v_accvgpr_write_b32 a165, 0
    v_accvgpr_write_b32 a166, 0
    v_accvgpr_write_b32 a167, 0
    v_accvgpr_write_b32 a168, 0
    v_accvgpr_write_b32 a169, 0
    v_accvgpr_write_b32 a170, 0
    v_accvgpr_write_b32 a171, 0
    v_accvgpr_write_b32 a172, 0
    v_accvgpr_write_b32 a173, 0
    v_accvgpr_write_b32 a174, 0
    v_accvgpr_write_b32 a175, 0
    v_accvgpr_write_b32 a176, 0
    v_accvgpr_write_b32 a177, 0
    v_accvgpr_write_b32 a178, 0
    v_accvgpr_write_b32 a179, 0
    s_mov_b32 s19, 7
K2_LOOP:
    s_waitcnt vmcnt(28)
    v_mfma_f32_16x16x32_bf16 a[0:3], v[16:19], v[36:39], a[0:3]
    v_mfma_f32_16x16x32_bf16 a[4:7], v[20:23], v[36:39], a[4:7]
    buffer_load_dwordx4 v[184:187], v1, s[8:11], s18 offen
    v_mfma_f32_16x16x32_bf16 a[8:11], v[24:27], v[36:39], a[8:11]
    v_mfma_f32_16x16x32_bf16 a[12:15], v[28:31], v[36:39], a[12:15]
    v_mfma_f32_16x16x32_bf16 a[16:19], v[32:35], v[36:39], a[16:19]
    buffer_load_dwordx4 v[188:191], v1, s[8:11], s18 offen offset:1024
    v_mfma_f32_16x16x32_bf16 a[20:23], v[16:19], v[40:43], a[20:23]
    v_mfma_f32_16x16x32_bf16 a[24:27], v[20:23], v[40:43], a[24:27]
    v_mfma_f32_16x16x32_bf16 a[28:31], v[24:27], v[40:43], a[28:31]
    buffer_load_dwordx4 v[192:195], v1, s[8:11], s18 offen offset:2048
    v_mfma_f32_16x16x32_bf16 a[32:35], v[28:31], v[40:43], a[32:35]
    v_mfma_f32_16x16x32_bf16 a[36:39], v[32:35], v[40:43], a[36:39]
    buffer_load_dwordx4 v[196:199], v1, s[8:11], s18 offen offset:3072
    v_mfma_f32_16x16x32_bf16 a[40:43], v[16:19], v[44:47], a[40:43]
    v_mfma_f32_16x16x32_bf16 a[44:47], v[20:23], v[44:47], a[44:47]
    v_mfma_f32_16x16x32_bf16 a[48:51], v[24:27], v[44:47], a[48:51]
    buffer_load_dwordx4 v[200:203], v2, s[8:11], s18 offen
    v_mfma_f32_16x16x32_bf16 a[52:55], v[28:31], v[44:47], a[52:55]
    v_mfma_f32_16x16x32_bf16 a[56:59], v[32:35], v[44:47], a[56:59]
    v_mfma_f32_16x16x32_bf16 a[60:63], v[16:19], v[48:51], a[60:63]
    buffer_load_dwordx4 v[204:207], v1, s[8:11], s17 offen
    v_mfma_f32_16x16x32_bf16 a[64:67], v[20:23], v[48:51], a[64:67]
    v_mfma_f32_16x16x32_bf16 a[68:71], v[24:27], v[48:51], a[68:71]
    v_mfma_f32_16x16x32_bf16 a[72:75], v[28:31], v[48:51], a[72:75]
    buffer_load_dwordx4 v[208:211], v1, s[8:11], s17 offen offset:1024
    v_mfma_f32_16x16x32_bf16 a[76:79], v[32:35], v[48:51], a[76:79]
    v_mfma_f32_16x16x32_bf16 a[80:83], v[16:19], v[52:55], a[80:83]
    v_mfma_f32_16x16x32_bf16 a[84:87], v[20:23], v[52:55], a[84:87]
    buffer_load_dwordx4 v[212:215], v1, s[8:11], s17 offen offset:2048
    v_mfma_f32_16x16x32_bf16 a[88:91], v[24:27], v[52:55], a[88:91]
    v_mfma_f32_16x16x32_bf16 a[92:95], v[28:31], v[52:55], a[92:95]
    buffer_load_dwordx4 v[216:219], v1, s[8:11], s17 offen offset:3072
    v_mfma_f32_16x16x32_bf16 a[96:99], v[32:35], v[52:55], a[96:99]
    v_mfma_f32_16x16x32_bf16 a[100:103], v[16:19], v[56:59], a[100:103]
    v_mfma_f32_16x16x32_bf16 a[104:107], v[20:23], v[56:59], a[104:107]
    buffer_load_dwordx4 v[220:223], v2, s[8:11], s17 offen
    v_mfma_f32_16x16x32_bf16 a[108:111], v[24:27], v[56:59], a[108:111]
    v_mfma_f32_16x16x32_bf16 a[112:115], v[28:31], v[56:59], a[112:115]
    v_mfma_f32_16x16x32_bf16 a[116:119], v[32:35], v[56:59], a[116:119]
    buffer_load_dwordx4 v[224:227], v2, s[8:11], s17 offen offset:1024
    v_mfma_f32_16x16x32_bf16 a[120:123], v[16:19], v[60:63], a[120:123]
    v_mfma_f32_16x16x32_bf16 a[124:127], v[20:23], v[60:63], a[124:127]
    v_mfma_f32_16x16x32_bf16 a[128:131], v[24:27], v[60:63], a[128:131]
    buffer_load_dwordx4 v[228:231], v2, s[8:11], s17 offen offset:2048
    v_mfma_f32_16x16x32_bf16 a[132:135], v[28:31], v[60:63], a[132:135]
    v_mfma_f32_16x16x32_bf16 a[136:139], v[32:35], v[60:63], a[136:139]
    v_mfma_f32_16x16x32_bf16 a[140:143], v[16:19], v[64:67], a[140:143]
    buffer_load_dwordx4 v[232:235], v2, s[8:11], s17 offen offset:3072
    v_mfma_f32_16x16x32_bf16 a[144:147], v[20:23], v[64:67], a[144:147]
    v_mfma_f32_16x16x32_bf16 a[148:151], v[24:27], v[64:67], a[148:151]
    buffer_load_dwordx4 v[236:239], v3, s[8:11], s17 offen
    v_mfma_f32_16x16x32_bf16 a[152:155], v[28:31], v[64:67], a[152:155]
    v_mfma_f32_16x16x32_bf16 a[156:159], v[32:35], v[64:67], a[156:159]
    v_mfma_f32_16x16x32_bf16 a[160:163], v[16:19], v[68:71], a[160:163]
    s_add_u32 s17, s17, 147456
    v_mfma_f32_16x16x32_bf16 a[164:167], v[20:23], v[68:71], a[164:167]
    v_mfma_f32_16x16x32_bf16 a[168:171], v[24:27], v[68:71], a[168:171]
    v_mfma_f32_16x16x32_bf16 a[172:175], v[28:31], v[68:71], a[172:175]
    s_add_u32 s18, s18, 40960
    v_mfma_f32_16x16x32_bf16 a[176:179], v[32:35], v[68:71], a[176:179]
    s_waitcnt vmcnt(28)
    v_mfma_f32_16x16x32_bf16 a[0:3], v[72:75], v[92:95], a[0:3]
    v_mfma_f32_16x16x32_bf16 a[4:7], v[76:79], v[92:95], a[4:7]
    buffer_load_dwordx4 v[16:19], v1, s[8:11], s18 offen
    v_mfma_f32_16x16x32_bf16 a[8:11], v[80:83], v[92:95], a[8:11]
    v_mfma_f32_16x16x32_bf16 a[12:15], v[84:87], v[92:95], a[12:15]
    v_mfma_f32_16x16x32_bf16 a[16:19], v[88:91], v[92:95], a[16:19]
    buffer_load_dwordx4 v[20:23], v1, s[8:11], s18 offen offset:1024
    v_mfma_f32_16x16x32_bf16 a[20:23], v[72:75], v[96:99], a[20:23]
    v_mfma_f32_16x16x32_bf16 a[24:27], v[76:79], v[96:99], a[24:27]
    v_mfma_f32_16x16x32_bf16 a[28:31], v[80:83], v[96:99], a[28:31]
    buffer_load_dwordx4 v[24:27], v1, s[8:11], s18 offen offset:2048
    v_mfma_f32_16x16x32_bf16 a[32:35], v[84:87], v[96:99], a[32:35]
    v_mfma_f32_16x16x32_bf16 a[36:39], v[88:91], v[96:99], a[36:39]
    buffer_load_dwordx4 v[28:31], v1, s[8:11], s18 offen offset:3072
    v_mfma_f32_16x16x32_bf16 a[40:43], v[72:75], v[100:103], a[40:43]
    v_mfma_f32_16x16x32_bf16 a[44:47], v[76:79], v[100:103], a[44:47]
    v_mfma_f32_16x16x32_bf16 a[48:51], v[80:83], v[100:103], a[48:51]
    buffer_load_dwordx4 v[32:35], v2, s[8:11], s18 offen
    v_mfma_f32_16x16x32_bf16 a[52:55], v[84:87], v[100:103], a[52:55]
    v_mfma_f32_16x16x32_bf16 a[56:59], v[88:91], v[100:103], a[56:59]
    v_mfma_f32_16x16x32_bf16 a[60:63], v[72:75], v[104:107], a[60:63]
    buffer_load_dwordx4 v[36:39], v1, s[8:11], s17 offen
    v_mfma_f32_16x16x32_bf16 a[64:67], v[76:79], v[104:107], a[64:67]
    v_mfma_f32_16x16x32_bf16 a[68:71], v[80:83], v[104:107], a[68:71]
    v_mfma_f32_16x16x32_bf16 a[72:75], v[84:87], v[104:107], a[72:75]
    buffer_load_dwordx4 v[40:43], v1, s[8:11], s17 offen offset:1024
    v_mfma_f32_16x16x32_bf16 a[76:79], v[88:91], v[104:107], a[76:79]
    v_mfma_f32_16x16x32_bf16 a[80:83], v[72:75], v[108:111], a[80:83]
    v_mfma_f32_16x16x32_bf16 a[84:87], v[76:79], v[108:111], a[84:87]
    buffer_load_dwordx4 v[44:47], v1, s[8:11], s17 offen offset:2048
    v_mfma_f32_16x16x32_bf16 a[88:91], v[80:83], v[108:111], a[88:91]
    v_mfma_f32_16x16x32_bf16 a[92:95], v[84:87], v[108:111], a[92:95]
    buffer_load_dwordx4 v[48:51], v1, s[8:11], s17 offen offset:3072
    v_mfma_f32_16x16x32_bf16 a[96:99], v[88:91], v[108:111], a[96:99]
    v_mfma_f32_16x16x32_bf16 a[100:103], v[72:75], v[112:115], a[100:103]
    v_mfma_f32_16x16x32_bf16 a[104:107], v[76:79], v[112:115], a[104:107]
    buffer_load_dwordx4 v[52:55], v2, s[8:11], s17 offen
    v_mfma_f32_16x16x32_bf16 a[108:111], v[80:83], v[112:115], a[108:111]
    v_mfma_f32_16x16x32_bf16 a[112:115], v[84:87], v[112:115], a[112:115]
    v_mfma_f32_16x16x32_bf16 a[116:119], v[88:91], v[112:115], a[116:119]
    buffer_load_dwordx4 v[56:59], v2, s[8:11], s17 offen offset:1024
    v_mfma_f32_16x16x32_bf16 a[120:123], v[72:75], v[116:119], a[120:123]
    v_mfma_f32_16x16x32_bf16 a[124:127], v[76:79], v[116:119], a[124:127]
    v_mfma_f32_16x16x32_bf16 a[128:131], v[80:83], v[116:119], a[128:131]
    buffer_load_dwordx4 v[60:63], v2, s[8:11], s17 offen offset:2048
    v_mfma_f32_16x16x32_bf16 a[132:135], v[84:87], v[116:119], a[132:135]
    v_mfma_f32_16x16x32_bf16 a[136:139], v[88:91], v[116:119], a[136:139]
    v_mfma_f32_16x16x32_bf16 a[140:143], v[72:75], v[120:123], a[140:143]
    buffer_load_dwordx4 v[64:67], v2, s[8:11], s17 offen offset:3072
    v_mfma_f32_16x16x32_bf16 a[144:147], v[76:79], v[120:123], a[144:147]
    v_mfma_f32_16x16x32_bf16 a[148:151], v[80:83], v[120:123], a[148:151]
    buffer_load_dwordx4 v[68:71], v3, s[8:11], s17 offen
    v_mfma_f32_16x16x32_bf16 a[152:155], v[84:87], v[120:123], a[152:155]
    v_mfma_f32_16x16x32_bf16 a[156:159], v[88:91], v[120:123], a[156:159]
    v_mfma_f32_16x16x32_bf16 a[160:163], v[72:75], v[124:127], a[160:163]
    s_add_u32 s17, s17, 147456
    v_mfma_f32_16x16x32_bf16 a[164:167], v[76:79], v[124:127], a[164:167]
    v_mfma_f32_16x16x32_bf16 a[168:171], v[80:83], v[124:127], a[168:171]
    v_mfma_f32_16x16x32_bf16 a[172:175], v[84:87], v[124:127], a[172:175]
    s_add_u32 s18, s18, 40960
    v_mfma_f32_16x16x32_bf16 a[176:179], v[88:91], v[124:127], a[176:179]
    s_waitcnt vmcnt(28)
    v_mfma_f32_16x16x32_bf16 a[0:3], v[128:131], v[148:151], a[0:3]
    v_mfma_f32_16x16x32_bf16 a[4:7], v[132:135], v[148:151], a[4:7]
    buffer_load_dwordx4 v[72:75], v1, s[8:11], s18 offen
    v_mfma_f32_16x16x32_bf16 a[8:11], v[136:139], v[148:151], a[8:11]
    v_mfma_f32_16x16x32_bf16 a[12:15], v[140:143], v[148:151], a[12:15]
    v_mfma_f32_16x16x32_bf16 a[16:19], v[144:147], v[148:151], a[16:19]
    buffer_load_dwordx4 v[76:79], v1, s[8:11], s18 offen offset:1024
    v_mfma_f32_16x16x32_bf16 a[20:23], v[128:131], v[152:155], a[20:23]
    v_mfma_f32_16x16x32_bf16 a[24:27], v[132:135], v[152:155], a[24:27]
    v_mfma_f32_16x16x32_bf16 a[28:31], v[136:139], v[152:155], a[28:31]
    buffer_load_dwordx4 v[80:83], v1, s[8:11], s18 offen offset:2048
    v_mfma_f32_16x16x32_bf16 a[32:35], v[140:143], v[152:155], a[32:35]
    v_mfma_f32_16x16x32_bf16 a[36:39], v[144:147], v[152:155], a[36:39]
    buffer_load_dwordx4 v[84:87], v1, s[8:11], s18 offen offset:3072
    v_mfma_f32_16x16x32_bf16 a[40:43], v[128:131], v[156:159], a[40:43]
    v_mfma_f32_16x16x32_bf16 a[44:47], v[132:135], v[156:159], a[44:47]
    v_mfma_f32_16x16x32_bf16 a[48:51], v[136:139], v[156:159], a[48:51]
    buffer_load_dwordx4 v[88:91], v2, s[8:11], s18 offen
    v_mfma_f32_16x16x32_bf16 a[52:55], v[140:143], v[156:159], a[52:55]
    v_mfma_f32_16x16x32_bf16 a[56:59], v[144:147], v[156:159], a[56:59]
    v_mfma_f32_16x16x32_bf16 a[60:63], v[128:131], v[160:163], a[60:63]
    buffer_load_dwordx4 v[92:95], v1, s[8:11], s17 offen
    v_mfma_f32_16x16x32_bf16 a[64:67], v[132:135], v[160:163], a[64:67]
    v_mfma_f32_16x16x32_bf16 a[68:71], v[136:139], v[160:163], a[68:71]
    v_mfma_f32_16x16x32_bf16 a[72:75], v[140:143], v[160:163], a[72:75]
    buffer_load_dwordx4 v[96:99], v1, s[8:11], s17 offen offset:1024
    v_mfma_f32_16x16x32_bf16 a[76:79], v[144:147], v[160:163], a[76:79]
    v_mfma_f32_16x16x32_bf16 a[80:83], v[128:131], v[164:167], a[80:83]
    v_mfma_f32_16x16x32_bf16 a[84:87], v[132:135], v[164:167], a[84:87]
    buffer_load_dwordx4 v[100:103], v1, s[8:11], s17 offen offset:2048
    v_mfma_f32_16x16x32_bf16 a[88:91], v[136:139], v[164:167], a[88:91]
    v_mfma_f32_16x16x32_bf16 a[92:95], v[140:143], v[164:167], a[92:95]
    buffer_load_dwordx4 v[104:107], v1, s[8:11], s17 offen offset:3072
    v_mfma_f32_16x16x32_bf16 a[96:99], v[144:147], v[164:167], a[96:99]
    v_mfma_f32_16x16x32_bf16 a[100:103], v[128:131], v[168:171], a[100:103]
    v_mfma_f32_16x16x32_bf16 a[104:107], v[132:135], v[168:171], a[104:107]
    buffer_load_dwordx4 v[108:111], v2, s[8:11], s17 offen
    v_mfma_f32_16x16x32_bf16 a[108:111], v[136:139], v[168:171], a[108:111]
    v_mfma_f32_16x16x32_bf16 a[112:115], v[140:143], v[168:171], a[112:115]
    v_mfma_f32_16x16x32_bf16 a[116:119], v[144:147], v[168:171], a[116:119]
    buffer_load_dwordx4 v[112:115], v2, s[8:11], s17 offen offset:1024
    v_mfma_f32_16x16x32_bf16 a[120:123], v[128:131], v[172:175], a[120:123]
    v_mfma_f32_16x16x32_bf16 a[124:127], v[132:135], v[172:175], a[124:127]
    v_mfma_f32_16x16x32_bf16 a[128:131], v[136:139], v[172:175], a[128:131]
    buffer_load_dwordx4 v[116:119], v2, s[8:11], s17 offen offset:2048
    v_mfma_f32_16x16x32_bf16 a[132:135], v[140:143], v[172:175], a[132:135]
    v_mfma_f32_16x16x32_bf16 a[136:139], v[144:147], v[172:175], a[136:139]
    v_mfma_f32_16x16x32_bf16 a[140:143], v[128:131], v[176:179], a[140:143]
    buffer_load_dwordx4 v[120:123], v2, s[8:11], s17 offen offset:3072
    v_mfma_f32_16x16x32_bf16 a[144:147], v[132:135], v[176:179], a[144:147]
    v_mfma_f32_16x16x32_bf16 a[148:151], v[136:139], v[176:179], a[148:151]
    buffer_load_dwordx4 v[124:127], v3, s[8:11], s17 offen
    v_mfma_f32_16x16x32_bf16 a[152:155], v[140:143], v[176:179], a[152:155]
    v_mfma_f32_16x16x32_bf16 a[156:159], v[144:147], v[176:179], a[156:159]
    v_mfma_f32_16x16x32_bf16 a[160:163], v[128:131], v[180:183], a[160:163]
    s_add_u32 s17, s17, 147456
    v_mfma_f32_16x16x32_bf16 a[164:167], v[132:135], v[180:183], a[164:167]
    v_mfma_f32_16x16x32_bf16 a[168:171], v[136:139], v[180:183], a[168:171]
    v_mfma_f32_16x16x32_bf16 a[172:175], v[140:143], v[180:183], a[172:175]
    s_add_u32 s18, s18, 40960
    v_mfma_f32_16x16x32_bf16 a[176:179], v[144:147], v[180:183], a[176:179]
    s_waitcnt vmcnt(28)
    v_mfma_f32_16x16x32_bf16 a[0:3], v[184:187], v[204:207], a[0:3]
    v_mfma_f32_16x16x32_bf16 a[4:7], v[188:191], v[204:207], a[4:7]
    buffer_load_dwordx4 v[128:131], v1, s[8:11], s18 offen
    v_mfma_f32_16x16x32_bf16 a[8:11], v[192:195], v[204:207], a[8:11]
    v_mfma_f32_16x16x32_bf16 a[12:15], v[196:199], v[204:207], a[12:15]
    v_mfma_f32_16x16x32_bf16 a[16:19], v[200:203], v[204:207], a[16:19]
    buffer_load_dwordx4 v[132:135], v1, s[8:11], s18 offen offset:1024
    v_mfma_f32_16x16x32_bf16 a[20:23], v[184:187], v[208:211], a[20:23]
    v_mfma_f32_16x16x32_bf16 a[24:27], v[188:191], v[208:211], a[24:27]
    v_mfma_f32_16x16x32_bf16 a[28:31], v[192:195], v[208:211], a[28:31]
    buffer_load_dwordx4 v[136:139], v1, s[8:11], s18 offen offset:2048
    v_mfma_f32_16x16x32_bf16 a[32:35], v[196:199], v[208:211], a[32:35]
    v_mfma_f32_16x16x32_bf16 a[36:39], v[200:203], v[208:211], a[36:39]
    buffer_load_dwordx4 v[140:143], v1, s[8:11], s18 offen offset:3072
    v_mfma_f32_16x16x32_bf16 a[40:43], v[184:187], v[212:215], a[40:43]
    v_mfma_f32_16x16x32_bf16 a[44:47], v[188:191], v[212:215], a[44:47]
    v_mfma_f32_16x16x32_bf16 a[48:51], v[192:195], v[212:215], a[48:51]
    buffer_load_dwordx4 v[144:147], v2, s[8:11], s18 offen
    v_mfma_f32_16x16x32_bf16 a[52:55], v[196:199], v[212:215], a[52:55]
    v_mfma_f32_16x16x32_bf16 a[56:59], v[200:203], v[212:215], a[56:59]
    v_mfma_f32_16x16x32_bf16 a[60:63], v[184:187], v[216:219], a[60:63]
    buffer_load_dwordx4 v[148:151], v1, s[8:11], s17 offen
    v_mfma_f32_16x16x32_bf16 a[64:67], v[188:191], v[216:219], a[64:67]
    v_mfma_f32_16x16x32_bf16 a[68:71], v[192:195], v[216:219], a[68:71]
    v_mfma_f32_16x16x32_bf16 a[72:75], v[196:199], v[216:219], a[72:75]
    buffer_load_dwordx4 v[152:155], v1, s[8:11], s17 offen offset:1024
    v_mfma_f32_16x16x32_bf16 a[76:79], v[200:203], v[216:219], a[76:79]
    v_mfma_f32_16x16x32_bf16 a[80:83], v[184:187], v[220:223], a[80:83]
    v_mfma_f32_16x16x32_bf16 a[84:87], v[188:191], v[220:223], a[84:87]
    buffer_load_dwordx4 v[156:159], v1, s[8:11], s17 offen offset:2048
    v_mfma_f32_16x16x32_bf16 a[88:91], v[192:195], v[220:223], a[88:91]
    v_mfma_f32_16x16x32_bf16 a[92:95], v[196:199], v[220:223], a[92:95]
    buffer_load_dwordx4 v[160:163], v1, s[8:11], s17 offen offset:3072
    v_mfma_f32_16x16x32_bf16 a[96:99], v[200:203], v[220:223], a[96:99]
    v_mfma_f32_16x16x32_bf16 a[100:103], v[184:187], v[224:227], a[100:103]
    v_mfma_f32_16x16x32_bf16 a[104:107], v[188:191], v[224:227], a[104:107]
    buffer_load_dwordx4 v[164:167], v2, s[8:11], s17 offen
    v_mfma_f32_16x16x32_bf16 a[108:111], v[192:195], v[224:227], a[108:111]
    v_mfma_f32_16x16x32_bf16 a[112:115], v[196:199], v[224:227], a[112:115]
    v_mfma_f32_16x16x32_bf16 a[116:119], v[200:203], v[224:227], a[116:119]
    buffer_load_dwordx4 v[168:171], v2, s[8:11], s17 offen offset:1024
    v_mfma_f32_16x16x32_bf16 a[120:123], v[184:187], v[228:231], a[120:123]
    v_mfma_f32_16x16x32_bf16 a[124:127], v[188:191], v[228:231], a[124:127]
    v_mfma_f32_16x16x32_bf16 a[128:131], v[192:195], v[228:231], a[128:131]
    buffer_load_dwordx4 v[172:175], v2, s[8:11], s17 offen offset:2048
    v_mfma_f32_16x16x32_bf16 a[132:135], v[196:199], v[228:231], a[132:135]
    v_mfma_f32_16x16x32_bf16 a[136:139], v[200:203], v[228:231], a[136:139]
    v_mfma_f32_16x16x32_bf16 a[140:143], v[184:187], v[232:235], a[140:143]
    buffer_load_dwordx4 v[176:179], v2, s[8:11], s17 offen offset:3072
    v_mfma_f32_16x16x32_bf16 a[144:147], v[188:191], v[232:235], a[144:147]
    v_mfma_f32_16x16x32_bf16 a[148:151], v[192:195], v[232:235], a[148:151]
    buffer_load_dwordx4 v[180:183], v3, s[8:11], s17 offen
    v_mfma_f32_16x16x32_bf16 a[152:155], v[196:199], v[232:235], a[152:155]
    v_mfma_f32_16x16x32_bf16 a[156:159], v[200:203], v[232:235], a[156:159]
    v_mfma_f32_16x16x32_bf16 a[160:163], v[184:187], v[236:239], a[160:163]
    s_add_u32 s17, s17, 147456
    v_mfma_f32_16x16x32_bf16 a[164:167], v[188:191], v[236:239], a[164:167]
    v_mfma_f32_16x16x32_bf16 a[168:171], v[192:195], v[236:239], a[168:171]
    v_mfma_f32_16x16x32_bf16 a[172:175], v[196:199], v[236:239], a[172:175]
    s_add_u32 s18, s18, 40960
    v_mfma_f32_16x16x32_bf16 a[176:179], v[200:203], v[236:239], a[176:179]
    s_sub_u32 s19, s19, 1
    s_cmp_lg_u32 s19, 0
    s_cbranch_scc1 K2_LOOP
    s_waitcnt vmcnt(28)
    v_mfma_f32_16x16x32_bf16 a[0:3], v[16:19], v[36:39], a[0:3]
    v_mfma_f32_16x16x32_bf16 a[4:7], v[20:23], v[36:39], a[4:7]
    buffer_load_dwordx4 v[184:187], v1, s[8:11], s18 offen
    v_mfma_f32_16x16x32_bf16 a[8:11], v[24:27], v[36:39], a[8:11]
    v_mfma_f32_16x16x32_bf16 a[12:15], v[28:31], v[36:39], a[12:15]
    v_mfma_f32_16x16x32_bf16 a[16:19], v[32:35], v[36:39], a[16:19]
    buffer_load_dwordx4 v[188:191], v1, s[8:11], s18 offen offset:1024
    v_mfma_f32_16x16x32_bf16 a[20:23], v[16:19], v[40:43], a[20:23]
    v_mfma_f32_16x16x32_bf16 a[24:27], v[20:23], v[40:43], a[24:27]
    v_mfma_f32_16x16x32_bf16 a[28:31], v[24:27], v[40:43], a[28:31]
    buffer_load_dwordx4 v[192:195], v1, s[8:11], s18 offen offset:2048
    v_mfma_f32_16x16x32_bf16 a[32:35], v[28:31], v[40:43], a[32:35]
    v_mfma_f32_16x16x32_bf16 a[36:39], v[32:35], v[40:43], a[36:39]
    buffer_load_dwordx4 v[196:199], v1, s[8:11], s18 offen offset:3072
    v_mfma_f32_16x16x32_bf16 a[40:43], v[16:19], v[44:47], a[40:43]
    v_mfma_f32_16x16x32_bf16 a[44:47], v[20:23], v[44:47], a[44:47]
    v_mfma_f32_16x16x32_bf16 a[48:51], v[24:27], v[44:47], a[48:51]
    buffer_load_dwordx4 v[200:203], v2, s[8:11], s18 offen
    v_mfma_f32_16x16x32_bf16 a[52:55], v[28:31], v[44:47], a[52:55]
    v_mfma_f32_16x16x32_bf16 a[56:59], v[32:35], v[44:47], a[56:59]
    v_mfma_f32_16x16x32_bf16 a[60:63], v[16:19], v[48:51], a[60:63]
    buffer_load_dwordx4 v[204:207], v1, s[8:11], s17 offen
    v_mfma_f32_16x16x32_bf16 a[64:67], v[20:23], v[48:51], a[64:67]
    v_mfma_f32_16x16x32_bf16 a[68:71], v[24:27], v[48:51], a[68:71]
    v_mfma_f32_16x16x32_bf16 a[72:75], v[28:31], v[48:51], a[72:75]
    buffer_load_dwordx4 v[208:211], v1, s[8:11], s17 offen offset:1024
    v_mfma_f32_16x16x32_bf16 a[76:79], v[32:35], v[48:51], a[76:79]
    v_mfma_f32_16x16x32_bf16 a[80:83], v[16:19], v[52:55], a[80:83]
    v_mfma_f32_16x16x32_bf16 a[84:87], v[20:23], v[52:55], a[84:87]
    buffer_load_dwordx4 v[212:215], v1, s[8:11], s17 offen offset:2048
    v_mfma_f32_16x16x32_bf16 a[88:91], v[24:27], v[52:55], a[88:91]
    v_mfma_f32_16x16x32_bf16 a[92:95], v[28:31], v[52:55], a[92:95]
    buffer_load_dwordx4 v[216:219], v1, s[8:11], s17 offen offset:3072
    v_mfma_f32_16x16x32_bf16 a[96:99], v[32:35], v[52:55], a[96:99]
    v_mfma_f32_16x16x32_bf16 a[100:103], v[16:19], v[56:59], a[100:103]
    v_mfma_f32_16x16x32_bf16 a[104:107], v[20:23], v[56:59], a[104:107]
    buffer_load_dwordx4 v[220:223], v2, s[8:11], s17 offen
    v_mfma_f32_16x16x32_bf16 a[108:111], v[24:27], v[56:59], a[108:111]
    v_mfma_f32_16x16x32_bf16 a[112:115], v[28:31], v[56:59], a[112:115]
    v_mfma_f32_16x16x32_bf16 a[116:119], v[32:35], v[56:59], a[116:119]
    buffer_load_dwordx4 v[224:227], v2, s[8:11], s17 offen offset:1024
    v_mfma_f32_16x16x32_bf16 a[120:123], v[16:19], v[60:63], a[120:123]
    v_mfma_f32_16x16x32_bf16 a[124:127], v[20:23], v[60:63], a[124:127]
    v_mfma_f32_16x16x32_bf16 a[128:131], v[24:27], v[60:63], a[128:131]
    buffer_load_dwordx4 v[228:231], v2, s[8:11], s17 offen offset:2048
    v_mfma_f32_16x16x32_bf16 a[132:135], v[28:31], v[60:63], a[132:135]
    v_mfma_f32_16x16x32_bf16 a[136:139], v[32:35], v[60:63], a[136:139]
    v_mfma_f32_16x16x32_bf16 a[140:143], v[16:19], v[64:67], a[140:143]
    buffer_load_dwordx4 v[232:235], v2, s[8:11], s17 offen offset:3072
    v_mfma_f32_16x16x32_bf16 a[144:147], v[20:23], v[64:67], a[144:147]
    v_mfma_f32_16x16x32_bf16 a[148:151], v[24:27], v[64:67], a[148:151]
    buffer_load_dwordx4 v[236:239], v3, s[8:11], s17 offen
    v_mfma_f32_16x16x32_bf16 a[152:155], v[28:31], v[64:67], a[152:155]
    v_mfma_f32_16x16x32_bf16 a[156:159], v[32:35], v[64:67], a[156:159]
    v_mfma_f32_16x16x32_bf16 a[160:163], v[16:19], v[68:71], a[160:163]
    s_add_u32 s17, s17, 147456
    v_mfma_f32_16x16x32_bf16 a[164:167], v[20:23], v[68:71], a[164:167]
    v_mfma_f32_16x16x32_bf16 a[168:171], v[24:27], v[68:71], a[168:171]
    v_mfma_f32_16x16x32_bf16 a[172:175], v[28:31], v[68:71], a[172:175]
    s_add_u32 s18, s18, 40960
    v_mfma_f32_16x16x32_bf16 a[176:179], v[32:35], v[68:71], a[176:179]
    s_waitcnt vmcnt(28)
    v_mfma_f32_16x16x32_bf16 a[0:3], v[72:75], v[92:95], a[0:3]
    v_mfma_f32_16x16x32_bf16 a[4:7], v[76:79], v[92:95], a[4:7]
    v_mfma_f32_16x16x32_bf16 a[8:11], v[80:83], v[92:95], a[8:11]
    v_mfma_f32_16x16x32_bf16 a[12:15], v[84:87], v[92:95], a[12:15]
    v_mfma_f32_16x16x32_bf16 a[16:19], v[88:91], v[92:95], a[16:19]
    v_mfma_f32_16x16x32_bf16 a[20:23], v[72:75], v[96:99], a[20:23]
    v_mfma_f32_16x16x32_bf16 a[24:27], v[76:79], v[96:99], a[24:27]
    v_mfma_f32_16x16x32_bf16 a[28:31], v[80:83], v[96:99], a[28:31]
    v_mfma_f32_16x16x32_bf16 a[32:35], v[84:87], v[96:99], a[32:35]
    v_mfma_f32_16x16x32_bf16 a[36:39], v[88:91], v[96:99], a[36:39]
    v_mfma_f32_16x16x32_bf16 a[40:43], v[72:75], v[100:103], a[40:43]
    v_mfma_f32_16x16x32_bf16 a[44:47], v[76:79], v[100:103], a[44:47]
    v_mfma_f32_16x16x32_bf16 a[48:51], v[80:83], v[100:103], a[48:51]
    v_mfma_f32_16x16x32_bf16 a[52:55], v[84:87], v[100:103], a[52:55]
    v_mfma_f32_16x16x32_bf16 a[56:59], v[88:91], v[100:103], a[56:59]
    v_mfma_f32_16x16x32_bf16 a[60:63], v[72:75], v[104:107], a[60:63]
    v_mfma_f32_16x16x32_bf16 a[64:67], v[76:79], v[104:107], a[64:67]
    v_mfma_f32_16x16x32_bf16 a[68:71], v[80:83], v[104:107], a[68:71]
    v_mfma_f32_16x16x32_bf16 a[72:75], v[84:87], v[104:107], a[72:75]
    v_mfma_f32_16x16x32_bf16 a[76:79], v[88:91], v[104:107], a[76:79]
    v_mfma_f32_16x16x32_bf16 a[80:83], v[72:75], v[108:111], a[80:83]
    v_mfma_f32_16x16x32_bf16 a[84:87], v[76:79], v[108:111], a[84:87]
    v_mfma_f32_16x16x32_bf16 a[88:91], v[80:83], v[108:111], a[88:91]
    v_mfma_f32_16x16x32_bf16 a[92:95], v[84:87], v[108:111], a[92:95]
    v_mfma_f32_16x16x32_bf16 a[96:99], v[88:91], v[108:111], a[96:99]
    v_mfma_f32_16x16x32_bf16 a[100:103], v[72:75], v[112:115], a[100:103]
    v_mfma_f32_16x16x32_bf16 a[104:107], v[76:79], v[112:115], a[104:107]
    v_mfma_f32_16x16x32_bf16 a[108:111], v[80:83], v[112:115], a[108:111]
    v_mfma_f32_16x16x32_bf16 a[112:115], v[84:87], v[112:115], a[112:115]
    v_mfma_f32_16x16x32_bf16 a[116:119], v[88:91], v[112:115], a[116:119]
    v_mfma_f32_16x16x32_bf16 a[120:123], v[72:75], v[116:119], a[120:123]
    v_mfma_f32_16x16x32_bf16 a[124:127], v[76:79], v[116:119], a[124:127]
    v_mfma_f32_16x16x32_bf16 a[128:131], v[80:83], v[116:119], a[128:131]
    v_mfma_f32_16x16x32_bf16 a[132:135], v[84:87], v[116:119], a[132:135]
    v_mfma_f32_16x16x32_bf16 a[136:139], v[88:91], v[116:119], a[136:139]
    v_mfma_f32_16x16x32_bf16 a[140:143], v[72:75], v[120:123], a[140:143]
    v_mfma_f32_16x16x32_bf16 a[144:147], v[76:79], v[120:123], a[144:147]
    v_mfma_f32_16x16x32_bf16 a[148:151], v[80:83], v[120:123], a[148:151]
    v_mfma_f32_16x16x32_bf16 a[152:155], v[84:87], v[120:123], a[152:155]
    v_mfma_f32_16x16x32_bf16 a[156:159], v[88:91], v[120:123], a[156:159]
    v_mfma_f32_16x16x32_bf16 a[160:163], v[72:75], v[124:127], a[160:163]
    v_mfma_f32_16x16x32_bf16 a[164:167], v[76:79], v[124:127], a[164:167]
    v_mfma_f32_16x16x32_bf16 a[168:171], v[80:83], v[124:127], a[168:171]
    v_mfma_f32_16x16x32_bf16 a[172:175], v[84:87], v[124:127], a[172:175]
    v_mfma_f32_16x16x32_bf16 a[176:179], v[88:91], v[124:127], a[176:179]
    s_waitcnt vmcnt(14)
    v_mfma_f32_16x16x32_bf16 a[0:3], v[128:131], v[148:151], a[0:3]
    v_mfma_f32_16x16x32_bf16 a[4:7], v[132:135], v[148:151], a[4:7]
    v_mfma_f32_16x16x32_bf16 a[8:11], v[136:139], v[148:151], a[8:11]
    v_mfma_f32_16x16x32_bf16 a[12:15], v[140:143], v[148:151], a[12:15]
    v_mfma_f32_16x16x32_bf16 a[16:19], v[144:147], v[148:151], a[16:19]
    v_mfma_f32_16x16x32_bf16 a[20:23], v[128:131], v[152:155], a[20:23]
    v_mfma_f32_16x16x32_bf16 a[24:27], v[132:135], v[152:155], a[24:27]
    v_mfma_f32_16x16x32_bf16 a[28:31], v[136:139], v[152:155], a[28:31]
    v_mfma_f32_16x16x32_bf16 a[32:35], v[140:143], v[152:155], a[32:35]
    v_mfma_f32_16x16x32_bf16 a[36:39], v[144:147], v[152:155], a[36:39]
    v_mfma_f32_16x16x32_bf16 a[40:43], v[128:131], v[156:159], a[40:43]
    v_mfma_f32_16x16x32_bf16 a[44:47], v[132:135], v[156:159], a[44:47]
    v_mfma_f32_16x16x32_bf16 a[48:51], v[136:139], v[156:159], a[48:51]
    v_mfma_f32_16x16x32_bf16 a[52:55], v[140:143], v[156:159], a[52:55]
    v_mfma_f32_16x16x32_bf16 a[56:59], v[144:147], v[156:159], a[56:59]
    v_mfma_f32_16x16x32_bf16 a[60:63], v[128:131], v[160:163], a[60:63]
    v_mfma_f32_16x16x32_bf16 a[64:67], v[132:135], v[160:163], a[64:67]
    v_mfma_f32_16x16x32_bf16 a[68:71], v[136:139], v[160:163], a[68:71]
    v_mfma_f32_16x16x32_bf16 a[72:75], v[140:143], v[160:163], a[72:75]
    v_mfma_f32_16x16x32_bf16 a[76:79], v[144:147], v[160:163], a[76:79]
    v_mfma_f32_16x16x32_bf16 a[80:83], v[128:131], v[164:167], a[80:83]
    v_mfma_f32_16x16x32_bf16 a[84:87], v[132:135], v[164:167], a[84:87]
    v_mfma_f32_16x16x32_bf16 a[88:91], v[136:139], v[164:167], a[88:91]
    v_mfma_f32_16x16x32_bf16 a[92:95], v[140:143], v[164:167], a[92:95]
    v_mfma_f32_16x16x32_bf16 a[96:99], v[144:147], v[164:167], a[96:99]
    v_mfma_f32_16x16x32_bf16 a[100:103], v[128:131], v[168:171], a[100:103]
    v_mfma_f32_16x16x32_bf16 a[104:107], v[132:135], v[168:171], a[104:107]
    v_mfma_f32_16x16x32_bf16 a[108:111], v[136:139], v[168:171], a[108:111]
    v_mfma_f32_16x16x32_bf16 a[112:115], v[140:143], v[168:171], a[112:115]
    v_mfma_f32_16x16x32_bf16 a[116:119], v[144:147], v[168:171], a[116:119]
    v_mfma_f32_16x16x32_bf16 a[120:123], v[128:131], v[172:175], a[120:123]
    v_mfma_f32_16x16x32_bf16 a[124:127], v[132:135], v[172:175], a[124:127]
    v_mfma_f32_16x16x32_bf16 a[128:131], v[136:139], v[172:175], a[128:131]
    v_mfma_f32_16x16x32_bf16 a[132:135], v[140:143], v[172:175], a[132:135]
    v_mfma_f32_16x16x32_bf16 a[136:139], v[144:147], v[172:175], a[136:139]
    v_mfma_f32_16x16x32_bf16 a[140:143], v[128:131], v[176:179], a[140:143]
    v_mfma_f32_16x16x32_bf16 a[144:147], v[132:135], v[176:179], a[144:147]
    v_mfma_f32_16x16x32_bf16 a[148:151], v[136:139], v[176:179], a[148:151]
    v_mfma_f32_16x16x32_bf16 a[152:155], v[140:143], v[176:179], a[152:155]
    v_mfma_f32_16x16x32_bf16 a[156:159], v[144:147], v[176:179], a[156:159]
    v_mfma_f32_16x16x32_bf16 a[160:163], v[128:131], v[180:183], a[160:163]
    v_mfma_f32_16x16x32_bf16 a[164:167], v[132:135], v[180:183], a[164:167]
    v_mfma_f32_16x16x32_bf16 a[168:171], v[136:139], v[180:183], a[168:171]
    v_mfma_f32_16x16x32_bf16 a[172:175], v[140:143], v[180:183], a[172:175]
    v_mfma_f32_16x16x32_bf16 a[176:179], v[144:147], v[180:183], a[176:179]
    s_waitcnt vmcnt(0)
    v_mfma_f32_16x16x32_bf16 a[0:3], v[184:187], v[204:207], a[0:3]
    v_mfma_f32_16x16x32_bf16 a[4:7], v[188:191], v[204:207], a[4:7]
    v_mfma_f32_16x16x32_bf16 a[8:11], v[192:195], v[204:207], a[8:11]
    v_mfma_f32_16x16x32_bf16 a[12:15], v[196:199], v[204:207], a[12:15]
    v_mfma_f32_16x16x32_bf16 a[16:19], v[200:203], v[204:207], a[16:19]
    v_mfma_f32_16x16x32_bf16 a[20:23], v[184:187], v[208:211], a[20:23]
    v_mfma_f32_16x16x32_bf16 a[24:27], v[188:191], v[208:211], a[24:27]
    v_mfma_f32_16x16x32_bf16 a[28:31], v[192:195], v[208:211], a[28:31]
    v_mfma_f32_16x16x32_bf16 a[32:35], v[196:199], v[208:211], a[32:35]
    v_mfma_f32_16x16x32_bf16 a[36:39], v[200:203], v[208:211], a[36:39]
    v_mfma_f32_16x16x32_bf16 a[40:43], v[184:187], v[212:215], a[40:43]
    v_mfma_f32_16x16x32_bf16 a[44:47], v[188:191], v[212:215], a[44:47]
    v_mfma_f32_16x16x32_bf16 a[48:51], v[192:195], v[212:215], a[48:51]
    v_mfma_f32_16x16x32_bf16 a[52:55], v[196:199], v[212:215], a[52:55]
    v_mfma_f32_16x16x32_bf16 a[56:59], v[200:203], v[212:215], a[56:59]
    v_mfma_f32_16x16x32_bf16 a[60:63], v[184:187], v[216:219], a[60:63]
    v_mfma_f32_16x16x32_bf16 a[64:67], v[188:191], v[216:219], a[64:67]
    v_mfma_f32_16x16x32_bf16 a[68:71], v[192:195], v[216:219], a[68:71]
    v_mfma_f32_16x16x32_bf16 a[72:75], v[196:199], v[216:219], a[72:75]
    v_mfma_f32_16x16x32_bf16 a[76:79], v[200:203], v[216:219], a[76:79]
    v_mfma_f32_16x16x32_bf16 a[80:83], v[184:187], v[220:223], a[80:83]
    v_mfma_f32_16x16x32_bf16 a[84:87], v[188:191], v[220:223], a[84:87]
    v_mfma_f32_16x16x32_bf16 a[88:91], v[192:195], v[220:223], a[88:91]
    v_mfma_f32_16x16x32_bf16 a[92:95], v[196:199], v[220:223], a[92:95]
    v_mfma_f32_16x16x32_bf16 a[96:99], v[200:203], v[220:223], a[96:99]
    v_mfma_f32_16x16x32_bf16 a[100:103], v[184:187], v[224:227], a[100:103]
    v_mfma_f32_16x16x32_bf16 a[104:107], v[188:191], v[224:227], a[104:107]
    v_mfma_f32_16x16x32_bf16 a[108:111], v[192:195], v[224:227], a[108:111]
    v_mfma_f32_16x16x32_bf16 a[112:115], v[196:199], v[224:227], a[112:115]
    v_mfma_f32_16x16x32_bf16 a[116:119], v[200:203], v[224:227], a[116:119]
    v_mfma_f32_16x16x32_bf16 a[120:123], v[184:187], v[228:231], a[120:123]
    v_mfma_f32_16x16x32_bf16 a[124:127], v[188:191], v[228:231], a[124:127]
    v_mfma_f32_16x16x32_bf16 a[128:131], v[192:195], v[228:231], a[128:131]
    v_mfma_f32_16x16x32_bf16 a[132:135], v[196:199], v[228:231], a[132:135]
    v_mfma_f32_16x16x32_bf16 a[136:139], v[200:203], v[228:231], a[136:139]
    v_mfma_f32_16x16x32_bf16 a[140:143], v[184:187], v[232:235], a[140:143]
    v_mfma_f32_16x16x32_bf16 a[144:147], v[188:191], v[232:235], a[144:147]
    v_mfma_f32_16x16x32_bf16 a[148:151], v[192:195], v[232:235], a[148:151]
    v_mfma_f32_16x16x32_bf16 a[152:155], v[196:199], v[232:235], a[152:155]
    v_mfma_f32_16x16x32_bf16 a[156:159], v[200:203], v[232:235], a[156:159]
    v_mfma_f32_16x16x32_bf16 a[160:163], v[184:187], v[236:239], a[160:163]
    v_mfma_f32_16x16x32_bf16 a[164:167], v[188:191], v[236:239], a[164:167]
    v_mfma_f32_16x16x32_bf16 a[168:171], v[192:195], v[236:239], a[168:171]
    v_mfma_f32_16x16x32_bf16 a[172:175], v[196:199], v[236:239], a[172:175]
    v_mfma_f32_16x16x32_bf16 a[176:179], v[200:203], v[236:239], a[176:179]
    v_and_b32 v5, 63, v0
    s_xor_b32 s20, s16, 0
    s_add_u32 s20, s20, 0
    s_sub_u32 s20, s20, 1
    s_mul_i32 s20, s20, 12288
    v_add_u32 v8, s20, v1
    s_xor_b32 s20, s16, 1
    s_add_u32 s20, s20, 3
    s_sub_u32 s20, s20, 1
    s_mul_i32 s20, s20, 12288
    v_add_u32 v9, s20, v1
    s_xor_b32 s20, s16, 2
    s_add_u32 s20, s20, 6
    s_sub_u32 s20, s20, 1
    s_mul_i32 s20, s20, 12288
    v_add_u32 v10, s20, v1
    s_xor_b32 s20, s16, 3
    s_add_u32 s20, s20, 9
    s_sub_u32 s20, s20, 1
    s_mul_i32 s20, s20, 12288
    v_add_u32 v11, s20, v1
    s_cmp_eq_u32 s16, 0
    s_cbranch_scc1 K2_SKIPW0
    ds_write_b128 v8, a[0:3]
    ds_write_b128 v8, a[4:7] offset:1024
    ds_write_b128 v8, a[8:11] offset:2048
    ds_write_b128 v8, a[12:15] offset:3072
    ds_write_b128 v8, a[16:19] offset:4096
    ds_write_b128 v8, a[20:23] offset:5120
    ds_write_b128 v8, a[24:27] offset:6144
    ds_write_b128 v8, a[28:31] offset:7168
    ds_write_b128 v8, a[32:35] offset:8192
    ds_write_b128 v8, a[36:39] offset:9216
    ds_write_b128 v8, a[40:43] offset:10240
    ds_write_b128 v8, a[44:47] offset:11264
K2_SKIPW0:
    s_cmp_eq_u32 s16, 1
    s_cbranch_scc1 K2_SKIPW1
    ds_write_b128 v9, a[48:51]
    ds_write_b128 v9, a[52:55] offset:1024
    ds_write_b128 v9, a[56:59] offset:2048
    ds_write_b128 v9, a[60:63] offset:3072
    ds_write_b128 v9, a[64:67] offset:4096
    ds_write_b128 v9, a[68:71] offset:5120
    ds_write_b128 v9, a[72:75] offset:6144
    ds_write_b128 v9, a[76:79] offset:7168
    ds_write_b128 v9, a[80:83] offset:8192
    ds_write_b128 v9, a[84:87] offset:9216
    ds_write_b128 v9, a[88:91] offset:10240
K2_SKIPW1:
    s_cmp_eq_u32 s16, 2
    s_cbranch_scc1 K2_SKIPW2
    ds_write_b128 v10, a[92:95]
    ds_write_b128 v10, a[96:99] offset:1024
    ds_write_b128 v10, a[100:103] offset:2048
    ds_write_b128 v10, a[104:107] offset:3072
    ds_write_b128 v10, a[108:111] offset:4096
    ds_write_b128 v10, a[112:115] offset:5120
    ds_write_b128 v10, a[116:119] offset:6144
    ds_write_b128 v10, a[120:123] offset:7168
    ds_write_b128 v10, a[124:127] offset:8192
    ds_write_b128 v10, a[128:131] offset:9216
    ds_write_b128 v10, a[132:135] offset:10240
K2_SKIPW2:
    s_cmp_eq_u32 s16, 3
    s_cbranch_scc1 K2_SKIPW3
    ds_write_b128 v11, a[136:139]
    ds_write_b128 v11, a[140:143] offset:1024
    ds_write_b128 v11, a[144:147] offset:2048
    ds_write_b128 v11, a[148:151] offset:3072
    ds_write_b128 v11, a[152:155] offset:4096
    ds_write_b128 v11, a[156:159] offset:5120
    ds_write_b128 v11, a[160:163] offset:6144
    ds_write_b128 v11, a[164:167] offset:7168
    ds_write_b128 v11, a[168:171] offset:8192
    ds_write_b128 v11, a[172:175] offset:9216
    ds_write_b128 v11, a[176:179] offset:10240
K2_SKIPW3:
    s_waitcnt lgkmcnt(0)
    s_barrier
    v_and_b32 v6, 15, v5
    v_mul_u32_u24 v6, 2560, v6
    v_lshrrev_b32 v7, 4, v5
    v_lshlrev_b32 v7, 3, v7
    v_add_u32 v6, v6, v7
    s_cmp_lg_u32 s16, 0
    s_cbranch_scc1 K2_RD1
    v_add_u32 v12, 0, v1
    ds_read_b128 v[16:19], v12
    ds_read_b128 v[20:23], v12 offset:12288
    ds_read_b128 v[24:27], v12 offset:24576
    ds_read_b128 v[28:31], v12 offset:1024
    ds_read_b128 v[32:35], v12 offset:13312
    ds_read_b128 v[36:39], v12 offset:25600
    ds_read_b128 v[40:43], v12 offset:2048
    ds_read_b128 v[44:47], v12 offset:14336
    ds_read_b128 v[48:51], v12 offset:26624
    ds_read_b128 v[52:55], v12 offset:3072
    ds_read_b128 v[56:59], v12 offset:15360
    ds_read_b128 v[60:63], v12 offset:27648
    ds_read_b128 v[64:67], v12 offset:4096
    ds_read_b128 v[68:71], v12 offset:16384
    ds_read_b128 v[72:75], v12 offset:28672
    ds_read_b128 v[76:79], v12 offset:5120
    ds_read_b128 v[80:83], v12 offset:17408
    ds_read_b128 v[84:87], v12 offset:29696
    ds_read_b128 v[88:91], v12 offset:6144
    ds_read_b128 v[92:95], v12 offset:18432
    ds_read_b128 v[96:99], v12 offset:30720
    ds_read_b128 v[100:103], v12 offset:7168
    ds_read_b128 v[104:107], v12 offset:19456
    ds_read_b128 v[108:111], v12 offset:31744
    ds_read_b128 v[112:115], v12 offset:8192
    ds_read_b128 v[116:119], v12 offset:20480
    ds_read_b128 v[120:123], v12 offset:32768
    ds_read_b128 v[124:127], v12 offset:9216
    ds_read_b128 v[128:131], v12 offset:21504
    ds_read_b128 v[132:135], v12 offset:33792
    ds_read_b128 v[136:139], v12 offset:10240
    ds_read_b128 v[140:143], v12 offset:22528
    ds_read_b128 v[144:147], v12 offset:34816
    ds_read_b128 v[148:151], v12 offset:11264
    ds_read_b128 v[152:155], v12 offset:23552
    ds_read_b128 v[156:159], v12 offset:35840
    v_accvgpr_read_b32 v200, a0
    v_accvgpr_read_b32 v201, a1
    v_accvgpr_read_b32 v202, a2
    v_accvgpr_read_b32 v203, a3
    s_waitcnt lgkmcnt(15)
    v_pk_add_f32 v[200:201], v[200:201], v[16:17]
    v_pk_add_f32 v[202:203], v[202:203], v[18:19]
    v_pk_add_f32 v[200:201], v[200:201], v[20:21]
    v_pk_add_f32 v[202:203], v[202:203], v[22:23]
    v_pk_add_f32 v[200:201], v[200:201], v[24:25]
    v_pk_add_f32 v[202:203], v[202:203], v[26:27]
    v_cvt_pk_bf16_f32 v220, v200, v201
    v_cvt_pk_bf16_f32 v221, v202, v203
    s_add_u32 s20, s27, 0
    buffer_store_dwordx2 v[220:221], v6, s[12:15], s20 offen
    v_accvgpr_read_b32 v204, a4
    v_accvgpr_read_b32 v205, a5
    v_accvgpr_read_b32 v206, a6
    v_accvgpr_read_b32 v207, a7
    v_pk_add_f32 v[204:205], v[204:205], v[28:29]
    v_pk_add_f32 v[206:207], v[206:207], v[30:31]
    v_pk_add_f32 v[204:205], v[204:205], v[32:33]
    v_pk_add_f32 v[206:207], v[206:207], v[34:35]
    v_pk_add_f32 v[204:205], v[204:205], v[36:37]
    v_pk_add_f32 v[206:207], v[206:207], v[38:39]
    v_cvt_pk_bf16_f32 v222, v204, v205
    v_cvt_pk_bf16_f32 v223, v206, v207
    s_add_u32 s20, s27, 0
    buffer_store_dwordx2 v[222:223], v6, s[12:15], s20 offen offset:32
    v_accvgpr_read_b32 v208, a8
    v_accvgpr_read_b32 v209, a9
    v_accvgpr_read_b32 v210, a10
    v_accvgpr_read_b32 v211, a11
    v_pk_add_f32 v[208:209], v[208:209], v[40:41]
    v_pk_add_f32 v[210:211], v[210:211], v[42:43]
    v_pk_add_f32 v[208:209], v[208:209], v[44:45]
    v_pk_add_f32 v[210:211], v[210:211], v[46:47]
    v_pk_add_f32 v[208:209], v[208:209], v[48:49]
    v_pk_add_f32 v[210:211], v[210:211], v[50:51]
    v_cvt_pk_bf16_f32 v224, v208, v209
    v_cvt_pk_bf16_f32 v225, v210, v211
    s_add_u32 s20, s27, 0
    buffer_store_dwordx2 v[224:225], v6, s[12:15], s20 offen offset:64
    v_accvgpr_read_b32 v212, a12
    v_accvgpr_read_b32 v213, a13
    v_accvgpr_read_b32 v214, a14
    v_accvgpr_read_b32 v215, a15
    v_pk_add_f32 v[212:213], v[212:213], v[52:53]
    v_pk_add_f32 v[214:215], v[214:215], v[54:55]
    v_pk_add_f32 v[212:213], v[212:213], v[56:57]
    v_pk_add_f32 v[214:215], v[214:215], v[58:59]
    v_pk_add_f32 v[212:213], v[212:213], v[60:61]
    v_pk_add_f32 v[214:215], v[214:215], v[62:63]
    v_cvt_pk_bf16_f32 v226, v212, v213
    v_cvt_pk_bf16_f32 v227, v214, v215
    s_add_u32 s20, s27, 0
    buffer_store_dwordx2 v[226:227], v6, s[12:15], s20 offen offset:96
    v_accvgpr_read_b32 v200, a16
    v_accvgpr_read_b32 v201, a17
    v_accvgpr_read_b32 v202, a18
    v_accvgpr_read_b32 v203, a19
    v_pk_add_f32 v[200:201], v[200:201], v[64:65]
    v_pk_add_f32 v[202:203], v[202:203], v[66:67]
    v_pk_add_f32 v[200:201], v[200:201], v[68:69]
    v_pk_add_f32 v[202:203], v[202:203], v[70:71]
    v_pk_add_f32 v[200:201], v[200:201], v[72:73]
    v_pk_add_f32 v[202:203], v[202:203], v[74:75]
    v_cvt_pk_bf16_f32 v220, v200, v201
    v_cvt_pk_bf16_f32 v221, v202, v203
    s_add_u32 s20, s27, 0
    buffer_store_dwordx2 v[220:221], v6, s[12:15], s20 offen offset:128
    v_accvgpr_read_b32 v204, a20
    v_accvgpr_read_b32 v205, a21
    v_accvgpr_read_b32 v206, a22
    v_accvgpr_read_b32 v207, a23
    v_pk_add_f32 v[204:205], v[204:205], v[76:77]
    v_pk_add_f32 v[206:207], v[206:207], v[78:79]
    v_pk_add_f32 v[204:205], v[204:205], v[80:81]
    v_pk_add_f32 v[206:207], v[206:207], v[82:83]
    v_pk_add_f32 v[204:205], v[204:205], v[84:85]
    v_pk_add_f32 v[206:207], v[206:207], v[86:87]
    v_cvt_pk_bf16_f32 v222, v204, v205
    v_cvt_pk_bf16_f32 v223, v206, v207
    s_add_u32 s20, s27, 40960
    buffer_store_dwordx2 v[222:223], v6, s[12:15], s20 offen
    v_accvgpr_read_b32 v208, a24
    v_accvgpr_read_b32 v209, a25
    v_accvgpr_read_b32 v210, a26
    v_accvgpr_read_b32 v211, a27
    v_pk_add_f32 v[208:209], v[208:209], v[88:89]
    v_pk_add_f32 v[210:211], v[210:211], v[90:91]
    v_pk_add_f32 v[208:209], v[208:209], v[92:93]
    v_pk_add_f32 v[210:211], v[210:211], v[94:95]
    v_pk_add_f32 v[208:209], v[208:209], v[96:97]
    v_pk_add_f32 v[210:211], v[210:211], v[98:99]
    v_cvt_pk_bf16_f32 v224, v208, v209
    v_cvt_pk_bf16_f32 v225, v210, v211
    s_add_u32 s20, s27, 40960
    buffer_store_dwordx2 v[224:225], v6, s[12:15], s20 offen offset:32
    v_accvgpr_read_b32 v212, a28
    v_accvgpr_read_b32 v213, a29
    v_accvgpr_read_b32 v214, a30
    v_accvgpr_read_b32 v215, a31
    s_waitcnt lgkmcnt(14)
    v_pk_add_f32 v[212:213], v[212:213], v[100:101]
    v_pk_add_f32 v[214:215], v[214:215], v[102:103]
    s_waitcnt lgkmcnt(13)
    v_pk_add_f32 v[212:213], v[212:213], v[104:105]
    v_pk_add_f32 v[214:215], v[214:215], v[106:107]
    s_waitcnt lgkmcnt(12)
    v_pk_add_f32 v[212:213], v[212:213], v[108:109]
    v_pk_add_f32 v[214:215], v[214:215], v[110:111]
    v_cvt_pk_bf16_f32 v226, v212, v213
    v_cvt_pk_bf16_f32 v227, v214, v215
    s_add_u32 s20, s27, 40960
    buffer_store_dwordx2 v[226:227], v6, s[12:15], s20 offen offset:64
    v_accvgpr_read_b32 v200, a32
    v_accvgpr_read_b32 v201, a33
    v_accvgpr_read_b32 v202, a34
    v_accvgpr_read_b32 v203, a35
    s_waitcnt lgkmcnt(11)
    v_pk_add_f32 v[200:201], v[200:201], v[112:113]
    v_pk_add_f32 v[202:203], v[202:203], v[114:115]
    s_waitcnt lgkmcnt(10)
    v_pk_add_f32 v[200:201], v[200:201], v[116:117]
    v_pk_add_f32 v[202:203], v[202:203], v[118:119]
    s_waitcnt lgkmcnt(9)
    v_pk_add_f32 v[200:201], v[200:201], v[120:121]
    v_pk_add_f32 v[202:203], v[202:203], v[122:123]
    v_cvt_pk_bf16_f32 v220, v200, v201
    v_cvt_pk_bf16_f32 v221, v202, v203
    s_add_u32 s20, s27, 40960
    buffer_store_dwordx2 v[220:221], v6, s[12:15], s20 offen offset:96
    v_accvgpr_read_b32 v204, a36
    v_accvgpr_read_b32 v205, a37
    v_accvgpr_read_b32 v206, a38
    v_accvgpr_read_b32 v207, a39
    s_waitcnt lgkmcnt(8)
    v_pk_add_f32 v[204:205], v[204:205], v[124:125]
    v_pk_add_f32 v[206:207], v[206:207], v[126:127]
    s_waitcnt lgkmcnt(7)
    v_pk_add_f32 v[204:205], v[204:205], v[128:129]
    v_pk_add_f32 v[206:207], v[206:207], v[130:131]
    s_waitcnt lgkmcnt(6)
    v_pk_add_f32 v[204:205], v[204:205], v[132:133]
    v_pk_add_f32 v[206:207], v[206:207], v[134:135]
    v_cvt_pk_bf16_f32 v222, v204, v205
    v_cvt_pk_bf16_f32 v223, v206, v207
    s_add_u32 s20, s27, 40960
    buffer_store_dwordx2 v[222:223], v6, s[12:15], s20 offen offset:128
    v_accvgpr_read_b32 v208, a40
    v_accvgpr_read_b32 v209, a41
    v_accvgpr_read_b32 v210, a42
    v_accvgpr_read_b32 v211, a43
    s_waitcnt lgkmcnt(5)
    v_pk_add_f32 v[208:209], v[208:209], v[136:137]
    v_pk_add_f32 v[210:211], v[210:211], v[138:139]
    s_waitcnt lgkmcnt(4)
    v_pk_add_f32 v[208:209], v[208:209], v[140:141]
    v_pk_add_f32 v[210:211], v[210:211], v[142:143]
    s_waitcnt lgkmcnt(3)
    v_pk_add_f32 v[208:209], v[208:209], v[144:145]
    v_pk_add_f32 v[210:211], v[210:211], v[146:147]
    v_cvt_pk_bf16_f32 v224, v208, v209
    v_cvt_pk_bf16_f32 v225, v210, v211
    s_add_u32 s20, s27, 81920
    buffer_store_dwordx2 v[224:225], v6, s[12:15], s20 offen
    v_accvgpr_read_b32 v212, a44
    v_accvgpr_read_b32 v213, a45
    v_accvgpr_read_b32 v214, a46
    v_accvgpr_read_b32 v215, a47
    s_waitcnt lgkmcnt(2)
    v_pk_add_f32 v[212:213], v[212:213], v[148:149]
    v_pk_add_f32 v[214:215], v[214:215], v[150:151]
    s_waitcnt lgkmcnt(1)
    v_pk_add_f32 v[212:213], v[212:213], v[152:153]
    v_pk_add_f32 v[214:215], v[214:215], v[154:155]
    s_waitcnt lgkmcnt(0)
    v_pk_add_f32 v[212:213], v[212:213], v[156:157]
    v_pk_add_f32 v[214:215], v[214:215], v[158:159]
    v_cvt_pk_bf16_f32 v226, v212, v213
    v_cvt_pk_bf16_f32 v227, v214, v215
    s_add_u32 s20, s27, 81920
    buffer_store_dwordx2 v[226:227], v6, s[12:15], s20 offen offset:32
    s_branch K2_FIN
K2_RD1:
    s_cmp_lg_u32 s16, 1
    s_cbranch_scc1 K2_RD2
    v_add_u32 v12, 36864, v1
    ds_read_b128 v[16:19], v12
    ds_read_b128 v[20:23], v12 offset:12288
    ds_read_b128 v[24:27], v12 offset:24576
    ds_read_b128 v[28:31], v12 offset:1024
    ds_read_b128 v[32:35], v12 offset:13312
    ds_read_b128 v[36:39], v12 offset:25600
    ds_read_b128 v[40:43], v12 offset:2048
    ds_read_b128 v[44:47], v12 offset:14336
    ds_read_b128 v[48:51], v12 offset:26624
    ds_read_b128 v[52:55], v12 offset:3072
    ds_read_b128 v[56:59], v12 offset:15360
    ds_read_b128 v[60:63], v12 offset:27648
    ds_read_b128 v[64:67], v12 offset:4096
    ds_read_b128 v[68:71], v12 offset:16384
    ds_read_b128 v[72:75], v12 offset:28672
    ds_read_b128 v[76:79], v12 offset:5120
    ds_read_b128 v[80:83], v12 offset:17408
    ds_read_b128 v[84:87], v12 offset:29696
    ds_read_b128 v[88:91], v12 offset:6144
    ds_read_b128 v[92:95], v12 offset:18432
    ds_read_b128 v[96:99], v12 offset:30720
    ds_read_b128 v[100:103], v12 offset:7168
    ds_read_b128 v[104:107], v12 offset:19456
    ds_read_b128 v[108:111], v12 offset:31744
    ds_read_b128 v[112:115], v12 offset:8192
    ds_read_b128 v[116:119], v12 offset:20480
    ds_read_b128 v[120:123], v12 offset:32768
    ds_read_b128 v[124:127], v12 offset:9216
    ds_read_b128 v[128:131], v12 offset:21504
    ds_read_b128 v[132:135], v12 offset:33792
    ds_read_b128 v[136:139], v12 offset:10240
    ds_read_b128 v[140:143], v12 offset:22528
    ds_read_b128 v[144:147], v12 offset:34816
    v_accvgpr_read_b32 v200, a48
    v_accvgpr_read_b32 v201, a49
    v_accvgpr_read_b32 v202, a50
    v_accvgpr_read_b32 v203, a51
    s_waitcnt lgkmcnt(15)
    v_pk_add_f32 v[200:201], v[200:201], v[16:17]
    v_pk_add_f32 v[202:203], v[202:203], v[18:19]
    v_pk_add_f32 v[200:201], v[200:201], v[20:21]
    v_pk_add_f32 v[202:203], v[202:203], v[22:23]
    v_pk_add_f32 v[200:201], v[200:201], v[24:25]
    v_pk_add_f32 v[202:203], v[202:203], v[26:27]
    v_cvt_pk_bf16_f32 v220, v200, v201
    v_cvt_pk_bf16_f32 v221, v202, v203
    s_add_u32 s20, s27, 81920
    buffer_store_dwordx2 v[220:221], v6, s[12:15], s20 offen offset:64
    v_accvgpr_read_b32 v204, a52
    v_accvgpr_read_b32 v205, a53
    v_accvgpr_read_b32 v206, a54
    v_accvgpr_read_b32 v207, a55
    v_pk_add_f32 v[204:205], v[204:205], v[28:29]
    v_pk_add_f32 v[206:207], v[206:207], v[30:31]
    v_pk_add_f32 v[204:205], v[204:205], v[32:33]
    v_pk_add_f32 v[206:207], v[206:207], v[34:35]
    v_pk_add_f32 v[204:205], v[204:205], v[36:37]
    v_pk_add_f32 v[206:207], v[206:207], v[38:39]
    v_cvt_pk_bf16_f32 v222, v204, v205
    v_cvt_pk_bf16_f32 v223, v206, v207
    s_add_u32 s20, s27, 81920
    buffer_store_dwordx2 v[222:223], v6, s[12:15], s20 offen offset:96
    v_accvgpr_read_b32 v208, a56
    v_accvgpr_read_b32 v209, a57
    v_accvgpr_read_b32 v210, a58
    v_accvgpr_read_b32 v211, a59
    v_pk_add_f32 v[208:209], v[208:209], v[40:41]
    v_pk_add_f32 v[210:211], v[210:211], v[42:43]
    v_pk_add_f32 v[208:209], v[208:209], v[44:45]
    v_pk_add_f32 v[210:211], v[210:211], v[46:47]
    v_pk_add_f32 v[208:209], v[208:209], v[48:49]
    v_pk_add_f32 v[210:211], v[210:211], v[50:51]
    v_cvt_pk_bf16_f32 v224, v208, v209
    v_cvt_pk_bf16_f32 v225, v210, v211
    s_add_u32 s20, s27, 81920
    buffer_store_dwordx2 v[224:225], v6, s[12:15], s20 offen offset:128
    v_accvgpr_read_b32 v212, a60
    v_accvgpr_read_b32 v213, a61
    v_accvgpr_read_b32 v214, a62
    v_accvgpr_read_b32 v215, a63
    v_pk_add_f32 v[212:213], v[212:213], v[52:53]
    v_pk_add_f32 v[214:215], v[214:215], v[54:55]
    v_pk_add_f32 v[212:213], v[212:213], v[56:57]
    v_pk_add_f32 v[214:215], v[214:215], v[58:59]
    v_pk_add_f32 v[212:213], v[212:213], v[60:61]
    v_pk_add_f32 v[214:215], v[214:215], v[62:63]
    v_cvt_pk_bf16_f32 v226, v212, v213
    v_cvt_pk_bf16_f32 v227, v214, v215
    s_add_u32 s20, s27, 122880
    buffer_store_dwordx2 v[226:227], v6, s[12:15], s20 offen
    v_accvgpr_read_b32 v200, a64
    v_accvgpr_read_b32 v201, a65
    v_accvgpr_read_b32 v202, a66
    v_accvgpr_read_b32 v203, a67
    v_pk_add_f32 v[200:201], v[200:201], v[64:65]
    v_pk_add_f32 v[202:203], v[202:203], v[66:67]
    v_pk_add_f32 v[200:201], v[200:201], v[68:69]
    v_pk_add_f32 v[202:203], v[202:203], v[70:71]
    v_pk_add_f32 v[200:201], v[200:201], v[72:73]
    v_pk_add_f32 v[202:203], v[202:203], v[74:75]
    v_cvt_pk_bf16_f32 v220, v200, v201
    v_cvt_pk_bf16_f32 v221, v202, v203
    s_add_u32 s20, s27, 122880
    buffer_store_dwordx2 v[220:221], v6, s[12:15], s20 offen offset:32
    v_accvgpr_read_b32 v204, a68
    v_accvgpr_read_b32 v205, a69
    v_accvgpr_read_b32 v206, a70
    v_accvgpr_read_b32 v207, a71
    v_pk_add_f32 v[204:205], v[204:205], v[76:77]
    v_pk_add_f32 v[206:207], v[206:207], v[78:79]
    v_pk_add_f32 v[204:205], v[204:205], v[80:81]
    v_pk_add_f32 v[206:207], v[206:207], v[82:83]
    v_pk_add_f32 v[204:205], v[204:205], v[84:85]
    v_pk_add_f32 v[206:207], v[206:207], v[86:87]
    v_cvt_pk_bf16_f32 v222, v204, v205
    v_cvt_pk_bf16_f32 v223, v206, v207
    s_add_u32 s20, s27, 122880
    buffer_store_dwordx2 v[222:223], v6, s[12:15], s20 offen offset:64
    v_accvgpr_read_b32 v208, a72
    v_accvgpr_read_b32 v209, a73
    v_accvgpr_read_b32 v210, a74
    v_accvgpr_read_b32 v211, a75
    s_waitcnt lgkmcnt(14)
    v_pk_add_f32 v[208:209], v[208:209], v[88:89]
    v_pk_add_f32 v[210:211], v[210:211], v[90:91]
    s_waitcnt lgkmcnt(13)
    v_pk_add_f32 v[208:209], v[208:209], v[92:93]
    v_pk_add_f32 v[210:211], v[210:211], v[94:95]
    s_waitcnt lgkmcnt(12)
    v_pk_add_f32 v[208:209], v[208:209], v[96:97]
    v_pk_add_f32 v[210:211], v[210:211], v[98:99]
    v_cvt_pk_bf16_f32 v224, v208, v209
    v_cvt_pk_bf16_f32 v225, v210, v211
    s_add_u32 s20, s27, 122880
    buffer_store_dwordx2 v[224:225], v6, s[12:15], s20 offen offset:96
    v_accvgpr_read_b32 v212, a76
    v_accvgpr_read_b32 v213, a77
    v_accvgpr_read_b32 v214, a78
    v_accvgpr_read_b32 v215, a79
    s_waitcnt lgkmcnt(11)
    v_pk_add_f32 v[212:213], v[212:213], v[100:101]
    v_pk_add_f32 v[214:215], v[214:215], v[102:103]
    s_waitcnt lgkmcnt(10)
    v_pk_add_f32 v[212:213], v[212:213], v[104:105]
    v_pk_add_f32 v[214:215], v[214:215], v[106:107]
    s_waitcnt lgkmcnt(9)
    v_pk_add_f32 v[212:213], v[212:213], v[108:109]
    v_pk_add_f32 v[214:215], v[214:215], v[110:111]
    v_cvt_pk_bf16_f32 v226, v212, v213
    v_cvt_pk_bf16_f32 v227, v214, v215
    s_add_u32 s20, s27, 122880
    buffer_store_dwordx2 v[226:227], v6, s[12:15], s20 offen offset:128
    v_accvgpr_read_b32 v200, a80
    v_accvgpr_read_b32 v201, a81
    v_accvgpr_read_b32 v202, a82
    v_accvgpr_read_b32 v203, a83
    s_waitcnt lgkmcnt(8)
    v_pk_add_f32 v[200:201], v[200:201], v[112:113]
    v_pk_add_f32 v[202:203], v[202:203], v[114:115]
    s_waitcnt lgkmcnt(7)
    v_pk_add_f32 v[200:201], v[200:201], v[116:117]
    v_pk_add_f32 v[202:203], v[202:203], v[118:119]
    s_waitcnt lgkmcnt(6)
    v_pk_add_f32 v[200:201], v[200:201], v[120:121]
    v_pk_add_f32 v[202:203], v[202:203], v[122:123]
    v_cvt_pk_bf16_f32 v220, v200, v201
    v_cvt_pk_bf16_f32 v221, v202, v203
    s_add_u32 s20, s27, 163840
    buffer_store_dwordx2 v[220:221], v6, s[12:15], s20 offen
    v_accvgpr_read_b32 v204, a84
    v_accvgpr_read_b32 v205, a85
    v_accvgpr_read_b32 v206, a86
    v_accvgpr_read_b32 v207, a87
    s_waitcnt lgkmcnt(5)
    v_pk_add_f32 v[204:205], v[204:205], v[124:125]
    v_pk_add_f32 v[206:207], v[206:207], v[126:127]
    s_waitcnt lgkmcnt(4)
    v_pk_add_f32 v[204:205], v[204:205], v[128:129]
    v_pk_add_f32 v[206:207], v[206:207], v[130:131]
    s_waitcnt lgkmcnt(3)
    v_pk_add_f32 v[204:205], v[204:205], v[132:133]
    v_pk_add_f32 v[206:207], v[206:207], v[134:135]
    v_cvt_pk_bf16_f32 v222, v204, v205
    v_cvt_pk_bf16_f32 v223, v206, v207
    s_add_u32 s20, s27, 163840
    buffer_store_dwordx2 v[222:223], v6, s[12:15], s20 offen offset:32
    v_accvgpr_read_b32 v208, a88
    v_accvgpr_read_b32 v209, a89
    v_accvgpr_read_b32 v210, a90
    v_accvgpr_read_b32 v211, a91
    s_waitcnt lgkmcnt(2)
    v_pk_add_f32 v[208:209], v[208:209], v[136:137]
    v_pk_add_f32 v[210:211], v[210:211], v[138:139]
    s_waitcnt lgkmcnt(1)
    v_pk_add_f32 v[208:209], v[208:209], v[140:141]
    v_pk_add_f32 v[210:211], v[210:211], v[142:143]
    s_waitcnt lgkmcnt(0)
    v_pk_add_f32 v[208:209], v[208:209], v[144:145]
    v_pk_add_f32 v[210:211], v[210:211], v[146:147]
    v_cvt_pk_bf16_f32 v224, v208, v209
    v_cvt_pk_bf16_f32 v225, v210, v211
    s_add_u32 s20, s27, 163840
    buffer_store_dwordx2 v[224:225], v6, s[12:15], s20 offen offset:64
    s_branch K2_FIN
K2_RD2:
    s_cmp_lg_u32 s16, 2
    s_cbranch_scc1 K2_RD3
    v_add_u32 v12, 73728, v1
    ds_read_b128 v[16:19], v12
    ds_read_b128 v[20:23], v12 offset:12288
    ds_read_b128 v[24:27], v12 offset:24576
    ds_read_b128 v[28:31], v12 offset:1024
    ds_read_b128 v[32:35], v12 offset:13312
    ds_read_b128 v[36:39], v12 offset:25600
    ds_read_b128 v[40:43], v12 offset:2048
    ds_read_b128 v[44:47], v12 offset:14336
    ds_read_b128 v[48:51], v12 offset:26624
    ds_read_b128 v[52:55], v12 offset:3072
    ds_read_b128 v[56:59], v12 offset:15360
    ds_read_b128 v[60:63], v12 offset:27648
    ds_read_b128 v[64:67], v12 offset:4096
    ds_read_b128 v[68:71], v12 offset:16384
    ds_read_b128 v[72:75], v12 offset:28672
    ds_read_b128 v[76:79], v12 offset:5120
    ds_read_b128 v[80:83], v12 offset:17408
    ds_read_b128 v[84:87], v12 offset:29696
    ds_read_b128 v[88:91], v12 offset:6144
    ds_read_b128 v[92:95], v12 offset:18432
    ds_read_b128 v[96:99], v12 offset:30720
    ds_read_b128 v[100:103], v12 offset:7168
    ds_read_b128 v[104:107], v12 offset:19456
    ds_read_b128 v[108:111], v12 offset:31744
    ds_read_b128 v[112:115], v12 offset:8192
    ds_read_b128 v[116:119], v12 offset:20480
    ds_read_b128 v[120:123], v12 offset:32768
    ds_read_b128 v[124:127], v12 offset:9216
    ds_read_b128 v[128:131], v12 offset:21504
    ds_read_b128 v[132:135], v12 offset:33792
    ds_read_b128 v[136:139], v12 offset:10240
    ds_read_b128 v[140:143], v12 offset:22528
    ds_read_b128 v[144:147], v12 offset:34816
    v_accvgpr_read_b32 v200, a92
    v_accvgpr_read_b32 v201, a93
    v_accvgpr_read_b32 v202, a94
    v_accvgpr_read_b32 v203, a95
    s_waitcnt lgkmcnt(15)
    v_pk_add_f32 v[200:201], v[200:201], v[16:17]
    v_pk_add_f32 v[202:203], v[202:203], v[18:19]
    v_pk_add_f32 v[200:201], v[200:201], v[20:21]
    v_pk_add_f32 v[202:203], v[202:203], v[22:23]
    v_pk_add_f32 v[200:201], v[200:201], v[24:25]
    v_pk_add_f32 v[202:203], v[202:203], v[26:27]
    v_cvt_pk_bf16_f32 v220, v200, v201
    v_cvt_pk_bf16_f32 v221, v202, v203
    s_add_u32 s20, s27, 163840
    buffer_store_dwordx2 v[220:221], v6, s[12:15], s20 offen offset:96
    v_accvgpr_read_b32 v204, a96
    v_accvgpr_read_b32 v205, a97
    v_accvgpr_read_b32 v206, a98
    v_accvgpr_read_b32 v207, a99
    v_pk_add_f32 v[204:205], v[204:205], v[28:29]
    v_pk_add_f32 v[206:207], v[206:207], v[30:31]
    v_pk_add_f32 v[204:205], v[204:205], v[32:33]
    v_pk_add_f32 v[206:207], v[206:207], v[34:35]
    v_pk_add_f32 v[204:205], v[204:205], v[36:37]
    v_pk_add_f32 v[206:207], v[206:207], v[38:39]
    v_cvt_pk_bf16_f32 v222, v204, v205
    v_cvt_pk_bf16_f32 v223, v206, v207
    s_add_u32 s20, s27, 163840
    buffer_store_dwordx2 v[222:223], v6, s[12:15], s20 offen offset:128
    v_accvgpr_read_b32 v208, a100
    v_accvgpr_read_b32 v209, a101
    v_accvgpr_read_b32 v210, a102
    v_accvgpr_read_b32 v211, a103
    v_pk_add_f32 v[208:209], v[208:209], v[40:41]
    v_pk_add_f32 v[210:211], v[210:211], v[42:43]
    v_pk_add_f32 v[208:209], v[208:209], v[44:45]
    v_pk_add_f32 v[210:211], v[210:211], v[46:47]
    v_pk_add_f32 v[208:209], v[208:209], v[48:49]
    v_pk_add_f32 v[210:211], v[210:211], v[50:51]
    v_cvt_pk_bf16_f32 v224, v208, v209
    v_cvt_pk_bf16_f32 v225, v210, v211
    s_add_u32 s20, s27, 204800
    buffer_store_dwordx2 v[224:225], v6, s[12:15], s20 offen
    v_accvgpr_read_b32 v212, a104
    v_accvgpr_read_b32 v213, a105
    v_accvgpr_read_b32 v214, a106
    v_accvgpr_read_b32 v215, a107
    v_pk_add_f32 v[212:213], v[212:213], v[52:53]
    v_pk_add_f32 v[214:215], v[214:215], v[54:55]
    v_pk_add_f32 v[212:213], v[212:213], v[56:57]
    v_pk_add_f32 v[214:215], v[214:215], v[58:59]
    v_pk_add_f32 v[212:213], v[212:213], v[60:61]
    v_pk_add_f32 v[214:215], v[214:215], v[62:63]
    v_cvt_pk_bf16_f32 v226, v212, v213
    v_cvt_pk_bf16_f32 v227, v214, v215
    s_add_u32 s20, s27, 204800
    buffer_store_dwordx2 v[226:227], v6, s[12:15], s20 offen offset:32
    v_accvgpr_read_b32 v200, a108
    v_accvgpr_read_b32 v201, a109
    v_accvgpr_read_b32 v202, a110
    v_accvgpr_read_b32 v203, a111
    v_pk_add_f32 v[200:201], v[200:201], v[64:65]
    v_pk_add_f32 v[202:203], v[202:203], v[66:67]
    v_pk_add_f32 v[200:201], v[200:201], v[68:69]
    v_pk_add_f32 v[202:203], v[202:203], v[70:71]
    v_pk_add_f32 v[200:201], v[200:201], v[72:73]
    v_pk_add_f32 v[202:203], v[202:203], v[74:75]
    v_cvt_pk_bf16_f32 v220, v200, v201
    v_cvt_pk_bf16_f32 v221, v202, v203
    s_add_u32 s20, s27, 204800
    buffer_store_dwordx2 v[220:221], v6, s[12:15], s20 offen offset:64
    v_accvgpr_read_b32 v204, a112
    v_accvgpr_read_b32 v205, a113
    v_accvgpr_read_b32 v206, a114
    v_accvgpr_read_b32 v207, a115
    v_pk_add_f32 v[204:205], v[204:205], v[76:77]
    v_pk_add_f32 v[206:207], v[206:207], v[78:79]
    v_pk_add_f32 v[204:205], v[204:205], v[80:81]
    v_pk_add_f32 v[206:207], v[206:207], v[82:83]
    v_pk_add_f32 v[204:205], v[204:205], v[84:85]
    v_pk_add_f32 v[206:207], v[206:207], v[86:87]
    v_cvt_pk_bf16_f32 v222, v204, v205
    v_cvt_pk_bf16_f32 v223, v206, v207
    s_add_u32 s20, s27, 204800
    buffer_store_dwordx2 v[222:223], v6, s[12:15], s20 offen offset:96
    v_accvgpr_read_b32 v208, a116
    v_accvgpr_read_b32 v209, a117
    v_accvgpr_read_b32 v210, a118
    v_accvgpr_read_b32 v211, a119
    s_waitcnt lgkmcnt(14)
    v_pk_add_f32 v[208:209], v[208:209], v[88:89]
    v_pk_add_f32 v[210:211], v[210:211], v[90:91]
    s_waitcnt lgkmcnt(13)
    v_pk_add_f32 v[208:209], v[208:209], v[92:93]
    v_pk_add_f32 v[210:211], v[210:211], v[94:95]
    s_waitcnt lgkmcnt(12)
    v_pk_add_f32 v[208:209], v[208:209], v[96:97]
    v_pk_add_f32 v[210:211], v[210:211], v[98:99]
    v_cvt_pk_bf16_f32 v224, v208, v209
    v_cvt_pk_bf16_f32 v225, v210, v211
    s_add_u32 s20, s27, 204800
    buffer_store_dwordx2 v[224:225], v6, s[12:15], s20 offen offset:128
    v_accvgpr_read_b32 v212, a120
    v_accvgpr_read_b32 v213, a121
    v_accvgpr_read_b32 v214, a122
    v_accvgpr_read_b32 v215, a123
    s_waitcnt lgkmcnt(11)
    v_pk_add_f32 v[212:213], v[212:213], v[100:101]
    v_pk_add_f32 v[214:215], v[214:215], v[102:103]
    s_waitcnt lgkmcnt(10)
    v_pk_add_f32 v[212:213], v[212:213], v[104:105]
    v_pk_add_f32 v[214:215], v[214:215], v[106:107]
    s_waitcnt lgkmcnt(9)
    v_pk_add_f32 v[212:213], v[212:213], v[108:109]
    v_pk_add_f32 v[214:215], v[214:215], v[110:111]
    v_cvt_pk_bf16_f32 v226, v212, v213
    v_cvt_pk_bf16_f32 v227, v214, v215
    s_add_u32 s20, s27, 245760
    buffer_store_dwordx2 v[226:227], v6, s[12:15], s20 offen
    v_accvgpr_read_b32 v200, a124
    v_accvgpr_read_b32 v201, a125
    v_accvgpr_read_b32 v202, a126
    v_accvgpr_read_b32 v203, a127
    s_waitcnt lgkmcnt(8)
    v_pk_add_f32 v[200:201], v[200:201], v[112:113]
    v_pk_add_f32 v[202:203], v[202:203], v[114:115]
    s_waitcnt lgkmcnt(7)
    v_pk_add_f32 v[200:201], v[200:201], v[116:117]
    v_pk_add_f32 v[202:203], v[202:203], v[118:119]
    s_waitcnt lgkmcnt(6)
    v_pk_add_f32 v[200:201], v[200:201], v[120:121]
    v_pk_add_f32 v[202:203], v[202:203], v[122:123]
    v_cvt_pk_bf16_f32 v220, v200, v201
    v_cvt_pk_bf16_f32 v221, v202, v203
    s_add_u32 s20, s27, 245760
    buffer_store_dwordx2 v[220:221], v6, s[12:15], s20 offen offset:32
    v_accvgpr_read_b32 v204, a128
    v_accvgpr_read_b32 v205, a129
    v_accvgpr_read_b32 v206, a130
    v_accvgpr_read_b32 v207, a131
    s_waitcnt lgkmcnt(5)
    v_pk_add_f32 v[204:205], v[204:205], v[124:125]
    v_pk_add_f32 v[206:207], v[206:207], v[126:127]
    s_waitcnt lgkmcnt(4)
    v_pk_add_f32 v[204:205], v[204:205], v[128:129]
    v_pk_add_f32 v[206:207], v[206:207], v[130:131]
    s_waitcnt lgkmcnt(3)
    v_pk_add_f32 v[204:205], v[204:205], v[132:133]
    v_pk_add_f32 v[206:207], v[206:207], v[134:135]
    v_cvt_pk_bf16_f32 v222, v204, v205
    v_cvt_pk_bf16_f32 v223, v206, v207
    s_add_u32 s20, s27, 245760
    buffer_store_dwordx2 v[222:223], v6, s[12:15], s20 offen offset:64
    v_accvgpr_read_b32 v208, a132
    v_accvgpr_read_b32 v209, a133
    v_accvgpr_read_b32 v210, a134
    v_accvgpr_read_b32 v211, a135
    s_waitcnt lgkmcnt(2)
    v_pk_add_f32 v[208:209], v[208:209], v[136:137]
    v_pk_add_f32 v[210:211], v[210:211], v[138:139]
    s_waitcnt lgkmcnt(1)
    v_pk_add_f32 v[208:209], v[208:209], v[140:141]
    v_pk_add_f32 v[210:211], v[210:211], v[142:143]
    s_waitcnt lgkmcnt(0)
    v_pk_add_f32 v[208:209], v[208:209], v[144:145]
    v_pk_add_f32 v[210:211], v[210:211], v[146:147]
    v_cvt_pk_bf16_f32 v224, v208, v209
    v_cvt_pk_bf16_f32 v225, v210, v211
    s_add_u32 s20, s27, 245760
    buffer_store_dwordx2 v[224:225], v6, s[12:15], s20 offen offset:96
    s_branch K2_FIN
K2_RD3:
    v_add_u32 v12, 110592, v1
    ds_read_b128 v[16:19], v12
    ds_read_b128 v[20:23], v12 offset:12288
    ds_read_b128 v[24:27], v12 offset:24576
    ds_read_b128 v[28:31], v12 offset:1024
    ds_read_b128 v[32:35], v12 offset:13312
    ds_read_b128 v[36:39], v12 offset:25600
    ds_read_b128 v[40:43], v12 offset:2048
    ds_read_b128 v[44:47], v12 offset:14336
    ds_read_b128 v[48:51], v12 offset:26624
    ds_read_b128 v[52:55], v12 offset:3072
    ds_read_b128 v[56:59], v12 offset:15360
    ds_read_b128 v[60:63], v12 offset:27648
    ds_read_b128 v[64:67], v12 offset:4096
    ds_read_b128 v[68:71], v12 offset:16384
    ds_read_b128 v[72:75], v12 offset:28672
    ds_read_b128 v[76:79], v12 offset:5120
    ds_read_b128 v[80:83], v12 offset:17408
    ds_read_b128 v[84:87], v12 offset:29696
    ds_read_b128 v[88:91], v12 offset:6144
    ds_read_b128 v[92:95], v12 offset:18432
    ds_read_b128 v[96:99], v12 offset:30720
    ds_read_b128 v[100:103], v12 offset:7168
    ds_read_b128 v[104:107], v12 offset:19456
    ds_read_b128 v[108:111], v12 offset:31744
    ds_read_b128 v[112:115], v12 offset:8192
    ds_read_b128 v[116:119], v12 offset:20480
    ds_read_b128 v[120:123], v12 offset:32768
    ds_read_b128 v[124:127], v12 offset:9216
    ds_read_b128 v[128:131], v12 offset:21504
    ds_read_b128 v[132:135], v12 offset:33792
    ds_read_b128 v[136:139], v12 offset:10240
    ds_read_b128 v[140:143], v12 offset:22528
    ds_read_b128 v[144:147], v12 offset:34816
    v_accvgpr_read_b32 v200, a136
    v_accvgpr_read_b32 v201, a137
    v_accvgpr_read_b32 v202, a138
    v_accvgpr_read_b32 v203, a139
    s_waitcnt lgkmcnt(15)
    v_pk_add_f32 v[200:201], v[200:201], v[16:17]
    v_pk_add_f32 v[202:203], v[202:203], v[18:19]
    v_pk_add_f32 v[200:201], v[200:201], v[20:21]
    v_pk_add_f32 v[202:203], v[202:203], v[22:23]
    v_pk_add_f32 v[200:201], v[200:201], v[24:25]
    v_pk_add_f32 v[202:203], v[202:203], v[26:27]
    v_cvt_pk_bf16_f32 v220, v200, v201
    v_cvt_pk_bf16_f32 v221, v202, v203
    s_add_u32 s20, s27, 245760
    buffer_store_dwordx2 v[220:221], v6, s[12:15], s20 offen offset:128
    v_accvgpr_read_b32 v204, a140
    v_accvgpr_read_b32 v205, a141
    v_accvgpr_read_b32 v206, a142
    v_accvgpr_read_b32 v207, a143
    v_pk_add_f32 v[204:205], v[204:205], v[28:29]
    v_pk_add_f32 v[206:207], v[206:207], v[30:31]
    v_pk_add_f32 v[204:205], v[204:205], v[32:33]
    v_pk_add_f32 v[206:207], v[206:207], v[34:35]
    v_pk_add_f32 v[204:205], v[204:205], v[36:37]
    v_pk_add_f32 v[206:207], v[206:207], v[38:39]
    v_cvt_pk_bf16_f32 v222, v204, v205
    v_cvt_pk_bf16_f32 v223, v206, v207
    s_add_u32 s20, s27, 286720
    buffer_store_dwordx2 v[222:223], v6, s[12:15], s20 offen
    v_accvgpr_read_b32 v208, a144
    v_accvgpr_read_b32 v209, a145
    v_accvgpr_read_b32 v210, a146
    v_accvgpr_read_b32 v211, a147
    v_pk_add_f32 v[208:209], v[208:209], v[40:41]
    v_pk_add_f32 v[210:211], v[210:211], v[42:43]
    v_pk_add_f32 v[208:209], v[208:209], v[44:45]
    v_pk_add_f32 v[210:211], v[210:211], v[46:47]
    v_pk_add_f32 v[208:209], v[208:209], v[48:49]
    v_pk_add_f32 v[210:211], v[210:211], v[50:51]
    v_cvt_pk_bf16_f32 v224, v208, v209
    v_cvt_pk_bf16_f32 v225, v210, v211
    s_add_u32 s20, s27, 286720
    buffer_store_dwordx2 v[224:225], v6, s[12:15], s20 offen offset:32
    v_accvgpr_read_b32 v212, a148
    v_accvgpr_read_b32 v213, a149
    v_accvgpr_read_b32 v214, a150
    v_accvgpr_read_b32 v215, a151
    v_pk_add_f32 v[212:213], v[212:213], v[52:53]
    v_pk_add_f32 v[214:215], v[214:215], v[54:55]
    v_pk_add_f32 v[212:213], v[212:213], v[56:57]
    v_pk_add_f32 v[214:215], v[214:215], v[58:59]
    v_pk_add_f32 v[212:213], v[212:213], v[60:61]
    v_pk_add_f32 v[214:215], v[214:215], v[62:63]
    v_cvt_pk_bf16_f32 v226, v212, v213
    v_cvt_pk_bf16_f32 v227, v214, v215
    s_add_u32 s20, s27, 286720
    buffer_store_dwordx2 v[226:227], v6, s[12:15], s20 offen offset:64
    v_accvgpr_read_b32 v200, a152
    v_accvgpr_read_b32 v201, a153
    v_accvgpr_read_b32 v202, a154
    v_accvgpr_read_b32 v203, a155
    v_pk_add_f32 v[200:201], v[200:201], v[64:65]
    v_pk_add_f32 v[202:203], v[202:203], v[66:67]
    v_pk_add_f32 v[200:201], v[200:201], v[68:69]
    v_pk_add_f32 v[202:203], v[202:203], v[70:71]
    v_pk_add_f32 v[200:201], v[200:201], v[72:73]
    v_pk_add_f32 v[202:203], v[202:203], v[74:75]
    v_cvt_pk_bf16_f32 v220, v200, v201
    v_cvt_pk_bf16_f32 v221, v202, v203
    s_add_u32 s20, s27, 286720
    buffer_store_dwordx2 v[220:221], v6, s[12:15], s20 offen offset:96
    v_accvgpr_read_b32 v204, a156
    v_accvgpr_read_b32 v205, a157
    v_accvgpr_read_b32 v206, a158
    v_accvgpr_read_b32 v207, a159
    v_pk_add_f32 v[204:205], v[204:205], v[76:77]
    v_pk_add_f32 v[206:207], v[206:207], v[78:79]
    v_pk_add_f32 v[204:205], v[204:205], v[80:81]
    v_pk_add_f32 v[206:207], v[206:207], v[82:83]
    v_pk_add_f32 v[204:205], v[204:205], v[84:85]
    v_pk_add_f32 v[206:207], v[206:207], v[86:87]
    v_cvt_pk_bf16_f32 v222, v204, v205
    v_cvt_pk_bf16_f32 v223, v206, v207
    s_add_u32 s20, s27, 286720
    buffer_store_dwordx2 v[222:223], v6, s[12:15], s20 offen offset:128
    v_accvgpr_read_b32 v208, a160
    v_accvgpr_read_b32 v209, a161
    v_accvgpr_read_b32 v210, a162
    v_accvgpr_read_b32 v211, a163
    s_waitcnt lgkmcnt(14)
    v_pk_add_f32 v[208:209], v[208:209], v[88:89]
    v_pk_add_f32 v[210:211], v[210:211], v[90:91]
    s_waitcnt lgkmcnt(13)
    v_pk_add_f32 v[208:209], v[208:209], v[92:93]
    v_pk_add_f32 v[210:211], v[210:211], v[94:95]
    s_waitcnt lgkmcnt(12)
    v_pk_add_f32 v[208:209], v[208:209], v[96:97]
    v_pk_add_f32 v[210:211], v[210:211], v[98:99]
    v_cvt_pk_bf16_f32 v224, v208, v209
    v_cvt_pk_bf16_f32 v225, v210, v211
    s_add_u32 s20, s27, 327680
    buffer_store_dwordx2 v[224:225], v6, s[12:15], s20 offen
    v_accvgpr_read_b32 v212, a164
    v_accvgpr_read_b32 v213, a165
    v_accvgpr_read_b32 v214, a166
    v_accvgpr_read_b32 v215, a167
    s_waitcnt lgkmcnt(11)
    v_pk_add_f32 v[212:213], v[212:213], v[100:101]
    v_pk_add_f32 v[214:215], v[214:215], v[102:103]
    s_waitcnt lgkmcnt(10)
    v_pk_add_f32 v[212:213], v[212:213], v[104:105]
    v_pk_add_f32 v[214:215], v[214:215], v[106:107]
    s_waitcnt lgkmcnt(9)
    v_pk_add_f32 v[212:213], v[212:213], v[108:109]
    v_pk_add_f32 v[214:215], v[214:215], v[110:111]
    v_cvt_pk_bf16_f32 v226, v212, v213
    v_cvt_pk_bf16_f32 v227, v214, v215
    s_add_u32 s20, s27, 327680
    buffer_store_dwordx2 v[226:227], v6, s[12:15], s20 offen offset:32
    v_accvgpr_read_b32 v200, a168
    v_accvgpr_read_b32 v201, a169
    v_accvgpr_read_b32 v202, a170
    v_accvgpr_read_b32 v203, a171
    s_waitcnt lgkmcnt(8)
    v_pk_add_f32 v[200:201], v[200:201], v[112:113]
    v_pk_add_f32 v[202:203], v[202:203], v[114:115]
    s_waitcnt lgkmcnt(7)
    v_pk_add_f32 v[200:201], v[200:201], v[116:117]
    v_pk_add_f32 v[202:203], v[202:203], v[118:119]
    s_waitcnt lgkmcnt(6)
    v_pk_add_f32 v[200:201], v[200:201], v[120:121]
    v_pk_add_f32 v[202:203], v[202:203], v[122:123]
    v_cvt_pk_bf16_f32 v220, v200, v201
    v_cvt_pk_bf16_f32 v221, v202, v203
    s_add_u32 s20, s27, 327680
    buffer_store_dwordx2 v[220:221], v6, s[12:15], s20 offen offset:64
    v_accvgpr_read_b32 v204, a172
    v_accvgpr_read_b32 v205, a173
    v_accvgpr_read_b32 v206, a174
    v_accvgpr_read_b32 v207, a175
    s_waitcnt lgkmcnt(5)
    v_pk_add_f32 v[204:205], v[204:205], v[124:125]
    v_pk_add_f32 v[206:207], v[206:207], v[126:127]
    s_waitcnt lgkmcnt(4)
    v_pk_add_f32 v[204:205], v[204:205], v[128:129]
    v_pk_add_f32 v[206:207], v[206:207], v[130:131]
    s_waitcnt lgkmcnt(3)
    v_pk_add_f32 v[204:205], v[204:205], v[132:133]
    v_pk_add_f32 v[206:207], v[206:207], v[134:135]
    v_cvt_pk_bf16_f32 v222, v204, v205
    v_cvt_pk_bf16_f32 v223, v206, v207
    s_add_u32 s20, s27, 327680
    buffer_store_dwordx2 v[222:223], v6, s[12:15], s20 offen offset:96
    v_accvgpr_read_b32 v208, a176
    v_accvgpr_read_b32 v209, a177
    v_accvgpr_read_b32 v210, a178
    v_accvgpr_read_b32 v211, a179
    s_waitcnt lgkmcnt(2)
    v_pk_add_f32 v[208:209], v[208:209], v[136:137]
    v_pk_add_f32 v[210:211], v[210:211], v[138:139]
    s_waitcnt lgkmcnt(1)
    v_pk_add_f32 v[208:209], v[208:209], v[140:141]
    v_pk_add_f32 v[210:211], v[210:211], v[142:143]
    s_waitcnt lgkmcnt(0)
    v_pk_add_f32 v[208:209], v[208:209], v[144:145]
    v_pk_add_f32 v[210:211], v[210:211], v[146:147]
    v_cvt_pk_bf16_f32 v224, v208, v209
    v_cvt_pk_bf16_f32 v225, v210, v211
    s_add_u32 s20, s27, 327680
    buffer_store_dwordx2 v[224:225], v6, s[12:15], s20 offen offset:128
    s_branch K2_FIN
K2_FIN:
K2_END:
    s_endpgm
.section .rodata,"a"
.p2align 6

.amdhsa_kernel attn_kernel
  .amdhsa_next_free_vgpr 512
  .amdhsa_next_free_sgpr 96
  .amdhsa_accum_offset 256
  .amdhsa_group_segment_fixed_size 0
  .amdhsa_kernarg_size 104
  .amdhsa_user_sgpr_count 2
  .amdhsa_user_sgpr_kernarg_segment_ptr 1
  .amdhsa_system_sgpr_workgroup_id_x 1
.end_amdhsa_kernel
.p2align 6

.amdhsa_kernel oproj_kernel
  .amdhsa_next_free_vgpr 436
  .amdhsa_next_free_sgpr 64
  .amdhsa_accum_offset 256
  .amdhsa_group_segment_fixed_size 0
  .amdhsa_kernarg_size 104
  .amdhsa_user_sgpr_count 2
  .amdhsa_user_sgpr_kernarg_segment_ptr 1
  .amdhsa_system_sgpr_workgroup_id_x 1
.end_amdhsa_kernel
```
